```python
import torch

def _softmax(x, axis=-1):
    return torch.softmax(x, dim=axis)
def _gelu(x):
    return torch.nn.functional.gelu(x, approximate="tanh")
def _silu(x):
    return torch.nn.functional.silu(x)
def _sigmoid(x):
    return torch.sigmoid(x)
def _layernorm(x, axis=-1, eps=1e-5):
    m = x.mean(dim=axis, keepdim=True)
    v = x.var(dim=axis, keepdim=True, unbiased=False)
    return (x - m) / torch.sqrt(v + eps)
def _scatter_add(tgt, idx, src, axis=0):
    return tgt.clone().index_add_(axis, idx, src)
def _segment_sum(src, seg, n):
    out = torch.zeros((n,) + src.shape[1:], dtype=src.dtype)
    return out.index_add_(0, seg, src)
def _pad(x, pw):
    flat = tuple(v for pair in reversed(pw) for v in pair)
    return torch.nn.functional.pad(x, flat)

kernel_name = 'interleave_layers__linear_kernel_hedgehog__mixer_channel_mlp__prompt'

def setup_inputs():

    _w = (lambda a: (lambda t: t.to(torch.bfloat16) if t.is_floating_point() else t)(torch.as_tensor(a)))
    def _A_setup():
        B, S, D, H = 1, 2048, 512, 32
        Dh = D // H
        return {
            "x": _w((lambda *s: torch.randn(*s, dtype=torch.bfloat16) * 0.05)(B, S, D)),
            "wqkv": _w((lambda *s: torch.randn(*s, dtype=torch.bfloat16) * 0.4)(D, 3 * D)),
            "w_phi": _w((lambda *s: torch.randn(*s, dtype=torch.bfloat16) * 0.4)(H, Dh, Dh) * (Dh ** -0.5)),
            "wo": _w((lambda *s: torch.randn(*s, dtype=torch.bfloat16) * 0.05)(D, D)),
        }
    _A_in = _A_setup()

    def _B_setup():
        B, S, D, F = 1, 2048, 512, 1792
        return {
            "x": _w((lambda *s: torch.randn(*s, dtype=torch.bfloat16) * 0.05)(B, S, D)),
            "w1": _w((lambda *s: torch.randn(*s, dtype=torch.bfloat16) * 3.2)(D, F) * (D ** -0.5)),
            "b1": _w((lambda *s: torch.randn(*s, dtype=torch.bfloat16) * 0.8)(F)),
            "w2": _w((lambda *s: torch.randn(*s, dtype=torch.bfloat16) * 0.8)(F, D) * (F ** -0.5)),
            "b2": _w((lambda *s: torch.randn(*s, dtype=torch.bfloat16) * 0.8)(D)),
        }
    _B_in = _B_setup()

    return {
        "A_x": _A_in["x"],
        "A_wqkv": _A_in["wqkv"],
        "A_w_phi": _A_in["w_phi"],
        "A_wo": _A_in["wo"],
        "B_x": _B_in["x"],
        "B_w1": _B_in["w1"],
        "B_b1": _B_in["b1"],
        "B_w2": _B_in["w2"],
        "B_b2": _B_in["b2"],
    }

def reference(A_x, A_wqkv, A_w_phi, A_wo, B_x, B_w1, B_b1, B_w2, B_b2):
    def _A_ref(x, wqkv, w_phi, wo):
        B, S, D = x.shape
        H = 32; Dh = D // H
        qkv = (lambda x, *d: x.permute(*d))((x @ wqkv).reshape(B, S, 3, H, Dh), 2, 0, 3, 1, 4)
        q, k, v = qkv[0], qkv[1], qkv[2]
        pq = torch.einsum("bhsd,hdf->bhsf", q, w_phi)
        pk = torch.einsum("bhsd,hdf->bhsf", k, w_phi)
        phi_q = torch.concatenate([_softmax(pq, axis=-1), _softmax(-pq, axis=-1)], axis=-1)
        phi_k = torch.concatenate([_softmax(pk, axis=-1), _softmax(-pk, axis=-1)], axis=-1)
        kv = torch.einsum("bhsf,bhsd->bhfd", phi_k, v)
        z  = torch.einsum("bhsf->bhf", phi_k)
        num = torch.einsum("bhqf,bhfd->bhqd", phi_q, kv)
        den = torch.einsum("bhqf,bhf->bhq", phi_q, z)[..., None] + 1e-6
        o = num / den
        return (lambda x, *d: x.permute(*d))(o, 0, 2, 1, 3).reshape(B, S, D) @ wo

    def _B_ref(x, w1, b1, w2, b2):
        y = _layernorm(x, axis=-1)
        h = _gelu(torch.einsum("bsd,df->bsf", y, w1) + b1)
        return torch.einsum("bsf,fd->bsd", h, w2) + b2

    x = A_x
    x = x + _A_ref(_layernorm(x, axis=-1), A_wqkv, A_w_phi, A_wo)
    x = x + _B_ref(_layernorm(x, axis=-1), B_w1, B_b1, B_w2, B_b2)
    x = x + _A_ref(_layernorm(x, axis=-1), A_wqkv, A_w_phi, A_wo)
    x = x + _B_ref(_layernorm(x, axis=-1), B_w1, B_b1, B_w2, B_b2)
    return x
```

```asm
; @launch grid=(256,1,1) block=(256,1,1) lds=163840
.amdgcn_target "amdgcn-amd-amdhsa--gfx950"
.text
.globl interleave_layers__linear_kernel_hedgehog__mixer_channel_mlp__prompt_kernel
.p2align 8
.type interleave_layers__linear_kernel_hedgehog__mixer_channel_mlp__prompt_kernel,@function
interleave_layers__linear_kernel_hedgehog__mixer_channel_mlp__prompt_kernel:
    s_cmp_ge_u32 s2, 256
    s_cbranch_scc1 L_end_interleave_layers__linear_kernel_hedgehog__mixer_channel_mlp__prompt_kernel
    s_load_dwordx16 s[16:31], s[0:1], 0
    s_load_dwordx8 s[32:39], s[0:1], 64
    v_lshrrev_b32 v2, 6, v0
    v_and_b32 v1, 63, v0
    v_readfirstlane_b32 s3, v2
    s_and_b32 s8, s2, 7
    s_lshr_b32 s9, s2, 3
    s_lshl_b32 s10, s8, 1
    s_lshr_b32 s11, s9, 4
    s_add_u32 s58, s10, s11
    s_and_b32 s59, s9, 15
    s_getreg_b32 s60, hwreg(HW_REG_XCC_ID)
    s_add_u32 s60, s60, 1
    s_mov_b32 s61, 0
    v_and_b32 v3, 15, v1
    v_lshrrev_b32 v4, 4, v1
    v_lshlrev_b32 v5, 4, v1
    v_lshrrev_b32 v6, 2, v3
    v_and_b32 v7, 3, v3
    v_lshl_add_u32 v8, v4, 2, v6
    s_waitcnt lgkmcnt(0)
    s_add_u32 s62, s38, 18612224
    s_addc_u32 s63, s39, 0
    s_cmp_lg_u32 s3, 2
    s_cbranch_scc1 cpf_interleave_layers__linear_kernel_hedgehog__mixer_channel_mlp__prompt_kernel_1
    s_getpc_b64 s[40:41]
L_pc_anchor:
    s_lshl_b32 s10, s9, 12
    s_min_u32 s10, s10, L_end_interleave_layers__linear_kernel_hedgehog__mixer_channel_mlp__prompt_kernel-L_pc_anchor-4096
    s_add_u32 s40, s40, s10
    s_addc_u32 s41, s41, 0
    s_and_b32 s40, s40, 0xffffff80
    global_load_dwordx4 v[32:35], v5, s[40:41] offset:0
    global_load_dwordx4 v[36:39], v5, s[40:41] offset:1024
    global_load_dwordx4 v[40:43], v5, s[40:41] offset:2048
    global_load_dwordx4 v[44:47], v5, s[40:41] offset:3072
cpf_interleave_layers__linear_kernel_hedgehog__mixer_channel_mlp__prompt_kernel_1:
    s_mov_b32 s8, 0
    s_mov_b32 s9, 0
    s_cmp_lg_u32 s3, 1
    s_cbranch_scc1 pub_interleave_layers__linear_kernel_hedgehog__mixer_channel_mlp__prompt_kernel_2
    s_mov_b64 exec, 1
    s_lshl_b32 s10, s58, 10
    s_lshl_b32 s11, s59, 2
    s_add_u32 s10, s10, s11
    v_mov_b32 v2, s10
    v_mov_b32 v9, 0
    v_mov_b32 v10, s60
    global_store_dword v2, v9, s[62:63] offset:512 sc1
    global_store_dword v2, v10, s[62:63] offset:768 sc1
    s_mov_b64 exec, -1
pub_interleave_layers__linear_kernel_hedgehog__mixer_channel_mlp__prompt_kernel_2:
    s_cmp_lt_u32 s59, 8
    s_cbranch_scc1 ini_interleave_layers__linear_kernel_hedgehog__mixer_channel_mlp__prompt_kernel_3
    v_mov_b32 v224, 0
    v_mov_b32 v225, 0
    v_mov_b32 v226, 0
    v_mov_b32 v227, 0
    s_cmp_ge_u32 s58, 2
    s_cbranch_scc1 ini2_interleave_layers__linear_kernel_hedgehog__mixer_channel_mlp__prompt_kernel_4
    s_and_b32 s10, s59, 7
    s_mul_i32 s13, s58, 131072
    s_lshl_b32 s11, s10, 13
    s_lshl_b32 s12, s3, 11
    s_add_u32 s11, s11, s12
    s_add_u32 s11, s11, s13
    s_add_u32 s11, s11, 17825792
    s_add_u32 s54, s38, s11
    s_addc_u32 s55, s39, 0
    global_store_dwordx4 v5, v[224:227], s[54:55] sc1
    global_store_dwordx4 v5, v[224:227], s[54:55] offset:1024 sc1
    s_lshl_b32 s11, s10, 9
    s_lshl_b32 s12, s3, 7
    s_add_u32 s11, s11, s12
    s_add_u32 s11, s11, s13
    s_add_u32 s11, s11, 17891328
    s_add_u32 s54, s38, s11
    s_addc_u32 s55, s39, 0
    v_lshlrev_b32 v14, 2, v1
    s_mov_b64 exec, 0xffffffff
    global_store_dword v14, v224, s[54:55] sc1
    s_mov_b64 exec, -1
    s_waitcnt vmcnt(0)
    s_cmp_lg_u32 s58, 0
    s_cbranch_scc1 ini2_interleave_layers__linear_kernel_hedgehog__mixer_channel_mlp__prompt_kernel_4
    s_lshl_b32 s10, s10, 2
    s_add_u32 s10, s10, 64
    v_mov_b32 v14, s10
    v_mov_b32 v15, 1
    s_mov_b64 exec, 1
    global_atomic_add v14, v15, s[36:37] sc1
    s_mov_b64 exec, -1
ini2_interleave_layers__linear_kernel_hedgehog__mixer_channel_mlp__prompt_kernel_4:
    s_cmp_lg_u32 s59, 15
    s_cbranch_scc1 ini3_interleave_layers__linear_kernel_hedgehog__mixer_channel_mlp__prompt_kernel_5
    s_cmp_lg_u32 s3, 0
    s_cbranch_scc1 ini3_interleave_layers__linear_kernel_hedgehog__mixer_channel_mlp__prompt_kernel_5
    s_mov_b64 exec, 1
    s_lshl_b32 s10, s58, 10
    v_mov_b32 v14, s10
    global_store_dword v14, v224, s[62:63] sc1
    global_store_dword v14, v224, s[62:63] offset:256 sc1
    global_store_dword v14, v224, s[62:63] offset:384 sc1
    s_waitcnt vmcnt(0)
    s_lshl_b32 s10, s58, 2
    v_mov_b32 v14, s10
    v_mov_b32 v15, 1
    global_atomic_add v14, v15, s[36:37] sc1
    s_waitcnt vmcnt(0)
    s_mov_b64 exec, -1
ini3_interleave_layers__linear_kernel_hedgehog__mixer_channel_mlp__prompt_kernel_5:
    s_lshl_b32 s10, s58, 3
    s_and_b32 s11, s59, 7
    s_add_u32 s10, s10, s11
    s_mul_i32 s11, s10, 14336
    s_mul_i32 s12, s3, 3584
    s_add_u32 s11, s11, s12
    s_add_u32 s46, s26, s11
    s_addc_u32 s47, s27, 0
    s_add_u32 s50, s30, s11
    s_addc_u32 s51, s31, 0
    s_lshl_b32 s11, s10, 12
    s_lshl_b32 s12, s3, 10
    s_add_u32 s11, s11, s12
    s_add_u32 s52, s22, s11
    s_addc_u32 s53, s23, 0
    global_load_dwordx4 v[32:35], v5, s[46:47] offset:0
    global_load_dwordx4 v[48:51], v5, s[50:51] offset:0
    global_load_dwordx4 v[36:39], v5, s[46:47] offset:1024
    global_load_dwordx4 v[52:55], v5, s[50:51] offset:1024
    global_load_dwordx4 v[40:43], v5, s[46:47] offset:2048
    global_load_dwordx4 v[56:59], v5, s[50:51] offset:2048
    s_mov_b64 exec, 0xffffffff
    global_load_dwordx4 v[44:47], v5, s[46:47] offset:3072
    global_load_dwordx4 v[60:63], v5, s[50:51] offset:3072
    s_mov_b64 exec, -1
    global_load_dwordx4 v[64:67], v5, s[52:53]
ini_interleave_layers__linear_kernel_hedgehog__mixer_channel_mlp__prompt_kernel_3:
    s_nop 15
    s_nop 3
    s_lshl_b32 s10, s58, 3
    s_lshl_b32 s11, s3, 1
    s_add_u32 s45, s10, s11
    s_lshl_b32 s10, s59, 7
    s_add_u32 s4, s10, 1024
    s_add_u32 s5, s10, 2048
    s_sub_u32 s11, s10, 1024
    s_cmp_ge_u32 s59, 8
    s_cselect_b32 s4, s11, s4
    s_cselect_b32 s5, s11, s5
    v_lshrrev_b32 v15, 3, v1
    v_and_b32 v16, 7, v1
    v_lshrrev_b32 v17, 1, v16
    v_lshrrev_b32 v18, 1, v15
    v_and_b32 v18, 3, v18
    v_xor_b32 v17, v17, v18
    v_and_b32 v16, 1, v16
    v_lshlrev_b32 v16, 4, v16
    v_lshl_add_u32 v16, v17, 5, v16
    s_lshl_b32 s10, s3, 3
    v_add_u32 v19, s10, v15
    v_and_b32 v20, 15, v19
    v_lshrrev_b32 v20, 2, v20
    v_lshlrev_b32 v20, 3, v20
    v_and_b32 v21, 3, v19
    v_add_u32 v20, v20, v21
    v_lshrrev_b32 v21, 4, v19
    v_lshl_add_u32 v20, v21, 2, v20
    v_mul_u32_u24 v13, 3072, v20
    v_add_u32 v13, v13, v16
    s_lshl_b32 s48, s3, 10
    v_and_b32 v19, 7, v1
    v_xor_b32 v19, v19, v15
    v_lshlrev_b32 v19, 4, v19
    v_lshl_add_u32 v14, v15, 10, v19
    s_lshl_b32 s12, s45, 14
    s_lshl_b32 s49, s3, 14
    s_add_u32 s49, s49, 65536
    s_add_u32 s40, s18, s4
    s_addc_u32 s41, s19, 0
    s_add_u32 s46, s16, s12
    s_addc_u32 s47, s17, 0
    s_add_u32 s50, s46, 0
    s_addc_u32 s51, s47, 0
    s_add_u32 m0, s49, 0
    s_nop 0
    global_load_lds_dwordx4 v14, s[50:51]
    s_add_u32 s50, s46, 8192
    s_addc_u32 s51, s47, 0
    s_add_u32 m0, s49, 1024
    s_nop 0
    global_load_lds_dwordx4 v14, s[50:51]
    s_add_u32 s50, s46, 16384
    s_addc_u32 s51, s47, 0
    s_add_u32 m0, s49, 2048
    s_nop 0
    global_load_lds_dwordx4 v14, s[50:51]
    s_add_u32 s50, s46, 24576
    s_addc_u32 s51, s47, 0
    s_add_u32 m0, s49, 3072
    s_nop 0
    global_load_lds_dwordx4 v14, s[50:51]
    s_add_u32 s46, s46, 128
    s_addc_u32 s47, s47, 0
    s_add_u32 m0, s48, 0
    s_nop 0
    global_load_lds_dwordx4 v13, s[40:41]
    s_add_u32 s40, s40, 98304
    s_addc_u32 s41, s41, 0
    s_add_u32 m0, s48, 4096
    s_nop 0
    global_load_lds_dwordx4 v13, s[40:41]
    s_add_u32 s40, s40, 98304
    s_addc_u32 s41, s41, 0
    s_add_u32 s50, s46, 0
    s_addc_u32 s51, s47, 0
    s_add_u32 m0, s49, 4096
    s_nop 0
    global_load_lds_dwordx4 v14, s[50:51]
    s_add_u32 s50, s46, 8192
    s_addc_u32 s51, s47, 0
    s_add_u32 m0, s49, 5120
    s_nop 0
    global_load_lds_dwordx4 v14, s[50:51]
    s_add_u32 s50, s46, 16384
    s_addc_u32 s51, s47, 0
    s_add_u32 m0, s49, 6144
    s_nop 0
    global_load_lds_dwordx4 v14, s[50:51]
    s_add_u32 s50, s46, 24576
    s_addc_u32 s51, s47, 0
    s_add_u32 m0, s49, 7168
    s_nop 0
    global_load_lds_dwordx4 v14, s[50:51]
    s_add_u32 s46, s46, 128
    s_addc_u32 s47, s47, 0
    s_add_u32 m0, s48, 8192
    s_nop 0
    global_load_lds_dwordx4 v13, s[40:41]
    s_add_u32 s40, s40, 98304
    s_addc_u32 s41, s41, 0
    s_add_u32 m0, s48, 12288
    s_nop 0
    global_load_lds_dwordx4 v13, s[40:41]
    s_add_u32 s40, s40, 98304
    s_addc_u32 s41, s41, 0
    s_add_u32 s50, s46, 0
    s_addc_u32 s51, s47, 0
    s_add_u32 m0, s49, 8192
    s_nop 0
    global_load_lds_dwordx4 v14, s[50:51]
    s_add_u32 s50, s46, 8192
    s_addc_u32 s51, s47, 0
    s_add_u32 m0, s49, 9216
    s_nop 0
    global_load_lds_dwordx4 v14, s[50:51]
    s_add_u32 s50, s46, 16384
    s_addc_u32 s51, s47, 0
    s_add_u32 m0, s49, 10240
    s_nop 0
    global_load_lds_dwordx4 v14, s[50:51]
    s_add_u32 s50, s46, 24576
    s_addc_u32 s51, s47, 0
    s_add_u32 m0, s49, 11264
    s_nop 0
    global_load_lds_dwordx4 v14, s[50:51]
    s_add_u32 s46, s46, 128
    s_addc_u32 s47, s47, 0
    s_add_u32 m0, s48, 16384
    s_nop 0
    global_load_lds_dwordx4 v13, s[40:41]
    s_add_u32 s40, s40, 98304
    s_addc_u32 s41, s41, 0
    s_add_u32 m0, s48, 20480
    s_nop 0
    global_load_lds_dwordx4 v13, s[40:41]
    s_add_u32 s40, s40, 98304
    s_addc_u32 s41, s41, 0
    v_add_u32 v19, 0, v15
    v_and_b32 v20, 15, v19
    v_lshrrev_b32 v20, 2, v20
    v_lshlrev_b32 v20, 3, v20
    v_and_b32 v21, 3, v19
    v_add_u32 v20, v20, v21
    v_add_u32 v20, 0, v20
    v_mul_u32_u24 v20, 3072, v20
    v_add_u32 v244, v20, v16
    v_add_u32 v19, 8, v15
    v_and_b32 v20, 15, v19
    v_lshrrev_b32 v20, 2, v20
    v_lshlrev_b32 v20, 3, v20
    v_and_b32 v21, 3, v19
    v_add_u32 v20, v20, v21
    v_add_u32 v20, 0, v20
    v_mul_u32_u24 v20, 3072, v20
    v_add_u32 v245, v20, v16
    v_add_u32 v19, 16, v15
    v_and_b32 v20, 15, v19
    v_lshrrev_b32 v20, 2, v20
    v_lshlrev_b32 v20, 3, v20
    v_and_b32 v21, 3, v19
    v_add_u32 v20, v20, v21
    v_add_u32 v20, 4, v20
    v_mul_u32_u24 v20, 3072, v20
    v_add_u32 v246, v20, v16
    v_add_u32 v19, 24, v15
    v_and_b32 v20, 15, v19
    v_lshrrev_b32 v20, 2, v20
    v_lshlrev_b32 v20, 3, v20
    v_and_b32 v21, 3, v19
    v_add_u32 v20, v20, v21
    v_add_u32 v20, 4, v20
    v_mul_u32_u24 v20, 3072, v20
    v_add_u32 v247, v20, v16
    s_mul_i32 s11, s3, 98304
    s_add_u32 s11, s11, s5
    s_add_u32 s42, s18, s11
    s_addc_u32 s43, s19, 0
    v_lshrrev_b32 v16, 1, v8
    v_and_b32 v16, 3, v16
    v_lshlrev_b32 v18, 7, v8
    v_lshl_add_u32 v18, v7, 3, v18
    v_xor_b32 v17, 0, v16
    v_lshl_add_u32 v9, v17, 5, v18
    v_xor_b32 v17, 1, v16
    v_lshl_add_u32 v10, v17, 5, v18
    v_xor_b32 v17, 2, v16
    v_lshl_add_u32 v11, v17, 5, v18
    v_xor_b32 v17, 3, v16
    v_lshl_add_u32 v12, v17, 5, v18
    v_add_u32 v19, 65536, v9
    v_add_u32 v20, 65536, v10
    v_add_u32 v21, 65536, v11
    v_add_u32 v22, 65536, v12
    v_xor_b32 v17, s3, v16
    v_lshl_add_u32 v23, v17, 5, v18
    v_add_u32 v24, 65536, v23
    v_and_b32 v17, 7, v3
    v_xor_b32 v17, v17, v4
    v_lshlrev_b32 v16, 7, v3
    v_lshl_add_u32 v25, v17, 4, v16
    v_add_u32 v25, s49, v25
    v_xor_b32 v26, 64, v25
    v_mov_b32 v240, 0
    v_mov_b32 v241, 0
    v_mov_b32 v242, 0
    v_mov_b32 v243, 0
    v_mov_b32 v28, 0x3f803f80
    v_mov_b32 v29, 0x3f803f80
    v_mov_b32 v30, 0x3f803f80
    v_mov_b32 v31, 0x3f803f80
    s_waitcnt vmcnt(12) lgkmcnt(0)
    s_barrier
    ds_read_b128 a[0:3], v25 offset:0
    ds_read_b128 v[224:227], v25 offset:0
    s_add_u32 s50, s46, 0
    ds_read_b128 a[64:67], v25 offset:2048
    s_addc_u32 s51, s47, 0
    ds_read_b128 v[228:231], v25 offset:2048
    s_add_u32 m0, s49, 12288
    ds_read_b128 a[4:7], v26 offset:0
    global_load_lds_dwordx4 v14, s[50:51]
    ds_read_b128 v[232:235], v26 offset:0
    s_add_u32 s50, s46, 8192
    ds_read_b128 a[68:71], v26 offset:2048
    s_addc_u32 s51, s47, 0
    ds_read_b128 v[236:239], v26 offset:2048
    s_add_u32 m0, s49, 13312
    ds_read_b64_tr_b16 v[104:105], v9 offset:0
    global_load_lds_dwordx4 v14, s[50:51]
    ds_read_b64_tr_b16 v[106:107], v9 offset:2048
    s_add_u32 s50, s46, 16384
    ds_read_b64_tr_b16 v[108:109], v10 offset:0
    s_addc_u32 s51, s47, 0
    ds_read_b64_tr_b16 v[110:111], v10 offset:2048
    s_add_u32 m0, s49, 14336
    ds_read_b64_tr_b16 v[112:113], v11 offset:0
    global_load_lds_dwordx4 v14, s[50:51]
    ds_read_b64_tr_b16 v[114:115], v11 offset:2048
    s_add_u32 s50, s46, 24576
    ds_read_b64_tr_b16 v[116:117], v12 offset:0
    ds_read_b64_tr_b16 v[118:119], v12 offset:2048
    s_addc_u32 s51, s47, 0
    ds_read_b64_tr_b16 v[120:121], v23 offset:0
    s_add_u32 m0, s49, 15360
    ds_read_b64_tr_b16 v[122:123], v23 offset:2048
    global_load_lds_dwordx4 v14, s[50:51]
    ds_read_b64_tr_b16 v[124:125], v9 offset:4096
    s_add_u32 s46, s46, 128
    ds_read_b64_tr_b16 v[126:127], v9 offset:6144
    s_addc_u32 s47, s47, 0
    ds_read_b64_tr_b16 v[128:129], v10 offset:4096
    s_add_u32 m0, s48, 24576
    ds_read_b64_tr_b16 v[130:131], v10 offset:6144
    global_load_lds_dwordx4 v13, s[40:41]
    ds_read_b64_tr_b16 v[132:133], v11 offset:4096
    s_add_u32 s40, s40, 98304
    ds_read_b64_tr_b16 v[134:135], v11 offset:6144
    s_addc_u32 s41, s41, 0
    ds_read_b64_tr_b16 v[136:137], v12 offset:4096
    s_add_u32 m0, s48, 28672
    ds_read_b64_tr_b16 v[138:139], v12 offset:6144
    global_load_lds_dwordx4 v13, s[40:41]
    ds_read_b64_tr_b16 v[140:141], v23 offset:4096
    s_add_u32 s40, s40, 98304
    ds_read_b64_tr_b16 v[142:143], v23 offset:6144
    s_addc_u32 s41, s41, 0
    s_waitcnt vmcnt(12) lgkmcnt(0)
    s_barrier
    v_mfma_f32_16x16x32_bf16 v[32:35], v[104:107], a[0:3], 0
    v_dot2_f32_bf16 v240, v224, v28, v240
    v_dot2_f32_bf16 v241, v224, v224, v241
    v_dot2_f32_bf16 v240, v225, v28, v240
    s_add_u32 s50, s46, 0
    v_mfma_f32_16x16x32_bf16 v[64:67], v[104:107], a[64:67], 0
    v_dot2_f32_bf16 v241, v225, v225, v241
    v_dot2_f32_bf16 v240, v226, v28, v240
    s_addc_u32 s51, s47, 0
    v_dot2_f32_bf16 v241, v226, v226, v241
    v_dot2_f32_bf16 v240, v227, v28, v240
    v_mfma_f32_16x16x32_bf16 v[36:39], v[108:111], a[0:3], 0
    s_add_u32 m0, s49, 0
    v_dot2_f32_bf16 v241, v227, v227, v241
    v_dot2_f32_bf16 v242, v228, v28, v242
    v_dot2_f32_bf16 v243, v228, v228, v243
    global_load_lds_dwordx4 v14, s[50:51]
    v_mfma_f32_16x16x32_bf16 v[68:71], v[108:111], a[64:67], 0
    v_dot2_f32_bf16 v242, v229, v28, v242
    v_dot2_f32_bf16 v243, v229, v229, v243
    s_add_u32 s50, s46, 8192
    v_dot2_f32_bf16 v242, v230, v28, v242
    v_dot2_f32_bf16 v243, v230, v230, v243
    v_mfma_f32_16x16x32_bf16 v[40:43], v[112:115], a[0:3], 0
    s_addc_u32 s51, s47, 0
    v_dot2_f32_bf16 v242, v231, v28, v242
    v_dot2_f32_bf16 v243, v231, v231, v243
    v_dot2_f32_bf16 v240, v232, v28, v240
    v_mfma_f32_16x16x32_bf16 v[72:75], v[112:115], a[64:67], 0
    s_add_u32 m0, s49, 1024
    v_dot2_f32_bf16 v241, v232, v232, v241
    v_dot2_f32_bf16 v240, v233, v28, v240
    global_load_lds_dwordx4 v14, s[50:51]
    v_dot2_f32_bf16 v241, v233, v233, v241
    v_mfma_f32_16x16x32_bf16 v[44:47], v[116:119], a[0:3], 0
    v_dot2_f32_bf16 v240, v234, v28, v240
    s_add_u32 s50, s46, 16384
    v_dot2_f32_bf16 v241, v234, v234, v241
    v_dot2_f32_bf16 v240, v235, v28, v240
    v_dot2_f32_bf16 v241, v235, v235, v241
    v_mfma_f32_16x16x32_bf16 v[76:79], v[116:119], a[64:67], 0
    s_addc_u32 s51, s47, 0
    v_dot2_f32_bf16 v242, v236, v28, v242
    v_dot2_f32_bf16 v243, v236, v236, v243
    s_add_u32 m0, s49, 2048
    v_dot2_f32_bf16 v242, v237, v28, v242
    v_mfma_f32_16x16x32_bf16 v[96:99], v[120:123], v[28:31], 0
    v_dot2_f32_bf16 v243, v237, v237, v243
    global_load_lds_dwordx4 v14, s[50:51]
    v_dot2_f32_bf16 v242, v238, v28, v242
    v_dot2_f32_bf16 v243, v238, v238, v243
    s_add_u32 s50, s46, 24576
    v_mfma_f32_16x16x32_bf16 v[32:35], v[124:127], a[4:7], v[32:35]
    v_dot2_f32_bf16 v242, v239, v28, v242
    v_dot2_f32_bf16 v243, v239, v239, v243
    ds_read_b128 a[8:11], v25 offset:4096
    s_addc_u32 s51, s47, 0
    v_mfma_f32_16x16x32_bf16 v[64:67], v[124:127], a[68:71], v[64:67]
    ds_read_b128 v[224:227], v25 offset:4096
    ds_read_b128 a[72:75], v25 offset:6144
    s_add_u32 m0, s49, 3072
    ds_read_b128 v[228:231], v25 offset:6144
    ds_read_b128 a[12:15], v26 offset:4096
    v_mfma_f32_16x16x32_bf16 v[36:39], v[128:131], a[4:7], v[36:39]
    global_load_lds_dwordx4 v14, s[50:51]
    ds_read_b128 v[232:235], v26 offset:4096
    ds_read_b128 a[76:79], v26 offset:6144
    ds_read_b128 v[236:239], v26 offset:6144
    s_add_u32 s46, s46, 128
    v_mfma_f32_16x16x32_bf16 v[68:71], v[128:131], a[68:71], v[68:71]
    ds_read_b64_tr_b16 v[144:145], v9 offset:8192
    ds_read_b64_tr_b16 v[146:147], v9 offset:10240
    s_addc_u32 s47, s47, 0
    ds_read_b64_tr_b16 v[148:149], v10 offset:8192
    ds_read_b64_tr_b16 v[150:151], v10 offset:10240
    v_mfma_f32_16x16x32_bf16 v[40:43], v[132:135], a[4:7], v[40:43]
    s_add_u32 m0, s48, 32768
    ds_read_b64_tr_b16 v[152:153], v11 offset:8192
    ds_read_b64_tr_b16 v[154:155], v11 offset:10240
    ds_read_b64_tr_b16 v[156:157], v12 offset:8192
    v_mfma_f32_16x16x32_bf16 v[72:75], v[132:135], a[68:71], v[72:75]
    global_load_lds_dwordx4 v13, s[40:41]
    ds_read_b64_tr_b16 v[158:159], v12 offset:10240
    ds_read_b64_tr_b16 v[160:161], v23 offset:8192
    s_add_u32 s40, s40, 98304
    ds_read_b64_tr_b16 v[162:163], v23 offset:10240
    v_mfma_f32_16x16x32_bf16 v[44:47], v[136:139], a[4:7], v[44:47]
    ds_read_b64_tr_b16 v[164:165], v9 offset:12288
    s_addc_u32 s41, s41, 0
    ds_read_b64_tr_b16 v[166:167], v9 offset:14336
    ds_read_b64_tr_b16 v[168:169], v10 offset:12288
    ds_read_b64_tr_b16 v[170:171], v10 offset:14336
    v_mfma_f32_16x16x32_bf16 v[76:79], v[136:139], a[68:71], v[76:79]
    s_add_u32 m0, s48, 36864
    ds_read_b64_tr_b16 v[172:173], v11 offset:12288
    ds_read_b64_tr_b16 v[174:175], v11 offset:14336
    global_load_lds_dwordx4 v13, s[40:41]
    ds_read_b64_tr_b16 v[176:177], v12 offset:12288
    v_mfma_f32_16x16x32_bf16 v[96:99], v[140:143], v[28:31], v[96:99]
    ds_read_b64_tr_b16 v[178:179], v12 offset:14336
    s_add_u32 s40, s40, 98304
    ds_read_b64_tr_b16 v[180:181], v23 offset:12288
    ds_read_b64_tr_b16 v[182:183], v23 offset:14336
    s_addc_u32 s41, s41, 0
    s_waitcnt vmcnt(12) lgkmcnt(0)
    s_barrier
    v_mfma_f32_16x16x32_bf16 v[32:35], v[144:147], a[8:11], v[32:35]
    v_dot2_f32_bf16 v240, v224, v28, v240
    v_dot2_f32_bf16 v241, v224, v224, v241
    v_dot2_f32_bf16 v240, v225, v28, v240
    s_add_u32 s50, s46, 0
    v_mfma_f32_16x16x32_bf16 v[64:67], v[144:147], a[72:75], v[64:67]
    v_dot2_f32_bf16 v241, v225, v225, v241
    v_dot2_f32_bf16 v240, v226, v28, v240
    s_addc_u32 s51, s47, 0
    v_dot2_f32_bf16 v241, v226, v226, v241
    v_dot2_f32_bf16 v240, v227, v28, v240
    v_mfma_f32_16x16x32_bf16 v[36:39], v[148:151], a[8:11], v[36:39]
    s_add_u32 m0, s49, 4096
    v_dot2_f32_bf16 v241, v227, v227, v241
    v_dot2_f32_bf16 v242, v228, v28, v242
    v_dot2_f32_bf16 v243, v228, v228, v243
    global_load_lds_dwordx4 v14, s[50:51]
    v_mfma_f32_16x16x32_bf16 v[68:71], v[148:151], a[72:75], v[68:71]
    v_dot2_f32_bf16 v242, v229, v28, v242
    v_dot2_f32_bf16 v243, v229, v229, v243
    s_add_u32 s50, s46, 8192
    v_dot2_f32_bf16 v242, v230, v28, v242
    v_dot2_f32_bf16 v243, v230, v230, v243
    v_mfma_f32_16x16x32_bf16 v[40:43], v[152:155], a[8:11], v[40:43]
    s_addc_u32 s51, s47, 0
    v_dot2_f32_bf16 v242, v231, v28, v242
    v_dot2_f32_bf16 v243, v231, v231, v243
    v_dot2_f32_bf16 v240, v232, v28, v240
    v_mfma_f32_16x16x32_bf16 v[72:75], v[152:155], a[72:75], v[72:75]
    s_add_u32 m0, s49, 5120
    v_dot2_f32_bf16 v241, v232, v232, v241
    v_dot2_f32_bf16 v240, v233, v28, v240
    global_load_lds_dwordx4 v14, s[50:51]
    v_dot2_f32_bf16 v241, v233, v233, v241
    v_mfma_f32_16x16x32_bf16 v[44:47], v[156:159], a[8:11], v[44:47]
    v_dot2_f32_bf16 v240, v234, v28, v240
    s_add_u32 s50, s46, 16384
    v_dot2_f32_bf16 v241, v234, v234, v241
    v_dot2_f32_bf16 v240, v235, v28, v240
    v_dot2_f32_bf16 v241, v235, v235, v241
    v_mfma_f32_16x16x32_bf16 v[76:79], v[156:159], a[72:75], v[76:79]
    s_addc_u32 s51, s47, 0
    v_dot2_f32_bf16 v242, v236, v28, v242
    v_dot2_f32_bf16 v243, v236, v236, v243
    s_add_u32 m0, s49, 6144
    v_dot2_f32_bf16 v242, v237, v28, v242
    v_mfma_f32_16x16x32_bf16 v[96:99], v[160:163], v[28:31], v[96:99]
    v_dot2_f32_bf16 v243, v237, v237, v243
    global_load_lds_dwordx4 v14, s[50:51]
    v_dot2_f32_bf16 v242, v238, v28, v242
    v_dot2_f32_bf16 v243, v238, v238, v243
    s_add_u32 s50, s46, 24576
    v_mfma_f32_16x16x32_bf16 v[32:35], v[164:167], a[12:15], v[32:35]
    v_dot2_f32_bf16 v242, v239, v28, v242
    v_dot2_f32_bf16 v243, v239, v239, v243
    ds_read_b128 a[16:19], v25 offset:8192
    s_addc_u32 s51, s47, 0
    v_mfma_f32_16x16x32_bf16 v[64:67], v[164:167], a[76:79], v[64:67]
    ds_read_b128 v[224:227], v25 offset:8192
    ds_read_b128 a[80:83], v25 offset:10240
    s_add_u32 m0, s49, 7168
    ds_read_b128 v[228:231], v25 offset:10240
    ds_read_b128 a[20:23], v26 offset:8192
    v_mfma_f32_16x16x32_bf16 v[36:39], v[168:171], a[12:15], v[36:39]
    global_load_lds_dwordx4 v14, s[50:51]
    ds_read_b128 v[232:235], v26 offset:8192
    ds_read_b128 a[84:87], v26 offset:10240
    ds_read_b128 v[236:239], v26 offset:10240
    s_add_u32 s46, s46, 128
    v_mfma_f32_16x16x32_bf16 v[68:71], v[168:171], a[76:79], v[68:71]
    ds_read_b64_tr_b16 v[104:105], v9 offset:16384
    ds_read_b64_tr_b16 v[106:107], v9 offset:18432
    s_addc_u32 s47, s47, 0
    ds_read_b64_tr_b16 v[108:109], v10 offset:16384
    ds_read_b64_tr_b16 v[110:111], v10 offset:18432
    v_mfma_f32_16x16x32_bf16 v[40:43], v[172:175], a[12:15], v[40:43]
    s_add_u32 m0, s48, 40960
    ds_read_b64_tr_b16 v[112:113], v11 offset:16384
    ds_read_b64_tr_b16 v[114:115], v11 offset:18432
    ds_read_b64_tr_b16 v[116:117], v12 offset:16384
    v_mfma_f32_16x16x32_bf16 v[72:75], v[172:175], a[76:79], v[72:75]
    global_load_lds_dwordx4 v13, s[40:41]
    ds_read_b64_tr_b16 v[118:119], v12 offset:18432
    ds_read_b64_tr_b16 v[120:121], v23 offset:16384
    s_add_u32 s40, s40, 98304
    ds_read_b64_tr_b16 v[122:123], v23 offset:18432
    v_mfma_f32_16x16x32_bf16 v[44:47], v[176:179], a[12:15], v[44:47]
    ds_read_b64_tr_b16 v[124:125], v9 offset:20480
    s_addc_u32 s41, s41, 0
    ds_read_b64_tr_b16 v[126:127], v9 offset:22528
    ds_read_b64_tr_b16 v[128:129], v10 offset:20480
    ds_read_b64_tr_b16 v[130:131], v10 offset:22528
    v_mfma_f32_16x16x32_bf16 v[76:79], v[176:179], a[76:79], v[76:79]
    s_add_u32 m0, s48, 45056
    ds_read_b64_tr_b16 v[132:133], v11 offset:20480
    ds_read_b64_tr_b16 v[134:135], v11 offset:22528
    global_load_lds_dwordx4 v13, s[40:41]
    ds_read_b64_tr_b16 v[136:137], v12 offset:20480
    v_mfma_f32_16x16x32_bf16 v[96:99], v[180:183], v[28:31], v[96:99]
    ds_read_b64_tr_b16 v[138:139], v12 offset:22528
    s_add_u32 s40, s40, 98304
    ds_read_b64_tr_b16 v[140:141], v23 offset:20480
    ds_read_b64_tr_b16 v[142:143], v23 offset:22528
    s_addc_u32 s41, s41, 0
    s_waitcnt vmcnt(12) lgkmcnt(0)
    s_barrier
    v_mfma_f32_16x16x32_bf16 v[32:35], v[104:107], a[16:19], v[32:35]
    v_dot2_f32_bf16 v240, v224, v28, v240
    v_dot2_f32_bf16 v241, v224, v224, v241
    v_dot2_f32_bf16 v240, v225, v28, v240
    s_add_u32 s50, s46, 0
    v_mfma_f32_16x16x32_bf16 v[64:67], v[104:107], a[80:83], v[64:67]
    v_dot2_f32_bf16 v241, v225, v225, v241
    v_dot2_f32_bf16 v240, v226, v28, v240
    s_addc_u32 s51, s47, 0
    v_dot2_f32_bf16 v241, v226, v226, v241
    v_dot2_f32_bf16 v240, v227, v28, v240
    v_mfma_f32_16x16x32_bf16 v[36:39], v[108:111], a[16:19], v[36:39]
    s_add_u32 m0, s49, 8192
    v_dot2_f32_bf16 v241, v227, v227, v241
    v_dot2_f32_bf16 v242, v228, v28, v242
    v_dot2_f32_bf16 v243, v228, v228, v243
    global_load_lds_dwordx4 v14, s[50:51]
    v_mfma_f32_16x16x32_bf16 v[68:71], v[108:111], a[80:83], v[68:71]
    v_dot2_f32_bf16 v242, v229, v28, v242
    v_dot2_f32_bf16 v243, v229, v229, v243
    s_add_u32 s50, s46, 8192
    v_dot2_f32_bf16 v242, v230, v28, v242
    v_dot2_f32_bf16 v243, v230, v230, v243
    v_mfma_f32_16x16x32_bf16 v[40:43], v[112:115], a[16:19], v[40:43]
    s_addc_u32 s51, s47, 0
    v_dot2_f32_bf16 v242, v231, v28, v242
    v_dot2_f32_bf16 v243, v231, v231, v243
    v_dot2_f32_bf16 v240, v232, v28, v240
    v_mfma_f32_16x16x32_bf16 v[72:75], v[112:115], a[80:83], v[72:75]
    s_add_u32 m0, s49, 9216
    v_dot2_f32_bf16 v241, v232, v232, v241
    v_dot2_f32_bf16 v240, v233, v28, v240
    global_load_lds_dwordx4 v14, s[50:51]
    v_dot2_f32_bf16 v241, v233, v233, v241
    v_mfma_f32_16x16x32_bf16 v[44:47], v[116:119], a[16:19], v[44:47]
    v_dot2_f32_bf16 v240, v234, v28, v240
    s_add_u32 s50, s46, 16384
    v_dot2_f32_bf16 v241, v234, v234, v241
    v_dot2_f32_bf16 v240, v235, v28, v240
    v_dot2_f32_bf16 v241, v235, v235, v241
    v_mfma_f32_16x16x32_bf16 v[76:79], v[116:119], a[80:83], v[76:79]
    s_addc_u32 s51, s47, 0
    v_dot2_f32_bf16 v242, v236, v28, v242
    v_dot2_f32_bf16 v243, v236, v236, v243
    s_add_u32 m0, s49, 10240
    v_dot2_f32_bf16 v242, v237, v28, v242
    v_mfma_f32_16x16x32_bf16 v[96:99], v[120:123], v[28:31], v[96:99]
    v_dot2_f32_bf16 v243, v237, v237, v243
    global_load_lds_dwordx4 v14, s[50:51]
    v_dot2_f32_bf16 v242, v238, v28, v242
    v_dot2_f32_bf16 v243, v238, v238, v243
    s_add_u32 s50, s46, 24576
    v_mfma_f32_16x16x32_bf16 v[32:35], v[124:127], a[20:23], v[32:35]
    v_dot2_f32_bf16 v242, v239, v28, v242
    v_dot2_f32_bf16 v243, v239, v239, v243
    ds_read_b128 a[24:27], v25 offset:12288
    s_addc_u32 s51, s47, 0
    v_mfma_f32_16x16x32_bf16 v[64:67], v[124:127], a[84:87], v[64:67]
    ds_read_b128 v[224:227], v25 offset:12288
    ds_read_b128 a[88:91], v25 offset:14336
    s_add_u32 m0, s49, 11264
    ds_read_b128 v[228:231], v25 offset:14336
    ds_read_b128 a[28:31], v26 offset:12288
    v_mfma_f32_16x16x32_bf16 v[36:39], v[128:131], a[20:23], v[36:39]
    global_load_lds_dwordx4 v14, s[50:51]
    ds_read_b128 v[232:235], v26 offset:12288
    ds_read_b128 a[92:95], v26 offset:14336
    ds_read_b128 v[236:239], v26 offset:14336
    s_add_u32 s46, s46, 128
    v_mfma_f32_16x16x32_bf16 v[68:71], v[128:131], a[84:87], v[68:71]
    ds_read_b64_tr_b16 v[144:145], v9 offset:24576
    ds_read_b64_tr_b16 v[146:147], v9 offset:26624
    s_addc_u32 s47, s47, 0
    ds_read_b64_tr_b16 v[148:149], v10 offset:24576
    ds_read_b64_tr_b16 v[150:151], v10 offset:26624
    v_mfma_f32_16x16x32_bf16 v[40:43], v[132:135], a[20:23], v[40:43]
    s_add_u32 m0, s48, 49152
    ds_read_b64_tr_b16 v[152:153], v11 offset:24576
    ds_read_b64_tr_b16 v[154:155], v11 offset:26624
    ds_read_b64_tr_b16 v[156:157], v12 offset:24576
    v_mfma_f32_16x16x32_bf16 v[72:75], v[132:135], a[84:87], v[72:75]
    global_load_lds_dwordx4 v13, s[40:41]
    ds_read_b64_tr_b16 v[158:159], v12 offset:26624
    ds_read_b64_tr_b16 v[160:161], v23 offset:24576
    s_add_u32 s40, s40, 98304
    ds_read_b64_tr_b16 v[162:163], v23 offset:26624
    v_mfma_f32_16x16x32_bf16 v[44:47], v[136:139], a[20:23], v[44:47]
    ds_read_b64_tr_b16 v[164:165], v9 offset:28672
    s_addc_u32 s41, s41, 0
    ds_read_b64_tr_b16 v[166:167], v9 offset:30720
    ds_read_b64_tr_b16 v[168:169], v10 offset:28672
    ds_read_b64_tr_b16 v[170:171], v10 offset:30720
    v_mfma_f32_16x16x32_bf16 v[76:79], v[136:139], a[84:87], v[76:79]
    s_add_u32 m0, s48, 53248
    ds_read_b64_tr_b16 v[172:173], v11 offset:28672
    ds_read_b64_tr_b16 v[174:175], v11 offset:30720
    global_load_lds_dwordx4 v13, s[40:41]
    ds_read_b64_tr_b16 v[176:177], v12 offset:28672
    v_mfma_f32_16x16x32_bf16 v[96:99], v[140:143], v[28:31], v[96:99]
    ds_read_b64_tr_b16 v[178:179], v12 offset:30720
    s_add_u32 s40, s40, 98304
    ds_read_b64_tr_b16 v[180:181], v23 offset:28672
    ds_read_b64_tr_b16 v[182:183], v23 offset:30720
    s_addc_u32 s41, s41, 0
    s_waitcnt vmcnt(12) lgkmcnt(0)
    s_barrier
    v_mfma_f32_16x16x32_bf16 v[32:35], v[144:147], a[24:27], v[32:35]
    v_dot2_f32_bf16 v240, v224, v28, v240
    v_dot2_f32_bf16 v241, v224, v224, v241
    v_dot2_f32_bf16 v240, v225, v28, v240
    s_add_u32 s50, s46, 0
    v_mfma_f32_16x16x32_bf16 v[64:67], v[144:147], a[88:91], v[64:67]
    v_dot2_f32_bf16 v241, v225, v225, v241
    v_dot2_f32_bf16 v240, v226, v28, v240
    s_addc_u32 s51, s47, 0
    v_dot2_f32_bf16 v241, v226, v226, v241
    v_dot2_f32_bf16 v240, v227, v28, v240
    v_mfma_f32_16x16x32_bf16 v[36:39], v[148:151], a[24:27], v[36:39]
    s_add_u32 m0, s49, 12288
    v_dot2_f32_bf16 v241, v227, v227, v241
    v_dot2_f32_bf16 v242, v228, v28, v242
    v_dot2_f32_bf16 v243, v228, v228, v243
    global_load_lds_dwordx4 v14, s[50:51]
    v_mfma_f32_16x16x32_bf16 v[68:71], v[148:151], a[88:91], v[68:71]
    v_dot2_f32_bf16 v242, v229, v28, v242
    v_dot2_f32_bf16 v243, v229, v229, v243
    s_add_u32 s50, s46, 8192
    v_dot2_f32_bf16 v242, v230, v28, v242
    v_dot2_f32_bf16 v243, v230, v230, v243
    v_mfma_f32_16x16x32_bf16 v[40:43], v[152:155], a[24:27], v[40:43]
    s_addc_u32 s51, s47, 0
    v_dot2_f32_bf16 v242, v231, v28, v242
    v_dot2_f32_bf16 v243, v231, v231, v243
    v_dot2_f32_bf16 v240, v232, v28, v240
    v_mfma_f32_16x16x32_bf16 v[72:75], v[152:155], a[88:91], v[72:75]
    s_add_u32 m0, s49, 13312
    v_dot2_f32_bf16 v241, v232, v232, v241
    v_dot2_f32_bf16 v240, v233, v28, v240
    global_load_lds_dwordx4 v14, s[50:51]
    v_dot2_f32_bf16 v241, v233, v233, v241
    v_mfma_f32_16x16x32_bf16 v[44:47], v[156:159], a[24:27], v[44:47]
    v_dot2_f32_bf16 v240, v234, v28, v240
    s_add_u32 s50, s46, 16384
    v_dot2_f32_bf16 v241, v234, v234, v241
    v_dot2_f32_bf16 v240, v235, v28, v240
    v_dot2_f32_bf16 v241, v235, v235, v241
    v_mfma_f32_16x16x32_bf16 v[76:79], v[156:159], a[88:91], v[76:79]
    s_addc_u32 s51, s47, 0
    v_dot2_f32_bf16 v242, v236, v28, v242
    v_dot2_f32_bf16 v243, v236, v236, v243
    s_add_u32 m0, s49, 14336
    v_dot2_f32_bf16 v242, v237, v28, v242
    v_mfma_f32_16x16x32_bf16 v[96:99], v[160:163], v[28:31], v[96:99]
    v_dot2_f32_bf16 v243, v237, v237, v243
    global_load_lds_dwordx4 v14, s[50:51]
    v_dot2_f32_bf16 v242, v238, v28, v242
    v_dot2_f32_bf16 v243, v238, v238, v243
    s_add_u32 s50, s46, 24576
    v_mfma_f32_16x16x32_bf16 v[32:35], v[164:167], a[28:31], v[32:35]
    v_dot2_f32_bf16 v242, v239, v28, v242
    v_dot2_f32_bf16 v243, v239, v239, v243
    ds_read_b128 a[32:35], v25 offset:0
    s_addc_u32 s51, s47, 0
    v_mfma_f32_16x16x32_bf16 v[64:67], v[164:167], a[92:95], v[64:67]
    ds_read_b128 v[224:227], v25 offset:0
    ds_read_b128 a[96:99], v25 offset:2048
    s_add_u32 m0, s49, 15360
    ds_read_b128 v[228:231], v25 offset:2048
    ds_read_b128 a[36:39], v26 offset:0
    v_mfma_f32_16x16x32_bf16 v[36:39], v[168:171], a[28:31], v[36:39]
    global_load_lds_dwordx4 v14, s[50:51]
    ds_read_b128 v[232:235], v26 offset:0
    ds_read_b128 a[100:103], v26 offset:2048
    ds_read_b128 v[236:239], v26 offset:2048
    s_add_u32 s46, s46, 128
    v_mfma_f32_16x16x32_bf16 v[68:71], v[168:171], a[92:95], v[68:71]
    ds_read_b64_tr_b16 v[104:105], v9 offset:32768
    ds_read_b64_tr_b16 v[106:107], v9 offset:34816
    s_addc_u32 s47, s47, 0
    ds_read_b64_tr_b16 v[108:109], v10 offset:32768
    ds_read_b64_tr_b16 v[110:111], v10 offset:34816
    v_mfma_f32_16x16x32_bf16 v[40:43], v[172:175], a[28:31], v[40:43]
    s_add_u32 m0, s48, 57344
    ds_read_b64_tr_b16 v[112:113], v11 offset:32768
    ds_read_b64_tr_b16 v[114:115], v11 offset:34816
    ds_read_b64_tr_b16 v[116:117], v12 offset:32768
    v_mfma_f32_16x16x32_bf16 v[72:75], v[172:175], a[92:95], v[72:75]
    global_load_lds_dwordx4 v13, s[40:41]
    ds_read_b64_tr_b16 v[118:119], v12 offset:34816
    ds_read_b64_tr_b16 v[120:121], v23 offset:32768
    s_add_u32 s40, s40, 98304
    ds_read_b64_tr_b16 v[122:123], v23 offset:34816
    v_mfma_f32_16x16x32_bf16 v[44:47], v[176:179], a[28:31], v[44:47]
    ds_read_b64_tr_b16 v[124:125], v9 offset:36864
    s_addc_u32 s41, s41, 0
    ds_read_b64_tr_b16 v[126:127], v9 offset:38912
    ds_read_b64_tr_b16 v[128:129], v10 offset:36864
    ds_read_b64_tr_b16 v[130:131], v10 offset:38912
    v_mfma_f32_16x16x32_bf16 v[76:79], v[176:179], a[92:95], v[76:79]
    s_add_u32 m0, s48, 61440
    ds_read_b64_tr_b16 v[132:133], v11 offset:36864
    ds_read_b64_tr_b16 v[134:135], v11 offset:38912
    global_load_lds_dwordx4 v13, s[40:41]
    ds_read_b64_tr_b16 v[136:137], v12 offset:36864
    v_mfma_f32_16x16x32_bf16 v[96:99], v[180:183], v[28:31], v[96:99]
    ds_read_b64_tr_b16 v[138:139], v12 offset:38912
    s_add_u32 s40, s40, 98304
    ds_read_b64_tr_b16 v[140:141], v23 offset:36864
    ds_read_b64_tr_b16 v[142:143], v23 offset:38912
    s_addc_u32 s41, s41, 0
    s_waitcnt vmcnt(12) lgkmcnt(0)
    s_barrier
    v_mfma_f32_16x16x32_bf16 v[32:35], v[104:107], a[32:35], v[32:35]
    v_dot2_f32_bf16 v240, v224, v28, v240
    v_dot2_f32_bf16 v241, v224, v224, v241
    v_dot2_f32_bf16 v240, v225, v28, v240
    v_mfma_f32_16x16x32_bf16 v[64:67], v[104:107], a[96:99], v[64:67]
    v_dot2_f32_bf16 v241, v225, v225, v241
    v_dot2_f32_bf16 v240, v226, v28, v240
    v_dot2_f32_bf16 v241, v226, v226, v241
    s_and_b32 s10, s59, 7
    v_mfma_f32_16x16x32_bf16 v[36:39], v[108:111], a[32:35], v[36:39]
    v_dot2_f32_bf16 v240, v227, v28, v240
    v_dot2_f32_bf16 v241, v227, v227, v241
    v_dot2_f32_bf16 v242, v228, v28, v242
    v_dot2_f32_bf16 v243, v228, v228, v243
    v_mfma_f32_16x16x32_bf16 v[68:71], v[108:111], a[96:99], v[68:71]
    v_dot2_f32_bf16 v242, v229, v28, v242
    v_dot2_f32_bf16 v243, v229, v229, v243
    s_lshl_b32 s10, s10, 11
    v_dot2_f32_bf16 v242, v230, v28, v242
    v_mfma_f32_16x16x32_bf16 v[40:43], v[112:115], a[32:35], v[40:43]
    v_dot2_f32_bf16 v243, v230, v230, v243
    v_dot2_f32_bf16 v242, v231, v28, v242
    v_dot2_f32_bf16 v243, v231, v231, v243
    v_dot2_f32_bf16 v240, v232, v28, v240
    v_mfma_f32_16x16x32_bf16 v[72:75], v[112:115], a[96:99], v[72:75]
    v_dot2_f32_bf16 v241, v232, v232, v241
    s_and_b32 s11, s3, 1
    v_dot2_f32_bf16 v240, v233, v28, v240
    v_dot2_f32_bf16 v241, v233, v233, v241
    v_mfma_f32_16x16x32_bf16 v[44:47], v[116:119], a[32:35], v[44:47]
    v_dot2_f32_bf16 v240, v234, v28, v240
    v_dot2_f32_bf16 v241, v234, v234, v241
    v_dot2_f32_bf16 v240, v235, v28, v240
    v_dot2_f32_bf16 v241, v235, v235, v241
    v_mfma_f32_16x16x32_bf16 v[76:79], v[116:119], a[96:99], v[76:79]
    s_lshl_b32 s11, s11, 10
    v_dot2_f32_bf16 v242, v236, v28, v242
    v_dot2_f32_bf16 v243, v236, v236, v243
    v_dot2_f32_bf16 v242, v237, v28, v242
    v_mfma_f32_16x16x32_bf16 v[96:99], v[120:123], v[28:31], v[96:99]
    v_dot2_f32_bf16 v243, v237, v237, v243
    v_dot2_f32_bf16 v242, v238, v28, v242
    v_dot2_f32_bf16 v243, v238, v238, v243
    s_add_u32 s10, s10, s11
    v_mfma_f32_16x16x32_bf16 v[32:35], v[124:127], a[36:39], v[32:35]
    v_dot2_f32_bf16 v242, v239, v28, v242
    v_dot2_f32_bf16 v243, v239, v239, v243
    ds_read_b128 a[40:43], v25 offset:4096
    v_mfma_f32_16x16x32_bf16 v[64:67], v[124:127], a[100:103], v[64:67]
    ds_read_b128 v[224:227], v25 offset:4096
    ds_read_b128 a[104:107], v25 offset:6144
    ds_read_b128 v[228:231], v25 offset:6144
    s_add_u32 s52, s20, s10
    v_mfma_f32_16x16x32_bf16 v[36:39], v[128:131], a[36:39], v[36:39]
    ds_read_b128 a[44:47], v26 offset:4096
    ds_read_b128 v[232:235], v26 offset:4096
    ds_read_b128 a[108:111], v26 offset:6144
    ds_read_b128 v[236:239], v26 offset:6144
    v_mfma_f32_16x16x32_bf16 v[68:71], v[128:131], a[100:103], v[68:71]
    ds_read_b64_tr_b16 v[144:145], v9 offset:40960
    ds_read_b64_tr_b16 v[146:147], v9 offset:43008
    s_addc_u32 s53, s21, 0
    ds_read_b64_tr_b16 v[148:149], v10 offset:40960
    v_mfma_f32_16x16x32_bf16 v[40:43], v[132:135], a[36:39], v[40:43]
    ds_read_b64_tr_b16 v[150:151], v10 offset:43008
    ds_read_b64_tr_b16 v[152:153], v11 offset:40960
    ds_read_b64_tr_b16 v[154:155], v11 offset:43008
    ds_read_b64_tr_b16 v[156:157], v12 offset:40960
    v_mfma_f32_16x16x32_bf16 v[72:75], v[132:135], a[100:103], v[72:75]
    ds_read_b64_tr_b16 v[158:159], v12 offset:43008
    s_add_u32 m0, s11, 147456
    ds_read_b64_tr_b16 v[160:161], v23 offset:40960
    ds_read_b64_tr_b16 v[162:163], v23 offset:43008
    v_mfma_f32_16x16x32_bf16 v[44:47], v[136:139], a[36:39], v[44:47]
    ds_read_b64_tr_b16 v[164:165], v9 offset:45056
    ds_read_b64_tr_b16 v[166:167], v9 offset:47104
    ds_read_b64_tr_b16 v[168:169], v10 offset:45056
    ds_read_b64_tr_b16 v[170:171], v10 offset:47104
    v_mfma_f32_16x16x32_bf16 v[76:79], v[136:139], a[100:103], v[76:79]
    global_load_lds_dwordx4 v5, s[52:53]
    ds_read_b64_tr_b16 v[172:173], v11 offset:45056
    ds_read_b64_tr_b16 v[174:175], v11 offset:47104
    ds_read_b64_tr_b16 v[176:177], v12 offset:45056
    v_mfma_f32_16x16x32_bf16 v[96:99], v[140:143], v[28:31], v[96:99]
    ds_read_b64_tr_b16 v[178:179], v12 offset:47104
    ds_read_b64_tr_b16 v[180:181], v23 offset:45056
    ds_read_b64_tr_b16 v[182:183], v23 offset:47104
    s_cmp_ge_u32 s59, 8
    s_cbranch_scc1 cb_interleave_layers__linear_kernel_hedgehog__mixer_channel_mlp__prompt_kernel_6
    s_add_u32 m0, s49, 0
    s_nop 0
    global_load_lds_dwordx4 v244, s[42:43]
    s_add_u32 m0, s49, 1024
    s_nop 0
    global_load_lds_dwordx4 v245, s[42:43]
    s_add_u32 m0, s49, 2048
    s_nop 0
    global_load_lds_dwordx4 v246, s[42:43]
    s_add_u32 m0, s49, 3072
    s_nop 0
    global_load_lds_dwordx4 v247, s[42:43]
    s_add_u32 s42, s42, 393216
    s_addc_u32 s43, s43, 0
cb_interleave_layers__linear_kernel_hedgehog__mixer_channel_mlp__prompt_kernel_6:
    s_cmp_ge_u32 s59, 8
    s_cbranch_scc1 wa_interleave_layers__linear_kernel_hedgehog__mixer_channel_mlp__prompt_kernel_7
    s_waitcnt vmcnt(11) lgkmcnt(0)
    s_branch wb_interleave_layers__linear_kernel_hedgehog__mixer_channel_mlp__prompt_kernel_8
wa_interleave_layers__linear_kernel_hedgehog__mixer_channel_mlp__prompt_kernel_7:
    s_waitcnt vmcnt(7) lgkmcnt(0)
wb_interleave_layers__linear_kernel_hedgehog__mixer_channel_mlp__prompt_kernel_8:
    s_barrier
    v_mfma_f32_16x16x32_bf16 v[32:35], v[144:147], a[40:43], v[32:35]
    v_dot2_f32_bf16 v240, v224, v28, v240
    v_dot2_f32_bf16 v241, v224, v224, v241
    v_dot2_f32_bf16 v240, v225, v28, v240
    v_mfma_f32_16x16x32_bf16 v[64:67], v[144:147], a[104:107], v[64:67]
    v_dot2_f32_bf16 v241, v225, v225, v241
    v_dot2_f32_bf16 v240, v226, v28, v240
    v_dot2_f32_bf16 v241, v226, v226, v241
    v_mfma_f32_16x16x32_bf16 v[36:39], v[148:151], a[40:43], v[36:39]
    v_dot2_f32_bf16 v240, v227, v28, v240
    v_dot2_f32_bf16 v241, v227, v227, v241
    v_dot2_f32_bf16 v242, v228, v28, v242
    v_dot2_f32_bf16 v243, v228, v228, v243
    v_mfma_f32_16x16x32_bf16 v[68:71], v[148:151], a[104:107], v[68:71]
    v_dot2_f32_bf16 v242, v229, v28, v242
    v_dot2_f32_bf16 v243, v229, v229, v243
    v_dot2_f32_bf16 v242, v230, v28, v242
    v_mfma_f32_16x16x32_bf16 v[40:43], v[152:155], a[40:43], v[40:43]
    v_dot2_f32_bf16 v243, v230, v230, v243
    v_dot2_f32_bf16 v242, v231, v28, v242
    v_dot2_f32_bf16 v243, v231, v231, v243
    v_mfma_f32_16x16x32_bf16 v[72:75], v[152:155], a[104:107], v[72:75]
    v_dot2_f32_bf16 v240, v232, v28, v240
    v_dot2_f32_bf16 v241, v232, v232, v241
    v_dot2_f32_bf16 v240, v233, v28, v240
    v_dot2_f32_bf16 v241, v233, v233, v241
    v_mfma_f32_16x16x32_bf16 v[44:47], v[156:159], a[40:43], v[44:47]
    v_dot2_f32_bf16 v240, v234, v28, v240
    v_dot2_f32_bf16 v241, v234, v234, v241
    v_dot2_f32_bf16 v240, v235, v28, v240
    v_mfma_f32_16x16x32_bf16 v[76:79], v[156:159], a[104:107], v[76:79]
    v_dot2_f32_bf16 v241, v235, v235, v241
    v_dot2_f32_bf16 v242, v236, v28, v242
    v_dot2_f32_bf16 v243, v236, v236, v243
    v_dot2_f32_bf16 v242, v237, v28, v242
    v_mfma_f32_16x16x32_bf16 v[96:99], v[160:163], v[28:31], v[96:99]
    v_dot2_f32_bf16 v243, v237, v237, v243
    v_dot2_f32_bf16 v242, v238, v28, v242
    v_dot2_f32_bf16 v243, v238, v238, v243
    v_mfma_f32_16x16x32_bf16 v[32:35], v[164:167], a[44:47], v[32:35]
    v_dot2_f32_bf16 v242, v239, v28, v242
    v_dot2_f32_bf16 v243, v239, v239, v243
    ds_read_b128 a[48:51], v25 offset:8192
    v_mfma_f32_16x16x32_bf16 v[64:67], v[164:167], a[108:111], v[64:67]
    ds_read_b128 v[224:227], v25 offset:8192
    ds_read_b128 a[112:115], v25 offset:10240
    ds_read_b128 v[228:231], v25 offset:10240
    ds_read_b128 a[52:55], v26 offset:8192
    v_mfma_f32_16x16x32_bf16 v[36:39], v[168:171], a[44:47], v[36:39]
    ds_read_b128 v[232:235], v26 offset:8192
    ds_read_b128 a[116:119], v26 offset:10240
    ds_read_b128 v[236:239], v26 offset:10240
    v_mfma_f32_16x16x32_bf16 v[68:71], v[168:171], a[108:111], v[68:71]
    ds_read_b64_tr_b16 v[104:105], v9 offset:49152
    ds_read_b64_tr_b16 v[106:107], v9 offset:51200
    ds_read_b64_tr_b16 v[108:109], v10 offset:49152
    ds_read_b64_tr_b16 v[110:111], v10 offset:51200
    v_mfma_f32_16x16x32_bf16 v[40:43], v[172:175], a[44:47], v[40:43]
    ds_read_b64_tr_b16 v[112:113], v11 offset:49152
    ds_read_b64_tr_b16 v[114:115], v11 offset:51200
    ds_read_b64_tr_b16 v[116:117], v12 offset:49152
    v_mfma_f32_16x16x32_bf16 v[72:75], v[172:175], a[108:111], v[72:75]
    ds_read_b64_tr_b16 v[118:119], v12 offset:51200
    ds_read_b64_tr_b16 v[120:121], v23 offset:49152
    ds_read_b64_tr_b16 v[122:123], v23 offset:51200
    v_mfma_f32_16x16x32_bf16 v[44:47], v[176:179], a[44:47], v[44:47]
    ds_read_b64_tr_b16 v[124:125], v9 offset:53248
    ds_read_b64_tr_b16 v[126:127], v9 offset:55296
    ds_read_b64_tr_b16 v[128:129], v10 offset:53248
    ds_read_b64_tr_b16 v[130:131], v10 offset:55296
    v_mfma_f32_16x16x32_bf16 v[76:79], v[176:179], a[108:111], v[76:79]
    ds_read_b64_tr_b16 v[132:133], v11 offset:53248
    ds_read_b64_tr_b16 v[134:135], v11 offset:55296
    ds_read_b64_tr_b16 v[136:137], v12 offset:53248
    v_mfma_f32_16x16x32_bf16 v[96:99], v[180:183], v[28:31], v[96:99]
    ds_read_b64_tr_b16 v[138:139], v12 offset:55296
    ds_read_b64_tr_b16 v[140:141], v23 offset:53248
    ds_read_b64_tr_b16 v[142:143], v23 offset:55296
    s_cmp_ge_u32 s59, 8
    s_cbranch_scc1 cb_interleave_layers__linear_kernel_hedgehog__mixer_channel_mlp__prompt_kernel_9
    s_add_u32 m0, s49, 4096
    s_nop 0
    global_load_lds_dwordx4 v244, s[42:43]
    s_add_u32 m0, s49, 5120
    s_nop 0
    global_load_lds_dwordx4 v245, s[42:43]
    s_add_u32 m0, s49, 6144
    s_nop 0
    global_load_lds_dwordx4 v246, s[42:43]
    s_add_u32 m0, s49, 7168
    s_nop 0
    global_load_lds_dwordx4 v247, s[42:43]
    s_add_u32 s42, s42, 393216
    s_addc_u32 s43, s43, 0
cb_interleave_layers__linear_kernel_hedgehog__mixer_channel_mlp__prompt_kernel_9:
    s_cmp_ge_u32 s59, 8
    s_cbranch_scc1 wa_interleave_layers__linear_kernel_hedgehog__mixer_channel_mlp__prompt_kernel_10
    s_waitcnt vmcnt(9) lgkmcnt(0)
    s_branch wb_interleave_layers__linear_kernel_hedgehog__mixer_channel_mlp__prompt_kernel_11
wa_interleave_layers__linear_kernel_hedgehog__mixer_channel_mlp__prompt_kernel_10:
    s_waitcnt vmcnt(1) lgkmcnt(0)
wb_interleave_layers__linear_kernel_hedgehog__mixer_channel_mlp__prompt_kernel_11:
    s_barrier
    v_mfma_f32_16x16x32_bf16 v[32:35], v[104:107], a[48:51], v[32:35]
    v_dot2_f32_bf16 v240, v224, v28, v240
    v_dot2_f32_bf16 v241, v224, v224, v241
    v_dot2_f32_bf16 v240, v225, v28, v240
    v_mfma_f32_16x16x32_bf16 v[64:67], v[104:107], a[112:115], v[64:67]
    v_dot2_f32_bf16 v241, v225, v225, v241
    v_dot2_f32_bf16 v240, v226, v28, v240
    v_dot2_f32_bf16 v241, v226, v226, v241
    v_mfma_f32_16x16x32_bf16 v[36:39], v[108:111], a[48:51], v[36:39]
    v_dot2_f32_bf16 v240, v227, v28, v240
    v_dot2_f32_bf16 v241, v227, v227, v241
    v_dot2_f32_bf16 v242, v228, v28, v242
    v_dot2_f32_bf16 v243, v228, v228, v243
    v_mfma_f32_16x16x32_bf16 v[68:71], v[108:111], a[112:115], v[68:71]
    v_dot2_f32_bf16 v242, v229, v28, v242
    v_dot2_f32_bf16 v243, v229, v229, v243
    v_dot2_f32_bf16 v242, v230, v28, v242
    v_mfma_f32_16x16x32_bf16 v[40:43], v[112:115], a[48:51], v[40:43]
    v_dot2_f32_bf16 v243, v230, v230, v243
    v_dot2_f32_bf16 v242, v231, v28, v242
    v_dot2_f32_bf16 v243, v231, v231, v243
    v_mfma_f32_16x16x32_bf16 v[72:75], v[112:115], a[112:115], v[72:75]
    v_dot2_f32_bf16 v240, v232, v28, v240
    v_dot2_f32_bf16 v241, v232, v232, v241
    v_dot2_f32_bf16 v240, v233, v28, v240
    v_dot2_f32_bf16 v241, v233, v233, v241
    v_mfma_f32_16x16x32_bf16 v[44:47], v[116:119], a[48:51], v[44:47]
    v_dot2_f32_bf16 v240, v234, v28, v240
    v_dot2_f32_bf16 v241, v234, v234, v241
    v_dot2_f32_bf16 v240, v235, v28, v240
    v_mfma_f32_16x16x32_bf16 v[76:79], v[116:119], a[112:115], v[76:79]
    v_dot2_f32_bf16 v241, v235, v235, v241
    v_dot2_f32_bf16 v242, v236, v28, v242
    v_dot2_f32_bf16 v243, v236, v236, v243
    v_dot2_f32_bf16 v242, v237, v28, v242
    v_mfma_f32_16x16x32_bf16 v[96:99], v[120:123], v[28:31], v[96:99]
    v_dot2_f32_bf16 v243, v237, v237, v243
    v_dot2_f32_bf16 v242, v238, v28, v242
    v_dot2_f32_bf16 v243, v238, v238, v243
    v_mfma_f32_16x16x32_bf16 v[32:35], v[124:127], a[52:55], v[32:35]
    v_dot2_f32_bf16 v242, v239, v28, v242
    v_dot2_f32_bf16 v243, v239, v239, v243
    ds_read_b128 a[56:59], v25 offset:12288
    v_mfma_f32_16x16x32_bf16 v[64:67], v[124:127], a[116:119], v[64:67]
    ds_read_b128 v[224:227], v25 offset:12288
    ds_read_b128 a[120:123], v25 offset:14336
    ds_read_b128 v[228:231], v25 offset:14336
    ds_read_b128 a[60:63], v26 offset:12288
    v_mfma_f32_16x16x32_bf16 v[36:39], v[128:131], a[52:55], v[36:39]
    ds_read_b128 v[232:235], v26 offset:12288
    ds_read_b128 a[124:127], v26 offset:14336
    ds_read_b128 v[236:239], v26 offset:14336
    v_mfma_f32_16x16x32_bf16 v[68:71], v[128:131], a[116:119], v[68:71]
    ds_read_b64_tr_b16 v[144:145], v9 offset:57344
    ds_read_b64_tr_b16 v[146:147], v9 offset:59392
    ds_read_b64_tr_b16 v[148:149], v10 offset:57344
    ds_read_b64_tr_b16 v[150:151], v10 offset:59392
    v_mfma_f32_16x16x32_bf16 v[40:43], v[132:135], a[52:55], v[40:43]
    ds_read_b64_tr_b16 v[152:153], v11 offset:57344
    ds_read_b64_tr_b16 v[154:155], v11 offset:59392
    ds_read_b64_tr_b16 v[156:157], v12 offset:57344
    v_mfma_f32_16x16x32_bf16 v[72:75], v[132:135], a[116:119], v[72:75]
    ds_read_b64_tr_b16 v[158:159], v12 offset:59392
    ds_read_b64_tr_b16 v[160:161], v23 offset:57344
    ds_read_b64_tr_b16 v[162:163], v23 offset:59392
    v_mfma_f32_16x16x32_bf16 v[44:47], v[136:139], a[52:55], v[44:47]
    ds_read_b64_tr_b16 v[164:165], v9 offset:61440
    ds_read_b64_tr_b16 v[166:167], v9 offset:63488
    ds_read_b64_tr_b16 v[168:169], v10 offset:61440
    ds_read_b64_tr_b16 v[170:171], v10 offset:63488
    v_mfma_f32_16x16x32_bf16 v[76:79], v[136:139], a[116:119], v[76:79]
    ds_read_b64_tr_b16 v[172:173], v11 offset:61440
    ds_read_b64_tr_b16 v[174:175], v11 offset:63488
    ds_read_b64_tr_b16 v[176:177], v12 offset:61440
    v_mfma_f32_16x16x32_bf16 v[96:99], v[140:143], v[28:31], v[96:99]
    ds_read_b64_tr_b16 v[178:179], v12 offset:63488
    ds_read_b64_tr_b16 v[180:181], v23 offset:61440
    ds_read_b64_tr_b16 v[182:183], v23 offset:63488
    s_cmp_ge_u32 s59, 8
    s_cbranch_scc1 cb_interleave_layers__linear_kernel_hedgehog__mixer_channel_mlp__prompt_kernel_12
    s_add_u32 m0, s49, 8192
    s_nop 0
    global_load_lds_dwordx4 v244, s[42:43]
    s_add_u32 m0, s49, 9216
    s_nop 0
    global_load_lds_dwordx4 v245, s[42:43]
    s_add_u32 m0, s49, 10240
    s_nop 0
    global_load_lds_dwordx4 v246, s[42:43]
    s_add_u32 m0, s49, 11264
    s_nop 0
    global_load_lds_dwordx4 v247, s[42:43]
    s_add_u32 s42, s42, 393216
    s_addc_u32 s43, s43, 0
cb_interleave_layers__linear_kernel_hedgehog__mixer_channel_mlp__prompt_kernel_12:
    s_waitcnt lgkmcnt(0)
    v_mfma_f32_16x16x32_bf16 v[32:35], v[144:147], a[56:59], v[32:35]
    s_cmp_ge_u32 s59, 8
    s_cbranch_scc1 cb_interleave_layers__linear_kernel_hedgehog__mixer_channel_mlp__prompt_kernel_13
    s_add_u32 m0, s49, 12288
    s_nop 0
    global_load_lds_dwordx4 v244, s[42:43]
    s_add_u32 m0, s49, 13312
    s_nop 0
    global_load_lds_dwordx4 v245, s[42:43]
    s_add_u32 m0, s49, 14336
    s_nop 0
    global_load_lds_dwordx4 v246, s[42:43]
    s_add_u32 m0, s49, 15360
    s_nop 0
    global_load_lds_dwordx4 v247, s[42:43]
    s_add_u32 s42, s42, 393216
    s_addc_u32 s43, s43, 0
cb_interleave_layers__linear_kernel_hedgehog__mixer_channel_mlp__prompt_kernel_13:
    v_mfma_f32_16x16x32_bf16 v[64:67], v[144:147], a[120:123], v[64:67]
    v_dot2_f32_bf16 v240, v224, v28, v240
    v_dot2_f32_bf16 v241, v224, v224, v241
    v_mfma_f32_16x16x32_bf16 v[36:39], v[148:151], a[56:59], v[36:39]
    v_dot2_f32_bf16 v240, v225, v28, v240
    v_dot2_f32_bf16 v241, v225, v225, v241
    v_mfma_f32_16x16x32_bf16 v[68:71], v[148:151], a[120:123], v[68:71]
    v_dot2_f32_bf16 v240, v226, v28, v240
    v_dot2_f32_bf16 v241, v226, v226, v241
    v_mfma_f32_16x16x32_bf16 v[40:43], v[152:155], a[56:59], v[40:43]
    v_dot2_f32_bf16 v240, v227, v28, v240
    v_dot2_f32_bf16 v241, v227, v227, v241
    v_mfma_f32_16x16x32_bf16 v[72:75], v[152:155], a[120:123], v[72:75]
    v_dot2_f32_bf16 v242, v228, v28, v242
    v_dot2_f32_bf16 v243, v228, v228, v243
    v_mfma_f32_16x16x32_bf16 v[44:47], v[156:159], a[56:59], v[44:47]
    v_dot2_f32_bf16 v242, v229, v28, v242
    v_mfma_f32_16x16x32_bf16 v[76:79], v[156:159], a[120:123], v[76:79]
    v_dot2_f32_bf16 v243, v229, v229, v243
    v_dot2_f32_bf16 v242, v230, v28, v242
    v_mfma_f32_16x16x32_bf16 v[96:99], v[160:163], v[28:31], v[96:99]
    v_dot2_f32_bf16 v243, v230, v230, v243
    v_dot2_f32_bf16 v242, v231, v28, v242
    v_mfma_f32_16x16x32_bf16 v[32:35], v[164:167], a[60:63], v[32:35]
    v_dot2_f32_bf16 v243, v231, v231, v243
    v_dot2_f32_bf16 v240, v232, v28, v240
    v_mfma_f32_16x16x32_bf16 v[64:67], v[164:167], a[124:127], v[64:67]
    v_dot2_f32_bf16 v241, v232, v232, v241
    v_dot2_f32_bf16 v240, v233, v28, v240
    v_mfma_f32_16x16x32_bf16 v[36:39], v[168:171], a[60:63], v[36:39]
    v_dot2_f32_bf16 v241, v233, v233, v241
    v_dot2_f32_bf16 v240, v234, v28, v240
    v_mfma_f32_16x16x32_bf16 v[68:71], v[168:171], a[124:127], v[68:71]
    v_dot2_f32_bf16 v241, v234, v234, v241
    v_mfma_f32_16x16x32_bf16 v[40:43], v[172:175], a[60:63], v[40:43]
    v_dot2_f32_bf16 v240, v235, v28, v240
    v_dot2_f32_bf16 v241, v235, v235, v241
    v_mfma_f32_16x16x32_bf16 v[72:75], v[172:175], a[124:127], v[72:75]
    v_dot2_f32_bf16 v242, v236, v28, v242
    v_dot2_f32_bf16 v243, v236, v236, v243
    v_mfma_f32_16x16x32_bf16 v[44:47], v[176:179], a[60:63], v[44:47]
    v_dot2_f32_bf16 v242, v237, v28, v242
    v_dot2_f32_bf16 v243, v237, v237, v243
    v_mfma_f32_16x16x32_bf16 v[76:79], v[176:179], a[124:127], v[76:79]
    v_dot2_f32_bf16 v242, v238, v28, v242
    v_dot2_f32_bf16 v243, v238, v238, v243
    v_mfma_f32_16x16x32_bf16 v[96:99], v[180:183], v[28:31], v[96:99]
    v_dot2_f32_bf16 v242, v239, v28, v242
    v_dot2_f32_bf16 v243, v239, v239, v243
    v_add_u32 v26, 151552, v5
    v_add_u32 v27, s48, v26
    s_nop 3
    ds_write_b128 v27, v[96:99]
    v_permlane32_swap_b32 v240, v241
    v_permlane32_swap_b32 v242, v243
    v_add_f32 v240, v240, v241
    v_add_f32 v242, v242, v243
    s_nop 1
    v_permlane16_swap_b32 v240, v242
    v_add_f32 v240, v240, v242
    v_mov_b32 v242, v240
    s_nop 1
    v_permlane16_swap_b32 v240, v242
    v_mov_b32 v241, v240
    v_mov_b32 v243, v242
    s_nop 0
    v_permlane32_swap_b32 v240, v241
    v_permlane32_swap_b32 v242, v243
    v_mul_f32 v240, 0x3b000000, v240
    v_mul_f32 v242, 0x3b000000, v242
    v_mul_f32 v241, 0x3b000000, v241
    v_mul_f32 v243, 0x3b000000, v243
    v_fma_f32 v241, -v240, v240, v241
    v_fma_f32 v243, -v242, v242, v243
    v_max_f32 v241, 0, v241
    v_max_f32 v243, 0, v243
    v_cvt_pk_bf16_f32 v186, 0, v240
    v_cvt_pk_bf16_f32 v194, 0, v242
    v_cvt_pk_bf16_f32 v187, 0, v241
    v_cvt_pk_bf16_f32 v195, 0, v243
    v_add_f32 v187, 0x3727c5ac, v187
    v_add_f32 v195, 0x3727c5ac, v195
    v_cvt_pk_bf16_f32 v187, 0, v187
    v_cvt_pk_bf16_f32 v195, 0, v195
    v_sqrt_f32 v187, v187
    v_sqrt_f32 v195, v195
    v_cvt_pk_bf16_f32 v187, 0, v187
    v_cvt_pk_bf16_f32 v195, 0, v195
    v_rcp_f32 v16, v187
    v_rcp_f32 v14, v195
    v_mul_f32 v17, v186, v16
    v_mul_f32 v15, v194, v14
    s_waitcnt vmcnt(0) lgkmcnt(0)
    s_barrier
    v_mov_b32 v250, v14
    v_mov_b32 v251, v15
    v_mov_b32 v252, v16
    v_mov_b32 v253, v17
    v_mov_b32 v248, 0x3fb8aa3b
    v_lshlrev_b32 v10, 5, v8
    v_lshl_add_u32 v10, v7, 3, v10
    v_add_u32 v10, 147456, v10
    s_lshl_b32 s10, s45, 5
    s_and_b32 s11, s59, 7
    s_lshl_b32 s11, s11, 2
    s_add_u32 s10, s10, s11
    s_lshl_b32 s10, s10, 10
    s_add_u32 s10, s10, 6291456
    s_add_u32 s54, s38, s10
    s_addc_u32 s55, s39, 0
    v_add_u32 v12, 32768, v5
    s_lshl_b32 s10, s3, 5
    v_add_u32 v11, s10, v3
    v_lshlrev_b32 v11, 5, v11
    v_lshl_add_u32 v11, v4, 3, v11
    v_lshrrev_b32 v16, 1, v3
    s_and_b32 s10, s3, 1
    s_lshl_b32 s10, s10, 2
    v_add_u32 v0, s10, v4
    v_xor_b32 v0, v16, v0
    v_and_b32 v17, 1, v1
    v_lshlrev_b32 v17, 4, v17
    v_lshl_add_u32 v17, v4, 10, v17
    v_lshl_add_u32 v0, v0, 5, v17
    s_lshl_b32 s10, s3, 12
    s_lshr_b32 s11, s59, 2
    s_lshl_b32 s11, s11, 8
    s_add_u32 s10, s10, s11
    s_add_u32 s24, s22, s10
    s_addc_u32 s25, s23, 0
    s_cmp_ge_u32 s59, 8
    s_cbranch_scc1 p1q_interleave_layers__linear_kernel_hedgehog__mixer_channel_mlp__prompt_kernel_14
    ds_read_b128 v[184:187], v26 offset:0
    ds_read_b64_tr_b16 v[200:201], v10 offset:0
    ds_read_b128 v[188:191], v26 offset:1024
    ds_read_b64_tr_b16 v[202:203], v10 offset:512
    ds_read_b128 v[192:195], v26 offset:2048
    ds_read_b64_tr_b16 v[204:205], v10 offset:1024
    ds_read_b128 v[196:199], v26 offset:3072
    ds_read_b64_tr_b16 v[206:207], v10 offset:1536
    ds_read_b64_tr_b16 v[104:105], v19 offset:0
    ds_read_b64_tr_b16 v[106:107], v19 offset:2048
    ds_read_b64_tr_b16 v[108:109], v20 offset:0
    ds_read_b64_tr_b16 v[110:111], v20 offset:2048
    ds_read_b64_tr_b16 v[112:113], v21 offset:0
    ds_read_b64_tr_b16 v[114:115], v21 offset:2048
    ds_read_b64_tr_b16 v[116:117], v22 offset:0
    ds_read_b64_tr_b16 v[118:119], v22 offset:2048
    ds_read_b64_tr_b16 v[120:121], v24 offset:0
    ds_read_b64_tr_b16 v[122:123], v24 offset:2048
    ds_read_b64_tr_b16 v[124:125], v19 offset:16384
    ds_read_b64_tr_b16 v[126:127], v19 offset:18432
    ds_read_b64_tr_b16 v[128:129], v20 offset:16384
    ds_read_b64_tr_b16 v[130:131], v20 offset:18432
    ds_read_b64_tr_b16 v[132:133], v21 offset:16384
    ds_read_b64_tr_b16 v[134:135], v21 offset:18432
    ds_read_b64_tr_b16 v[136:137], v22 offset:16384
    ds_read_b64_tr_b16 v[138:139], v22 offset:18432
    ds_read_b64_tr_b16 v[140:141], v24 offset:16384
    ds_read_b64_tr_b16 v[142:143], v24 offset:18432
    s_waitcnt lgkmcnt(0)
    v_mfma_f32_16x16x32_bf16 v[48:51], v[104:107], a[0:3], 0
    ds_read_b64_tr_b16 v[144:145], v19 offset:32768
    ds_read_b64_tr_b16 v[146:147], v19 offset:34816
    v_mfma_f32_16x16x32_bf16 v[80:83], v[104:107], a[64:67], 0
    ds_read_b64_tr_b16 v[148:149], v20 offset:32768
    ds_read_b64_tr_b16 v[150:151], v20 offset:34816
    v_mfma_f32_16x16x32_bf16 v[52:55], v[108:111], a[0:3], 0
    ds_read_b64_tr_b16 v[152:153], v21 offset:32768
    ds_read_b64_tr_b16 v[154:155], v21 offset:34816
    v_mfma_f32_16x16x32_bf16 v[84:87], v[108:111], a[64:67], 0
    ds_read_b64_tr_b16 v[156:157], v22 offset:32768
    ds_read_b64_tr_b16 v[158:159], v22 offset:34816
    v_mfma_f32_16x16x32_bf16 v[56:59], v[112:115], a[0:3], 0
    ds_read_b64_tr_b16 v[160:161], v24 offset:32768
    ds_read_b64_tr_b16 v[162:163], v24 offset:34816
    v_mfma_f32_16x16x32_bf16 v[88:91], v[112:115], a[64:67], 0
    ds_read_b64_tr_b16 v[164:165], v19 offset:49152
    ds_read_b64_tr_b16 v[166:167], v19 offset:51200
    v_mfma_f32_16x16x32_bf16 v[60:63], v[116:119], a[0:3], 0
    ds_read_b64_tr_b16 v[168:169], v20 offset:49152
    ds_read_b64_tr_b16 v[170:171], v20 offset:51200
    v_mfma_f32_16x16x32_bf16 v[92:95], v[116:119], a[64:67], 0
    ds_read_b64_tr_b16 v[172:173], v21 offset:49152
    ds_read_b64_tr_b16 v[174:175], v21 offset:51200
    v_mfma_f32_16x16x32_bf16 v[100:103], v[120:123], v[28:31], 0
    ds_read_b64_tr_b16 v[176:177], v22 offset:49152
    ds_read_b64_tr_b16 v[178:179], v22 offset:51200
    v_mfma_f32_16x16x32_bf16 v[48:51], v[124:127], a[4:7], v[48:51]
    ds_read_b64_tr_b16 v[180:181], v24 offset:49152
    ds_read_b64_tr_b16 v[182:183], v24 offset:51200
    v_mfma_f32_16x16x32_bf16 v[80:83], v[124:127], a[68:71], v[80:83]
    global_load_dwordx4 a[128:131], v0, s[24:25]
    s_add_u32 s24, s24, 16384
    s_addc_u32 s25, s25, 0
    global_load_dwordx4 a[132:135], v0, s[24:25]
    s_add_u32 s24, s24, 16384
    s_addc_u32 s25, s25, 0
    v_mfma_f32_16x16x32_bf16 v[52:55], v[128:131], a[4:7], v[52:55]
    global_load_dwordx4 a[136:139], v0, s[24:25]
    s_add_u32 s24, s24, 16384
    s_addc_u32 s25, s25, 0
    global_load_dwordx4 a[140:143], v0, s[24:25]
    s_add_u32 s24, s24, 16384
    s_addc_u32 s25, s25, 0
    v_mfma_f32_16x16x32_bf16 v[84:87], v[128:131], a[68:71], v[84:87]
    v_mfma_f32_16x16x32_bf16 v[56:59], v[132:135], a[4:7], v[56:59]
    v_mfma_f32_16x16x32_bf16 v[88:91], v[132:135], a[68:71], v[88:91]
    v_mfma_f32_16x16x32_bf16 v[60:63], v[136:139], a[4:7], v[60:63]
    v_mfma_f32_16x16x32_bf16 v[92:95], v[136:139], a[68:71], v[92:95]
    v_mfma_f32_16x16x32_bf16 v[100:103], v[140:143], v[28:31], v[100:103]
    s_waitcnt lgkmcnt(0)
    v_mfma_f32_16x16x32_bf16 v[48:51], v[144:147], a[8:11], v[48:51]
    ds_read_b64_tr_b16 v[104:105], v19 offset:4096
    ds_read_b64_tr_b16 v[106:107], v19 offset:6144
    v_mfma_f32_16x16x32_bf16 v[80:83], v[144:147], a[72:75], v[80:83]
    ds_read_b64_tr_b16 v[108:109], v20 offset:4096
    ds_read_b64_tr_b16 v[110:111], v20 offset:6144
    v_mfma_f32_16x16x32_bf16 v[52:55], v[148:151], a[8:11], v[52:55]
    ds_read_b64_tr_b16 v[112:113], v21 offset:4096
    ds_read_b64_tr_b16 v[114:115], v21 offset:6144
    v_mfma_f32_16x16x32_bf16 v[84:87], v[148:151], a[72:75], v[84:87]
    ds_read_b64_tr_b16 v[116:117], v22 offset:4096
    ds_read_b64_tr_b16 v[118:119], v22 offset:6144
    v_mfma_f32_16x16x32_bf16 v[56:59], v[152:155], a[8:11], v[56:59]
    ds_read_b64_tr_b16 v[120:121], v24 offset:4096
    ds_read_b64_tr_b16 v[122:123], v24 offset:6144
    v_mfma_f32_16x16x32_bf16 v[88:91], v[152:155], a[72:75], v[88:91]
    ds_read_b64_tr_b16 v[124:125], v19 offset:20480
    ds_read_b64_tr_b16 v[126:127], v19 offset:22528
    v_mfma_f32_16x16x32_bf16 v[60:63], v[156:159], a[8:11], v[60:63]
    ds_read_b64_tr_b16 v[128:129], v20 offset:20480
    ds_read_b64_tr_b16 v[130:131], v20 offset:22528
    v_mfma_f32_16x16x32_bf16 v[92:95], v[156:159], a[72:75], v[92:95]
    ds_read_b64_tr_b16 v[132:133], v21 offset:20480
    ds_read_b64_tr_b16 v[134:135], v21 offset:22528
    v_mfma_f32_16x16x32_bf16 v[100:103], v[160:163], v[28:31], v[100:103]
    ds_read_b64_tr_b16 v[136:137], v22 offset:20480
    ds_read_b64_tr_b16 v[138:139], v22 offset:22528
    v_mfma_f32_16x16x32_bf16 v[48:51], v[164:167], a[12:15], v[48:51]
    ds_read_b64_tr_b16 v[140:141], v24 offset:20480
    ds_read_b64_tr_b16 v[142:143], v24 offset:22528
    v_mfma_f32_16x16x32_bf16 v[80:83], v[164:167], a[76:79], v[80:83]
    global_load_dwordx4 a[144:147], v0, s[24:25]
    s_add_u32 s24, s24, 16384
    s_addc_u32 s25, s25, 0
    global_load_dwordx4 a[148:151], v0, s[24:25]
    s_add_u32 s24, s24, 16384
    s_addc_u32 s25, s25, 0
    v_mfma_f32_16x16x32_bf16 v[52:55], v[168:171], a[12:15], v[52:55]
    global_load_dwordx4 a[152:155], v0, s[24:25]
    s_add_u32 s24, s24, 16384
    s_addc_u32 s25, s25, 0
    global_load_dwordx4 a[156:159], v0, s[24:25]
    s_add_u32 s24, s24, 16384
    s_addc_u32 s25, s25, 0
    v_mfma_f32_16x16x32_bf16 v[84:87], v[168:171], a[76:79], v[84:87]
    v_mfma_f32_16x16x32_bf16 v[56:59], v[172:175], a[12:15], v[56:59]
    v_mfma_f32_16x16x32_bf16 v[88:91], v[172:175], a[76:79], v[88:91]
    v_mfma_f32_16x16x32_bf16 v[60:63], v[176:179], a[12:15], v[60:63]
    v_mfma_f32_16x16x32_bf16 v[92:95], v[176:179], a[76:79], v[92:95]
    v_mfma_f32_16x16x32_bf16 v[100:103], v[180:183], v[28:31], v[100:103]
    s_waitcnt lgkmcnt(0)
    v_mfma_f32_16x16x32_bf16 v[48:51], v[104:107], a[16:19], v[48:51]
    ds_read_b64_tr_b16 v[144:145], v19 offset:36864
    ds_read_b64_tr_b16 v[146:147], v19 offset:38912
    v_mfma_f32_16x16x32_bf16 v[80:83], v[104:107], a[80:83], v[80:83]
    ds_read_b64_tr_b16 v[148:149], v20 offset:36864
    ds_read_b64_tr_b16 v[150:151], v20 offset:38912
    v_mfma_f32_16x16x32_bf16 v[52:55], v[108:111], a[16:19], v[52:55]
    ds_read_b64_tr_b16 v[152:153], v21 offset:36864
    ds_read_b64_tr_b16 v[154:155], v21 offset:38912
    v_mfma_f32_16x16x32_bf16 v[84:87], v[108:111], a[80:83], v[84:87]
    ds_read_b64_tr_b16 v[156:157], v22 offset:36864
    ds_read_b64_tr_b16 v[158:159], v22 offset:38912
    v_mfma_f32_16x16x32_bf16 v[56:59], v[112:115], a[16:19], v[56:59]
    ds_read_b64_tr_b16 v[160:161], v24 offset:36864
    ds_read_b64_tr_b16 v[162:163], v24 offset:38912
    v_mfma_f32_16x16x32_bf16 v[88:91], v[112:115], a[80:83], v[88:91]
    ds_read_b64_tr_b16 v[164:165], v19 offset:53248
    ds_read_b64_tr_b16 v[166:167], v19 offset:55296
    v_mfma_f32_16x16x32_bf16 v[60:63], v[116:119], a[16:19], v[60:63]
    ds_read_b64_tr_b16 v[168:169], v20 offset:53248
    ds_read_b64_tr_b16 v[170:171], v20 offset:55296
    v_mfma_f32_16x16x32_bf16 v[92:95], v[116:119], a[80:83], v[92:95]
    ds_read_b64_tr_b16 v[172:173], v21 offset:53248
    ds_read_b64_tr_b16 v[174:175], v21 offset:55296
    v_mfma_f32_16x16x32_bf16 v[100:103], v[120:123], v[28:31], v[100:103]
    ds_read_b64_tr_b16 v[176:177], v22 offset:53248
    ds_read_b64_tr_b16 v[178:179], v22 offset:55296
    v_mfma_f32_16x16x32_bf16 v[48:51], v[124:127], a[20:23], v[48:51]
    ds_read_b64_tr_b16 v[180:181], v24 offset:53248
    ds_read_b64_tr_b16 v[182:183], v24 offset:55296
    v_mfma_f32_16x16x32_bf16 v[80:83], v[124:127], a[84:87], v[80:83]
    global_load_dwordx4 a[160:163], v0, s[24:25]
    s_add_u32 s24, s24, 16384
    s_addc_u32 s25, s25, 0
    global_load_dwordx4 a[164:167], v0, s[24:25]
    s_add_u32 s24, s24, 16384
    s_addc_u32 s25, s25, 0
    v_mfma_f32_16x16x32_bf16 v[52:55], v[128:131], a[20:23], v[52:55]
    global_load_dwordx4 a[168:171], v0, s[24:25]
    s_add_u32 s24, s24, 16384
    s_addc_u32 s25, s25, 0
    global_load_dwordx4 a[172:175], v0, s[24:25]
    s_add_u32 s24, s24, 16384
    s_addc_u32 s25, s25, 0
    v_mfma_f32_16x16x32_bf16 v[84:87], v[128:131], a[84:87], v[84:87]
    v_mfma_f32_16x16x32_bf16 v[56:59], v[132:135], a[20:23], v[56:59]
    v_mfma_f32_16x16x32_bf16 v[88:91], v[132:135], a[84:87], v[88:91]
    v_mfma_f32_16x16x32_bf16 v[60:63], v[136:139], a[20:23], v[60:63]
    v_mfma_f32_16x16x32_bf16 v[92:95], v[136:139], a[84:87], v[92:95]
    v_mfma_f32_16x16x32_bf16 v[100:103], v[140:143], v[28:31], v[100:103]
    s_waitcnt lgkmcnt(0)
    v_mfma_f32_16x16x32_bf16 v[48:51], v[144:147], a[24:27], v[48:51]
    ds_read_b64_tr_b16 v[104:105], v19 offset:8192
    ds_read_b64_tr_b16 v[106:107], v19 offset:10240
    v_mfma_f32_16x16x32_bf16 v[80:83], v[144:147], a[88:91], v[80:83]
    ds_read_b64_tr_b16 v[108:109], v20 offset:8192
    ds_read_b64_tr_b16 v[110:111], v20 offset:10240
    v_mfma_f32_16x16x32_bf16 v[52:55], v[148:151], a[24:27], v[52:55]
    ds_read_b64_tr_b16 v[112:113], v21 offset:8192
    ds_read_b64_tr_b16 v[114:115], v21 offset:10240
    v_mfma_f32_16x16x32_bf16 v[84:87], v[148:151], a[88:91], v[84:87]
    ds_read_b64_tr_b16 v[116:117], v22 offset:8192
    ds_read_b64_tr_b16 v[118:119], v22 offset:10240
    v_mfma_f32_16x16x32_bf16 v[56:59], v[152:155], a[24:27], v[56:59]
    ds_read_b64_tr_b16 v[120:121], v24 offset:8192
    ds_read_b64_tr_b16 v[122:123], v24 offset:10240
    v_mfma_f32_16x16x32_bf16 v[88:91], v[152:155], a[88:91], v[88:91]
    ds_read_b64_tr_b16 v[124:125], v19 offset:24576
    ds_read_b64_tr_b16 v[126:127], v19 offset:26624
    v_mfma_f32_16x16x32_bf16 v[60:63], v[156:159], a[24:27], v[60:63]
    ds_read_b64_tr_b16 v[128:129], v20 offset:24576
    ds_read_b64_tr_b16 v[130:131], v20 offset:26624
    v_mfma_f32_16x16x32_bf16 v[92:95], v[156:159], a[88:91], v[92:95]
    ds_read_b64_tr_b16 v[132:133], v21 offset:24576
    ds_read_b64_tr_b16 v[134:135], v21 offset:26624
    v_mfma_f32_16x16x32_bf16 v[100:103], v[160:163], v[28:31], v[100:103]
    ds_read_b64_tr_b16 v[136:137], v22 offset:24576
    ds_read_b64_tr_b16 v[138:139], v22 offset:26624
    v_mfma_f32_16x16x32_bf16 v[48:51], v[164:167], a[28:31], v[48:51]
    ds_read_b64_tr_b16 v[140:141], v24 offset:24576
    ds_read_b64_tr_b16 v[142:143], v24 offset:26624
    v_mfma_f32_16x16x32_bf16 v[80:83], v[164:167], a[92:95], v[80:83]
    global_load_dwordx4 a[176:179], v0, s[24:25]
    s_add_u32 s24, s24, 16384
    s_addc_u32 s25, s25, 0
    global_load_dwordx4 a[180:183], v0, s[24:25]
    s_add_u32 s24, s24, 16384
    s_addc_u32 s25, s25, 0
    v_mfma_f32_16x16x32_bf16 v[52:55], v[168:171], a[28:31], v[52:55]
    global_load_dwordx4 a[184:187], v0, s[24:25]
    s_add_u32 s24, s24, 16384
    s_addc_u32 s25, s25, 0
    global_load_dwordx4 a[188:191], v0, s[24:25]
    s_add_u32 s24, s24, 16384
    s_addc_u32 s25, s25, 0
    v_mfma_f32_16x16x32_bf16 v[84:87], v[168:171], a[92:95], v[84:87]
    v_mfma_f32_16x16x32_bf16 v[56:59], v[172:175], a[28:31], v[56:59]
    v_mfma_f32_16x16x32_bf16 v[88:91], v[172:175], a[92:95], v[88:91]
    v_mfma_f32_16x16x32_bf16 v[60:63], v[176:179], a[28:31], v[60:63]
    v_mfma_f32_16x16x32_bf16 v[92:95], v[176:179], a[92:95], v[92:95]
    v_mfma_f32_16x16x32_bf16 v[100:103], v[180:183], v[28:31], v[100:103]
    s_waitcnt lgkmcnt(0)
    v_mfma_f32_16x16x32_bf16 v[48:51], v[104:107], a[32:35], v[48:51]
    ds_read_b64_tr_b16 v[144:145], v19 offset:40960
    ds_read_b64_tr_b16 v[146:147], v19 offset:43008
    v_mfma_f32_16x16x32_bf16 v[80:83], v[104:107], a[96:99], v[80:83]
    ds_read_b64_tr_b16 v[148:149], v20 offset:40960
    ds_read_b64_tr_b16 v[150:151], v20 offset:43008
    v_mfma_f32_16x16x32_bf16 v[52:55], v[108:111], a[32:35], v[52:55]
    ds_read_b64_tr_b16 v[152:153], v21 offset:40960
    ds_read_b64_tr_b16 v[154:155], v21 offset:43008
    v_mfma_f32_16x16x32_bf16 v[84:87], v[108:111], a[96:99], v[84:87]
    ds_read_b64_tr_b16 v[156:157], v22 offset:40960
    ds_read_b64_tr_b16 v[158:159], v22 offset:43008
    v_mfma_f32_16x16x32_bf16 v[56:59], v[112:115], a[32:35], v[56:59]
    ds_read_b64_tr_b16 v[160:161], v24 offset:40960
    ds_read_b64_tr_b16 v[162:163], v24 offset:43008
    v_mfma_f32_16x16x32_bf16 v[88:91], v[112:115], a[96:99], v[88:91]
    ds_read_b64_tr_b16 v[164:165], v19 offset:57344
    ds_read_b64_tr_b16 v[166:167], v19 offset:59392
    v_mfma_f32_16x16x32_bf16 v[60:63], v[116:119], a[32:35], v[60:63]
    ds_read_b64_tr_b16 v[168:169], v20 offset:57344
    ds_read_b64_tr_b16 v[170:171], v20 offset:59392
    v_mfma_f32_16x16x32_bf16 v[92:95], v[116:119], a[96:99], v[92:95]
    ds_read_b64_tr_b16 v[172:173], v21 offset:57344
    ds_read_b64_tr_b16 v[174:175], v21 offset:59392
    v_mfma_f32_16x16x32_bf16 v[100:103], v[120:123], v[28:31], v[100:103]
    ds_read_b64_tr_b16 v[176:177], v22 offset:57344
    ds_read_b64_tr_b16 v[178:179], v22 offset:59392
    v_mfma_f32_16x16x32_bf16 v[48:51], v[124:127], a[36:39], v[48:51]
    ds_read_b64_tr_b16 v[180:181], v24 offset:57344
    ds_read_b64_tr_b16 v[182:183], v24 offset:59392
    v_mfma_f32_16x16x32_bf16 v[80:83], v[124:127], a[100:103], v[80:83]
    global_load_dwordx4 a[192:195], v0, s[24:25]
    s_add_u32 s24, s24, 16384
    s_addc_u32 s25, s25, 0
    global_load_dwordx4 a[196:199], v0, s[24:25]
    s_add_u32 s24, s24, 16384
    s_addc_u32 s25, s25, 0
    v_mfma_f32_16x16x32_bf16 v[52:55], v[128:131], a[36:39], v[52:55]
    global_load_dwordx4 a[200:203], v0, s[24:25]
    s_add_u32 s24, s24, 16384
    s_addc_u32 s25, s25, 0
    global_load_dwordx4 a[204:207], v0, s[24:25]
    s_add_u32 s24, s24, 16384
    s_addc_u32 s25, s25, 0
    v_mfma_f32_16x16x32_bf16 v[84:87], v[128:131], a[100:103], v[84:87]
    v_mfma_f32_16x16x32_bf16 v[56:59], v[132:135], a[36:39], v[56:59]
    v_mfma_f32_16x16x32_bf16 v[88:91], v[132:135], a[100:103], v[88:91]
    v_mfma_f32_16x16x32_bf16 v[60:63], v[136:139], a[36:39], v[60:63]
    v_mfma_f32_16x16x32_bf16 v[92:95], v[136:139], a[100:103], v[92:95]
    v_mfma_f32_16x16x32_bf16 v[100:103], v[140:143], v[28:31], v[100:103]
    s_waitcnt lgkmcnt(0)
    v_mfma_f32_16x16x32_bf16 v[48:51], v[144:147], a[40:43], v[48:51]
    ds_read_b64_tr_b16 v[104:105], v19 offset:12288
    ds_read_b64_tr_b16 v[106:107], v19 offset:14336
    v_mfma_f32_16x16x32_bf16 v[80:83], v[144:147], a[104:107], v[80:83]
    ds_read_b64_tr_b16 v[108:109], v20 offset:12288
    ds_read_b64_tr_b16 v[110:111], v20 offset:14336
    v_mfma_f32_16x16x32_bf16 v[52:55], v[148:151], a[40:43], v[52:55]
    ds_read_b64_tr_b16 v[112:113], v21 offset:12288
    ds_read_b64_tr_b16 v[114:115], v21 offset:14336
    v_mfma_f32_16x16x32_bf16 v[84:87], v[148:151], a[104:107], v[84:87]
    ds_read_b64_tr_b16 v[116:117], v22 offset:12288
    ds_read_b64_tr_b16 v[118:119], v22 offset:14336
    v_mfma_f32_16x16x32_bf16 v[56:59], v[152:155], a[40:43], v[56:59]
    ds_read_b64_tr_b16 v[120:121], v24 offset:12288
    ds_read_b64_tr_b16 v[122:123], v24 offset:14336
    v_mfma_f32_16x16x32_bf16 v[88:91], v[152:155], a[104:107], v[88:91]
    ds_read_b64_tr_b16 v[124:125], v19 offset:28672
    ds_read_b64_tr_b16 v[126:127], v19 offset:30720
    v_mfma_f32_16x16x32_bf16 v[60:63], v[156:159], a[40:43], v[60:63]
    ds_read_b64_tr_b16 v[128:129], v20 offset:28672
    ds_read_b64_tr_b16 v[130:131], v20 offset:30720
    v_mfma_f32_16x16x32_bf16 v[92:95], v[156:159], a[104:107], v[92:95]
    ds_read_b64_tr_b16 v[132:133], v21 offset:28672
    ds_read_b64_tr_b16 v[134:135], v21 offset:30720
    v_mfma_f32_16x16x32_bf16 v[100:103], v[160:163], v[28:31], v[100:103]
    ds_read_b64_tr_b16 v[136:137], v22 offset:28672
    ds_read_b64_tr_b16 v[138:139], v22 offset:30720
    v_mfma_f32_16x16x32_bf16 v[48:51], v[164:167], a[44:47], v[48:51]
    ds_read_b64_tr_b16 v[140:141], v24 offset:28672
    ds_read_b64_tr_b16 v[142:143], v24 offset:30720
    v_mfma_f32_16x16x32_bf16 v[80:83], v[164:167], a[108:111], v[80:83]
    global_load_dwordx4 a[208:211], v0, s[24:25]
    s_add_u32 s24, s24, 16384
    s_addc_u32 s25, s25, 0
    global_load_dwordx4 a[212:215], v0, s[24:25]
    s_add_u32 s24, s24, 16384
    s_addc_u32 s25, s25, 0
    v_mfma_f32_16x16x32_bf16 v[52:55], v[168:171], a[44:47], v[52:55]
    global_load_dwordx4 a[216:219], v0, s[24:25]
    s_add_u32 s24, s24, 16384
    s_addc_u32 s25, s25, 0
    global_load_dwordx4 a[220:223], v0, s[24:25]
    s_add_u32 s24, s24, 16384
    s_addc_u32 s25, s25, 0
    v_mfma_f32_16x16x32_bf16 v[84:87], v[168:171], a[108:111], v[84:87]
    v_mfma_f32_16x16x32_bf16 v[56:59], v[172:175], a[44:47], v[56:59]
    v_mfma_f32_16x16x32_bf16 v[88:91], v[172:175], a[108:111], v[88:91]
    v_mfma_f32_16x16x32_bf16 v[60:63], v[176:179], a[44:47], v[60:63]
    v_mfma_f32_16x16x32_bf16 v[92:95], v[176:179], a[108:111], v[92:95]
    v_mfma_f32_16x16x32_bf16 v[100:103], v[180:183], v[28:31], v[100:103]
    s_waitcnt lgkmcnt(0)
    v_mfma_f32_16x16x32_bf16 v[48:51], v[104:107], a[48:51], v[48:51]
    ds_read_b64_tr_b16 v[144:145], v19 offset:45056
    ds_read_b64_tr_b16 v[146:147], v19 offset:47104
    v_mfma_f32_16x16x32_bf16 v[80:83], v[104:107], a[112:115], v[80:83]
    ds_read_b64_tr_b16 v[148:149], v20 offset:45056
    ds_read_b64_tr_b16 v[150:151], v20 offset:47104
    v_mfma_f32_16x16x32_bf16 v[52:55], v[108:111], a[48:51], v[52:55]
    ds_read_b64_tr_b16 v[152:153], v21 offset:45056
    ds_read_b64_tr_b16 v[154:155], v21 offset:47104
    v_mfma_f32_16x16x32_bf16 v[84:87], v[108:111], a[112:115], v[84:87]
    ds_read_b64_tr_b16 v[156:157], v22 offset:45056
    ds_read_b64_tr_b16 v[158:159], v22 offset:47104
    v_mfma_f32_16x16x32_bf16 v[56:59], v[112:115], a[48:51], v[56:59]
    ds_read_b64_tr_b16 v[160:161], v24 offset:45056
    ds_read_b64_tr_b16 v[162:163], v24 offset:47104
    v_mfma_f32_16x16x32_bf16 v[88:91], v[112:115], a[112:115], v[88:91]
    ds_read_b64_tr_b16 v[164:165], v19 offset:61440
    ds_read_b64_tr_b16 v[166:167], v19 offset:63488
    v_mfma_f32_16x16x32_bf16 v[60:63], v[116:119], a[48:51], v[60:63]
    ds_read_b64_tr_b16 v[168:169], v20 offset:61440
    ds_read_b64_tr_b16 v[170:171], v20 offset:63488
    v_mfma_f32_16x16x32_bf16 v[92:95], v[116:119], a[112:115], v[92:95]
    ds_read_b64_tr_b16 v[172:173], v21 offset:61440
    ds_read_b64_tr_b16 v[174:175], v21 offset:63488
    v_mfma_f32_16x16x32_bf16 v[100:103], v[120:123], v[28:31], v[100:103]
    ds_read_b64_tr_b16 v[176:177], v22 offset:61440
    ds_read_b64_tr_b16 v[178:179], v22 offset:63488
    v_mfma_f32_16x16x32_bf16 v[48:51], v[124:127], a[52:55], v[48:51]
    ds_read_b64_tr_b16 v[180:181], v24 offset:61440
    ds_read_b64_tr_b16 v[182:183], v24 offset:63488
    v_mfma_f32_16x16x32_bf16 v[80:83], v[124:127], a[116:119], v[80:83]
    global_load_dwordx4 a[224:227], v0, s[24:25]
    s_add_u32 s24, s24, 16384
    s_addc_u32 s25, s25, 0
    global_load_dwordx4 a[228:231], v0, s[24:25]
    s_add_u32 s24, s24, 16384
    s_addc_u32 s25, s25, 0
    v_mfma_f32_16x16x32_bf16 v[52:55], v[128:131], a[52:55], v[52:55]
    global_load_dwordx4 a[232:235], v0, s[24:25]
    s_add_u32 s24, s24, 16384
    s_addc_u32 s25, s25, 0
    global_load_dwordx4 a[236:239], v0, s[24:25]
    s_add_u32 s24, s24, 16384
    s_addc_u32 s25, s25, 0
    v_mfma_f32_16x16x32_bf16 v[84:87], v[128:131], a[116:119], v[84:87]
    v_mfma_f32_16x16x32_bf16 v[56:59], v[132:135], a[52:55], v[56:59]
    v_mfma_f32_16x16x32_bf16 v[88:91], v[132:135], a[116:119], v[88:91]
    v_mfma_f32_16x16x32_bf16 v[60:63], v[136:139], a[52:55], v[60:63]
    v_mfma_f32_16x16x32_bf16 v[92:95], v[136:139], a[116:119], v[92:95]
    v_mfma_f32_16x16x32_bf16 v[100:103], v[140:143], v[28:31], v[100:103]
    s_waitcnt lgkmcnt(0)
    v_mfma_f32_16x16x32_bf16 v[48:51], v[144:147], a[56:59], v[48:51]
    global_load_dwordx4 a[240:243], v0, s[24:25]
    s_add_u32 s24, s24, 16384
    s_addc_u32 s25, s25, 0
    global_load_dwordx4 a[244:247], v0, s[24:25]
    s_add_u32 s24, s24, 16384
    s_addc_u32 s25, s25, 0
    v_mfma_f32_16x16x32_bf16 v[80:83], v[144:147], a[120:123], v[80:83]
    global_load_dwordx4 a[248:251], v0, s[24:25]
    s_add_u32 s24, s24, 16384
    s_addc_u32 s25, s25, 0
    global_load_dwordx4 a[252:255], v0, s[24:25]
    s_add_u32 s24, s24, 16384
    s_addc_u32 s25, s25, 0
    v_mfma_f32_16x16x32_bf16 v[52:55], v[148:151], a[56:59], v[52:55]
    v_mfma_f32_16x16x32_bf16 v[84:87], v[148:151], a[120:123], v[84:87]
    v_mfma_f32_16x16x32_bf16 v[56:59], v[152:155], a[56:59], v[56:59]
    v_mfma_f32_16x16x32_bf16 v[88:91], v[152:155], a[120:123], v[88:91]
    v_mfma_f32_16x16x32_bf16 v[60:63], v[156:159], a[56:59], v[60:63]
    v_mfma_f32_16x16x32_bf16 v[92:95], v[156:159], a[120:123], v[92:95]
    v_mfma_f32_16x16x32_bf16 v[100:103], v[160:163], v[28:31], v[100:103]
    v_mfma_f32_16x16x32_bf16 v[48:51], v[164:167], a[60:63], v[48:51]
    v_mfma_f32_16x16x32_bf16 v[80:83], v[164:167], a[124:127], v[80:83]
    v_mfma_f32_16x16x32_bf16 v[52:55], v[168:171], a[60:63], v[52:55]
    v_mfma_f32_16x16x32_bf16 v[84:87], v[168:171], a[124:127], v[84:87]
    v_mfma_f32_16x16x32_bf16 v[56:59], v[172:175], a[60:63], v[56:59]
    v_mfma_f32_16x16x32_bf16 v[88:91], v[172:175], a[124:127], v[88:91]
    v_mfma_f32_16x16x32_bf16 v[60:63], v[176:179], a[60:63], v[60:63]
    v_mfma_f32_16x16x32_bf16 v[92:95], v[176:179], a[124:127], v[92:95]
    v_mfma_f32_16x16x32_bf16 v[100:103], v[180:183], v[28:31], v[100:103]
    s_nop 7
    ds_write_b128 v27, v[100:103] offset:4096
    v_mul_f32 v32, v32, v252
    v_mul_f32 v64, v64, v250
    v_mul_f32 v36, v36, v252
    v_mul_f32 v68, v68, v250
    v_mul_f32 v33, v33, v252
    v_mul_f32 v65, v65, v250
    v_mul_f32 v37, v37, v252
    v_mul_f32 v69, v69, v250
    v_mul_f32 v34, v34, v252
    v_mul_f32 v66, v66, v250
    v_mul_f32 v38, v38, v252
    v_mul_f32 v70, v70, v250
    v_mul_f32 v35, v35, v252
    v_mul_f32 v67, v67, v250
    v_mul_f32 v39, v39, v252
    v_mul_f32 v71, v71, v250
    v_fma_f32 v32, -v184, v253, v32
    v_fma_f32 v64, -v184, v251, v64
    v_fma_f32 v36, -v188, v253, v36
    v_fma_f32 v68, -v188, v251, v68
    v_fma_f32 v33, -v185, v253, v33
    v_fma_f32 v65, -v185, v251, v65
    v_fma_f32 v37, -v189, v253, v37
    v_fma_f32 v69, -v189, v251, v69
    v_fma_f32 v34, -v186, v253, v34
    v_fma_f32 v66, -v186, v251, v66
    v_fma_f32 v38, -v190, v253, v38
    v_fma_f32 v70, -v190, v251, v70
    v_fma_f32 v35, -v187, v253, v35
    v_fma_f32 v67, -v187, v251, v67
    v_fma_f32 v39, -v191, v253, v39
    v_fma_f32 v71, -v191, v251, v71
    v_cvt_pk_bf16_f32 v208, v32, v33
    v_cvt_pk_bf16_f32 v104, v64, v65
    v_cvt_pk_bf16_f32 v210, v36, v37
    v_cvt_pk_bf16_f32 v106, v68, v69
    v_cvt_pk_bf16_f32 v209, v34, v35
    v_cvt_pk_bf16_f32 v105, v66, v67
    v_cvt_pk_bf16_f32 v211, v38, v39
    v_cvt_pk_bf16_f32 v107, v70, v71
    v_mfma_f32_16x16x16_bf16 v[212:215], v[200:201], v[208:209], 0
    v_mfma_f32_16x16x16_bf16 v[108:111], v[200:201], v[104:105], 0
    v_mfma_f32_16x16x16_bf16 v[216:219], v[202:203], v[210:211], 0
    v_mfma_f32_16x16x16_bf16 v[112:115], v[202:203], v[106:107], 0
    s_nop 4
    v_cvt_pk_bf16_f32 v212, 0, v212
    v_cvt_pk_bf16_f32 v108, 0, v108
    v_cvt_pk_bf16_f32 v213, 0, v213
    v_cvt_pk_bf16_f32 v109, 0, v109
    v_cvt_pk_bf16_f32 v214, 0, v214
    v_cvt_pk_bf16_f32 v110, 0, v110
    v_cvt_pk_bf16_f32 v215, 0, v215
    v_cvt_pk_bf16_f32 v111, 0, v111
    v_cvt_pk_bf16_f32 v216, 0, v216
    v_cvt_pk_bf16_f32 v112, 0, v112
    v_cvt_pk_bf16_f32 v217, 0, v217
    v_cvt_pk_bf16_f32 v113, 0, v113
    v_cvt_pk_bf16_f32 v218, 0, v218
    v_cvt_pk_bf16_f32 v114, 0, v114
    v_cvt_pk_bf16_f32 v219, 0, v219
    v_cvt_pk_bf16_f32 v115, 0, v115
    v_max3_f32 v236, v212, v213, v214
    v_max3_f32 v132, v108, v109, v110
    v_max3_f32 v237, -v212, -v213, -v214
    v_max3_f32 v133, -v108, -v109, -v110
    v_max3_f32 v238, v216, v217, v218
    v_max3_f32 v134, v112, v113, v114
    v_max3_f32 v239, -v216, -v217, -v218
    v_max3_f32 v135, -v112, -v113, -v114
    v_max_f32 v236, v236, v215
    v_max_f32 v132, v132, v111
    v_max_f32 v237, v237, -v215
    v_max_f32 v133, v133, -v111
    v_max_f32 v238, v238, v219
    v_max_f32 v134, v134, v115
    v_max_f32 v239, v239, -v219
    v_max_f32 v135, v135, -v115
    v_permlane32_swap_b32 v236, v237
    v_permlane32_swap_b32 v132, v133
    v_permlane32_swap_b32 v238, v239
    v_permlane32_swap_b32 v134, v135
    v_max_f32 v236, v236, v237
    v_max_f32 v132, v132, v133
    v_max_f32 v238, v238, v239
    v_max_f32 v134, v134, v135
    s_nop 0
    v_permlane16_swap_b32 v236, v238
    v_permlane16_swap_b32 v132, v134
    v_max_f32 v236, v236, v238
    v_max_f32 v132, v132, v134
    v_mov_b32 v238, v236
    v_mov_b32 v134, v132
    s_nop 0
    v_permlane16_swap_b32 v236, v238
    v_permlane16_swap_b32 v132, v134
    v_mov_b32 v237, v236
    v_mov_b32 v133, v132
    v_mov_b32 v239, v238
    v_mov_b32 v135, v134
    v_permlane32_swap_b32 v236, v237
    v_permlane32_swap_b32 v132, v133
    v_permlane32_swap_b32 v238, v239
    v_permlane32_swap_b32 v134, v135
    v_mul_f32 v236, v236, v248
    v_mul_f32 v132, v132, v248
    v_mul_f32 v237, v237, v248
    v_mul_f32 v133, v133, v248
    v_mul_f32 v238, v238, v248
    v_mul_f32 v134, v134, v248
    v_mul_f32 v239, v239, v248
    v_mul_f32 v135, v135, v248
    v_fma_f32 v220, v212, v248, -v236
    v_fma_f32 v116, v108, v248, -v132
    v_fma_f32 v224, -v212, v248, -v237
    v_fma_f32 v120, -v108, v248, -v133
    v_fma_f32 v221, v213, v248, -v236
    v_fma_f32 v117, v109, v248, -v132
    v_fma_f32 v225, -v213, v248, -v237
    v_fma_f32 v121, -v109, v248, -v133
    v_fma_f32 v222, v214, v248, -v236
    v_fma_f32 v118, v110, v248, -v132
    v_fma_f32 v226, -v214, v248, -v237
    v_fma_f32 v122, -v110, v248, -v133
    v_fma_f32 v223, v215, v248, -v236
    v_fma_f32 v119, v111, v248, -v132
    v_fma_f32 v227, -v215, v248, -v237
    v_fma_f32 v123, -v111, v248, -v133
    v_fma_f32 v228, v216, v248, -v238
    v_fma_f32 v124, v112, v248, -v134
    v_fma_f32 v232, -v216, v248, -v239
    v_fma_f32 v128, -v112, v248, -v135
    v_fma_f32 v229, v217, v248, -v238
    v_fma_f32 v125, v113, v248, -v134
    v_fma_f32 v233, -v217, v248, -v239
    v_fma_f32 v129, -v113, v248, -v135
    v_fma_f32 v230, v218, v248, -v238
    v_fma_f32 v126, v114, v248, -v134
    v_fma_f32 v234, -v218, v248, -v239
    v_fma_f32 v130, -v114, v248, -v135
    v_fma_f32 v231, v219, v248, -v238
    v_fma_f32 v127, v115, v248, -v134
    v_fma_f32 v235, -v219, v248, -v239
    v_fma_f32 v131, -v115, v248, -v135
    v_exp_f32 v220, v220
    v_exp_f32 v116, v116
    v_exp_f32 v221, v221
    v_exp_f32 v117, v117
    v_exp_f32 v222, v222
    v_exp_f32 v118, v118
    v_exp_f32 v223, v223
    v_exp_f32 v119, v119
    v_exp_f32 v224, v224
    v_exp_f32 v120, v120
    v_exp_f32 v225, v225
    v_exp_f32 v121, v121
    v_exp_f32 v226, v226
    v_exp_f32 v122, v122
    v_exp_f32 v227, v227
    v_exp_f32 v123, v123
    v_exp_f32 v228, v228
    v_exp_f32 v124, v124
    v_exp_f32 v229, v229
    v_exp_f32 v125, v125
    v_exp_f32 v230, v230
    v_exp_f32 v126, v126
    v_exp_f32 v231, v231
    v_exp_f32 v127, v127
    v_exp_f32 v232, v232
    v_exp_f32 v128, v128
    v_exp_f32 v233, v233
    v_exp_f32 v129, v129
    v_exp_f32 v234, v234
    v_exp_f32 v130, v130
    v_exp_f32 v235, v235
    v_exp_f32 v131, v131
    v_add_f32 v236, v220, v221
    v_add_f32 v132, v116, v117
    v_add_f32 v212, v222, v223
    v_add_f32 v108, v118, v119
    v_add_f32 v237, v224, v225
    v_add_f32 v133, v120, v121
    v_add_f32 v213, v226, v227
    v_add_f32 v109, v122, v123
    v_add_f32 v238, v228, v229
    v_add_f32 v134, v124, v125
    v_add_f32 v214, v230, v231
    v_add_f32 v110, v126, v127
    v_add_f32 v239, v232, v233
    v_add_f32 v135, v128, v129
    v_add_f32 v215, v234, v235
    v_add_f32 v111, v130, v131
    v_add_f32 v236, v236, v212
    v_add_f32 v132, v132, v108
    v_add_f32 v237, v237, v213
    v_add_f32 v133, v133, v109
    v_add_f32 v238, v238, v214
    v_add_f32 v134, v134, v110
    v_add_f32 v239, v239, v215
    v_add_f32 v135, v135, v111
    v_permlane32_swap_b32 v236, v237
    v_permlane32_swap_b32 v132, v133
    v_permlane32_swap_b32 v238, v239
    v_permlane32_swap_b32 v134, v135
    v_add_f32 v236, v236, v237
    v_add_f32 v132, v132, v133
    v_add_f32 v238, v238, v239
    v_add_f32 v134, v134, v135
    s_nop 0
    v_permlane16_swap_b32 v236, v238
    v_permlane16_swap_b32 v132, v134
    v_add_f32 v236, v236, v238
    v_add_f32 v132, v132, v134
    v_mov_b32 v238, v236
    v_mov_b32 v134, v132
    s_nop 0
    v_permlane16_swap_b32 v236, v238
    v_permlane16_swap_b32 v132, v134
    v_mov_b32 v237, v236
    v_mov_b32 v133, v132
    v_mov_b32 v239, v238
    v_mov_b32 v135, v134
    v_permlane32_swap_b32 v236, v237
    v_permlane32_swap_b32 v132, v133
    v_permlane32_swap_b32 v238, v239
    v_permlane32_swap_b32 v134, v135
    v_rcp_f32 v236, v236
    v_rcp_f32 v132, v132
    v_rcp_f32 v237, v237
    v_rcp_f32 v133, v133
    v_rcp_f32 v238, v238
    v_rcp_f32 v134, v134
    v_rcp_f32 v239, v239
    v_rcp_f32 v135, v135
    v_pk_mul_f32 v[220:221], v[220:221], v[236:237] op_sel:[0,0] op_sel_hi:[1,0]
    v_pk_mul_f32 v[116:117], v[116:117], v[132:133] op_sel:[0,0] op_sel_hi:[1,0]
    v_pk_mul_f32 v[222:223], v[222:223], v[236:237] op_sel:[0,0] op_sel_hi:[1,0]
    v_pk_mul_f32 v[118:119], v[118:119], v[132:133] op_sel:[0,0] op_sel_hi:[1,0]
    v_pk_mul_f32 v[224:225], v[224:225], v[236:237] op_sel:[0,1] op_sel_hi:[1,1]
    v_pk_mul_f32 v[120:121], v[120:121], v[132:133] op_sel:[0,1] op_sel_hi:[1,1]
    v_pk_mul_f32 v[226:227], v[226:227], v[236:237] op_sel:[0,1] op_sel_hi:[1,1]
    v_pk_mul_f32 v[122:123], v[122:123], v[132:133] op_sel:[0,1] op_sel_hi:[1,1]
    v_pk_mul_f32 v[228:229], v[228:229], v[238:239] op_sel:[0,0] op_sel_hi:[1,0]
    v_pk_mul_f32 v[124:125], v[124:125], v[134:135] op_sel:[0,0] op_sel_hi:[1,0]
    v_pk_mul_f32 v[230:231], v[230:231], v[238:239] op_sel:[0,0] op_sel_hi:[1,0]
    v_pk_mul_f32 v[126:127], v[126:127], v[134:135] op_sel:[0,0] op_sel_hi:[1,0]
    v_pk_mul_f32 v[232:233], v[232:233], v[238:239] op_sel:[0,1] op_sel_hi:[1,1]
    v_pk_mul_f32 v[128:129], v[128:129], v[134:135] op_sel:[0,1] op_sel_hi:[1,1]
    v_pk_mul_f32 v[234:235], v[234:235], v[238:239] op_sel:[0,1] op_sel_hi:[1,1]
    v_pk_mul_f32 v[130:131], v[130:131], v[134:135] op_sel:[0,1] op_sel_hi:[1,1]
    v_cvt_pk_bf16_f32 v240, v220, v221
    v_cvt_pk_bf16_f32 v136, v116, v117
    v_cvt_pk_bf16_f32 v241, v222, v223
    v_cvt_pk_bf16_f32 v137, v118, v119
    v_cvt_pk_bf16_f32 v242, v224, v225
    v_cvt_pk_bf16_f32 v138, v120, v121
    v_cvt_pk_bf16_f32 v243, v226, v227
    v_cvt_pk_bf16_f32 v139, v122, v123
    v_cvt_pk_bf16_f32 v244, v228, v229
    v_cvt_pk_bf16_f32 v140, v124, v125
    v_cvt_pk_bf16_f32 v245, v230, v231
    v_cvt_pk_bf16_f32 v141, v126, v127
    v_cvt_pk_bf16_f32 v246, v232, v233
    v_cvt_pk_bf16_f32 v142, v128, v129
    v_cvt_pk_bf16_f32 v247, v234, v235
    v_cvt_pk_bf16_f32 v143, v130, v131
    ds_write_b64 v11, v[240:241] offset:0
    ds_write_b64 v11, v[136:137] offset:512
    ds_write_b64 v11, v[242:243] offset:4096
    ds_write_b64 v11, v[138:139] offset:4608
    ds_write_b64 v11, v[244:245] offset:12288
    ds_write_b64 v11, v[140:141] offset:12800
    ds_write_b64 v11, v[246:247] offset:16384
    ds_write_b64 v11, v[142:143] offset:16896
    v_mul_f32 v40, v40, v252
    v_mul_f32 v72, v72, v250
    v_mul_f32 v44, v44, v252
    v_mul_f32 v76, v76, v250
    v_mul_f32 v41, v41, v252
    v_mul_f32 v73, v73, v250
    v_mul_f32 v45, v45, v252
    v_mul_f32 v77, v77, v250
    v_mul_f32 v42, v42, v252
    v_mul_f32 v74, v74, v250
    v_mul_f32 v46, v46, v252
    v_mul_f32 v78, v78, v250
    v_mul_f32 v43, v43, v252
    v_mul_f32 v75, v75, v250
    v_mul_f32 v47, v47, v252
    v_mul_f32 v79, v79, v250
    v_fma_f32 v40, -v192, v253, v40
    v_fma_f32 v72, -v192, v251, v72
    v_fma_f32 v44, -v196, v253, v44
    v_fma_f32 v76, -v196, v251, v76
    v_fma_f32 v41, -v193, v253, v41
    v_fma_f32 v73, -v193, v251, v73
    v_fma_f32 v45, -v197, v253, v45
    v_fma_f32 v77, -v197, v251, v77
    v_fma_f32 v42, -v194, v253, v42
    v_fma_f32 v74, -v194, v251, v74
    v_fma_f32 v46, -v198, v253, v46
    v_fma_f32 v78, -v198, v251, v78
    v_fma_f32 v43, -v195, v253, v43
    v_fma_f32 v75, -v195, v251, v75
    v_fma_f32 v47, -v199, v253, v47
    v_fma_f32 v79, -v199, v251, v79
    v_cvt_pk_bf16_f32 v208, v40, v41
    v_cvt_pk_bf16_f32 v104, v72, v73
    v_cvt_pk_bf16_f32 v210, v44, v45
    v_cvt_pk_bf16_f32 v106, v76, v77
    v_cvt_pk_bf16_f32 v209, v42, v43
    v_cvt_pk_bf16_f32 v105, v74, v75
    v_cvt_pk_bf16_f32 v211, v46, v47
    v_cvt_pk_bf16_f32 v107, v78, v79
    v_mfma_f32_16x16x16_bf16 v[212:215], v[204:205], v[208:209], 0
    v_mfma_f32_16x16x16_bf16 v[108:111], v[204:205], v[104:105], 0
    v_mfma_f32_16x16x16_bf16 v[216:219], v[206:207], v[210:211], 0
    v_mfma_f32_16x16x16_bf16 v[112:115], v[206:207], v[106:107], 0
    s_nop 4
    v_cvt_pk_bf16_f32 v212, 0, v212
    v_cvt_pk_bf16_f32 v108, 0, v108
    v_cvt_pk_bf16_f32 v213, 0, v213
    v_cvt_pk_bf16_f32 v109, 0, v109
    v_cvt_pk_bf16_f32 v214, 0, v214
    v_cvt_pk_bf16_f32 v110, 0, v110
    v_cvt_pk_bf16_f32 v215, 0, v215
    v_cvt_pk_bf16_f32 v111, 0, v111
    v_cvt_pk_bf16_f32 v216, 0, v216
    v_cvt_pk_bf16_f32 v112, 0, v112
    v_cvt_pk_bf16_f32 v217, 0, v217
    v_cvt_pk_bf16_f32 v113, 0, v113
    v_cvt_pk_bf16_f32 v218, 0, v218
    v_cvt_pk_bf16_f32 v114, 0, v114
    v_cvt_pk_bf16_f32 v219, 0, v219
    v_cvt_pk_bf16_f32 v115, 0, v115
    v_max3_f32 v236, v212, v213, v214
    v_max3_f32 v132, v108, v109, v110
    v_max3_f32 v237, -v212, -v213, -v214
    v_max3_f32 v133, -v108, -v109, -v110
    v_max3_f32 v238, v216, v217, v218
    v_max3_f32 v134, v112, v113, v114
    v_max3_f32 v239, -v216, -v217, -v218
    v_max3_f32 v135, -v112, -v113, -v114
    v_max_f32 v236, v236, v215
    v_max_f32 v132, v132, v111
    v_max_f32 v237, v237, -v215
    v_max_f32 v133, v133, -v111
    v_max_f32 v238, v238, v219
    v_max_f32 v134, v134, v115
    v_max_f32 v239, v239, -v219
    v_max_f32 v135, v135, -v115
    v_permlane32_swap_b32 v236, v237
    v_permlane32_swap_b32 v132, v133
    v_permlane32_swap_b32 v238, v239
    v_permlane32_swap_b32 v134, v135
    v_max_f32 v236, v236, v237
    v_max_f32 v132, v132, v133
    v_max_f32 v238, v238, v239
    v_max_f32 v134, v134, v135
    s_nop 0
    v_permlane16_swap_b32 v236, v238
    v_permlane16_swap_b32 v132, v134
    v_max_f32 v236, v236, v238
    v_max_f32 v132, v132, v134
    v_mov_b32 v238, v236
    v_mov_b32 v134, v132
    s_nop 0
    v_permlane16_swap_b32 v236, v238
    v_permlane16_swap_b32 v132, v134
    v_mov_b32 v237, v236
    v_mov_b32 v133, v132
    v_mov_b32 v239, v238
    v_mov_b32 v135, v134
    v_permlane32_swap_b32 v236, v237
    v_permlane32_swap_b32 v132, v133
    v_permlane32_swap_b32 v238, v239
    v_permlane32_swap_b32 v134, v135
    v_mul_f32 v236, v236, v248
    v_mul_f32 v132, v132, v248
    v_mul_f32 v237, v237, v248
    v_mul_f32 v133, v133, v248
    v_mul_f32 v238, v238, v248
    v_mul_f32 v134, v134, v248
    v_mul_f32 v239, v239, v248
    v_mul_f32 v135, v135, v248
    v_fma_f32 v220, v212, v248, -v236
    v_fma_f32 v116, v108, v248, -v132
    v_fma_f32 v224, -v212, v248, -v237
    v_fma_f32 v120, -v108, v248, -v133
    v_fma_f32 v221, v213, v248, -v236
    v_fma_f32 v117, v109, v248, -v132
    v_fma_f32 v225, -v213, v248, -v237
    v_fma_f32 v121, -v109, v248, -v133
    v_fma_f32 v222, v214, v248, -v236
    v_fma_f32 v118, v110, v248, -v132
    v_fma_f32 v226, -v214, v248, -v237
    v_fma_f32 v122, -v110, v248, -v133
    v_fma_f32 v223, v215, v248, -v236
    v_fma_f32 v119, v111, v248, -v132
    v_fma_f32 v227, -v215, v248, -v237
    v_fma_f32 v123, -v111, v248, -v133
    v_fma_f32 v228, v216, v248, -v238
    v_fma_f32 v124, v112, v248, -v134
    v_fma_f32 v232, -v216, v248, -v239
    v_fma_f32 v128, -v112, v248, -v135
    v_fma_f32 v229, v217, v248, -v238
    v_fma_f32 v125, v113, v248, -v134
    v_fma_f32 v233, -v217, v248, -v239
    v_fma_f32 v129, -v113, v248, -v135
    v_fma_f32 v230, v218, v248, -v238
    v_fma_f32 v126, v114, v248, -v134
    v_fma_f32 v234, -v218, v248, -v239
    v_fma_f32 v130, -v114, v248, -v135
    v_fma_f32 v231, v219, v248, -v238
    v_fma_f32 v127, v115, v248, -v134
    v_fma_f32 v235, -v219, v248, -v239
    v_fma_f32 v131, -v115, v248, -v135
    v_exp_f32 v220, v220
    v_exp_f32 v116, v116
    v_exp_f32 v221, v221
    v_exp_f32 v117, v117
    v_exp_f32 v222, v222
    v_exp_f32 v118, v118
    v_exp_f32 v223, v223
    v_exp_f32 v119, v119
    v_exp_f32 v224, v224
    v_exp_f32 v120, v120
    v_exp_f32 v225, v225
    v_exp_f32 v121, v121
    v_exp_f32 v226, v226
    v_exp_f32 v122, v122
    v_exp_f32 v227, v227
    v_exp_f32 v123, v123
    v_exp_f32 v228, v228
    v_exp_f32 v124, v124
    v_exp_f32 v229, v229
    v_exp_f32 v125, v125
    v_exp_f32 v230, v230
    v_exp_f32 v126, v126
    v_exp_f32 v231, v231
    v_exp_f32 v127, v127
    v_exp_f32 v232, v232
    v_exp_f32 v128, v128
    v_exp_f32 v233, v233
    v_exp_f32 v129, v129
    v_exp_f32 v234, v234
    v_exp_f32 v130, v130
    v_exp_f32 v235, v235
    v_exp_f32 v131, v131
    v_add_f32 v236, v220, v221
    v_add_f32 v132, v116, v117
    v_add_f32 v212, v222, v223
    v_add_f32 v108, v118, v119
    v_add_f32 v237, v224, v225
    v_add_f32 v133, v120, v121
    v_add_f32 v213, v226, v227
    v_add_f32 v109, v122, v123
    v_add_f32 v238, v228, v229
    v_add_f32 v134, v124, v125
    v_add_f32 v214, v230, v231
    v_add_f32 v110, v126, v127
    v_add_f32 v239, v232, v233
    v_add_f32 v135, v128, v129
    v_add_f32 v215, v234, v235
    v_add_f32 v111, v130, v131
    v_add_f32 v236, v236, v212
    v_add_f32 v132, v132, v108
    v_add_f32 v237, v237, v213
    v_add_f32 v133, v133, v109
    v_add_f32 v238, v238, v214
    v_add_f32 v134, v134, v110
    v_add_f32 v239, v239, v215
    v_add_f32 v135, v135, v111
    v_permlane32_swap_b32 v236, v237
    v_permlane32_swap_b32 v132, v133
    v_permlane32_swap_b32 v238, v239
    v_permlane32_swap_b32 v134, v135
    v_add_f32 v236, v236, v237
    v_add_f32 v132, v132, v133
    v_add_f32 v238, v238, v239
    v_add_f32 v134, v134, v135
    s_nop 0
    v_permlane16_swap_b32 v236, v238
    v_permlane16_swap_b32 v132, v134
    v_add_f32 v236, v236, v238
    v_add_f32 v132, v132, v134
    v_mov_b32 v238, v236
    v_mov_b32 v134, v132
    s_nop 0
    v_permlane16_swap_b32 v236, v238
    v_permlane16_swap_b32 v132, v134
    v_mov_b32 v237, v236
    v_mov_b32 v133, v132
    v_mov_b32 v239, v238
    v_mov_b32 v135, v134
    v_permlane32_swap_b32 v236, v237
    v_permlane32_swap_b32 v132, v133
    v_permlane32_swap_b32 v238, v239
    v_permlane32_swap_b32 v134, v135
    v_rcp_f32 v236, v236
    v_rcp_f32 v132, v132
    v_rcp_f32 v237, v237
    v_rcp_f32 v133, v133
    v_rcp_f32 v238, v238
    v_rcp_f32 v134, v134
    v_rcp_f32 v239, v239
    v_rcp_f32 v135, v135
    v_pk_mul_f32 v[220:221], v[220:221], v[236:237] op_sel:[0,0] op_sel_hi:[1,0]
    v_pk_mul_f32 v[116:117], v[116:117], v[132:133] op_sel:[0,0] op_sel_hi:[1,0]
    v_pk_mul_f32 v[222:223], v[222:223], v[236:237] op_sel:[0,0] op_sel_hi:[1,0]
    v_pk_mul_f32 v[118:119], v[118:119], v[132:133] op_sel:[0,0] op_sel_hi:[1,0]
    v_pk_mul_f32 v[224:225], v[224:225], v[236:237] op_sel:[0,1] op_sel_hi:[1,1]
    v_pk_mul_f32 v[120:121], v[120:121], v[132:133] op_sel:[0,1] op_sel_hi:[1,1]
    v_pk_mul_f32 v[226:227], v[226:227], v[236:237] op_sel:[0,1] op_sel_hi:[1,1]
    v_pk_mul_f32 v[122:123], v[122:123], v[132:133] op_sel:[0,1] op_sel_hi:[1,1]
    v_pk_mul_f32 v[228:229], v[228:229], v[238:239] op_sel:[0,0] op_sel_hi:[1,0]
    v_pk_mul_f32 v[124:125], v[124:125], v[134:135] op_sel:[0,0] op_sel_hi:[1,0]
    v_pk_mul_f32 v[230:231], v[230:231], v[238:239] op_sel:[0,0] op_sel_hi:[1,0]
    v_pk_mul_f32 v[126:127], v[126:127], v[134:135] op_sel:[0,0] op_sel_hi:[1,0]
    v_pk_mul_f32 v[232:233], v[232:233], v[238:239] op_sel:[0,1] op_sel_hi:[1,1]
    v_pk_mul_f32 v[128:129], v[128:129], v[134:135] op_sel:[0,1] op_sel_hi:[1,1]
    v_pk_mul_f32 v[234:235], v[234:235], v[238:239] op_sel:[0,1] op_sel_hi:[1,1]
    v_pk_mul_f32 v[130:131], v[130:131], v[134:135] op_sel:[0,1] op_sel_hi:[1,1]
    v_cvt_pk_bf16_f32 v240, v220, v221
    v_cvt_pk_bf16_f32 v136, v116, v117
    v_cvt_pk_bf16_f32 v241, v222, v223
    v_cvt_pk_bf16_f32 v137, v118, v119
    v_cvt_pk_bf16_f32 v242, v224, v225
    v_cvt_pk_bf16_f32 v138, v120, v121
    v_cvt_pk_bf16_f32 v243, v226, v227
    v_cvt_pk_bf16_f32 v139, v122, v123
    v_cvt_pk_bf16_f32 v244, v228, v229
    v_cvt_pk_bf16_f32 v140, v124, v125
    v_cvt_pk_bf16_f32 v245, v230, v231
    v_cvt_pk_bf16_f32 v141, v126, v127
    v_cvt_pk_bf16_f32 v246, v232, v233
    v_cvt_pk_bf16_f32 v142, v128, v129
    v_cvt_pk_bf16_f32 v247, v234, v235
    v_cvt_pk_bf16_f32 v143, v130, v131
    ds_write_b64 v11, v[240:241] offset:24576
    ds_write_b64 v11, v[136:137] offset:25088
    ds_write_b64 v11, v[242:243] offset:28672
    ds_write_b64 v11, v[138:139] offset:29184
    ds_write_b64 v11, v[244:245] offset:36864
    ds_write_b64 v11, v[140:141] offset:37376
    ds_write_b64 v11, v[246:247] offset:40960
    ds_write_b64 v11, v[142:143] offset:41472
    s_waitcnt lgkmcnt(0)
    s_barrier
    ds_read_b128 v[184:187], v26 offset:4096
    ds_read_b128 v[188:191], v26 offset:5120
    ds_read_b128 v[192:195], v26 offset:6144
    ds_read_b128 v[196:199], v26 offset:7168
    s_lshl_b32 s10, s59, 2
    s_add_u32 s10, s10, 64
    v_mov_b32 v12, s10
    global_load_dword v254, v12, s[36:37] sc1
    s_waitcnt lgkmcnt(0)
    v_mul_f32 v48, v48, v252
    v_mul_f32 v52, v52, v252
    v_mul_f32 v56, v56, v252
    v_mul_f32 v60, v60, v252
    v_mul_f32 v49, v49, v252
    v_mul_f32 v53, v53, v252
    v_mul_f32 v57, v57, v252
    v_mul_f32 v61, v61, v252
    v_mul_f32 v50, v50, v252
    v_mul_f32 v54, v54, v252
    v_mul_f32 v58, v58, v252
    v_mul_f32 v62, v62, v252
    v_mul_f32 v51, v51, v252
    v_mul_f32 v55, v55, v252
    v_mul_f32 v59, v59, v252
    v_mul_f32 v63, v63, v252
    v_fma_f32 v48, -v184, v253, v48
    v_fma_f32 v52, -v188, v253, v52
    v_fma_f32 v56, -v192, v253, v56
    v_fma_f32 v60, -v196, v253, v60
    v_fma_f32 v49, -v185, v253, v49
    v_fma_f32 v53, -v189, v253, v53
    v_fma_f32 v57, -v193, v253, v57
    v_fma_f32 v61, -v197, v253, v61
    v_fma_f32 v50, -v186, v253, v50
    v_fma_f32 v54, -v190, v253, v54
    v_fma_f32 v58, -v194, v253, v58
    v_fma_f32 v62, -v198, v253, v62
    v_fma_f32 v51, -v187, v253, v51
    v_fma_f32 v55, -v191, v253, v55
    v_fma_f32 v59, -v195, v253, v59
    v_fma_f32 v63, -v199, v253, v63
    v_cvt_pk_bf16_f32 v220, v48, v49
    v_cvt_pk_bf16_f32 v222, v52, v53
    v_cvt_pk_bf16_f32 v224, v56, v57
    v_cvt_pk_bf16_f32 v226, v60, v61
    v_cvt_pk_bf16_f32 v221, v50, v51
    v_cvt_pk_bf16_f32 v223, v54, v55
    v_cvt_pk_bf16_f32 v225, v58, v59
    v_cvt_pk_bf16_f32 v227, v62, v63
    ds_write_b64 v11, v[220:221] offset:8192
    ds_write_b64 v11, v[222:223] offset:20480
    ds_write_b64 v11, v[224:225] offset:32768
    ds_write_b64 v11, v[226:227] offset:45056
    v_mul_f32 v80, v80, v250
    v_mul_f32 v84, v84, v250
    v_mul_f32 v88, v88, v250
    v_mul_f32 v92, v92, v250
    v_mul_f32 v81, v81, v250
    v_mul_f32 v85, v85, v250
    v_mul_f32 v89, v89, v250
    v_mul_f32 v93, v93, v250
    v_mul_f32 v82, v82, v250
    v_mul_f32 v86, v86, v250
    v_mul_f32 v90, v90, v250
    v_mul_f32 v94, v94, v250
    v_mul_f32 v83, v83, v250
    v_mul_f32 v87, v87, v250
    v_mul_f32 v91, v91, v250
    v_mul_f32 v95, v95, v250
    v_fma_f32 v80, -v184, v251, v80
    v_fma_f32 v84, -v188, v251, v84
    v_fma_f32 v88, -v192, v251, v88
    v_fma_f32 v92, -v196, v251, v92
    v_fma_f32 v81, -v185, v251, v81
    v_fma_f32 v85, -v189, v251, v85
    v_fma_f32 v89, -v193, v251, v89
    v_fma_f32 v93, -v197, v251, v93
    v_fma_f32 v82, -v186, v251, v82
    v_fma_f32 v86, -v190, v251, v86
    v_fma_f32 v90, -v194, v251, v90
    v_fma_f32 v94, -v198, v251, v94
    v_fma_f32 v83, -v187, v251, v83
    v_fma_f32 v87, -v191, v251, v87
    v_fma_f32 v91, -v195, v251, v91
    v_fma_f32 v95, -v199, v251, v95
    v_cvt_pk_bf16_f32 v228, v80, v81
    v_cvt_pk_bf16_f32 v230, v84, v85
    v_cvt_pk_bf16_f32 v232, v88, v89
    v_cvt_pk_bf16_f32 v234, v92, v93
    v_cvt_pk_bf16_f32 v229, v82, v83
    v_cvt_pk_bf16_f32 v231, v86, v87
    v_cvt_pk_bf16_f32 v233, v90, v91
    v_cvt_pk_bf16_f32 v235, v94, v95
    ds_write_b64 v11, v[228:229] offset:8704
    ds_write_b64 v11, v[230:231] offset:20992
    ds_write_b64 v11, v[232:233] offset:33280
    ds_write_b64 v11, v[234:235] offset:45568
    s_waitcnt lgkmcnt(0)
    s_barrier
    s_mul_i32 s12, s3, 12288
    v_lshlrev_b32 v24, 5, v8
    v_lshl_add_u32 v24, v7, 3, v24
    v_add_u32 v24, s12, v24
    ds_read_b64_tr_b16 v[104:105], v24 offset:0
    ds_read_b64_tr_b16 v[120:121], v24 offset:4096
    ds_read_b64_tr_b16 v[136:137], v24 offset:8192
    ds_read_b64_tr_b16 v[106:107], v24 offset:512
    ds_read_b64_tr_b16 v[122:123], v24 offset:4608
    ds_read_b64_tr_b16 v[138:139], v24 offset:8704
    ds_read_b64_tr_b16 v[108:109], v24 offset:1024
    ds_read_b64_tr_b16 v[124:125], v24 offset:5120
    ds_read_b64_tr_b16 v[140:141], v24 offset:9216
    ds_read_b64_tr_b16 v[110:111], v24 offset:1536
    ds_read_b64_tr_b16 v[126:127], v24 offset:5632
    ds_read_b64_tr_b16 v[142:143], v24 offset:9728
    ds_read_b64_tr_b16 v[112:113], v24 offset:2048
    ds_read_b64_tr_b16 v[128:129], v24 offset:6144
    ds_read_b64_tr_b16 v[144:145], v24 offset:10240
    ds_read_b64_tr_b16 v[114:115], v24 offset:2560
    ds_read_b64_tr_b16 v[130:131], v24 offset:6656
    ds_read_b64_tr_b16 v[146:147], v24 offset:10752
    ds_read_b64_tr_b16 v[116:117], v24 offset:3072
    ds_read_b64_tr_b16 v[132:133], v24 offset:7168
    ds_read_b64_tr_b16 v[148:149], v24 offset:11264
    ds_read_b64_tr_b16 v[118:119], v24 offset:3584
    ds_read_b64_tr_b16 v[134:135], v24 offset:7680
    ds_read_b64_tr_b16 v[150:151], v24 offset:11776
    s_lshl_b32 s10, s59, 2
    s_add_u32 s10, s10, s3
    s_lshl_b32 s14, s10, 11
    s_add_u32 s14, s14, 17825792
    s_add_u32 s54, s38, s14
    s_addc_u32 s55, s39, 0
    s_lshl_b32 s14, s10, 7
    s_add_u32 s14, s14, 17891328
    s_add_u32 s56, s38, s14
    s_addc_u32 s57, s39, 0
    v_lshlrev_b32 v25, 2, v1
    s_waitcnt lgkmcnt(0)
    s_barrier
    v_mfma_f32_16x16x32_bf16 v[32:35], v[104:107], v[136:139], 0
    v_mfma_f32_16x16x32_bf16 v[40:43], v[28:31], v[104:107], 0
    v_mfma_f32_16x16x32_bf16 v[36:39], v[120:123], v[136:139], 0
    v_mfma_f32_16x16x32_bf16 v[44:47], v[28:31], v[120:123], 0
    v_mfma_f32_16x16x32_bf16 v[32:35], v[108:111], v[140:143], v[32:35]
    v_mfma_f32_16x16x32_bf16 v[40:43], v[28:31], v[108:111], v[40:43]
    v_mfma_f32_16x16x32_bf16 v[36:39], v[124:127], v[140:143], v[36:39]
    v_mfma_f32_16x16x32_bf16 v[44:47], v[28:31], v[124:127], v[44:47]
    v_mfma_f32_16x16x32_bf16 v[32:35], v[112:115], v[144:147], v[32:35]
    v_mfma_f32_16x16x32_bf16 v[40:43], v[28:31], v[112:115], v[40:43]
    v_mfma_f32_16x16x32_bf16 v[36:39], v[128:131], v[144:147], v[36:39]
    v_mfma_f32_16x16x32_bf16 v[44:47], v[28:31], v[128:131], v[44:47]
    v_mfma_f32_16x16x32_bf16 v[32:35], v[116:119], v[148:151], v[32:35]
    v_mfma_f32_16x16x32_bf16 v[40:43], v[28:31], v[116:119], v[40:43]
    v_mfma_f32_16x16x32_bf16 v[36:39], v[132:135], v[148:151], v[36:39]
    v_mfma_f32_16x16x32_bf16 v[44:47], v[28:31], v[132:135], v[44:47]
    s_mov_b32 s15, 0
poll_interleave_layers__linear_kernel_hedgehog__mixer_channel_mlp__prompt_kernel_16:
    s_waitcnt vmcnt(0)
    v_readfirstlane_b32 s14, v254
    s_cmp_ge_u32 s14, 4
    s_cbranch_scc1 pollok_interleave_layers__linear_kernel_hedgehog__mixer_channel_mlp__prompt_kernel_17
    global_load_dword v254, v12, s[36:37] sc1
    s_sleep 1
    s_add_u32 s15, s15, 1
    s_cmp_lt_u32 s15, 400000
    s_cbranch_scc1 poll_interleave_layers__linear_kernel_hedgehog__mixer_channel_mlp__prompt_kernel_16
pollok_interleave_layers__linear_kernel_hedgehog__mixer_channel_mlp__prompt_kernel_17:
    s_nop 15
    s_nop 3
    global_atomic_add_f32 v25, v32, s[54:55] offset:0
    global_atomic_add_f32 v25, v33, s[54:55] offset:256
    global_atomic_add_f32 v25, v34, s[54:55] offset:512
    global_atomic_add_f32 v25, v35, s[54:55] offset:768
    global_atomic_add_f32 v25, v36, s[54:55] offset:1024
    global_atomic_add_f32 v25, v37, s[54:55] offset:1280
    global_atomic_add_f32 v25, v38, s[54:55] offset:1536
    global_atomic_add_f32 v25, v39, s[54:55] offset:1792
    s_mov_b64 exec, 0xffff
    global_atomic_add_f32 v25, v40, s[56:57]
    global_atomic_add_f32 v25, v44, s[56:57] offset:64
    s_mov_b64 exec, -1
    s_waitcnt vmcnt(0)
    s_branch p1d_interleave_layers__linear_kernel_hedgehog__mixer_channel_mlp__prompt_kernel_15
p1q_interleave_layers__linear_kernel_hedgehog__mixer_channel_mlp__prompt_kernel_14:
    s_nop 15
    s_nop 3
    s_and_b32 s10, s59, 7
    s_lshr_b32 s10, s10, 1
    s_cmp_lg_u32 s10, s3
    s_cbranch_scc1 xf_interleave_layers__linear_kernel_hedgehog__mixer_channel_mlp__prompt_kernel_18
    v_lshlrev_b32 v224, 1, v4
    v_and_b32 v224, 3, v224
    v_lshl_add_u32 v224, v224, 4, v3
    v_lshlrev_b32 v224, 4, v224
    v_lshrrev_b32 v225, 1, v4
    v_lshl_add_u32 v224, v225, 3, v224
    v_add_u32 v225, 4096, v224
    v_add_u32 v226, 8192, v224
    v_add_u32 v227, 12288, v224
    s_and_b32 s10, s59, 1
    s_add_u32 s11, s45, s10
    s_lshl_b32 s11, s11, 14
    s_add_u32 s11, s11, 0
    s_add_u32 s56, s38, s11
    s_addc_u32 s57, s39, 0
    s_cmp_eq_u32 s10, 1
    s_cbranch_scc1 xi_interleave_layers__linear_kernel_hedgehog__mixer_channel_mlp__prompt_kernel_19
    global_store_dwordx2 v224, a[0:1], s[56:57] offset:0 sc1
    global_store_dwordx2 v224, a[2:3], s[56:57] offset:256 sc1
    global_store_dwordx2 v224, a[4:5], s[56:57] offset:1024 sc1
    global_store_dwordx2 v224, a[6:7], s[56:57] offset:1280 sc1
    global_store_dwordx2 v224, a[8:9], s[56:57] offset:2048 sc1
    global_store_dwordx2 v224, a[10:11], s[56:57] offset:2304 sc1
    global_store_dwordx2 v224, a[12:13], s[56:57] offset:3072 sc1
    global_store_dwordx2 v224, a[14:15], s[56:57] offset:3328 sc1
    global_store_dwordx2 v225, a[16:17], s[56:57] offset:0 sc1
    global_store_dwordx2 v225, a[18:19], s[56:57] offset:256 sc1
    global_store_dwordx2 v225, a[20:21], s[56:57] offset:1024 sc1
    global_store_dwordx2 v225, a[22:23], s[56:57] offset:1280 sc1
    global_store_dwordx2 v225, a[24:25], s[56:57] offset:2048 sc1
    global_store_dwordx2 v225, a[26:27], s[56:57] offset:2304 sc1
    global_store_dwordx2 v225, a[28:29], s[56:57] offset:3072 sc1
    global_store_dwordx2 v225, a[30:31], s[56:57] offset:3328 sc1
    global_store_dwordx2 v226, a[32:33], s[56:57] offset:0 sc1
    global_store_dwordx2 v226, a[34:35], s[56:57] offset:256 sc1
    global_store_dwordx2 v226, a[36:37], s[56:57] offset:1024 sc1
    global_store_dwordx2 v226, a[38:39], s[56:57] offset:1280 sc1
    global_store_dwordx2 v226, a[40:41], s[56:57] offset:2048 sc1
    global_store_dwordx2 v226, a[42:43], s[56:57] offset:2304 sc1
    global_store_dwordx2 v226, a[44:45], s[56:57] offset:3072 sc1
    global_store_dwordx2 v226, a[46:47], s[56:57] offset:3328 sc1
    global_store_dwordx2 v227, a[48:49], s[56:57] offset:0 sc1
    global_store_dwordx2 v227, a[50:51], s[56:57] offset:256 sc1
    global_store_dwordx2 v227, a[52:53], s[56:57] offset:1024 sc1
    global_store_dwordx2 v227, a[54:55], s[56:57] offset:1280 sc1
    global_store_dwordx2 v227, a[56:57], s[56:57] offset:2048 sc1
    global_store_dwordx2 v227, a[58:59], s[56:57] offset:2304 sc1
    global_store_dwordx2 v227, a[60:61], s[56:57] offset:3072 sc1
    global_store_dwordx2 v227, a[62:63], s[56:57] offset:3328 sc1
    s_branch xe_interleave_layers__linear_kernel_hedgehog__mixer_channel_mlp__prompt_kernel_20
xi_interleave_layers__linear_kernel_hedgehog__mixer_channel_mlp__prompt_kernel_19:
    global_store_dwordx2 v224, a[64:65], s[56:57] offset:0 sc1
    global_store_dwordx2 v224, a[66:67], s[56:57] offset:256 sc1
    global_store_dwordx2 v224, a[68:69], s[56:57] offset:1024 sc1
    global_store_dwordx2 v224, a[70:71], s[56:57] offset:1280 sc1
    global_store_dwordx2 v224, a[72:73], s[56:57] offset:2048 sc1
    global_store_dwordx2 v224, a[74:75], s[56:57] offset:2304 sc1
    global_store_dwordx2 v224, a[76:77], s[56:57] offset:3072 sc1
    global_store_dwordx2 v224, a[78:79], s[56:57] offset:3328 sc1
    global_store_dwordx2 v225, a[80:81], s[56:57] offset:0 sc1
    global_store_dwordx2 v225, a[82:83], s[56:57] offset:256 sc1
    global_store_dwordx2 v225, a[84:85], s[56:57] offset:1024 sc1
    global_store_dwordx2 v225, a[86:87], s[56:57] offset:1280 sc1
    global_store_dwordx2 v225, a[88:89], s[56:57] offset:2048 sc1
    global_store_dwordx2 v225, a[90:91], s[56:57] offset:2304 sc1
    global_store_dwordx2 v225, a[92:93], s[56:57] offset:3072 sc1
    global_store_dwordx2 v225, a[94:95], s[56:57] offset:3328 sc1
    global_store_dwordx2 v226, a[96:97], s[56:57] offset:0 sc1
    global_store_dwordx2 v226, a[98:99], s[56:57] offset:256 sc1
    global_store_dwordx2 v226, a[100:101], s[56:57] offset:1024 sc1
    global_store_dwordx2 v226, a[102:103], s[56:57] offset:1280 sc1
    global_store_dwordx2 v226, a[104:105], s[56:57] offset:2048 sc1
    global_store_dwordx2 v226, a[106:107], s[56:57] offset:2304 sc1
    global_store_dwordx2 v226, a[108:109], s[56:57] offset:3072 sc1
    global_store_dwordx2 v226, a[110:111], s[56:57] offset:3328 sc1
    global_store_dwordx2 v227, a[112:113], s[56:57] offset:0 sc1
    global_store_dwordx2 v227, a[114:115], s[56:57] offset:256 sc1
    global_store_dwordx2 v227, a[116:117], s[56:57] offset:1024 sc1
    global_store_dwordx2 v227, a[118:119], s[56:57] offset:1280 sc1
    global_store_dwordx2 v227, a[120:121], s[56:57] offset:2048 sc1
    global_store_dwordx2 v227, a[122:123], s[56:57] offset:2304 sc1
    global_store_dwordx2 v227, a[124:125], s[56:57] offset:3072 sc1
    global_store_dwordx2 v227, a[126:127], s[56:57] offset:3328 sc1
xe_interleave_layers__linear_kernel_hedgehog__mixer_channel_mlp__prompt_kernel_20:
xf_interleave_layers__linear_kernel_hedgehog__mixer_channel_mlp__prompt_kernel_18:
    ds_read_b128 v[184:187], v26 offset:0
    ds_read_b64_tr_b16 v[200:201], v10 offset:0
    ds_read_b128 v[188:191], v26 offset:1024
    ds_read_b64_tr_b16 v[202:203], v10 offset:512
    ds_read_b128 v[192:195], v26 offset:2048
    ds_read_b64_tr_b16 v[204:205], v10 offset:1024
    ds_read_b128 v[196:199], v26 offset:3072
    ds_read_b64_tr_b16 v[206:207], v10 offset:1536
    s_waitcnt lgkmcnt(0)
    v_mul_f32 v32, v32, v252
    v_mul_f32 v64, v64, v250
    v_mul_f32 v36, v36, v252
    v_mul_f32 v68, v68, v250
    v_mul_f32 v33, v33, v252
    v_mul_f32 v65, v65, v250
    v_mul_f32 v37, v37, v252
    v_mul_f32 v69, v69, v250
    v_mul_f32 v34, v34, v252
    v_mul_f32 v66, v66, v250
    v_mul_f32 v38, v38, v252
    v_mul_f32 v70, v70, v250
    v_mul_f32 v35, v35, v252
    v_mul_f32 v67, v67, v250
    v_mul_f32 v39, v39, v252
    v_mul_f32 v71, v71, v250
    v_fma_f32 v32, -v184, v253, v32
    global_load_dwordx4 a[128:131], v0, s[24:25]
    s_add_u32 s24, s24, 16384
    s_addc_u32 s25, s25, 0
    v_fma_f32 v64, -v184, v251, v64
    v_fma_f32 v36, -v188, v253, v36
    v_fma_f32 v68, -v188, v251, v68
    v_fma_f32 v33, -v185, v253, v33
    v_fma_f32 v65, -v185, v251, v65
    v_fma_f32 v37, -v189, v253, v37
    v_fma_f32 v69, -v189, v251, v69
    v_fma_f32 v34, -v186, v253, v34
    v_fma_f32 v66, -v186, v251, v66
    v_fma_f32 v38, -v190, v253, v38
    v_fma_f32 v70, -v190, v251, v70
    v_fma_f32 v35, -v187, v253, v35
    v_fma_f32 v67, -v187, v251, v67
    v_fma_f32 v39, -v191, v253, v39
    v_fma_f32 v71, -v191, v251, v71
    v_cvt_pk_bf16_f32 v208, v32, v33
    global_load_dwordx4 a[132:135], v0, s[24:25]
    s_add_u32 s24, s24, 16384
    s_addc_u32 s25, s25, 0
    v_cvt_pk_bf16_f32 v104, v64, v65
    v_cvt_pk_bf16_f32 v210, v36, v37
    v_cvt_pk_bf16_f32 v106, v68, v69
    v_cvt_pk_bf16_f32 v209, v34, v35
    v_cvt_pk_bf16_f32 v105, v66, v67
    v_cvt_pk_bf16_f32 v211, v38, v39
    v_cvt_pk_bf16_f32 v107, v70, v71
    v_mfma_f32_16x16x16_bf16 v[212:215], v[200:201], v[208:209], 0
    v_mfma_f32_16x16x16_bf16 v[108:111], v[200:201], v[104:105], 0
    v_mfma_f32_16x16x16_bf16 v[216:219], v[202:203], v[210:211], 0
    v_mfma_f32_16x16x16_bf16 v[112:115], v[202:203], v[106:107], 0
    s_nop 4
    v_cvt_pk_bf16_f32 v212, 0, v212
    v_cvt_pk_bf16_f32 v108, 0, v108
    v_cvt_pk_bf16_f32 v213, 0, v213
    v_cvt_pk_bf16_f32 v109, 0, v109
    v_cvt_pk_bf16_f32 v214, 0, v214
    v_cvt_pk_bf16_f32 v110, 0, v110
    global_load_dwordx4 a[136:139], v0, s[24:25]
    s_add_u32 s24, s24, 16384
    s_addc_u32 s25, s25, 0
    v_cvt_pk_bf16_f32 v215, 0, v215
    v_cvt_pk_bf16_f32 v111, 0, v111
    v_cvt_pk_bf16_f32 v216, 0, v216
    v_cvt_pk_bf16_f32 v112, 0, v112
    v_cvt_pk_bf16_f32 v217, 0, v217
    v_cvt_pk_bf16_f32 v113, 0, v113
    v_cvt_pk_bf16_f32 v218, 0, v218
    v_cvt_pk_bf16_f32 v114, 0, v114
    v_cvt_pk_bf16_f32 v219, 0, v219
    v_cvt_pk_bf16_f32 v115, 0, v115
    v_max3_f32 v236, v212, v213, v214
    v_max3_f32 v132, v108, v109, v110
    v_max3_f32 v237, -v212, -v213, -v214
    v_max3_f32 v133, -v108, -v109, -v110
    v_max3_f32 v238, v216, v217, v218
    v_max3_f32 v134, v112, v113, v114
    global_load_dwordx4 a[140:143], v0, s[24:25]
    s_add_u32 s24, s24, 16384
    s_addc_u32 s25, s25, 0
    v_max3_f32 v239, -v216, -v217, -v218
    v_max3_f32 v135, -v112, -v113, -v114
    v_max_f32 v236, v236, v215
    v_max_f32 v132, v132, v111
    v_max_f32 v237, v237, -v215
    v_max_f32 v133, v133, -v111
    v_max_f32 v238, v238, v219
    v_max_f32 v134, v134, v115
    v_max_f32 v239, v239, -v219
    v_max_f32 v135, v135, -v115
    v_permlane32_swap_b32 v236, v237
    v_permlane32_swap_b32 v132, v133
    v_permlane32_swap_b32 v238, v239
    v_permlane32_swap_b32 v134, v135
    v_max_f32 v236, v236, v237
    v_max_f32 v132, v132, v133
    v_max_f32 v238, v238, v239
    global_load_dwordx4 a[144:147], v0, s[24:25]
    s_add_u32 s24, s24, 16384
    s_addc_u32 s25, s25, 0
    v_max_f32 v134, v134, v135
    v_permlane16_swap_b32 v236, v238
    s_nop 0
    v_permlane16_swap_b32 v132, v134
    v_max_f32 v236, v236, v238
    v_max_f32 v132, v132, v134
    v_mov_b32 v238, v236
    v_mov_b32 v134, v132
    s_nop 0
    v_permlane16_swap_b32 v236, v238
    v_permlane16_swap_b32 v132, v134
    v_mov_b32 v237, v236
    v_mov_b32 v133, v132
    v_mov_b32 v239, v238
    v_mov_b32 v135, v134
    v_permlane32_swap_b32 v236, v237
    v_permlane32_swap_b32 v132, v133
    v_permlane32_swap_b32 v238, v239
    global_load_dwordx4 a[148:151], v0, s[24:25]
    s_add_u32 s24, s24, 16384
    s_addc_u32 s25, s25, 0
    v_permlane32_swap_b32 v134, v135
    v_mul_f32 v236, v236, v248
    v_mul_f32 v132, v132, v248
    v_mul_f32 v237, v237, v248
    v_mul_f32 v133, v133, v248
    v_mul_f32 v238, v238, v248
    v_mul_f32 v134, v134, v248
    v_mul_f32 v239, v239, v248
    v_mul_f32 v135, v135, v248
    v_fma_f32 v220, v212, v248, -v236
    v_fma_f32 v116, v108, v248, -v132
    v_fma_f32 v224, -v212, v248, -v237
    v_fma_f32 v120, -v108, v248, -v133
    v_fma_f32 v221, v213, v248, -v236
    v_fma_f32 v117, v109, v248, -v132
    v_fma_f32 v225, -v213, v248, -v237
    v_fma_f32 v121, -v109, v248, -v133
    global_load_dwordx4 a[152:155], v0, s[24:25]
    s_add_u32 s24, s24, 16384
    s_addc_u32 s25, s25, 0
    v_fma_f32 v222, v214, v248, -v236
    v_fma_f32 v118, v110, v248, -v132
    v_fma_f32 v226, -v214, v248, -v237
    v_fma_f32 v122, -v110, v248, -v133
    v_fma_f32 v223, v215, v248, -v236
    v_fma_f32 v119, v111, v248, -v132
    v_fma_f32 v227, -v215, v248, -v237
    v_fma_f32 v123, -v111, v248, -v133
    v_fma_f32 v228, v216, v248, -v238
    v_fma_f32 v124, v112, v248, -v134
    v_fma_f32 v232, -v216, v248, -v239
    v_fma_f32 v128, -v112, v248, -v135
    v_fma_f32 v229, v217, v248, -v238
    v_fma_f32 v125, v113, v248, -v134
    v_fma_f32 v233, -v217, v248, -v239
    v_fma_f32 v129, -v113, v248, -v135
    global_load_dwordx4 a[156:159], v0, s[24:25]
    s_add_u32 s24, s24, 16384
    s_addc_u32 s25, s25, 0
    v_fma_f32 v230, v218, v248, -v238
    v_fma_f32 v126, v114, v248, -v134
    v_fma_f32 v234, -v218, v248, -v239
    v_fma_f32 v130, -v114, v248, -v135
    v_fma_f32 v231, v219, v248, -v238
    v_fma_f32 v127, v115, v248, -v134
    v_fma_f32 v235, -v219, v248, -v239
    v_fma_f32 v131, -v115, v248, -v135
    v_exp_f32 v220, v220
    v_exp_f32 v116, v116
    v_exp_f32 v221, v221
    v_exp_f32 v117, v117
    v_exp_f32 v222, v222
    v_exp_f32 v118, v118
    v_exp_f32 v223, v223
    v_exp_f32 v119, v119
    v_exp_f32 v224, v224
    global_load_dwordx4 a[160:163], v0, s[24:25]
    s_add_u32 s24, s24, 16384
    s_addc_u32 s25, s25, 0
    v_exp_f32 v120, v120
    v_exp_f32 v225, v225
    v_exp_f32 v121, v121
    v_exp_f32 v226, v226
    v_exp_f32 v122, v122
    v_exp_f32 v227, v227
    v_exp_f32 v123, v123
    v_exp_f32 v228, v228
    v_exp_f32 v124, v124
    v_exp_f32 v229, v229
    v_exp_f32 v125, v125
    v_exp_f32 v230, v230
    v_exp_f32 v126, v126
    v_exp_f32 v231, v231
    v_exp_f32 v127, v127
    v_exp_f32 v232, v232
    global_load_dwordx4 a[164:167], v0, s[24:25]
    s_add_u32 s24, s24, 16384
    s_addc_u32 s25, s25, 0
    v_exp_f32 v128, v128
    v_exp_f32 v233, v233
    v_exp_f32 v129, v129
    v_exp_f32 v234, v234
    v_exp_f32 v130, v130
    v_exp_f32 v235, v235
    v_exp_f32 v131, v131
    v_add_f32 v236, v220, v221
    v_add_f32 v132, v116, v117
    v_add_f32 v212, v222, v223
    v_add_f32 v108, v118, v119
    v_add_f32 v237, v224, v225
    v_add_f32 v133, v120, v121
    v_add_f32 v213, v226, v227
    v_add_f32 v109, v122, v123
    v_add_f32 v238, v228, v229
    v_add_f32 v134, v124, v125
    global_load_dwordx4 a[168:171], v0, s[24:25]
    s_add_u32 s24, s24, 16384
    s_addc_u32 s25, s25, 0
    v_add_f32 v214, v230, v231
    v_add_f32 v110, v126, v127
    v_add_f32 v239, v232, v233
    v_add_f32 v135, v128, v129
    v_add_f32 v215, v234, v235
    v_add_f32 v111, v130, v131
    v_add_f32 v236, v236, v212
    v_add_f32 v132, v132, v108
    v_add_f32 v237, v237, v213
    v_add_f32 v133, v133, v109
    v_add_f32 v238, v238, v214
    v_add_f32 v134, v134, v110
    v_add_f32 v239, v239, v215
    v_add_f32 v135, v135, v111
    v_permlane32_swap_b32 v236, v237
    v_permlane32_swap_b32 v132, v133
    global_load_dwordx4 a[172:175], v0, s[24:25]
    s_add_u32 s24, s24, 16384
    s_addc_u32 s25, s25, 0
    v_permlane32_swap_b32 v238, v239
    v_permlane32_swap_b32 v134, v135
    v_add_f32 v236, v236, v237
    v_add_f32 v132, v132, v133
    v_add_f32 v238, v238, v239
    v_add_f32 v134, v134, v135
    s_nop 0
    v_permlane16_swap_b32 v236, v238
    v_permlane16_swap_b32 v132, v134
    v_add_f32 v236, v236, v238
    v_add_f32 v132, v132, v134
    v_mov_b32 v238, v236
    v_mov_b32 v134, v132
    s_nop 0
    v_permlane16_swap_b32 v236, v238
    v_permlane16_swap_b32 v132, v134
    v_mov_b32 v237, v236
    v_mov_b32 v133, v132
    v_mov_b32 v239, v238
    global_load_dwordx4 a[176:179], v0, s[24:25]
    s_add_u32 s24, s24, 16384
    s_addc_u32 s25, s25, 0
    v_mov_b32 v135, v134
    v_permlane32_swap_b32 v236, v237
    v_permlane32_swap_b32 v132, v133
    v_permlane32_swap_b32 v238, v239
    v_permlane32_swap_b32 v134, v135
    v_rcp_f32 v236, v236
    v_rcp_f32 v132, v132
    v_rcp_f32 v237, v237
    v_rcp_f32 v133, v133
    v_rcp_f32 v238, v238
    v_rcp_f32 v134, v134
    v_rcp_f32 v239, v239
    v_rcp_f32 v135, v135
    v_pk_mul_f32 v[220:221], v[220:221], v[236:237] op_sel:[0,0] op_sel_hi:[1,0]
    v_pk_mul_f32 v[116:117], v[116:117], v[132:133] op_sel:[0,0] op_sel_hi:[1,0]
    v_pk_mul_f32 v[222:223], v[222:223], v[236:237] op_sel:[0,0] op_sel_hi:[1,0]
    global_load_dwordx4 a[180:183], v0, s[24:25]
    s_add_u32 s24, s24, 16384
    s_addc_u32 s25, s25, 0
    v_pk_mul_f32 v[118:119], v[118:119], v[132:133] op_sel:[0,0] op_sel_hi:[1,0]
    v_pk_mul_f32 v[224:225], v[224:225], v[236:237] op_sel:[0,1] op_sel_hi:[1,1]
    v_pk_mul_f32 v[120:121], v[120:121], v[132:133] op_sel:[0,1] op_sel_hi:[1,1]
    v_pk_mul_f32 v[226:227], v[226:227], v[236:237] op_sel:[0,1] op_sel_hi:[1,1]
    v_pk_mul_f32 v[122:123], v[122:123], v[132:133] op_sel:[0,1] op_sel_hi:[1,1]
    v_pk_mul_f32 v[228:229], v[228:229], v[238:239] op_sel:[0,0] op_sel_hi:[1,0]
    v_pk_mul_f32 v[124:125], v[124:125], v[134:135] op_sel:[0,0] op_sel_hi:[1,0]
    v_pk_mul_f32 v[230:231], v[230:231], v[238:239] op_sel:[0,0] op_sel_hi:[1,0]
    v_pk_mul_f32 v[126:127], v[126:127], v[134:135] op_sel:[0,0] op_sel_hi:[1,0]
    v_pk_mul_f32 v[232:233], v[232:233], v[238:239] op_sel:[0,1] op_sel_hi:[1,1]
    v_pk_mul_f32 v[128:129], v[128:129], v[134:135] op_sel:[0,1] op_sel_hi:[1,1]
    v_pk_mul_f32 v[234:235], v[234:235], v[238:239] op_sel:[0,1] op_sel_hi:[1,1]
    v_pk_mul_f32 v[130:131], v[130:131], v[134:135] op_sel:[0,1] op_sel_hi:[1,1]
    v_cvt_pk_bf16_f32 v240, v220, v221
    v_cvt_pk_bf16_f32 v136, v116, v117
    v_cvt_pk_bf16_f32 v241, v222, v223
    v_cvt_pk_bf16_f32 v137, v118, v119
    global_load_dwordx4 a[184:187], v0, s[24:25]
    s_add_u32 s24, s24, 16384
    s_addc_u32 s25, s25, 0
    v_cvt_pk_bf16_f32 v242, v224, v225
    v_cvt_pk_bf16_f32 v138, v120, v121
    v_cvt_pk_bf16_f32 v243, v226, v227
    v_cvt_pk_bf16_f32 v139, v122, v123
    v_cvt_pk_bf16_f32 v244, v228, v229
    v_cvt_pk_bf16_f32 v140, v124, v125
    v_cvt_pk_bf16_f32 v245, v230, v231
    v_cvt_pk_bf16_f32 v141, v126, v127
    v_cvt_pk_bf16_f32 v246, v232, v233
    v_cvt_pk_bf16_f32 v142, v128, v129
    v_cvt_pk_bf16_f32 v247, v234, v235
    v_cvt_pk_bf16_f32 v143, v130, v131
    s_cmp_eq_u32 s61, 1
    s_cbranch_scc1 sf_interleave_layers__linear_kernel_hedgehog__mixer_channel_mlp__prompt_kernel_21
    global_store_dwordx4 v5, v[240:243], s[54:55] offset:0 sc1
    s_branch se_interleave_layers__linear_kernel_hedgehog__mixer_channel_mlp__prompt_kernel_22
sf_interleave_layers__linear_kernel_hedgehog__mixer_channel_mlp__prompt_kernel_21:
    global_store_dwordx4 v5, v[240:243], s[54:55] offset:0
se_interleave_layers__linear_kernel_hedgehog__mixer_channel_mlp__prompt_kernel_22:
    s_cmp_eq_u32 s61, 1
    s_cbranch_scc1 sf_interleave_layers__linear_kernel_hedgehog__mixer_channel_mlp__prompt_kernel_23
    global_store_dwordx4 v12, v[136:139], s[54:55] offset:0 sc1
    s_branch se_interleave_layers__linear_kernel_hedgehog__mixer_channel_mlp__prompt_kernel_24
sf_interleave_layers__linear_kernel_hedgehog__mixer_channel_mlp__prompt_kernel_23:
    global_store_dwordx4 v12, v[136:139], s[54:55] offset:0
se_interleave_layers__linear_kernel_hedgehog__mixer_channel_mlp__prompt_kernel_24:
    s_cmp_eq_u32 s61, 1
    s_cbranch_scc1 sf_interleave_layers__linear_kernel_hedgehog__mixer_channel_mlp__prompt_kernel_25
    global_store_dwordx4 v5, v[244:247], s[54:55] offset:1024 sc1
    s_branch se_interleave_layers__linear_kernel_hedgehog__mixer_channel_mlp__prompt_kernel_26
sf_interleave_layers__linear_kernel_hedgehog__mixer_channel_mlp__prompt_kernel_25:
    global_store_dwordx4 v5, v[244:247], s[54:55] offset:1024
se_interleave_layers__linear_kernel_hedgehog__mixer_channel_mlp__prompt_kernel_26:
    s_cmp_eq_u32 s61, 1
    s_cbranch_scc1 sf_interleave_layers__linear_kernel_hedgehog__mixer_channel_mlp__prompt_kernel_27
    global_store_dwordx4 v12, v[140:143], s[54:55] offset:1024 sc1
    s_branch se_interleave_layers__linear_kernel_hedgehog__mixer_channel_mlp__prompt_kernel_28
sf_interleave_layers__linear_kernel_hedgehog__mixer_channel_mlp__prompt_kernel_27:
    global_store_dwordx4 v12, v[140:143], s[54:55] offset:1024
se_interleave_layers__linear_kernel_hedgehog__mixer_channel_mlp__prompt_kernel_28:
    global_load_dwordx4 a[188:191], v0, s[24:25]
    s_add_u32 s24, s24, 16384
    s_addc_u32 s25, s25, 0
    v_mul_f32 v40, v40, v252
    v_mul_f32 v72, v72, v250
    v_mul_f32 v44, v44, v252
    v_mul_f32 v76, v76, v250
    v_mul_f32 v41, v41, v252
    v_mul_f32 v73, v73, v250
    v_mul_f32 v45, v45, v252
    v_mul_f32 v77, v77, v250
    v_mul_f32 v42, v42, v252
    v_mul_f32 v74, v74, v250
    v_mul_f32 v46, v46, v252
    v_mul_f32 v78, v78, v250
    v_mul_f32 v43, v43, v252
    v_mul_f32 v75, v75, v250
    v_mul_f32 v47, v47, v252
    v_mul_f32 v79, v79, v250
    v_fma_f32 v40, -v192, v253, v40
    global_load_dwordx4 a[192:195], v0, s[24:25]
    s_add_u32 s24, s24, 16384
    s_addc_u32 s25, s25, 0
    v_fma_f32 v72, -v192, v251, v72
    v_fma_f32 v44, -v196, v253, v44
    v_fma_f32 v76, -v196, v251, v76
    v_fma_f32 v41, -v193, v253, v41
    v_fma_f32 v73, -v193, v251, v73
    v_fma_f32 v45, -v197, v253, v45
    v_fma_f32 v77, -v197, v251, v77
    v_fma_f32 v42, -v194, v253, v42
    v_fma_f32 v74, -v194, v251, v74
    v_fma_f32 v46, -v198, v253, v46
    v_fma_f32 v78, -v198, v251, v78
    v_fma_f32 v43, -v195, v253, v43
    v_fma_f32 v75, -v195, v251, v75
    v_fma_f32 v47, -v199, v253, v47
    v_fma_f32 v79, -v199, v251, v79
    v_cvt_pk_bf16_f32 v208, v40, v41
    global_load_dwordx4 a[196:199], v0, s[24:25]
    s_add_u32 s24, s24, 16384
    s_addc_u32 s25, s25, 0
    v_cvt_pk_bf16_f32 v104, v72, v73
    v_cvt_pk_bf16_f32 v210, v44, v45
    v_cvt_pk_bf16_f32 v106, v76, v77
    v_cvt_pk_bf16_f32 v209, v42, v43
    v_cvt_pk_bf16_f32 v105, v74, v75
    v_cvt_pk_bf16_f32 v211, v46, v47
    v_cvt_pk_bf16_f32 v107, v78, v79
    v_mfma_f32_16x16x16_bf16 v[212:215], v[204:205], v[208:209], 0
    v_mfma_f32_16x16x16_bf16 v[108:111], v[204:205], v[104:105], 0
    v_mfma_f32_16x16x16_bf16 v[216:219], v[206:207], v[210:211], 0
    v_mfma_f32_16x16x16_bf16 v[112:115], v[206:207], v[106:107], 0
    s_nop 4
    v_cvt_pk_bf16_f32 v212, 0, v212
    v_cvt_pk_bf16_f32 v108, 0, v108
    v_cvt_pk_bf16_f32 v213, 0, v213
    v_cvt_pk_bf16_f32 v109, 0, v109
    v_cvt_pk_bf16_f32 v214, 0, v214
    v_cvt_pk_bf16_f32 v110, 0, v110
    global_load_dwordx4 a[200:203], v0, s[24:25]
    s_add_u32 s24, s24, 16384
    s_addc_u32 s25, s25, 0
    v_cvt_pk_bf16_f32 v215, 0, v215
    v_cvt_pk_bf16_f32 v111, 0, v111
    v_cvt_pk_bf16_f32 v216, 0, v216
    v_cvt_pk_bf16_f32 v112, 0, v112
    v_cvt_pk_bf16_f32 v217, 0, v217
    v_cvt_pk_bf16_f32 v113, 0, v113
    v_cvt_pk_bf16_f32 v218, 0, v218
    v_cvt_pk_bf16_f32 v114, 0, v114
    v_cvt_pk_bf16_f32 v219, 0, v219
    v_cvt_pk_bf16_f32 v115, 0, v115
    v_max3_f32 v236, v212, v213, v214
    v_max3_f32 v132, v108, v109, v110
    v_max3_f32 v237, -v212, -v213, -v214
    v_max3_f32 v133, -v108, -v109, -v110
    v_max3_f32 v238, v216, v217, v218
    v_max3_f32 v134, v112, v113, v114
    global_load_dwordx4 a[204:207], v0, s[24:25]
    s_add_u32 s24, s24, 16384
    s_addc_u32 s25, s25, 0
    v_max3_f32 v239, -v216, -v217, -v218
    v_max3_f32 v135, -v112, -v113, -v114
    v_max_f32 v236, v236, v215
    v_max_f32 v132, v132, v111
    v_max_f32 v237, v237, -v215
    v_max_f32 v133, v133, -v111
    v_max_f32 v238, v238, v219
    v_max_f32 v134, v134, v115
    v_max_f32 v239, v239, -v219
    v_max_f32 v135, v135, -v115
    v_permlane32_swap_b32 v236, v237
    v_permlane32_swap_b32 v132, v133
    v_permlane32_swap_b32 v238, v239
    v_permlane32_swap_b32 v134, v135
    v_max_f32 v236, v236, v237
    v_max_f32 v132, v132, v133
    v_max_f32 v238, v238, v239
    global_load_dwordx4 a[208:211], v0, s[24:25]
    s_add_u32 s24, s24, 16384
    s_addc_u32 s25, s25, 0
    v_max_f32 v134, v134, v135
    v_permlane16_swap_b32 v236, v238
    s_nop 0
    v_permlane16_swap_b32 v132, v134
    v_max_f32 v236, v236, v238
    v_max_f32 v132, v132, v134
    v_mov_b32 v238, v236
    v_mov_b32 v134, v132
    s_nop 0
    v_permlane16_swap_b32 v236, v238
    v_permlane16_swap_b32 v132, v134
    v_mov_b32 v237, v236
    v_mov_b32 v133, v132
    v_mov_b32 v239, v238
    v_mov_b32 v135, v134
    v_permlane32_swap_b32 v236, v237
    v_permlane32_swap_b32 v132, v133
    v_permlane32_swap_b32 v238, v239
    global_load_dwordx4 a[212:215], v0, s[24:25]
    s_add_u32 s24, s24, 16384
    s_addc_u32 s25, s25, 0
    v_permlane32_swap_b32 v134, v135
    v_mul_f32 v236, v236, v248
    v_mul_f32 v132, v132, v248
    v_mul_f32 v237, v237, v248
    v_mul_f32 v133, v133, v248
    v_mul_f32 v238, v238, v248
    v_mul_f32 v134, v134, v248
    v_mul_f32 v239, v239, v248
    v_mul_f32 v135, v135, v248
    v_fma_f32 v220, v212, v248, -v236
    v_fma_f32 v116, v108, v248, -v132
    v_fma_f32 v224, -v212, v248, -v237
    v_fma_f32 v120, -v108, v248, -v133
    v_fma_f32 v221, v213, v248, -v236
    v_fma_f32 v117, v109, v248, -v132
    v_fma_f32 v225, -v213, v248, -v237
    v_fma_f32 v121, -v109, v248, -v133
    global_load_dwordx4 a[216:219], v0, s[24:25]
    s_add_u32 s24, s24, 16384
    s_addc_u32 s25, s25, 0
    v_fma_f32 v222, v214, v248, -v236
    v_fma_f32 v118, v110, v248, -v132
    v_fma_f32 v226, -v214, v248, -v237
    v_fma_f32 v122, -v110, v248, -v133
    v_fma_f32 v223, v215, v248, -v236
    v_fma_f32 v119, v111, v248, -v132
    v_fma_f32 v227, -v215, v248, -v237
    v_fma_f32 v123, -v111, v248, -v133
    v_fma_f32 v228, v216, v248, -v238
    v_fma_f32 v124, v112, v248, -v134
    v_fma_f32 v232, -v216, v248, -v239
    v_fma_f32 v128, -v112, v248, -v135
    v_fma_f32 v229, v217, v248, -v238
    v_fma_f32 v125, v113, v248, -v134
    v_fma_f32 v233, -v217, v248, -v239
    v_fma_f32 v129, -v113, v248, -v135
    global_load_dwordx4 a[220:223], v0, s[24:25]
    s_add_u32 s24, s24, 16384
    s_addc_u32 s25, s25, 0
    v_fma_f32 v230, v218, v248, -v238
    v_fma_f32 v126, v114, v248, -v134
    v_fma_f32 v234, -v218, v248, -v239
    v_fma_f32 v130, -v114, v248, -v135
    v_fma_f32 v231, v219, v248, -v238
    v_fma_f32 v127, v115, v248, -v134
    v_fma_f32 v235, -v219, v248, -v239
    v_fma_f32 v131, -v115, v248, -v135
    v_exp_f32 v220, v220
    v_exp_f32 v116, v116
    v_exp_f32 v221, v221
    v_exp_f32 v117, v117
    v_exp_f32 v222, v222
    v_exp_f32 v118, v118
    v_exp_f32 v223, v223
    v_exp_f32 v119, v119
    v_exp_f32 v224, v224
    global_load_dwordx4 a[224:227], v0, s[24:25]
    s_add_u32 s24, s24, 16384
    s_addc_u32 s25, s25, 0
    v_exp_f32 v120, v120
    v_exp_f32 v225, v225
    v_exp_f32 v121, v121
    v_exp_f32 v226, v226
    v_exp_f32 v122, v122
    v_exp_f32 v227, v227
    v_exp_f32 v123, v123
    v_exp_f32 v228, v228
    v_exp_f32 v124, v124
    v_exp_f32 v229, v229
    v_exp_f32 v125, v125
    v_exp_f32 v230, v230
    v_exp_f32 v126, v126
    v_exp_f32 v231, v231
    v_exp_f32 v127, v127
    v_exp_f32 v232, v232
    global_load_dwordx4 a[228:231], v0, s[24:25]
    s_add_u32 s24, s24, 16384
    s_addc_u32 s25, s25, 0
    v_exp_f32 v128, v128
    v_exp_f32 v233, v233
    v_exp_f32 v129, v129
    v_exp_f32 v234, v234
    v_exp_f32 v130, v130
    v_exp_f32 v235, v235
    v_exp_f32 v131, v131
    v_add_f32 v236, v220, v221
    v_add_f32 v132, v116, v117
    v_add_f32 v212, v222, v223
    v_add_f32 v108, v118, v119
    v_add_f32 v237, v224, v225
    v_add_f32 v133, v120, v121
    v_add_f32 v213, v226, v227
    v_add_f32 v109, v122, v123
    v_add_f32 v238, v228, v229
    v_add_f32 v134, v124, v125
    global_load_dwordx4 a[232:235], v0, s[24:25]
    s_add_u32 s24, s24, 16384
    s_addc_u32 s25, s25, 0
    v_add_f32 v214, v230, v231
    v_add_f32 v110, v126, v127
    v_add_f32 v239, v232, v233
    v_add_f32 v135, v128, v129
    v_add_f32 v215, v234, v235
    v_add_f32 v111, v130, v131
    v_add_f32 v236, v236, v212
    v_add_f32 v132, v132, v108
    v_add_f32 v237, v237, v213
    v_add_f32 v133, v133, v109
    v_add_f32 v238, v238, v214
    v_add_f32 v134, v134, v110
    v_add_f32 v239, v239, v215
    v_add_f32 v135, v135, v111
    v_permlane32_swap_b32 v236, v237
    v_permlane32_swap_b32 v132, v133
    global_load_dwordx4 a[236:239], v0, s[24:25]
    s_add_u32 s24, s24, 16384
    s_addc_u32 s25, s25, 0
    v_permlane32_swap_b32 v238, v239
    v_permlane32_swap_b32 v134, v135
    v_add_f32 v236, v236, v237
    v_add_f32 v132, v132, v133
    v_add_f32 v238, v238, v239
    v_add_f32 v134, v134, v135
    s_nop 0
    v_permlane16_swap_b32 v236, v238
    v_permlane16_swap_b32 v132, v134
    v_add_f32 v236, v236, v238
    v_add_f32 v132, v132, v134
    v_mov_b32 v238, v236
    v_mov_b32 v134, v132
    s_nop 0
    v_permlane16_swap_b32 v236, v238
    v_permlane16_swap_b32 v132, v134
    v_mov_b32 v237, v236
    v_mov_b32 v133, v132
    v_mov_b32 v239, v238
    global_load_dwordx4 a[240:243], v0, s[24:25]
    s_add_u32 s24, s24, 16384
    s_addc_u32 s25, s25, 0
    v_mov_b32 v135, v134
    v_permlane32_swap_b32 v236, v237
    v_permlane32_swap_b32 v132, v133
    v_permlane32_swap_b32 v238, v239
    v_permlane32_swap_b32 v134, v135
    v_rcp_f32 v236, v236
    v_rcp_f32 v132, v132
    v_rcp_f32 v237, v237
    v_rcp_f32 v133, v133
    v_rcp_f32 v238, v238
    v_rcp_f32 v134, v134
    v_rcp_f32 v239, v239
    v_rcp_f32 v135, v135
    v_pk_mul_f32 v[220:221], v[220:221], v[236:237] op_sel:[0,0] op_sel_hi:[1,0]
    v_pk_mul_f32 v[116:117], v[116:117], v[132:133] op_sel:[0,0] op_sel_hi:[1,0]
    v_pk_mul_f32 v[222:223], v[222:223], v[236:237] op_sel:[0,0] op_sel_hi:[1,0]
    global_load_dwordx4 a[244:247], v0, s[24:25]
    s_add_u32 s24, s24, 16384
    s_addc_u32 s25, s25, 0
    v_pk_mul_f32 v[118:119], v[118:119], v[132:133] op_sel:[0,0] op_sel_hi:[1,0]
    v_pk_mul_f32 v[224:225], v[224:225], v[236:237] op_sel:[0,1] op_sel_hi:[1,1]
    v_pk_mul_f32 v[120:121], v[120:121], v[132:133] op_sel:[0,1] op_sel_hi:[1,1]
    v_pk_mul_f32 v[226:227], v[226:227], v[236:237] op_sel:[0,1] op_sel_hi:[1,1]
    v_pk_mul_f32 v[122:123], v[122:123], v[132:133] op_sel:[0,1] op_sel_hi:[1,1]
    v_pk_mul_f32 v[228:229], v[228:229], v[238:239] op_sel:[0,0] op_sel_hi:[1,0]
    v_pk_mul_f32 v[124:125], v[124:125], v[134:135] op_sel:[0,0] op_sel_hi:[1,0]
    v_pk_mul_f32 v[230:231], v[230:231], v[238:239] op_sel:[0,0] op_sel_hi:[1,0]
    v_pk_mul_f32 v[126:127], v[126:127], v[134:135] op_sel:[0,0] op_sel_hi:[1,0]
    v_pk_mul_f32 v[232:233], v[232:233], v[238:239] op_sel:[0,1] op_sel_hi:[1,1]
    v_pk_mul_f32 v[128:129], v[128:129], v[134:135] op_sel:[0,1] op_sel_hi:[1,1]
    v_pk_mul_f32 v[234:235], v[234:235], v[238:239] op_sel:[0,1] op_sel_hi:[1,1]
    v_pk_mul_f32 v[130:131], v[130:131], v[134:135] op_sel:[0,1] op_sel_hi:[1,1]
    v_cvt_pk_bf16_f32 v240, v220, v221
    v_cvt_pk_bf16_f32 v136, v116, v117
    v_cvt_pk_bf16_f32 v241, v222, v223
    v_cvt_pk_bf16_f32 v137, v118, v119
    global_load_dwordx4 a[248:251], v0, s[24:25]
    s_add_u32 s24, s24, 16384
    s_addc_u32 s25, s25, 0
    v_cvt_pk_bf16_f32 v242, v224, v225
    v_cvt_pk_bf16_f32 v138, v120, v121
    v_cvt_pk_bf16_f32 v243, v226, v227
    v_cvt_pk_bf16_f32 v139, v122, v123
    v_cvt_pk_bf16_f32 v244, v228, v229
    v_cvt_pk_bf16_f32 v140, v124, v125
    v_cvt_pk_bf16_f32 v245, v230, v231
    v_cvt_pk_bf16_f32 v141, v126, v127
    v_cvt_pk_bf16_f32 v246, v232, v233
    v_cvt_pk_bf16_f32 v142, v128, v129
    v_cvt_pk_bf16_f32 v247, v234, v235
    v_cvt_pk_bf16_f32 v143, v130, v131
    s_cmp_eq_u32 s61, 1
    s_cbranch_scc1 sf_interleave_layers__linear_kernel_hedgehog__mixer_channel_mlp__prompt_kernel_29
    global_store_dwordx4 v5, v[240:243], s[54:55] offset:2048 sc1
    s_branch se_interleave_layers__linear_kernel_hedgehog__mixer_channel_mlp__prompt_kernel_30
sf_interleave_layers__linear_kernel_hedgehog__mixer_channel_mlp__prompt_kernel_29:
    global_store_dwordx4 v5, v[240:243], s[54:55] offset:2048
se_interleave_layers__linear_kernel_hedgehog__mixer_channel_mlp__prompt_kernel_30:
    s_cmp_eq_u32 s61, 1
    s_cbranch_scc1 sf_interleave_layers__linear_kernel_hedgehog__mixer_channel_mlp__prompt_kernel_31
    global_store_dwordx4 v12, v[136:139], s[54:55] offset:2048 sc1
    s_branch se_interleave_layers__linear_kernel_hedgehog__mixer_channel_mlp__prompt_kernel_32
sf_interleave_layers__linear_kernel_hedgehog__mixer_channel_mlp__prompt_kernel_31:
    global_store_dwordx4 v12, v[136:139], s[54:55] offset:2048
se_interleave_layers__linear_kernel_hedgehog__mixer_channel_mlp__prompt_kernel_32:
    s_cmp_eq_u32 s61, 1
    s_cbranch_scc1 sf_interleave_layers__linear_kernel_hedgehog__mixer_channel_mlp__prompt_kernel_33
    global_store_dwordx4 v5, v[244:247], s[54:55] offset:3072 sc1
    s_branch se_interleave_layers__linear_kernel_hedgehog__mixer_channel_mlp__prompt_kernel_34
sf_interleave_layers__linear_kernel_hedgehog__mixer_channel_mlp__prompt_kernel_33:
    global_store_dwordx4 v5, v[244:247], s[54:55] offset:3072
se_interleave_layers__linear_kernel_hedgehog__mixer_channel_mlp__prompt_kernel_34:
    s_cmp_eq_u32 s61, 1
    s_cbranch_scc1 sf_interleave_layers__linear_kernel_hedgehog__mixer_channel_mlp__prompt_kernel_35
    global_store_dwordx4 v12, v[140:143], s[54:55] offset:3072 sc1
    s_branch se_interleave_layers__linear_kernel_hedgehog__mixer_channel_mlp__prompt_kernel_36
sf_interleave_layers__linear_kernel_hedgehog__mixer_channel_mlp__prompt_kernel_35:
    global_store_dwordx4 v12, v[140:143], s[54:55] offset:3072
se_interleave_layers__linear_kernel_hedgehog__mixer_channel_mlp__prompt_kernel_36:
    global_load_dwordx4 a[252:255], v0, s[24:25]
    s_add_u32 s24, s24, 16384
    s_addc_u32 s25, s25, 0
    s_waitcnt vmcnt(0)
p1d_interleave_layers__linear_kernel_hedgehog__mixer_channel_mlp__prompt_kernel_15:
    s_nop 15
    s_nop 3
    s_barrier
    s_cmp_lg_u32 s3, 0
    s_cbranch_scc1 sg_interleave_layers__linear_kernel_hedgehog__mixer_channel_mlp__prompt_kernel_37
    s_mov_b64 exec, 1
    s_lshl_b32 s10, s58, 2
    v_mov_b32 v2, s10
    s_mov_b32 s15, 0
ip_interleave_layers__linear_kernel_hedgehog__mixer_channel_mlp__prompt_kernel_38:
    global_load_dword v26, v2, s[36:37] sc1
    s_waitcnt vmcnt(0)
    v_readfirstlane_b32 s10, v26
    s_cmp_ge_u32 s10, 1
    s_cbranch_scc1 iq_interleave_layers__linear_kernel_hedgehog__mixer_channel_mlp__prompt_kernel_39
    s_sleep 1
    s_add_u32 s15, s15, 1
    s_cmp_lt_u32 s15, 400000
    s_cbranch_scc1 ip_interleave_layers__linear_kernel_hedgehog__mixer_channel_mlp__prompt_kernel_38
iq_interleave_layers__linear_kernel_hedgehog__mixer_channel_mlp__prompt_kernel_39:
    s_lshl_b32 s10, s58, 10
    v_mov_b32 v2, s10
    v_mov_b32 v26, 1
    global_atomic_add v2, v26, s[62:63] sc1
    s_cmp_lt_u32 s59, 8
    s_cbranch_scc1 qd_interleave_layers__linear_kernel_hedgehog__mixer_channel_mlp__prompt_kernel_40
    global_atomic_add v2, v26, s[62:63] offset:384 sc1
qd_interleave_layers__linear_kernel_hedgehog__mixer_channel_mlp__prompt_kernel_40:
    s_mov_b64 exec, -1
sg_interleave_layers__linear_kernel_hedgehog__mixer_channel_mlp__prompt_kernel_37:
    s_lshl_b32 s48, s3, 10
    v_add_u32 v9, s48, v5
    v_add_u32 v10, 65536, v9
    ds_write_b128 v9, a[128:131] offset:0
    ds_write_b128 v9, a[132:135] offset:4096
    ds_write_b128 v9, a[136:139] offset:8192
    ds_write_b128 v9, a[140:143] offset:12288
    ds_write_b128 v9, a[144:147] offset:16384
    ds_write_b128 v9, a[148:151] offset:20480
    ds_write_b128 v9, a[152:155] offset:24576
    ds_write_b128 v9, a[156:159] offset:28672
    ds_write_b128 v9, a[160:163] offset:32768
    ds_write_b128 v9, a[164:167] offset:36864
    ds_write_b128 v9, a[168:171] offset:40960
    ds_write_b128 v9, a[172:175] offset:45056
    ds_write_b128 v9, a[176:179] offset:49152
    ds_write_b128 v9, a[180:183] offset:53248
    ds_write_b128 v9, a[184:187] offset:57344
    ds_write_b128 v9, a[188:191] offset:61440
    ds_write_b128 v10, a[192:195] offset:0
    ds_write_b128 v10, a[196:199] offset:4096
    ds_write_b128 v10, a[200:203] offset:8192
    ds_write_b128 v10, a[204:207] offset:12288
    ds_write_b128 v10, a[208:211] offset:16384
    ds_write_b128 v10, a[212:215] offset:20480
    ds_write_b128 v10, a[216:219] offset:24576
    ds_write_b128 v10, a[220:223] offset:28672
    ds_write_b128 v10, a[224:227] offset:32768
    ds_write_b128 v10, a[228:231] offset:36864
    ds_write_b128 v10, a[232:235] offset:40960
    ds_write_b128 v10, a[236:239] offset:45056
    ds_write_b128 v10, a[240:243] offset:49152
    ds_write_b128 v10, a[244:247] offset:53248
    ds_write_b128 v10, a[248:251] offset:57344
    ds_write_b128 v10, a[252:255] offset:61440
    s_lshl_b32 s6, s58, 2
    s_and_b32 s10, s59, 3
    s_add_u32 s6, s6, s10
    s_lshr_b32 s7, s59, 2
    s_lshl_b32 s12, s6, 6
    s_lshl_b32 s13, s3, 3
    s_add_u32 s12, s12, s13
    s_lshl_b32 s12, s12, 10
    s_add_u32 s12, s12, 6291456
    s_add_u32 s44, s38, s12
    s_addc_u32 s45, s39, 0
    v_add_u32 v19, 4096, v5
    v_add_u32 v20, 32768, v5
    v_add_u32 v21, 36864, v5
    s_lshl_b32 s10, s6, 5
    s_lshl_b32 s11, s7, 2
    s_add_u32 s10, s10, s11
    s_add_u32 s10, s10, s3
    s_lshl_b32 s50, s10, 10
    s_add_u32 s10, s50, 0
    s_add_u32 s52, s38, s10
    s_addc_u32 s53, s39, 0
    s_mov_b64 exec, 1
    s_lshl_b32 s10, s58, 2
    v_mov_b32 v2, s10
    s_mov_b32 s15, 0
qip_interleave_layers__linear_kernel_hedgehog__mixer_channel_mlp__prompt_kernel_41:
    global_load_dword v26, v2, s[36:37] sc1
    s_waitcnt vmcnt(0)
    v_readfirstlane_b32 s10, v26
    s_cmp_ge_u32 s10, 1
    s_cbranch_scc1 qiq_interleave_layers__linear_kernel_hedgehog__mixer_channel_mlp__prompt_kernel_42
    s_sleep 1
    s_add_u32 s15, s15, 1
    s_cmp_lt_u32 s15, 400000
    s_cbranch_scc1 qip_interleave_layers__linear_kernel_hedgehog__mixer_channel_mlp__prompt_kernel_41
qiq_interleave_layers__linear_kernel_hedgehog__mixer_channel_mlp__prompt_kernel_42:
    s_lshl_b32 s10, s58, 10
    v_mov_b32 v2, s10
    s_mov_b32 s15, 0
qp_interleave_layers__linear_kernel_hedgehog__mixer_channel_mlp__prompt_kernel_43:
    global_load_dword v26, v2, s[62:63] offset:384 sc1
    s_waitcnt vmcnt(0)
    v_readfirstlane_b32 s10, v26
    s_cmp_ge_u32 s10, 8
    s_cbranch_scc1 qq_interleave_layers__linear_kernel_hedgehog__mixer_channel_mlp__prompt_kernel_44
    s_sleep 1
    s_add_u32 s15, s15, 1
    s_cmp_lt_u32 s15, 400000
    s_cbranch_scc1 qp_interleave_layers__linear_kernel_hedgehog__mixer_channel_mlp__prompt_kernel_43
qq_interleave_layers__linear_kernel_hedgehog__mixer_channel_mlp__prompt_kernel_44:
    s_mov_b64 exec, -1
    global_load_dwordx4 v[96:99], v5, s[44:45] offset:0 sc1
    global_load_dwordx4 v[128:131], v20, s[44:45] offset:0 sc1
    global_load_dwordx4 v[100:103], v5, s[44:45] offset:1024 sc1
    global_load_dwordx4 v[132:135], v20, s[44:45] offset:1024 sc1
    global_load_dwordx4 v[104:107], v5, s[44:45] offset:2048 sc1
    global_load_dwordx4 v[136:139], v20, s[44:45] offset:2048 sc1
    global_load_dwordx4 v[108:111], v5, s[44:45] offset:3072 sc1
    global_load_dwordx4 v[140:143], v20, s[44:45] offset:3072 sc1
    global_load_dwordx4 v[112:115], v19, s[44:45] offset:0 sc1
    global_load_dwordx4 v[144:147], v21, s[44:45] offset:0 sc1
    global_load_dwordx4 v[116:119], v19, s[44:45] offset:1024 sc1
    global_load_dwordx4 v[148:151], v21, s[44:45] offset:1024 sc1
    global_load_dwordx4 v[120:123], v19, s[44:45] offset:2048 sc1
    global_load_dwordx4 v[152:155], v21, s[44:45] offset:2048 sc1
    global_load_dwordx4 v[124:127], v19, s[44:45] offset:3072 sc1
    global_load_dwordx4 v[156:159], v21, s[44:45] offset:3072 sc1
    global_load_dwordx4 v[176:179], v5, s[52:53] sc1
    v_add_u32 v19, 16384, v5
    global_load_dwordx4 v[180:183], v19, s[52:53] sc1
    s_cmp_lt_u32 s59, 8
    s_cbranch_scc1 wm_interleave_layers__linear_kernel_hedgehog__mixer_channel_mlp__prompt_kernel_45
    s_cmp_lg_u32 s3, 1
    s_cbranch_scc1 wm_interleave_layers__linear_kernel_hedgehog__mixer_channel_mlp__prompt_kernel_45
    s_lshl_b32 s10, s58, 3
    s_and_b32 s11, s59, 7
    s_add_u32 s10, s10, s11
    s_lshl_b32 s11, s10, 14
    s_add_u32 s11, s11, 2097152
    s_add_u32 s46, s38, s11
    s_addc_u32 s47, s39, 0
    global_load_dwordx4 v[32:35], v5, s[46:47] offset:0
    global_load_dwordx4 v[36:39], v5, s[46:47] offset:1024
    global_load_dwordx4 v[40:43], v5, s[46:47] offset:2048
    global_load_dwordx4 v[44:47], v5, s[46:47] offset:3072
    s_add_u32 s46, s46, 4096
    s_addc_u32 s47, s47, 0
    global_load_dwordx4 v[48:51], v5, s[46:47] offset:0
    global_load_dwordx4 v[52:55], v5, s[46:47] offset:1024
    global_load_dwordx4 v[56:59], v5, s[46:47] offset:2048
    global_load_dwordx4 v[60:63], v5, s[46:47] offset:3072
    s_add_u32 s46, s46, 4096
    s_addc_u32 s47, s47, 0
    global_load_dwordx4 v[32:35], v5, s[46:47] offset:0
    global_load_dwordx4 v[36:39], v5, s[46:47] offset:1024
    global_load_dwordx4 v[40:43], v5, s[46:47] offset:2048
    global_load_dwordx4 v[44:47], v5, s[46:47] offset:3072
    s_add_u32 s46, s46, 4096
    s_addc_u32 s47, s47, 0
    global_load_dwordx4 v[48:51], v5, s[46:47] offset:0
    global_load_dwordx4 v[52:55], v5, s[46:47] offset:1024
    global_load_dwordx4 v[56:59], v5, s[46:47] offset:2048
    global_load_dwordx4 v[60:63], v5, s[46:47] offset:3072
    s_add_u32 s46, s46, 4096
    s_addc_u32 s47, s47, 0
    s_lshl_b32 s11, s10, 11
    s_add_u32 s11, s11, 18087936
    s_add_u32 s46, s38, s11
    s_addc_u32 s47, s39, 0
    global_load_dwordx4 v[64:67], v5, s[46:47]
    global_load_dwordx4 v[68:71], v5, s[46:47] offset:1024
wm_interleave_layers__linear_kernel_hedgehog__mixer_channel_mlp__prompt_kernel_45:
    s_cmp_lt_u32 s59, 8
    s_cbranch_scc1 wm_interleave_layers__linear_kernel_hedgehog__mixer_channel_mlp__prompt_kernel_46
    s_cmp_lt_u32 s3, 2
    s_cbranch_scc1 wm_interleave_layers__linear_kernel_hedgehog__mixer_channel_mlp__prompt_kernel_46
    s_lshl_b32 s10, s58, 3
    s_and_b32 s11, s59, 7
    s_add_u32 s10, s10, s11
    s_mul_i32 s10, s10, 57344
    s_and_b32 s11, s3, 1
    s_mul_i32 s11, s11, 28672
    s_add_u32 s10, s10, s11
    s_add_u32 s10, s10, 10485760
    s_add_u32 s46, s38, s10
    s_addc_u32 s47, s39, 0
    global_load_dwordx4 v[32:35], v5, s[46:47] offset:0
    global_load_dwordx4 v[36:39], v5, s[46:47] offset:1024
    global_load_dwordx4 v[40:43], v5, s[46:47] offset:2048
    global_load_dwordx4 v[44:47], v5, s[46:47] offset:3072
    s_add_u32 s46, s46, 4096
    s_addc_u32 s47, s47, 0
    global_load_dwordx4 v[48:51], v5, s[46:47] offset:0
    global_load_dwordx4 v[52:55], v5, s[46:47] offset:1024
    global_load_dwordx4 v[56:59], v5, s[46:47] offset:2048
    global_load_dwordx4 v[60:63], v5, s[46:47] offset:3072
    s_add_u32 s46, s46, 4096
    s_addc_u32 s47, s47, 0
    global_load_dwordx4 v[32:35], v5, s[46:47] offset:0
    global_load_dwordx4 v[36:39], v5, s[46:47] offset:1024
    global_load_dwordx4 v[40:43], v5, s[46:47] offset:2048
    global_load_dwordx4 v[44:47], v5, s[46:47] offset:3072
    s_add_u32 s46, s46, 4096
    s_addc_u32 s47, s47, 0
    global_load_dwordx4 v[48:51], v5, s[46:47] offset:0
    global_load_dwordx4 v[52:55], v5, s[46:47] offset:1024
    global_load_dwordx4 v[56:59], v5, s[46:47] offset:2048
    global_load_dwordx4 v[60:63], v5, s[46:47] offset:3072
    s_add_u32 s46, s46, 4096
    s_addc_u32 s47, s47, 0
    global_load_dwordx4 v[32:35], v5, s[46:47] offset:0
    global_load_dwordx4 v[36:39], v5, s[46:47] offset:1024
    global_load_dwordx4 v[40:43], v5, s[46:47] offset:2048
    global_load_dwordx4 v[44:47], v5, s[46:47] offset:3072
    s_add_u32 s46, s46, 4096
    s_addc_u32 s47, s47, 0
    global_load_dwordx4 v[48:51], v5, s[46:47] offset:0
    global_load_dwordx4 v[52:55], v5, s[46:47] offset:1024
    global_load_dwordx4 v[56:59], v5, s[46:47] offset:2048
    global_load_dwordx4 v[60:63], v5, s[46:47] offset:3072
    s_add_u32 s46, s46, 4096
    s_addc_u32 s47, s47, 0
    global_load_dwordx4 v[32:35], v5, s[46:47] offset:0
    global_load_dwordx4 v[36:39], v5, s[46:47] offset:1024
    global_load_dwordx4 v[40:43], v5, s[46:47] offset:2048
    global_load_dwordx4 v[44:47], v5, s[46:47] offset:3072
    s_add_u32 s46, s46, 4096
    s_addc_u32 s47, s47, 0
wm_interleave_layers__linear_kernel_hedgehog__mixer_channel_mlp__prompt_kernel_46:
    v_lshrrev_b32 v15, 3, v1
    v_and_b32 v16, 7, v1
    v_lshrrev_b32 v17, 1, v16
    v_lshrrev_b32 v18, 1, v15
    v_and_b32 v18, 3, v18
    v_xor_b32 v17, v17, v18
    v_and_b32 v16, 1, v16
    v_lshlrev_b32 v16, 4, v16
    v_lshl_add_u32 v16, v17, 5, v16
    v_mul_u32_u24 v0, 3584, v15
    v_add_u32 v0, v0, v16
    s_min_u32 s10, s59, 13
    s_lshl_b32 s4, s10, 8
    s_add_u32 s5, s4, 128
    s_mul_i32 s11, s3, 28672
    s_add_u32 s12, s11, s4
    s_add_u32 s24, s26, s12
    s_addc_u32 s25, s27, 0
    s_add_u32 s12, s11, s5
    s_add_u32 s100, s26, s12
    s_addc_u32 s101, s27, 0
    s_cmp_eq_u32 s3, 0
    s_cbranch_scc1 nl_interleave_layers__linear_kernel_hedgehog__mixer_channel_mlp__prompt_kernel_47
    global_load_dwordx4 a[0:3], v0, s[24:25]
    s_add_u32 s24, s24, 114688
    s_addc_u32 s25, s25, 0
    global_load_dwordx4 a[4:7], v0, s[24:25]
    s_add_u32 s24, s24, 114688
    s_addc_u32 s25, s25, 0
    global_load_dwordx4 a[8:11], v0, s[24:25]
    s_add_u32 s24, s24, 114688
    s_addc_u32 s25, s25, 0
    global_load_dwordx4 a[12:15], v0, s[24:25]
    s_add_u32 s24, s24, 114688
    s_addc_u32 s25, s25, 0
    global_load_dwordx4 a[16:19], v0, s[24:25]
    s_add_u32 s24, s24, 114688
    s_addc_u32 s25, s25, 0
    global_load_dwordx4 a[20:23], v0, s[24:25]
    s_add_u32 s24, s24, 114688
    s_addc_u32 s25, s25, 0
    global_load_dwordx4 a[24:27], v0, s[24:25]
    s_add_u32 s24, s24, 114688
    s_addc_u32 s25, s25, 0
    global_load_dwordx4 a[28:31], v0, s[24:25]
    s_add_u32 s24, s24, 114688
    s_addc_u32 s25, s25, 0
    global_load_dwordx4 a[32:35], v0, s[24:25]
    s_add_u32 s24, s24, 114688
    s_addc_u32 s25, s25, 0
    global_load_dwordx4 a[36:39], v0, s[24:25]
    s_add_u32 s24, s24, 114688
    s_addc_u32 s25, s25, 0
    global_load_dwordx4 a[40:43], v0, s[24:25]
    s_add_u32 s24, s24, 114688
    s_addc_u32 s25, s25, 0
    global_load_dwordx4 a[44:47], v0, s[24:25]
    s_add_u32 s24, s24, 114688
    s_addc_u32 s25, s25, 0
    global_load_dwordx4 a[48:51], v0, s[24:25]
    s_add_u32 s24, s24, 114688
    s_addc_u32 s25, s25, 0
    global_load_dwordx4 a[52:55], v0, s[24:25]
    s_add_u32 s24, s24, 114688
    s_addc_u32 s25, s25, 0
    global_load_dwordx4 a[56:59], v0, s[24:25]
    s_add_u32 s24, s24, 114688
    s_addc_u32 s25, s25, 0
    global_load_dwordx4 a[60:63], v0, s[24:25]
    s_add_u32 s24, s24, 114688
    s_addc_u32 s25, s25, 0
    global_load_dwordx4 a[64:67], v0, s[100:101]
    s_add_u32 s100, s100, 114688
    s_addc_u32 s101, s101, 0
    global_load_dwordx4 a[68:71], v0, s[100:101]
    s_add_u32 s100, s100, 114688
    s_addc_u32 s101, s101, 0
    global_load_dwordx4 a[72:75], v0, s[100:101]
    s_add_u32 s100, s100, 114688
    s_addc_u32 s101, s101, 0
    global_load_dwordx4 a[76:79], v0, s[100:101]
    s_add_u32 s100, s100, 114688
    s_addc_u32 s101, s101, 0
    global_load_dwordx4 a[80:83], v0, s[100:101]
    s_add_u32 s100, s100, 114688
    s_addc_u32 s101, s101, 0
    global_load_dwordx4 a[84:87], v0, s[100:101]
    s_add_u32 s100, s100, 114688
    s_addc_u32 s101, s101, 0
    global_load_dwordx4 a[88:91], v0, s[100:101]
    s_add_u32 s100, s100, 114688
    s_addc_u32 s101, s101, 0
    global_load_dwordx4 a[92:95], v0, s[100:101]
    s_add_u32 s100, s100, 114688
    s_addc_u32 s101, s101, 0
    global_load_dwordx4 a[96:99], v0, s[100:101]
    s_add_u32 s100, s100, 114688
    s_addc_u32 s101, s101, 0
    global_load_dwordx4 a[100:103], v0, s[100:101]
    s_add_u32 s100, s100, 114688
    s_addc_u32 s101, s101, 0
    global_load_dwordx4 a[104:107], v0, s[100:101]
    s_add_u32 s100, s100, 114688
    s_addc_u32 s101, s101, 0
    global_load_dwordx4 a[108:111], v0, s[100:101]
    s_add_u32 s100, s100, 114688
    s_addc_u32 s101, s101, 0
    global_load_dwordx4 a[112:115], v0, s[100:101]
    s_add_u32 s100, s100, 114688
    s_addc_u32 s101, s101, 0
    global_load_dwordx4 a[116:119], v0, s[100:101]
    s_add_u32 s100, s100, 114688
    s_addc_u32 s101, s101, 0
    global_load_dwordx4 a[120:123], v0, s[100:101]
    s_add_u32 s100, s100, 114688
    s_addc_u32 s101, s101, 0
    global_load_dwordx4 a[124:127], v0, s[100:101]
    s_add_u32 s100, s100, 114688
    s_addc_u32 s101, s101, 0
nl_interleave_layers__linear_kernel_hedgehog__mixer_channel_mlp__prompt_kernel_47:
    s_cmp_lg_u32 s3, 0
    s_cbranch_scc1 wt_interleave_layers__linear_kernel_hedgehog__mixer_channel_mlp__prompt_kernel_48
    s_mov_b64 exec, 0xffff
    v_lshlrev_b32 v2, 2, v1
    s_mov_b32 s15, 0
fp_interleave_layers__linear_kernel_hedgehog__mixer_channel_mlp__prompt_kernel_49:
    global_load_dword v26, v2, s[36:37] sc1
    s_waitcnt vmcnt(0)
    v_cmp_gt_u32 vcc, 1, v26
    s_nop 4
    s_cbranch_vccz fq_interleave_layers__linear_kernel_hedgehog__mixer_channel_mlp__prompt_kernel_50
    s_sleep 1
    s_add_u32 s15, s15, 1
    s_cmp_lt_u32 s15, 400000
    s_cbranch_scc1 fp_interleave_layers__linear_kernel_hedgehog__mixer_channel_mlp__prompt_kernel_49
fq_interleave_layers__linear_kernel_hedgehog__mixer_channel_mlp__prompt_kernel_50:
    v_lshlrev_b32 v2, 10, v1
    v_mov_b32 v27, 16
    s_mov_b32 s15, 0
pp_interleave_layers__linear_kernel_hedgehog__mixer_channel_mlp__prompt_kernel_51:
    global_load_dword v26, v2, s[62:63] sc1
    s_waitcnt vmcnt(0)
    v_cmp_gt_u32 vcc, v27, v26
    s_nop 4
    s_cbranch_vccz pq_interleave_layers__linear_kernel_hedgehog__mixer_channel_mlp__prompt_kernel_52
    s_sleep 1
    s_add_u32 s15, s15, 1
    s_cmp_lt_u32 s15, 400000
    s_cbranch_scc1 pp_interleave_layers__linear_kernel_hedgehog__mixer_channel_mlp__prompt_kernel_51
pq_interleave_layers__linear_kernel_hedgehog__mixer_channel_mlp__prompt_kernel_52:
    s_mov_b64 exec, -1
wt_interleave_layers__linear_kernel_hedgehog__mixer_channel_mlp__prompt_kernel_48:
    s_waitcnt lgkmcnt(0)
    s_barrier
    s_lshl_b32 s10, s58, 10
    v_and_b32 v2, 15, v1
    v_lshlrev_b32 v2, 2, v2
    v_add_u32 v2, s10, v2
    global_load_dword v26, v2, s[62:63] offset:768 sc1
    s_waitcnt vmcnt(0)
    v_cmp_ne_u32 vcc, s60, v26
    s_nop 4
    s_cmp_eq_u64 vcc, 0
    s_cselect_b32 s61, 1, 0
L_layer:
    s_nop 15
    s_nop 3
    v_lshlrev_b32 v9, 2, v1
    v_mov_b32 v10, 0x3f803f80
    s_mul_i32 s13, s9, 131072
    s_lshl_b32 s10, s3, 10
    s_add_u32 s10, s10, 17891328
    s_add_u32 s10, s10, s13
    s_lshl_b32 s11, s3, 14
    s_add_u32 s11, s11, 17825792
    s_add_u32 s11, s11, s13
    s_add_u32 s40, s38, s10
    s_addc_u32 s41, s39, 0
    s_add_u32 s42, s38, s11
    s_addc_u32 s43, s39, 0
    global_load_dwordx4 v[12:15], v5, s[40:41] sc1
    v_add_u32 v16, 4096, v9
    v_add_u32 v17, 8192, v9
    v_add_u32 v18, 12288, v9
    global_load_dword v32, v9, s[42:43] offset:0 sc1
    global_load_dword v33, v9, s[42:43] offset:256 sc1
    global_load_dword v34, v9, s[42:43] offset:512 sc1
    global_load_dword v35, v9, s[42:43] offset:768 sc1
    global_load_dword v36, v9, s[42:43] offset:1024 sc1
    global_load_dword v37, v9, s[42:43] offset:1280 sc1
    global_load_dword v38, v9, s[42:43] offset:1536 sc1
    global_load_dword v39, v9, s[42:43] offset:1792 sc1
    global_load_dword v40, v9, s[42:43] offset:2048 sc1
    global_load_dword v41, v9, s[42:43] offset:2304 sc1
    global_load_dword v42, v9, s[42:43] offset:2560 sc1
    global_load_dword v43, v9, s[42:43] offset:2816 sc1
    global_load_dword v44, v9, s[42:43] offset:3072 sc1
    global_load_dword v45, v9, s[42:43] offset:3328 sc1
    global_load_dword v46, v9, s[42:43] offset:3584 sc1
    global_load_dword v47, v9, s[42:43] offset:3840 sc1
    global_load_dword v48, v16, s[42:43] offset:0 sc1
    global_load_dword v49, v16, s[42:43] offset:256 sc1
    global_load_dword v50, v16, s[42:43] offset:512 sc1
    global_load_dword v51, v16, s[42:43] offset:768 sc1
    global_load_dword v52, v16, s[42:43] offset:1024 sc1
    global_load_dword v53, v16, s[42:43] offset:1280 sc1
    global_load_dword v54, v16, s[42:43] offset:1536 sc1
    global_load_dword v55, v16, s[42:43] offset:1792 sc1
    global_load_dword v56, v16, s[42:43] offset:2048 sc1
    global_load_dword v57, v16, s[42:43] offset:2304 sc1
    global_load_dword v58, v16, s[42:43] offset:2560 sc1
    global_load_dword v59, v16, s[42:43] offset:2816 sc1
    global_load_dword v60, v16, s[42:43] offset:3072 sc1
    global_load_dword v61, v16, s[42:43] offset:3328 sc1
    global_load_dword v62, v16, s[42:43] offset:3584 sc1
    global_load_dword v63, v16, s[42:43] offset:3840 sc1
    global_load_dword v64, v17, s[42:43] offset:0 sc1
    global_load_dword v65, v17, s[42:43] offset:256 sc1
    global_load_dword v66, v17, s[42:43] offset:512 sc1
    global_load_dword v67, v17, s[42:43] offset:768 sc1
    global_load_dword v68, v17, s[42:43] offset:1024 sc1
    global_load_dword v69, v17, s[42:43] offset:1280 sc1
    global_load_dword v70, v17, s[42:43] offset:1536 sc1
    global_load_dword v71, v17, s[42:43] offset:1792 sc1
    global_load_dword v72, v17, s[42:43] offset:2048 sc1
    global_load_dword v73, v17, s[42:43] offset:2304 sc1
    global_load_dword v74, v17, s[42:43] offset:2560 sc1
    global_load_dword v75, v17, s[42:43] offset:2816 sc1
    global_load_dword v76, v17, s[42:43] offset:3072 sc1
    global_load_dword v77, v17, s[42:43] offset:3328 sc1
    global_load_dword v78, v17, s[42:43] offset:3584 sc1
    global_load_dword v79, v17, s[42:43] offset:3840 sc1
    global_load_dword v80, v18, s[42:43] offset:0 sc1
    global_load_dword v81, v18, s[42:43] offset:256 sc1
    global_load_dword v82, v18, s[42:43] offset:512 sc1
    global_load_dword v83, v18, s[42:43] offset:768 sc1
    global_load_dword v84, v18, s[42:43] offset:1024 sc1
    global_load_dword v85, v18, s[42:43] offset:1280 sc1
    global_load_dword v86, v18, s[42:43] offset:1536 sc1
    global_load_dword v87, v18, s[42:43] offset:1792 sc1
    s_lshl_b32 s10, s3, 12
    s_add_u32 s49, s10, 131072
    s_waitcnt vmcnt(56)
    v_cvt_pk_bf16_f32 v12, v12, v13
    v_cvt_pk_bf16_f32 v13, v14, v15
    v_lshl_add_u32 v14, v1, 3, s49
    ds_write_b64 v14, v[12:13]
    v_lshl_add_u32 v14, v4, 3, s49
    s_waitcnt lgkmcnt(0)
    ds_read_b64 v[192:193], v14 offset:0
    ds_read_b64 v[194:195], v14 offset:32
    ds_read_b64 v[196:197], v14 offset:64
    ds_read_b64 v[198:199], v14 offset:96
    ds_read_b64 v[200:201], v14 offset:128
    ds_read_b64 v[202:203], v14 offset:160
    ds_read_b64 v[204:205], v14 offset:192
    ds_read_b64 v[206:207], v14 offset:224
    ds_read_b64 v[208:209], v14 offset:256
    ds_read_b64 v[210:211], v14 offset:288
    ds_read_b64 v[212:213], v14 offset:320
    ds_read_b64 v[214:215], v14 offset:352
    ds_read_b64 v[216:217], v14 offset:384
    ds_read_b64 v[218:219], v14 offset:416
    ds_read_b64 v[220:221], v14 offset:448
    ds_read_b64 v[222:223], v14 offset:480
    v_mov_b32 v29, 0x358637bd
    v_add_u32 v11, s49, v5
    s_waitcnt vmcnt(48) lgkmcnt(0)
    v_cvt_pk_bf16_f32 v32, v32, v33
    v_cvt_pk_bf16_f32 v33, v34, v35
    v_cvt_pk_bf16_f32 v34, v36, v37
    v_cvt_pk_bf16_f32 v35, v38, v39
    s_nop 1
    v_mfma_f32_16x16x32_bf16 v[224:227], v[32:35], v[96:99], 0
    v_mfma_f32_16x16x32_bf16 v[228:231], v[192:195], v[96:99], 0
    v_mfma_f32_16x16x32_bf16 v[232:235], v[32:35], v[128:131], 0
    v_mfma_f32_16x16x32_bf16 v[236:239], v[192:195], v[128:131], 0
    global_load_dword v88, v18, s[42:43] offset:2048 sc1
    global_load_dword v89, v18, s[42:43] offset:2304 sc1
    global_load_dword v90, v18, s[42:43] offset:2560 sc1
    global_load_dword v91, v18, s[42:43] offset:2816 sc1
    global_load_dword v92, v18, s[42:43] offset:3072 sc1
    global_load_dword v93, v18, s[42:43] offset:3328 sc1
    global_load_dword v94, v18, s[42:43] offset:3584 sc1
    global_load_dword v95, v18, s[42:43] offset:3840 sc1
    s_waitcnt vmcnt(48)
    v_cvt_pk_bf16_f32 v36, v40, v41
    v_cvt_pk_bf16_f32 v37, v42, v43
    v_cvt_pk_bf16_f32 v38, v44, v45
    v_cvt_pk_bf16_f32 v39, v46, v47
    s_nop 1
    v_mfma_f32_16x16x32_bf16 v[240:243], v[36:39], v[100:103], 0
    v_mfma_f32_16x16x32_bf16 v[244:247], v[196:199], v[100:103], 0
    v_mfma_f32_16x16x32_bf16 v[248:251], v[36:39], v[132:135], 0
    v_mfma_f32_16x16x32_bf16 v[252:255], v[196:199], v[132:135], 0
    v_cvt_pk_bf16_f32 v228, 0, v228
    v_cvt_pk_bf16_f32 v236, 0, v236
    v_add_f32 v228, v228, v29
    v_add_f32 v236, v236, v29
    v_cvt_pk_bf16_f32 v228, 0, v228
    v_cvt_pk_bf16_f32 v236, 0, v236
    v_rcp_f32 v228, v228
    v_rcp_f32 v236, v236
    v_cvt_pk_bf16_f32 v224, 0, v224
    v_cvt_pk_bf16_f32 v232, 0, v232
    v_cvt_pk_bf16_f32 v225, 0, v225
    v_cvt_pk_bf16_f32 v233, 0, v233
    v_cvt_pk_bf16_f32 v226, 0, v226
    v_cvt_pk_bf16_f32 v234, 0, v234
    v_cvt_pk_bf16_f32 v227, 0, v227
    v_cvt_pk_bf16_f32 v235, 0, v235
    v_pk_mul_f32 v[224:225], v[224:225], v[228:229] op_sel_hi:[1,0]
    v_pk_mul_f32 v[232:233], v[232:233], v[236:237] op_sel_hi:[1,0]
    v_pk_mul_f32 v[226:227], v[226:227], v[228:229] op_sel_hi:[1,0]
    v_pk_mul_f32 v[234:235], v[234:235], v[236:237] op_sel_hi:[1,0]
    v_cvt_pk_bf16_f32 v96, v224, v225
    v_cvt_pk_bf16_f32 v128, v232, v233
    v_cvt_pk_bf16_f32 v97, v226, v227
    v_cvt_pk_bf16_f32 v129, v234, v235
    s_waitcnt vmcnt(40)
    v_cvt_pk_bf16_f32 v40, v48, v49
    v_cvt_pk_bf16_f32 v41, v50, v51
    v_cvt_pk_bf16_f32 v42, v52, v53
    v_cvt_pk_bf16_f32 v43, v54, v55
    s_nop 1
    v_mfma_f32_16x16x32_bf16 v[224:227], v[40:43], v[104:107], 0
    v_mfma_f32_16x16x32_bf16 v[228:231], v[200:203], v[104:107], 0
    v_mfma_f32_16x16x32_bf16 v[232:235], v[40:43], v[136:139], 0
    v_mfma_f32_16x16x32_bf16 v[236:239], v[200:203], v[136:139], 0
    v_cvt_pk_bf16_f32 v244, 0, v244
    v_cvt_pk_bf16_f32 v252, 0, v252
    v_add_f32 v244, v244, v29
    v_add_f32 v252, v252, v29
    v_cvt_pk_bf16_f32 v244, 0, v244
    v_cvt_pk_bf16_f32 v252, 0, v252
    v_rcp_f32 v244, v244
    v_rcp_f32 v252, v252
    v_cvt_pk_bf16_f32 v240, 0, v240
    v_cvt_pk_bf16_f32 v248, 0, v248
    v_cvt_pk_bf16_f32 v241, 0, v241
    v_cvt_pk_bf16_f32 v249, 0, v249
    v_cvt_pk_bf16_f32 v242, 0, v242
    v_cvt_pk_bf16_f32 v250, 0, v250
    v_cvt_pk_bf16_f32 v243, 0, v243
    v_cvt_pk_bf16_f32 v251, 0, v251
    v_pk_mul_f32 v[240:241], v[240:241], v[244:245] op_sel_hi:[1,0]
    v_pk_mul_f32 v[248:249], v[248:249], v[252:253] op_sel_hi:[1,0]
    v_pk_mul_f32 v[242:243], v[242:243], v[244:245] op_sel_hi:[1,0]
    v_pk_mul_f32 v[250:251], v[250:251], v[252:253] op_sel_hi:[1,0]
    v_cvt_pk_bf16_f32 v98, v240, v241
    v_cvt_pk_bf16_f32 v130, v248, v249
    v_cvt_pk_bf16_f32 v99, v242, v243
    v_cvt_pk_bf16_f32 v131, v250, v251
    ds_write_b128 v11, v[96:99] offset:0
    ds_write_b128 v11, v[128:131] offset:16384
    s_waitcnt vmcnt(32)
    v_cvt_pk_bf16_f32 v44, v56, v57
    v_cvt_pk_bf16_f32 v45, v58, v59
    v_cvt_pk_bf16_f32 v46, v60, v61
    v_cvt_pk_bf16_f32 v47, v62, v63
    s_nop 1
    v_mfma_f32_16x16x32_bf16 v[240:243], v[44:47], v[108:111], 0
    v_mfma_f32_16x16x32_bf16 v[244:247], v[204:207], v[108:111], 0
    v_mfma_f32_16x16x32_bf16 v[248:251], v[44:47], v[140:143], 0
    v_mfma_f32_16x16x32_bf16 v[252:255], v[204:207], v[140:143], 0
    v_cvt_pk_bf16_f32 v228, 0, v228
    v_cvt_pk_bf16_f32 v236, 0, v236
    v_add_f32 v228, v228, v29
    v_add_f32 v236, v236, v29
    v_cvt_pk_bf16_f32 v228, 0, v228
    v_cvt_pk_bf16_f32 v236, 0, v236
    v_rcp_f32 v228, v228
    v_rcp_f32 v236, v236
    v_cvt_pk_bf16_f32 v224, 0, v224
    v_cvt_pk_bf16_f32 v232, 0, v232
    v_cvt_pk_bf16_f32 v225, 0, v225
    v_cvt_pk_bf16_f32 v233, 0, v233
    v_cvt_pk_bf16_f32 v226, 0, v226
    v_cvt_pk_bf16_f32 v234, 0, v234
    v_cvt_pk_bf16_f32 v227, 0, v227
    v_cvt_pk_bf16_f32 v235, 0, v235
    v_pk_mul_f32 v[224:225], v[224:225], v[228:229] op_sel_hi:[1,0]
    v_pk_mul_f32 v[232:233], v[232:233], v[236:237] op_sel_hi:[1,0]
    v_pk_mul_f32 v[226:227], v[226:227], v[228:229] op_sel_hi:[1,0]
    v_pk_mul_f32 v[234:235], v[234:235], v[236:237] op_sel_hi:[1,0]
    v_cvt_pk_bf16_f32 v104, v224, v225
    v_cvt_pk_bf16_f32 v136, v232, v233
    v_cvt_pk_bf16_f32 v105, v226, v227
    v_cvt_pk_bf16_f32 v137, v234, v235
    s_waitcnt vmcnt(24)
    v_cvt_pk_bf16_f32 v48, v64, v65
    v_cvt_pk_bf16_f32 v49, v66, v67
    v_cvt_pk_bf16_f32 v50, v68, v69
    v_cvt_pk_bf16_f32 v51, v70, v71
    s_nop 1
    v_mfma_f32_16x16x32_bf16 v[224:227], v[48:51], v[112:115], 0
    v_mfma_f32_16x16x32_bf16 v[228:231], v[208:211], v[112:115], 0
    v_mfma_f32_16x16x32_bf16 v[232:235], v[48:51], v[144:147], 0
    v_mfma_f32_16x16x32_bf16 v[236:239], v[208:211], v[144:147], 0
    v_cvt_pk_bf16_f32 v244, 0, v244
    v_cvt_pk_bf16_f32 v252, 0, v252
    v_add_f32 v244, v244, v29
    v_add_f32 v252, v252, v29
    v_cvt_pk_bf16_f32 v244, 0, v244
    v_cvt_pk_bf16_f32 v252, 0, v252
    v_rcp_f32 v244, v244
    v_rcp_f32 v252, v252
    v_cvt_pk_bf16_f32 v240, 0, v240
    v_cvt_pk_bf16_f32 v248, 0, v248
    v_cvt_pk_bf16_f32 v241, 0, v241
    v_cvt_pk_bf16_f32 v249, 0, v249
    v_cvt_pk_bf16_f32 v242, 0, v242
    v_cvt_pk_bf16_f32 v250, 0, v250
    v_cvt_pk_bf16_f32 v243, 0, v243
    v_cvt_pk_bf16_f32 v251, 0, v251
    v_pk_mul_f32 v[240:241], v[240:241], v[244:245] op_sel_hi:[1,0]
    v_pk_mul_f32 v[248:249], v[248:249], v[252:253] op_sel_hi:[1,0]
    v_pk_mul_f32 v[242:243], v[242:243], v[244:245] op_sel_hi:[1,0]
    v_pk_mul_f32 v[250:251], v[250:251], v[252:253] op_sel_hi:[1,0]
    v_cvt_pk_bf16_f32 v106, v240, v241
    v_cvt_pk_bf16_f32 v138, v248, v249
    v_cvt_pk_bf16_f32 v107, v242, v243
    v_cvt_pk_bf16_f32 v139, v250, v251
    ds_write_b128 v11, v[104:107] offset:1024
    ds_write_b128 v11, v[136:139] offset:17408
    s_waitcnt vmcnt(16)
    v_cvt_pk_bf16_f32 v52, v72, v73
    v_cvt_pk_bf16_f32 v53, v74, v75
    v_cvt_pk_bf16_f32 v54, v76, v77
    v_cvt_pk_bf16_f32 v55, v78, v79
    s_nop 1
    v_mfma_f32_16x16x32_bf16 v[240:243], v[52:55], v[116:119], 0
    v_mfma_f32_16x16x32_bf16 v[244:247], v[212:215], v[116:119], 0
    v_mfma_f32_16x16x32_bf16 v[248:251], v[52:55], v[148:151], 0
    v_mfma_f32_16x16x32_bf16 v[252:255], v[212:215], v[148:151], 0
    v_cvt_pk_bf16_f32 v228, 0, v228
    v_cvt_pk_bf16_f32 v236, 0, v236
    v_add_f32 v228, v228, v29
    v_add_f32 v236, v236, v29
    v_cvt_pk_bf16_f32 v228, 0, v228
    v_cvt_pk_bf16_f32 v236, 0, v236
    v_rcp_f32 v228, v228
    v_rcp_f32 v236, v236
    v_cvt_pk_bf16_f32 v224, 0, v224
    v_cvt_pk_bf16_f32 v232, 0, v232
    v_cvt_pk_bf16_f32 v225, 0, v225
    v_cvt_pk_bf16_f32 v233, 0, v233
    v_cvt_pk_bf16_f32 v226, 0, v226
    v_cvt_pk_bf16_f32 v234, 0, v234
    v_cvt_pk_bf16_f32 v227, 0, v227
    v_cvt_pk_bf16_f32 v235, 0, v235
    v_pk_mul_f32 v[224:225], v[224:225], v[228:229] op_sel_hi:[1,0]
    v_pk_mul_f32 v[232:233], v[232:233], v[236:237] op_sel_hi:[1,0]
    v_pk_mul_f32 v[226:227], v[226:227], v[228:229] op_sel_hi:[1,0]
    v_pk_mul_f32 v[234:235], v[234:235], v[236:237] op_sel_hi:[1,0]
    v_cvt_pk_bf16_f32 v112, v224, v225
    v_cvt_pk_bf16_f32 v144, v232, v233
    v_cvt_pk_bf16_f32 v113, v226, v227
    v_cvt_pk_bf16_f32 v145, v234, v235
    s_waitcnt vmcnt(8)
    v_cvt_pk_bf16_f32 v56, v80, v81
    v_cvt_pk_bf16_f32 v57, v82, v83
    v_cvt_pk_bf16_f32 v58, v84, v85
    v_cvt_pk_bf16_f32 v59, v86, v87
    s_nop 1
    v_mfma_f32_16x16x32_bf16 v[224:227], v[56:59], v[120:123], 0
    v_mfma_f32_16x16x32_bf16 v[228:231], v[216:219], v[120:123], 0
    v_mfma_f32_16x16x32_bf16 v[232:235], v[56:59], v[152:155], 0
    v_mfma_f32_16x16x32_bf16 v[236:239], v[216:219], v[152:155], 0
    v_cvt_pk_bf16_f32 v244, 0, v244
    v_cvt_pk_bf16_f32 v252, 0, v252
    v_add_f32 v244, v244, v29
    v_add_f32 v252, v252, v29
    v_cvt_pk_bf16_f32 v244, 0, v244
    v_cvt_pk_bf16_f32 v252, 0, v252
    v_rcp_f32 v244, v244
    v_rcp_f32 v252, v252
    v_cvt_pk_bf16_f32 v240, 0, v240
    v_cvt_pk_bf16_f32 v248, 0, v248
    v_cvt_pk_bf16_f32 v241, 0, v241
    v_cvt_pk_bf16_f32 v249, 0, v249
    v_cvt_pk_bf16_f32 v242, 0, v242
    v_cvt_pk_bf16_f32 v250, 0, v250
    v_cvt_pk_bf16_f32 v243, 0, v243
    v_cvt_pk_bf16_f32 v251, 0, v251
    v_pk_mul_f32 v[240:241], v[240:241], v[244:245] op_sel_hi:[1,0]
    v_pk_mul_f32 v[248:249], v[248:249], v[252:253] op_sel_hi:[1,0]
    v_pk_mul_f32 v[242:243], v[242:243], v[244:245] op_sel_hi:[1,0]
    v_pk_mul_f32 v[250:251], v[250:251], v[252:253] op_sel_hi:[1,0]
    v_cvt_pk_bf16_f32 v114, v240, v241
    v_cvt_pk_bf16_f32 v146, v248, v249
    v_cvt_pk_bf16_f32 v115, v242, v243
    v_cvt_pk_bf16_f32 v147, v250, v251
    ds_write_b128 v11, v[112:115] offset:2048
    ds_write_b128 v11, v[144:147] offset:18432
    s_waitcnt vmcnt(0)
    v_cvt_pk_bf16_f32 v60, v88, v89
    v_cvt_pk_bf16_f32 v61, v90, v91
    v_cvt_pk_bf16_f32 v62, v92, v93
    v_cvt_pk_bf16_f32 v63, v94, v95
    s_nop 1
    v_mfma_f32_16x16x32_bf16 v[240:243], v[60:63], v[124:127], 0
    v_mfma_f32_16x16x32_bf16 v[244:247], v[220:223], v[124:127], 0
    v_mfma_f32_16x16x32_bf16 v[248:251], v[60:63], v[156:159], 0
    v_mfma_f32_16x16x32_bf16 v[252:255], v[220:223], v[156:159], 0
    v_cvt_pk_bf16_f32 v228, 0, v228
    v_cvt_pk_bf16_f32 v236, 0, v236
    v_add_f32 v228, v228, v29
    v_add_f32 v236, v236, v29
    v_cvt_pk_bf16_f32 v228, 0, v228
    v_cvt_pk_bf16_f32 v236, 0, v236
    v_rcp_f32 v228, v228
    v_rcp_f32 v236, v236
    v_cvt_pk_bf16_f32 v224, 0, v224
    v_cvt_pk_bf16_f32 v232, 0, v232
    v_cvt_pk_bf16_f32 v225, 0, v225
    v_cvt_pk_bf16_f32 v233, 0, v233
    v_cvt_pk_bf16_f32 v226, 0, v226
    v_cvt_pk_bf16_f32 v234, 0, v234
    v_cvt_pk_bf16_f32 v227, 0, v227
    v_cvt_pk_bf16_f32 v235, 0, v235
    v_pk_mul_f32 v[224:225], v[224:225], v[228:229] op_sel_hi:[1,0]
    v_pk_mul_f32 v[232:233], v[232:233], v[236:237] op_sel_hi:[1,0]
    v_pk_mul_f32 v[226:227], v[226:227], v[228:229] op_sel_hi:[1,0]
    v_pk_mul_f32 v[234:235], v[234:235], v[236:237] op_sel_hi:[1,0]
    v_cvt_pk_bf16_f32 v120, v224, v225
    v_cvt_pk_bf16_f32 v152, v232, v233
    v_cvt_pk_bf16_f32 v121, v226, v227
    v_cvt_pk_bf16_f32 v153, v234, v235
    v_cvt_pk_bf16_f32 v244, 0, v244
    v_cvt_pk_bf16_f32 v252, 0, v252
    v_add_f32 v244, v244, v29
    v_add_f32 v252, v252, v29
    v_cvt_pk_bf16_f32 v244, 0, v244
    v_cvt_pk_bf16_f32 v252, 0, v252
    v_rcp_f32 v244, v244
    v_rcp_f32 v252, v252
    v_cvt_pk_bf16_f32 v240, 0, v240
    v_cvt_pk_bf16_f32 v248, 0, v248
    v_cvt_pk_bf16_f32 v241, 0, v241
    v_cvt_pk_bf16_f32 v249, 0, v249
    v_cvt_pk_bf16_f32 v242, 0, v242
    v_cvt_pk_bf16_f32 v250, 0, v250
    v_cvt_pk_bf16_f32 v243, 0, v243
    v_cvt_pk_bf16_f32 v251, 0, v251
    v_pk_mul_f32 v[240:241], v[240:241], v[244:245] op_sel_hi:[1,0]
    v_pk_mul_f32 v[248:249], v[248:249], v[252:253] op_sel_hi:[1,0]
    v_pk_mul_f32 v[242:243], v[242:243], v[244:245] op_sel_hi:[1,0]
    v_pk_mul_f32 v[250:251], v[250:251], v[252:253] op_sel_hi:[1,0]
    v_cvt_pk_bf16_f32 v122, v240, v241
    v_cvt_pk_bf16_f32 v154, v248, v249
    v_cvt_pk_bf16_f32 v123, v242, v243
    v_cvt_pk_bf16_f32 v155, v250, v251
    ds_write_b128 v11, v[120:123] offset:3072
    ds_write_b128 v11, v[152:155] offset:19456
    s_cmp_lg_u32 s3, 0
    s_cbranch_scc1 l0_interleave_layers__linear_kernel_hedgehog__mixer_channel_mlp__prompt_kernel_53
l1_interleave_layers__linear_kernel_hedgehog__mixer_channel_mlp__prompt_kernel_54:
    global_load_dwordx4 a[0:3], v0, s[24:25]
    s_add_u32 s24, s24, 114688
    s_addc_u32 s25, s25, 0
    global_load_dwordx4 a[4:7], v0, s[24:25]
    s_add_u32 s24, s24, 114688
    s_addc_u32 s25, s25, 0
    global_load_dwordx4 a[8:11], v0, s[24:25]
    s_add_u32 s24, s24, 114688
    s_addc_u32 s25, s25, 0
    global_load_dwordx4 a[12:15], v0, s[24:25]
    s_add_u32 s24, s24, 114688
    s_addc_u32 s25, s25, 0
    global_load_dwordx4 a[16:19], v0, s[24:25]
    s_add_u32 s24, s24, 114688
    s_addc_u32 s25, s25, 0
    global_load_dwordx4 a[20:23], v0, s[24:25]
    s_add_u32 s24, s24, 114688
    s_addc_u32 s25, s25, 0
    global_load_dwordx4 a[24:27], v0, s[24:25]
    s_add_u32 s24, s24, 114688
    s_addc_u32 s25, s25, 0
    global_load_dwordx4 a[28:31], v0, s[24:25]
    s_add_u32 s24, s24, 114688
    s_addc_u32 s25, s25, 0
    global_load_dwordx4 a[32:35], v0, s[24:25]
    s_add_u32 s24, s24, 114688
    s_addc_u32 s25, s25, 0
    global_load_dwordx4 a[36:39], v0, s[24:25]
    s_add_u32 s24, s24, 114688
    s_addc_u32 s25, s25, 0
    global_load_dwordx4 a[40:43], v0, s[24:25]
    s_add_u32 s24, s24, 114688
    s_addc_u32 s25, s25, 0
    global_load_dwordx4 a[44:47], v0, s[24:25]
    s_add_u32 s24, s24, 114688
    s_addc_u32 s25, s25, 0
    global_load_dwordx4 a[48:51], v0, s[24:25]
    s_add_u32 s24, s24, 114688
    s_addc_u32 s25, s25, 0
    global_load_dwordx4 a[52:55], v0, s[24:25]
    s_add_u32 s24, s24, 114688
    s_addc_u32 s25, s25, 0
    global_load_dwordx4 a[56:59], v0, s[24:25]
    s_add_u32 s24, s24, 114688
    s_addc_u32 s25, s25, 0
    global_load_dwordx4 a[60:63], v0, s[24:25]
    s_add_u32 s24, s24, 114688
    s_addc_u32 s25, s25, 0
    global_load_dwordx4 a[64:67], v0, s[100:101]
    s_add_u32 s100, s100, 114688
    s_addc_u32 s101, s101, 0
    global_load_dwordx4 a[68:71], v0, s[100:101]
    s_add_u32 s100, s100, 114688
    s_addc_u32 s101, s101, 0
    global_load_dwordx4 a[72:75], v0, s[100:101]
    s_add_u32 s100, s100, 114688
    s_addc_u32 s101, s101, 0
    global_load_dwordx4 a[76:79], v0, s[100:101]
    s_add_u32 s100, s100, 114688
    s_addc_u32 s101, s101, 0
    global_load_dwordx4 a[80:83], v0, s[100:101]
    s_add_u32 s100, s100, 114688
    s_addc_u32 s101, s101, 0
    global_load_dwordx4 a[84:87], v0, s[100:101]
    s_add_u32 s100, s100, 114688
    s_addc_u32 s101, s101, 0
    global_load_dwordx4 a[88:91], v0, s[100:101]
    s_add_u32 s100, s100, 114688
    s_addc_u32 s101, s101, 0
    global_load_dwordx4 a[92:95], v0, s[100:101]
    s_add_u32 s100, s100, 114688
    s_addc_u32 s101, s101, 0
    global_load_dwordx4 a[96:99], v0, s[100:101]
    s_add_u32 s100, s100, 114688
    s_addc_u32 s101, s101, 0
    global_load_dwordx4 a[100:103], v0, s[100:101]
    s_add_u32 s100, s100, 114688
    s_addc_u32 s101, s101, 0
    global_load_dwordx4 a[104:107], v0, s[100:101]
    s_add_u32 s100, s100, 114688
    s_addc_u32 s101, s101, 0
    global_load_dwordx4 a[108:111], v0, s[100:101]
    s_add_u32 s100, s100, 114688
    s_addc_u32 s101, s101, 0
    global_load_dwordx4 a[112:115], v0, s[100:101]
    s_add_u32 s100, s100, 114688
    s_addc_u32 s101, s101, 0
    global_load_dwordx4 a[116:119], v0, s[100:101]
    s_add_u32 s100, s100, 114688
    s_addc_u32 s101, s101, 0
    global_load_dwordx4 a[120:123], v0, s[100:101]
    s_add_u32 s100, s100, 114688
    s_addc_u32 s101, s101, 0
    global_load_dwordx4 a[124:127], v0, s[100:101]
    s_add_u32 s100, s100, 114688
    s_addc_u32 s101, s101, 0
l0_interleave_layers__linear_kernel_hedgehog__mixer_channel_mlp__prompt_kernel_53:
    v_mov_b32 v12, v176
    v_mov_b32 v24, v180
    v_mov_b32 v13, v177
    v_mov_b32 v25, v181
    v_mov_b32 v14, v178
    v_mov_b32 v26, v182
    v_mov_b32 v15, v179
    v_mov_b32 v27, v183
    v_and_b32 v16, 7, v8
    v_lshlrev_b32 v17, 8, v8
    v_lshl_add_u32 v17, v7, 3, v17
    s_lshl_b32 s10, s3, 1
    v_xor_b32 v18, s10, v16
    v_lshl_add_u32 v20, v18, 5, v17
    v_xor_b32 v18, 1, v18
    v_lshl_add_u32 v21, v18, 5, v17
    v_add_u32 v22, 65536, v20
    v_add_u32 v23, 65536, v21
    v_add_u32 v19, 131072, v5
    s_waitcnt lgkmcnt(0)
    s_barrier
    ds_read_b128 v[64:67], v19 offset:0
    ds_read_b128 v[68:71], v19 offset:16384
    ds_read_b64_tr_b16 v[72:73], v20 offset:0
    ds_read_b64_tr_b16 v[74:75], v20 offset:4096
    ds_read_b64_tr_b16 v[76:77], v21 offset:0
    ds_read_b64_tr_b16 v[78:79], v21 offset:4096
    ds_read_b128 v[80:83], v19 offset:1024
    ds_read_b128 v[84:87], v19 offset:17408
    ds_read_b64_tr_b16 v[88:89], v20 offset:8192
    ds_read_b64_tr_b16 v[90:91], v20 offset:12288
    ds_read_b64_tr_b16 v[92:93], v21 offset:8192
    ds_read_b64_tr_b16 v[94:95], v21 offset:12288
    ds_read_b128 v[96:99], v19 offset:2048
    ds_read_b128 v[100:103], v19 offset:18432
    ds_read_b64_tr_b16 v[104:105], v20 offset:16384
    ds_read_b64_tr_b16 v[106:107], v20 offset:20480
    ds_read_b64_tr_b16 v[108:109], v21 offset:16384
    ds_read_b64_tr_b16 v[110:111], v21 offset:20480
    ds_read_b128 v[112:115], v19 offset:3072
    ds_read_b128 v[116:119], v19 offset:19456
    ds_read_b64_tr_b16 v[120:121], v20 offset:24576
    ds_read_b64_tr_b16 v[122:123], v20 offset:28672
    ds_read_b64_tr_b16 v[124:125], v21 offset:24576
    ds_read_b64_tr_b16 v[126:127], v21 offset:28672
    s_waitcnt lgkmcnt(0)
    v_mfma_f32_16x16x32_bf16 v[32:35], v[72:75], v[64:67], 0
    ds_read_b128 v[128:131], v19 offset:4096
    ds_read_b128 v[132:135], v19 offset:20480
    v_mfma_f32_16x16x32_bf16 v[40:43], v[72:75], v[68:71], 0
    ds_read_b64_tr_b16 v[136:137], v20 offset:32768
    ds_read_b64_tr_b16 v[138:139], v20 offset:36864
    v_mfma_f32_16x16x32_bf16 v[36:39], v[76:79], v[64:67], 0
    ds_read_b64_tr_b16 v[140:141], v21 offset:32768
    ds_read_b64_tr_b16 v[142:143], v21 offset:36864
    v_mfma_f32_16x16x32_bf16 v[44:47], v[76:79], v[68:71], 0
    ds_read_b128 v[144:147], v19 offset:5120
    ds_read_b128 v[148:151], v19 offset:21504
    v_mfma_f32_16x16x32_bf16 v[32:35], v[88:91], v[80:83], v[32:35]
    ds_read_b64_tr_b16 v[152:153], v20 offset:40960
    ds_read_b64_tr_b16 v[154:155], v20 offset:45056
    v_mfma_f32_16x16x32_bf16 v[40:43], v[88:91], v[84:87], v[40:43]
    ds_read_b64_tr_b16 v[156:157], v21 offset:40960
    ds_read_b64_tr_b16 v[158:159], v21 offset:45056
    v_mfma_f32_16x16x32_bf16 v[36:39], v[92:95], v[80:83], v[36:39]
    ds_read_b128 v[160:163], v19 offset:6144
    ds_read_b128 v[164:167], v19 offset:22528
    v_mfma_f32_16x16x32_bf16 v[44:47], v[92:95], v[84:87], v[44:47]
    ds_read_b64_tr_b16 v[168:169], v20 offset:49152
    ds_read_b64_tr_b16 v[170:171], v20 offset:53248
    v_mfma_f32_16x16x32_bf16 v[32:35], v[104:107], v[96:99], v[32:35]
    ds_read_b64_tr_b16 v[172:173], v21 offset:49152
    ds_read_b64_tr_b16 v[174:175], v21 offset:53248
    v_mfma_f32_16x16x32_bf16 v[40:43], v[104:107], v[100:103], v[40:43]
    ds_read_b128 v[176:179], v19 offset:7168
    ds_read_b128 v[180:183], v19 offset:23552
    v_mfma_f32_16x16x32_bf16 v[36:39], v[108:111], v[96:99], v[36:39]
    ds_read_b64_tr_b16 v[184:185], v20 offset:57344
    ds_read_b64_tr_b16 v[186:187], v20 offset:61440
    v_mfma_f32_16x16x32_bf16 v[44:47], v[108:111], v[100:103], v[44:47]
    ds_read_b64_tr_b16 v[188:189], v21 offset:57344
    ds_read_b64_tr_b16 v[190:191], v21 offset:61440
    v_mfma_f32_16x16x32_bf16 v[32:35], v[120:123], v[112:115], v[32:35]
    v_mfma_f32_16x16x32_bf16 v[40:43], v[120:123], v[116:119], v[40:43]
    v_mfma_f32_16x16x32_bf16 v[36:39], v[124:127], v[112:115], v[36:39]
    v_mfma_f32_16x16x32_bf16 v[44:47], v[124:127], v[116:119], v[44:47]
    s_waitcnt lgkmcnt(0)
    v_mfma_f32_16x16x32_bf16 v[32:35], v[136:139], v[128:131], v[32:35]
    ds_read_b128 v[64:67], v19 offset:8192
    ds_read_b128 v[68:71], v19 offset:24576
    v_mfma_f32_16x16x32_bf16 v[40:43], v[136:139], v[132:135], v[40:43]
    ds_read_b64_tr_b16 v[72:73], v22 offset:0
    ds_read_b64_tr_b16 v[74:75], v22 offset:4096
    v_mfma_f32_16x16x32_bf16 v[36:39], v[140:143], v[128:131], v[36:39]
    ds_read_b64_tr_b16 v[76:77], v23 offset:0
    ds_read_b64_tr_b16 v[78:79], v23 offset:4096
    v_mfma_f32_16x16x32_bf16 v[44:47], v[140:143], v[132:135], v[44:47]
    ds_read_b128 v[80:83], v19 offset:9216
    ds_read_b128 v[84:87], v19 offset:25600
    v_mfma_f32_16x16x32_bf16 v[32:35], v[152:155], v[144:147], v[32:35]
    ds_read_b64_tr_b16 v[88:89], v22 offset:8192
    ds_read_b64_tr_b16 v[90:91], v22 offset:12288
    v_mfma_f32_16x16x32_bf16 v[40:43], v[152:155], v[148:151], v[40:43]
    ds_read_b64_tr_b16 v[92:93], v23 offset:8192
    ds_read_b64_tr_b16 v[94:95], v23 offset:12288
    v_mfma_f32_16x16x32_bf16 v[36:39], v[156:159], v[144:147], v[36:39]
    ds_read_b128 v[96:99], v19 offset:10240
    ds_read_b128 v[100:103], v19 offset:26624
    v_mfma_f32_16x16x32_bf16 v[44:47], v[156:159], v[148:151], v[44:47]
    ds_read_b64_tr_b16 v[104:105], v22 offset:16384
    ds_read_b64_tr_b16 v[106:107], v22 offset:20480
    v_mfma_f32_16x16x32_bf16 v[32:35], v[168:171], v[160:163], v[32:35]
    ds_read_b64_tr_b16 v[108:109], v23 offset:16384
    ds_read_b64_tr_b16 v[110:111], v23 offset:20480
    v_mfma_f32_16x16x32_bf16 v[40:43], v[168:171], v[164:167], v[40:43]
    ds_read_b128 v[112:115], v19 offset:11264
    ds_read_b128 v[116:119], v19 offset:27648
    v_mfma_f32_16x16x32_bf16 v[36:39], v[172:175], v[160:163], v[36:39]
    ds_read_b64_tr_b16 v[120:121], v22 offset:24576
    ds_read_b64_tr_b16 v[122:123], v22 offset:28672
    v_mfma_f32_16x16x32_bf16 v[44:47], v[172:175], v[164:167], v[44:47]
    ds_read_b64_tr_b16 v[124:125], v23 offset:24576
    ds_read_b64_tr_b16 v[126:127], v23 offset:28672
    v_mfma_f32_16x16x32_bf16 v[32:35], v[184:187], v[176:179], v[32:35]
    v_mfma_f32_16x16x32_bf16 v[40:43], v[184:187], v[180:183], v[40:43]
    v_mfma_f32_16x16x32_bf16 v[36:39], v[188:191], v[176:179], v[36:39]
    v_mfma_f32_16x16x32_bf16 v[44:47], v[188:191], v[180:183], v[44:47]
    s_waitcnt lgkmcnt(0)
    v_mfma_f32_16x16x32_bf16 v[32:35], v[72:75], v[64:67], v[32:35]
    ds_read_b128 v[128:131], v19 offset:12288
    ds_read_b128 v[132:135], v19 offset:28672
    v_mfma_f32_16x16x32_bf16 v[40:43], v[72:75], v[68:71], v[40:43]
    ds_read_b64_tr_b16 v[136:137], v22 offset:32768
    ds_read_b64_tr_b16 v[138:139], v22 offset:36864
    v_mfma_f32_16x16x32_bf16 v[36:39], v[76:79], v[64:67], v[36:39]
    ds_read_b64_tr_b16 v[140:141], v23 offset:32768
    ds_read_b64_tr_b16 v[142:143], v23 offset:36864
    v_mfma_f32_16x16x32_bf16 v[44:47], v[76:79], v[68:71], v[44:47]
    ds_read_b128 v[144:147], v19 offset:13312
    ds_read_b128 v[148:151], v19 offset:29696
    v_mfma_f32_16x16x32_bf16 v[32:35], v[88:91], v[80:83], v[32:35]
    ds_read_b64_tr_b16 v[152:153], v22 offset:40960
    ds_read_b64_tr_b16 v[154:155], v22 offset:45056
    v_mfma_f32_16x16x32_bf16 v[40:43], v[88:91], v[84:87], v[40:43]
    ds_read_b64_tr_b16 v[156:157], v23 offset:40960
    ds_read_b64_tr_b16 v[158:159], v23 offset:45056
    v_mfma_f32_16x16x32_bf16 v[36:39], v[92:95], v[80:83], v[36:39]
    ds_read_b128 v[160:163], v19 offset:14336
    ds_read_b128 v[164:167], v19 offset:30720
    v_mfma_f32_16x16x32_bf16 v[44:47], v[92:95], v[84:87], v[44:47]
    ds_read_b64_tr_b16 v[168:169], v22 offset:49152
    ds_read_b64_tr_b16 v[170:171], v22 offset:53248
    v_mfma_f32_16x16x32_bf16 v[32:35], v[104:107], v[96:99], v[32:35]
    ds_read_b64_tr_b16 v[172:173], v23 offset:49152
    ds_read_b64_tr_b16 v[174:175], v23 offset:53248
    v_mfma_f32_16x16x32_bf16 v[40:43], v[104:107], v[100:103], v[40:43]
    ds_read_b128 v[176:179], v19 offset:15360
    ds_read_b128 v[180:183], v19 offset:31744
    v_mfma_f32_16x16x32_bf16 v[36:39], v[108:111], v[96:99], v[36:39]
    ds_read_b64_tr_b16 v[184:185], v22 offset:57344
    ds_read_b64_tr_b16 v[186:187], v22 offset:61440
    v_mfma_f32_16x16x32_bf16 v[44:47], v[108:111], v[100:103], v[44:47]
    ds_read_b64_tr_b16 v[188:189], v23 offset:57344
    ds_read_b64_tr_b16 v[190:191], v23 offset:61440
    v_mfma_f32_16x16x32_bf16 v[32:35], v[120:123], v[112:115], v[32:35]
    v_mfma_f32_16x16x32_bf16 v[40:43], v[120:123], v[116:119], v[40:43]
    v_mfma_f32_16x16x32_bf16 v[36:39], v[124:127], v[112:115], v[36:39]
    v_mfma_f32_16x16x32_bf16 v[44:47], v[124:127], v[116:119], v[44:47]
    s_waitcnt lgkmcnt(0)
    s_barrier
    v_mfma_f32_16x16x32_bf16 v[32:35], v[136:139], v[128:131], v[32:35]
    v_mfma_f32_16x16x32_bf16 v[40:43], v[136:139], v[132:135], v[40:43]
    v_mfma_f32_16x16x32_bf16 v[36:39], v[140:143], v[128:131], v[36:39]
    v_mfma_f32_16x16x32_bf16 v[44:47], v[140:143], v[132:135], v[44:47]
    v_mfma_f32_16x16x32_bf16 v[32:35], v[152:155], v[144:147], v[32:35]
    v_mfma_f32_16x16x32_bf16 v[40:43], v[152:155], v[148:151], v[40:43]
    v_mfma_f32_16x16x32_bf16 v[36:39], v[156:159], v[144:147], v[36:39]
    v_mfma_f32_16x16x32_bf16 v[44:47], v[156:159], v[148:151], v[44:47]
    v_mfma_f32_16x16x32_bf16 v[32:35], v[168:171], v[160:163], v[32:35]
    v_mfma_f32_16x16x32_bf16 v[40:43], v[168:171], v[164:167], v[40:43]
    v_mfma_f32_16x16x32_bf16 v[36:39], v[172:175], v[160:163], v[36:39]
    v_mfma_f32_16x16x32_bf16 v[44:47], v[172:175], v[164:167], v[44:47]
    v_mfma_f32_16x16x32_bf16 v[32:35], v[184:187], v[176:179], v[32:35]
    v_mfma_f32_16x16x32_bf16 v[40:43], v[184:187], v[180:183], v[40:43]
    v_mfma_f32_16x16x32_bf16 v[36:39], v[188:191], v[176:179], v[36:39]
    v_mfma_f32_16x16x32_bf16 v[44:47], v[188:191], v[180:183], v[44:47]
    s_waitcnt vmcnt(0)
    s_lshl_b32 s48, s3, 10
    v_add_u32 v16, s48, v5
    v_add_u32 v17, 65536, v16
    ds_write_b128 v16, a[0:3] offset:0
    ds_write_b128 v16, a[4:7] offset:4096
    ds_write_b128 v16, a[8:11] offset:8192
    ds_write_b128 v16, a[12:15] offset:12288
    ds_write_b128 v16, a[16:19] offset:16384
    ds_write_b128 v16, a[20:23] offset:20480
    ds_write_b128 v16, a[24:27] offset:24576
    ds_write_b128 v16, a[28:31] offset:28672
    ds_write_b128 v16, a[32:35] offset:32768
    ds_write_b128 v16, a[36:39] offset:36864
    ds_write_b128 v16, a[40:43] offset:40960
    ds_write_b128 v16, a[44:47] offset:45056
    ds_write_b128 v16, a[48:51] offset:49152
    ds_write_b128 v16, a[52:55] offset:53248
    ds_write_b128 v16, a[56:59] offset:57344
    ds_write_b128 v16, a[60:63] offset:61440
    v_cvt_pk_bf16_f32 v32, 0, v32
    v_cvt_pk_bf16_f32 v33, 0, v33
    v_lshlrev_b32 v30, 16, v12
    v_and_b32 v31, 0xffff0000, v12
    v_pk_add_f32 v[32:33], v[32:33], v[30:31]
    v_cvt_pk_bf16_f32 v48, v32, v33
    v_cvt_pk_bf16_f32 v34, 0, v34
    v_cvt_pk_bf16_f32 v35, 0, v35
    v_lshlrev_b32 v30, 16, v13
    v_and_b32 v31, 0xffff0000, v13
    v_pk_add_f32 v[34:35], v[34:35], v[30:31]
    v_cvt_pk_bf16_f32 v49, v34, v35
    v_cvt_pk_bf16_f32 v36, 0, v36
    v_cvt_pk_bf16_f32 v37, 0, v37
    v_lshlrev_b32 v30, 16, v14
    v_and_b32 v31, 0xffff0000, v14
    v_pk_add_f32 v[36:37], v[36:37], v[30:31]
    v_cvt_pk_bf16_f32 v50, v36, v37
    v_cvt_pk_bf16_f32 v38, 0, v38
    v_cvt_pk_bf16_f32 v39, 0, v39
    v_lshlrev_b32 v30, 16, v15
    v_and_b32 v31, 0xffff0000, v15
    v_pk_add_f32 v[38:39], v[38:39], v[30:31]
    v_cvt_pk_bf16_f32 v51, v38, v39
    v_cvt_pk_bf16_f32 v40, 0, v40
    v_cvt_pk_bf16_f32 v41, 0, v41
    v_lshlrev_b32 v30, 16, v24
    v_and_b32 v31, 0xffff0000, v24
    v_pk_add_f32 v[40:41], v[40:41], v[30:31]
    v_cvt_pk_bf16_f32 v52, v40, v41
    v_cvt_pk_bf16_f32 v42, 0, v42
    v_cvt_pk_bf16_f32 v43, 0, v43
    v_lshlrev_b32 v30, 16, v25
    v_and_b32 v31, 0xffff0000, v25
    v_pk_add_f32 v[42:43], v[42:43], v[30:31]
    v_cvt_pk_bf16_f32 v53, v42, v43
    v_cvt_pk_bf16_f32 v44, 0, v44
    v_cvt_pk_bf16_f32 v45, 0, v45
    v_lshlrev_b32 v30, 16, v26
    v_and_b32 v31, 0xffff0000, v26
    v_pk_add_f32 v[44:45], v[44:45], v[30:31]
    v_cvt_pk_bf16_f32 v54, v44, v45
    v_cvt_pk_bf16_f32 v46, 0, v46
    v_cvt_pk_bf16_f32 v47, 0, v47
    v_lshlrev_b32 v30, 16, v27
    v_and_b32 v31, 0xffff0000, v27
    v_pk_add_f32 v[46:47], v[46:47], v[30:31]
    v_cvt_pk_bf16_f32 v55, v46, v47
    s_add_u32 s10, s50, 2097152
    s_add_u32 s54, s38, s10
    s_addc_u32 s55, s39, 0
    v_add_u32 v20, 16384, v5
    s_cmp_eq_u32 s61, 1
    s_cbranch_scc1 sf_interleave_layers__linear_kernel_hedgehog__mixer_channel_mlp__prompt_kernel_55
    global_store_dwordx4 v5, v[48:51], s[54:55] sc1
    global_store_dwordx4 v20, v[52:55], s[54:55] sc1
    s_branch se_interleave_layers__linear_kernel_hedgehog__mixer_channel_mlp__prompt_kernel_56
sf_interleave_layers__linear_kernel_hedgehog__mixer_channel_mlp__prompt_kernel_55:
    global_store_dwordx4 v5, v[48:51], s[54:55]
    global_store_dwordx4 v20, v[52:55], s[54:55]
se_interleave_layers__linear_kernel_hedgehog__mixer_channel_mlp__prompt_kernel_56:
    s_lshl_b32 s10, s7, 2
    s_add_u32 s10, s10, s3
    s_lshr_b32 s11, s10, 3
    s_lshl_b32 s11, s11, 10
    s_lshr_b32 s12, s10, 1
    s_and_b32 s12, s12, 3
    s_lshl_b32 s12, s12, 8
    s_add_u32 s11, s11, s12
    s_and_b32 s12, s10, 1
    s_lshl_b32 s12, s12, 3
    s_add_u32 s11, s11, s12
    s_lshl_b32 s12, s6, 12
    s_add_u32 s11, s11, s12
    s_add_u32 s11, s11, 18087936
    s_add_u32 s56, s38, s11
    s_addc_u32 s57, s39, 0
    v_mov_b32 v24, 0
    v_mov_b32 v26, 0
    v_mov_b32 v25, 0
    v_mov_b32 v27, 0
    v_dot2_f32_bf16 v24, v48, v10, v24
    v_dot2_f32_bf16 v26, v52, v10, v26
    v_dot2_f32_bf16 v25, v48, v48, v25
    v_dot2_f32_bf16 v27, v52, v52, v27
    v_dot2_f32_bf16 v24, v49, v10, v24
    v_dot2_f32_bf16 v26, v53, v10, v26
    v_dot2_f32_bf16 v25, v49, v49, v25
    v_dot2_f32_bf16 v27, v53, v53, v27
    v_dot2_f32_bf16 v24, v50, v10, v24
    v_dot2_f32_bf16 v26, v54, v10, v26
    v_dot2_f32_bf16 v25, v50, v50, v25
    v_dot2_f32_bf16 v27, v54, v54, v27
    v_dot2_f32_bf16 v24, v51, v10, v24
    v_dot2_f32_bf16 v26, v55, v10, v26
    v_dot2_f32_bf16 v25, v51, v51, v25
    v_dot2_f32_bf16 v27, v55, v55, v27
    s_nop 1
    v_permlane32_swap_b32 v24, v25
    v_permlane32_swap_b32 v26, v27
    v_add_f32 v24, v24, v25
    v_add_f32 v26, v26, v27
    s_nop 1
    v_permlane16_swap_b32 v24, v26
    v_add_f32 v24, v24, v26
    v_mov_b32 v26, v24
    s_nop 1
    v_permlane16_swap_b32 v24, v26
    v_mov_b32 v25, v24
    v_mov_b32 v27, v26
    s_nop 0
    v_permlane32_swap_b32 v24, v25
    v_permlane32_swap_b32 v26, v27
    s_mov_b64 exec, 0xffff
    s_cmp_eq_u32 s61, 1
    s_cbranch_scc1 sf_interleave_layers__linear_kernel_hedgehog__mixer_channel_mlp__prompt_kernel_57
    global_store_dwordx2 v5, v[24:25], s[56:57] sc1
    global_store_dwordx2 v5, v[26:27], s[56:57] offset:2048 sc1
    s_branch se_interleave_layers__linear_kernel_hedgehog__mixer_channel_mlp__prompt_kernel_58
sf_interleave_layers__linear_kernel_hedgehog__mixer_channel_mlp__prompt_kernel_57:
    global_store_dwordx2 v5, v[24:25], s[56:57]
    global_store_dwordx2 v5, v[26:27], s[56:57] offset:2048
se_interleave_layers__linear_kernel_hedgehog__mixer_channel_mlp__prompt_kernel_58:
    s_mov_b64 exec, -1
    s_lshl_b32 s48, s3, 10
    v_add_u32 v16, s48, v5
    v_add_u32 v17, 65536, v16
    ds_write_b128 v17, a[64:67] offset:0
    ds_write_b128 v17, a[68:71] offset:4096
    ds_write_b128 v17, a[72:75] offset:8192
    ds_write_b128 v17, a[76:79] offset:12288
    ds_write_b128 v17, a[80:83] offset:16384
    ds_write_b128 v17, a[84:87] offset:20480
    ds_write_b128 v17, a[88:91] offset:24576
    ds_write_b128 v17, a[92:95] offset:28672
    ds_write_b128 v17, a[96:99] offset:32768
    ds_write_b128 v17, a[100:103] offset:36864
    ds_write_b128 v17, a[104:107] offset:40960
    ds_write_b128 v17, a[108:111] offset:45056
    ds_write_b128 v17, a[112:115] offset:49152
    ds_write_b128 v17, a[116:119] offset:53248
    ds_write_b128 v17, a[120:123] offset:57344
    ds_write_b128 v17, a[124:127] offset:61440
    s_waitcnt vmcnt(0)
    s_barrier
    s_cmp_lg_u32 s3, 0
    s_cbranch_scc1 sg_interleave_layers__linear_kernel_hedgehog__mixer_channel_mlp__prompt_kernel_59
    s_mov_b64 exec, 1
    s_lshl_b32 s10, s58, 10
    s_cmp_eq_u32 s61, 1
    s_cbranch_scc1 sgf_interleave_layers__linear_kernel_hedgehog__mixer_channel_mlp__prompt_kernel_60
    v_mov_b32 v2, s10
    v_mov_b32 v26, 1
    global_atomic_add v2, v26, s[62:63] offset:256 sc1
    s_branch sge_interleave_layers__linear_kernel_hedgehog__mixer_channel_mlp__prompt_kernel_61
sgf_interleave_layers__linear_kernel_hedgehog__mixer_channel_mlp__prompt_kernel_60:
    s_lshl_b32 s11, s59, 2
    s_add_u32 s10, s10, s11
    v_mov_b32 v2, s10
    s_add_u32 s11, s8, 1
    v_mov_b32 v26, s11
    global_store_dword v2, v26, s[62:63] offset:512
sge_interleave_layers__linear_kernel_hedgehog__mixer_channel_mlp__prompt_kernel_61:
    s_mov_b64 exec, -1
sg_interleave_layers__linear_kernel_hedgehog__mixer_channel_mlp__prompt_kernel_59:
    s_add_u32 s8, s8, 1
    s_min_u32 s10, s59, 13
    s_lshl_b32 s10, s10, 8
    s_add_u32 s52, s28, s10
    s_addc_u32 s53, s29, 0
    s_mov_b32 m0, 147456
    s_mov_b64 exec, 0xffff
    global_load_lds_dwordx4 v5, s[52:53]
    s_mov_b64 exec, -1
    s_cmp_ge_u32 s59, 14
    s_cbranch_scc1 p3i_interleave_layers__linear_kernel_hedgehog__mixer_channel_mlp__prompt_kernel_62
    s_lshl_b32 s10, s58, 3
    s_lshl_b32 s11, s3, 1
    s_add_u32 s45, s10, s11
    s_lshl_b32 s12, s45, 14
    s_add_u32 s12, s12, 2097152
    s_add_u32 s46, s38, s12
    s_addc_u32 s47, s39, 0
    v_add_u32 v25, 16384, v5
    s_lshl_b32 s10, s45, 11
    s_add_u32 s10, s10, 18087936
    s_add_u32 s50, s38, s10
    s_addc_u32 s51, s39, 0
    v_lshrrev_b32 v15, 3, v1
    v_and_b32 v16, 7, v1
    v_lshrrev_b32 v17, 1, v16
    v_lshrrev_b32 v18, 1, v15
    v_and_b32 v18, 3, v18
    v_xor_b32 v17, v17, v18
    v_and_b32 v16, 1, v16
    v_lshlrev_b32 v16, 4, v16
    v_lshl_add_u32 v16, v17, 5, v16
    v_mul_u32_u24 v0, 1024, v15
    v_add_u32 v0, v0, v16
    s_lshl_b32 s11, s3, 13
    s_lshr_b32 s12, s59, 1
    s_lshl_b32 s12, s12, 7
    s_add_u32 s11, s11, s12
    s_add_u32 s24, s30, s11
    s_addc_u32 s25, s31, 0
    v_lshrrev_b32 v16, 1, v8
    v_and_b32 v16, 3, v16
    v_lshlrev_b32 v18, 7, v8
    v_lshl_add_u32 v18, v7, 3, v18
    v_xor_b32 v17, 0, v16
    v_lshl_add_u32 v9, v17, 5, v18
    v_xor_b32 v17, 1, v16
    v_lshl_add_u32 v10, v17, 5, v18
    v_xor_b32 v17, 2, v16
    v_lshl_add_u32 v11, v17, 5, v18
    v_xor_b32 v17, 3, v16
    v_lshl_add_u32 v12, v17, 5, v18
    v_add_u32 v19, 65536, v9
    v_add_u32 v20, 65536, v10
    v_add_u32 v21, 65536, v11
    v_add_u32 v22, 65536, v12
    v_xor_b32 v17, s3, v16
    v_lshl_add_u32 v23, v17, 5, v18
    v_add_u32 v24, 65536, v23
    v_mov_b32 v28, 0x3f803f80
    v_mov_b32 v29, 0x3f803f80
    v_mov_b32 v30, 0x3f803f80
    v_mov_b32 v31, 0x3f803f80
    s_cmp_lg_u32 s3, 0
    s_cbranch_scc1 wt_interleave_layers__linear_kernel_hedgehog__mixer_channel_mlp__prompt_kernel_64
    s_mov_b64 exec, 0xffff
    s_lshl_b32 s10, s58, 10
    s_cmp_eq_u32 s61, 1
    s_cselect_b32 s11, 2, 1
    s_cselect_b32 s12, 4, 0
    s_cselect_b32 s13, 1, 16
    s_mul_i32 s13, s13, s8
    s_lshl_b32 s11, s11, 8
    s_add_u32 s10, s10, s11
    v_mul_u32_u24 v2, s12, v1
    v_add_u32 v2, s10, v2
    v_mov_b32 v27, s13
    s_mov_b32 s15, 0
pp_interleave_layers__linear_kernel_hedgehog__mixer_channel_mlp__prompt_kernel_65:
    global_load_dword v26, v2, s[62:63] sc1
    s_waitcnt vmcnt(0)
    v_cmp_gt_u32 vcc, v27, v26
    s_nop 4
    s_cbranch_vccz pq_interleave_layers__linear_kernel_hedgehog__mixer_channel_mlp__prompt_kernel_66
    s_sleep 1
    s_add_u32 s15, s15, 1
    s_cmp_lt_u32 s15, 400000
    s_cbranch_scc1 pp_interleave_layers__linear_kernel_hedgehog__mixer_channel_mlp__prompt_kernel_65
pq_interleave_layers__linear_kernel_hedgehog__mixer_channel_mlp__prompt_kernel_66:
    s_mov_b64 exec, -1
wt_interleave_layers__linear_kernel_hedgehog__mixer_channel_mlp__prompt_kernel_64:
    s_waitcnt vmcnt(0) lgkmcnt(0)
    s_barrier
    global_load_dwordx4 v[184:187], v5, s[50:51] offset:0 sc1
    global_load_dwordx4 v[188:191], v5, s[50:51] offset:1024 sc1
    global_load_dwordx4 v[192:195], v5, s[50:51] offset:2048 sc1
    global_load_dwordx4 v[196:199], v5, s[50:51] offset:3072 sc1
    global_load_dwordx4 a[0:3], v5, s[46:47] offset:0 sc1
    global_load_dwordx4 a[64:67], v25, s[46:47] offset:0 sc1
    global_load_dwordx4 a[4:7], v5, s[46:47] offset:1024 sc1
    global_load_dwordx4 a[68:71], v25, s[46:47] offset:1024 sc1
    global_load_dwordx4 a[8:11], v5, s[46:47] offset:2048 sc1
    global_load_dwordx4 a[72:75], v25, s[46:47] offset:2048 sc1
    global_load_dwordx4 a[12:15], v5, s[46:47] offset:3072 sc1
    global_load_dwordx4 a[76:79], v25, s[46:47] offset:3072 sc1
    s_add_u32 s46, s46, 4096
    s_addc_u32 s47, s47, 0
    global_load_dwordx4 a[16:19], v5, s[46:47] offset:0 sc1
    global_load_dwordx4 a[80:83], v25, s[46:47] offset:0 sc1
    global_load_dwordx4 a[20:23], v5, s[46:47] offset:1024 sc1
    global_load_dwordx4 a[84:87], v25, s[46:47] offset:1024 sc1
    global_load_dwordx4 a[24:27], v5, s[46:47] offset:2048 sc1
    global_load_dwordx4 a[88:91], v25, s[46:47] offset:2048 sc1
    global_load_dwordx4 a[28:31], v5, s[46:47] offset:3072 sc1
    global_load_dwordx4 a[92:95], v25, s[46:47] offset:3072 sc1
    s_add_u32 s46, s46, 4096
    s_addc_u32 s47, s47, 0
    ds_read_b64_tr_b16 v[104:105], v9 offset:0
    ds_read_b64_tr_b16 v[106:107], v9 offset:2048
    ds_read_b64_tr_b16 v[108:109], v10 offset:0
    ds_read_b64_tr_b16 v[110:111], v10 offset:2048
    ds_read_b64_tr_b16 v[112:113], v11 offset:0
    ds_read_b64_tr_b16 v[114:115], v11 offset:2048
    ds_read_b64_tr_b16 v[116:117], v12 offset:0
    ds_read_b64_tr_b16 v[118:119], v12 offset:2048
    ds_read_b64_tr_b16 v[120:121], v23 offset:0
    ds_read_b64_tr_b16 v[122:123], v23 offset:2048
    ds_read_b64_tr_b16 v[124:125], v19 offset:0
    ds_read_b64_tr_b16 v[126:127], v19 offset:2048
    ds_read_b64_tr_b16 v[128:129], v20 offset:0
    ds_read_b64_tr_b16 v[130:131], v20 offset:2048
    ds_read_b64_tr_b16 v[132:133], v21 offset:0
    ds_read_b64_tr_b16 v[134:135], v21 offset:2048
    ds_read_b64_tr_b16 v[136:137], v22 offset:0
    ds_read_b64_tr_b16 v[138:139], v22 offset:2048
    ds_read_b64_tr_b16 v[140:141], v24 offset:0
    ds_read_b64_tr_b16 v[142:143], v24 offset:2048
    s_waitcnt vmcnt(16)
    v_pk_add_f32 v[184:185], v[184:185], v[186:187]
    v_pk_add_f32 v[188:189], v[188:189], v[190:191]
    v_pk_add_f32 v[184:185], v[184:185], v[188:189]
    v_pk_add_f32 v[192:193], v[192:193], v[194:195]
    v_pk_add_f32 v[196:197], v[196:197], v[198:199]
    v_pk_add_f32 v[192:193], v[192:193], v[196:197]
    v_permlane32_swap_b32 v184, v185
    s_nop 0
    v_permlane32_swap_b32 v192, v193
    v_add_f32 v184, v184, v185
    v_add_f32 v192, v192, v193
    s_nop 1
    v_permlane16_swap_b32 v184, v192
    v_add_f32 v184, v184, v192
    v_mov_b32 v192, v184
    s_nop 1
    v_permlane16_swap_b32 v184, v192
    v_mov_b32 v185, v184
    v_mov_b32 v193, v192
    s_nop 0
    v_permlane32_swap_b32 v184, v185
    v_permlane32_swap_b32 v192, v193
    v_mul_f32 v184, 0x3b000000, v184
    v_mul_f32 v192, 0x3b000000, v192
    v_mul_f32 v185, 0x3b000000, v185
    v_mul_f32 v193, 0x3b000000, v193
    v_fma_f32 v185, -v184, v184, v185
    v_fma_f32 v193, -v192, v192, v193
    v_max_f32 v185, 0, v185
    v_max_f32 v193, 0, v193
    v_cvt_pk_bf16_f32 v186, 0, v184
    v_cvt_pk_bf16_f32 v194, 0, v192
    v_cvt_pk_bf16_f32 v187, 0, v185
    v_cvt_pk_bf16_f32 v195, 0, v193
    v_add_f32 v187, 0x3727c5ac, v187
    v_add_f32 v195, 0x3727c5ac, v195
    v_cvt_pk_bf16_f32 v187, 0, v187
    v_cvt_pk_bf16_f32 v195, 0, v195
    v_sqrt_f32 v187, v187
    v_sqrt_f32 v195, v195
    v_cvt_pk_bf16_f32 v187, 0, v187
    v_cvt_pk_bf16_f32 v195, 0, v195
    v_rcp_f32 v16, v187
    v_rcp_f32 v14, v195
    v_sub_f32 v188, v184, v186
    v_sub_f32 v196, v192, v194
    v_mul_f32 v188, v188, v16
    v_mul_f32 v196, v196, v14
    v_cvt_pk_bf16_f32 v188, 0, v188
    v_cvt_pk_bf16_f32 v196, 0, v196
    v_mul_f32 v189, v185, v16
    v_mul_f32 v197, v193, v14
    v_mul_f32 v189, v189, v16
    v_mul_f32 v197, v197, v14
    v_cvt_pk_bf16_f32 v189, 0, v189
    v_cvt_pk_bf16_f32 v197, 0, v197
    v_add_f32 v189, 0x3727c5ac, v189
    v_add_f32 v197, 0x3727c5ac, v197
    v_cvt_pk_bf16_f32 v189, 0, v189
    v_cvt_pk_bf16_f32 v197, 0, v197
    v_sqrt_f32 v189, v189
    v_sqrt_f32 v197, v197
    v_cvt_pk_bf16_f32 v189, 0, v189
    v_cvt_pk_bf16_f32 v197, 0, v197
    v_rcp_f32 v189, v189
    v_rcp_f32 v197, v197
    v_fma_f32 v17, v186, v16, v188
    v_fma_f32 v15, v194, v14, v196
    v_mul_f32 v17, v17, v189
    v_mul_f32 v15, v15, v197
    v_mul_f32 v16, v16, v189
    v_mul_f32 v14, v14, v197
    s_waitcnt vmcnt(14) lgkmcnt(0)
    v_mfma_f32_16x16x32_bf16 v[32:35], v[104:107], a[0:3], 0
    ds_read_b64_tr_b16 v[144:145], v9 offset:4096
    ds_read_b64_tr_b16 v[146:147], v9 offset:6144
    v_mfma_f32_16x16x32_bf16 v[64:67], v[104:107], a[64:67], 0
    ds_read_b64_tr_b16 v[148:149], v10 offset:4096
    ds_read_b64_tr_b16 v[150:151], v10 offset:6144
    v_mfma_f32_16x16x32_bf16 v[36:39], v[108:111], a[0:3], 0
    ds_read_b64_tr_b16 v[152:153], v11 offset:4096
    ds_read_b64_tr_b16 v[154:155], v11 offset:6144
    v_mfma_f32_16x16x32_bf16 v[68:71], v[108:111], a[64:67], 0
    ds_read_b64_tr_b16 v[156:157], v12 offset:4096
    ds_read_b64_tr_b16 v[158:159], v12 offset:6144
    v_mfma_f32_16x16x32_bf16 v[40:43], v[112:115], a[0:3], 0
    ds_read_b64_tr_b16 v[160:161], v23 offset:4096
    ds_read_b64_tr_b16 v[162:163], v23 offset:6144
    v_mfma_f32_16x16x32_bf16 v[72:75], v[112:115], a[64:67], 0
    ds_read_b64_tr_b16 v[164:165], v19 offset:4096
    ds_read_b64_tr_b16 v[166:167], v19 offset:6144
    v_mfma_f32_16x16x32_bf16 v[44:47], v[116:119], a[0:3], 0
    ds_read_b64_tr_b16 v[168:169], v20 offset:4096
    ds_read_b64_tr_b16 v[170:171], v20 offset:6144
    v_mfma_f32_16x16x32_bf16 v[76:79], v[116:119], a[64:67], 0
    ds_read_b64_tr_b16 v[172:173], v21 offset:4096
    ds_read_b64_tr_b16 v[174:175], v21 offset:6144
    v_mfma_f32_16x16x32_bf16 v[96:99], v[120:123], v[28:31], 0
    ds_read_b64_tr_b16 v[176:177], v22 offset:4096
    ds_read_b64_tr_b16 v[178:179], v22 offset:6144
    v_mfma_f32_16x16x32_bf16 v[48:51], v[124:127], a[0:3], 0
    ds_read_b64_tr_b16 v[180:181], v24 offset:4096
    ds_read_b64_tr_b16 v[182:183], v24 offset:6144
    v_mfma_f32_16x16x32_bf16 v[80:83], v[124:127], a[64:67], 0
    global_load_dwordx4 a[32:35], v5, s[46:47] offset:0 sc1
    global_load_dwordx4 a[96:99], v25, s[46:47] offset:0 sc1
    v_mfma_f32_16x16x32_bf16 v[52:55], v[128:131], a[0:3], 0
    v_mfma_f32_16x16x32_bf16 v[84:87], v[128:131], a[64:67], 0
    v_mfma_f32_16x16x32_bf16 v[56:59], v[132:135], a[0:3], 0
    v_mfma_f32_16x16x32_bf16 v[88:91], v[132:135], a[64:67], 0
    v_mfma_f32_16x16x32_bf16 v[60:63], v[136:139], a[0:3], 0
    v_mfma_f32_16x16x32_bf16 v[92:95], v[136:139], a[64:67], 0
    v_mfma_f32_16x16x32_bf16 v[100:103], v[140:143], v[28:31], 0
    s_waitcnt vmcnt(14) lgkmcnt(0)
    v_mfma_f32_16x16x32_bf16 v[32:35], v[144:147], a[4:7], v[32:35]
    ds_read_b64_tr_b16 v[104:105], v9 offset:8192
    ds_read_b64_tr_b16 v[106:107], v9 offset:10240
    v_mfma_f32_16x16x32_bf16 v[64:67], v[144:147], a[68:71], v[64:67]
    ds_read_b64_tr_b16 v[108:109], v10 offset:8192
    ds_read_b64_tr_b16 v[110:111], v10 offset:10240
    v_mfma_f32_16x16x32_bf16 v[36:39], v[148:151], a[4:7], v[36:39]
    ds_read_b64_tr_b16 v[112:113], v11 offset:8192
    ds_read_b64_tr_b16 v[114:115], v11 offset:10240
    v_mfma_f32_16x16x32_bf16 v[68:71], v[148:151], a[68:71], v[68:71]
    ds_read_b64_tr_b16 v[116:117], v12 offset:8192
    ds_read_b64_tr_b16 v[118:119], v12 offset:10240
    v_mfma_f32_16x16x32_bf16 v[40:43], v[152:155], a[4:7], v[40:43]
    ds_read_b64_tr_b16 v[120:121], v23 offset:8192
    ds_read_b64_tr_b16 v[122:123], v23 offset:10240
    v_mfma_f32_16x16x32_bf16 v[72:75], v[152:155], a[68:71], v[72:75]
    ds_read_b64_tr_b16 v[124:125], v19 offset:8192
    ds_read_b64_tr_b16 v[126:127], v19 offset:10240
    v_mfma_f32_16x16x32_bf16 v[44:47], v[156:159], a[4:7], v[44:47]
    ds_read_b64_tr_b16 v[128:129], v20 offset:8192
    ds_read_b64_tr_b16 v[130:131], v20 offset:10240
    v_mfma_f32_16x16x32_bf16 v[76:79], v[156:159], a[68:71], v[76:79]
    ds_read_b64_tr_b16 v[132:133], v21 offset:8192
    ds_read_b64_tr_b16 v[134:135], v21 offset:10240
    v_mfma_f32_16x16x32_bf16 v[96:99], v[160:163], v[28:31], v[96:99]
    ds_read_b64_tr_b16 v[136:137], v22 offset:8192
    ds_read_b64_tr_b16 v[138:139], v22 offset:10240
    v_mfma_f32_16x16x32_bf16 v[48:51], v[164:167], a[4:7], v[48:51]
    ds_read_b64_tr_b16 v[140:141], v24 offset:8192
    ds_read_b64_tr_b16 v[142:143], v24 offset:10240
    v_mfma_f32_16x16x32_bf16 v[80:83], v[164:167], a[68:71], v[80:83]
    global_load_dwordx4 a[36:39], v5, s[46:47] offset:1024 sc1
    global_load_dwordx4 a[100:103], v25, s[46:47] offset:1024 sc1
    v_mfma_f32_16x16x32_bf16 v[52:55], v[168:171], a[4:7], v[52:55]
    v_mfma_f32_16x16x32_bf16 v[84:87], v[168:171], a[68:71], v[84:87]
    v_mfma_f32_16x16x32_bf16 v[56:59], v[172:175], a[4:7], v[56:59]
    v_mfma_f32_16x16x32_bf16 v[88:91], v[172:175], a[68:71], v[88:91]
    v_mfma_f32_16x16x32_bf16 v[60:63], v[176:179], a[4:7], v[60:63]
    v_mfma_f32_16x16x32_bf16 v[92:95], v[176:179], a[68:71], v[92:95]
    v_mfma_f32_16x16x32_bf16 v[100:103], v[180:183], v[28:31], v[100:103]
    s_waitcnt vmcnt(14) lgkmcnt(0)
    v_mfma_f32_16x16x32_bf16 v[32:35], v[104:107], a[8:11], v[32:35]
    ds_read_b64_tr_b16 v[144:145], v9 offset:12288
    ds_read_b64_tr_b16 v[146:147], v9 offset:14336
    v_mfma_f32_16x16x32_bf16 v[64:67], v[104:107], a[72:75], v[64:67]
    ds_read_b64_tr_b16 v[148:149], v10 offset:12288
    ds_read_b64_tr_b16 v[150:151], v10 offset:14336
    v_mfma_f32_16x16x32_bf16 v[36:39], v[108:111], a[8:11], v[36:39]
    ds_read_b64_tr_b16 v[152:153], v11 offset:12288
    ds_read_b64_tr_b16 v[154:155], v11 offset:14336
    v_mfma_f32_16x16x32_bf16 v[68:71], v[108:111], a[72:75], v[68:71]
    ds_read_b64_tr_b16 v[156:157], v12 offset:12288
    ds_read_b64_tr_b16 v[158:159], v12 offset:14336
    v_mfma_f32_16x16x32_bf16 v[40:43], v[112:115], a[8:11], v[40:43]
    ds_read_b64_tr_b16 v[160:161], v23 offset:12288
    ds_read_b64_tr_b16 v[162:163], v23 offset:14336
    v_mfma_f32_16x16x32_bf16 v[72:75], v[112:115], a[72:75], v[72:75]
    ds_read_b64_tr_b16 v[164:165], v19 offset:12288
    ds_read_b64_tr_b16 v[166:167], v19 offset:14336
    v_mfma_f32_16x16x32_bf16 v[44:47], v[116:119], a[8:11], v[44:47]
    ds_read_b64_tr_b16 v[168:169], v20 offset:12288
    ds_read_b64_tr_b16 v[170:171], v20 offset:14336
    v_mfma_f32_16x16x32_bf16 v[76:79], v[116:119], a[72:75], v[76:79]
    ds_read_b64_tr_b16 v[172:173], v21 offset:12288
    ds_read_b64_tr_b16 v[174:175], v21 offset:14336
    v_mfma_f32_16x16x32_bf16 v[96:99], v[120:123], v[28:31], v[96:99]
    ds_read_b64_tr_b16 v[176:177], v22 offset:12288
    ds_read_b64_tr_b16 v[178:179], v22 offset:14336
    v_mfma_f32_16x16x32_bf16 v[48:51], v[124:127], a[8:11], v[48:51]
    ds_read_b64_tr_b16 v[180:181], v24 offset:12288
    ds_read_b64_tr_b16 v[182:183], v24 offset:14336
    v_mfma_f32_16x16x32_bf16 v[80:83], v[124:127], a[72:75], v[80:83]
    global_load_dwordx4 a[40:43], v5, s[46:47] offset:2048 sc1
    global_load_dwordx4 a[104:107], v25, s[46:47] offset:2048 sc1
    v_mfma_f32_16x16x32_bf16 v[52:55], v[128:131], a[8:11], v[52:55]
    v_mfma_f32_16x16x32_bf16 v[84:87], v[128:131], a[72:75], v[84:87]
    v_mfma_f32_16x16x32_bf16 v[56:59], v[132:135], a[8:11], v[56:59]
    v_mfma_f32_16x16x32_bf16 v[88:91], v[132:135], a[72:75], v[88:91]
    v_mfma_f32_16x16x32_bf16 v[60:63], v[136:139], a[8:11], v[60:63]
    v_mfma_f32_16x16x32_bf16 v[92:95], v[136:139], a[72:75], v[92:95]
    v_mfma_f32_16x16x32_bf16 v[100:103], v[140:143], v[28:31], v[100:103]
    s_waitcnt vmcnt(14) lgkmcnt(0)
    v_mfma_f32_16x16x32_bf16 v[32:35], v[144:147], a[12:15], v[32:35]
    ds_read_b64_tr_b16 v[104:105], v9 offset:16384
    ds_read_b64_tr_b16 v[106:107], v9 offset:18432
    v_mfma_f32_16x16x32_bf16 v[64:67], v[144:147], a[76:79], v[64:67]
    ds_read_b64_tr_b16 v[108:109], v10 offset:16384
    ds_read_b64_tr_b16 v[110:111], v10 offset:18432
    v_mfma_f32_16x16x32_bf16 v[36:39], v[148:151], a[12:15], v[36:39]
    ds_read_b64_tr_b16 v[112:113], v11 offset:16384
    ds_read_b64_tr_b16 v[114:115], v11 offset:18432
    v_mfma_f32_16x16x32_bf16 v[68:71], v[148:151], a[76:79], v[68:71]
    ds_read_b64_tr_b16 v[116:117], v12 offset:16384
    ds_read_b64_tr_b16 v[118:119], v12 offset:18432
    v_mfma_f32_16x16x32_bf16 v[40:43], v[152:155], a[12:15], v[40:43]
    ds_read_b64_tr_b16 v[120:121], v23 offset:16384
    ds_read_b64_tr_b16 v[122:123], v23 offset:18432
    v_mfma_f32_16x16x32_bf16 v[72:75], v[152:155], a[76:79], v[72:75]
    ds_read_b64_tr_b16 v[124:125], v19 offset:16384
    ds_read_b64_tr_b16 v[126:127], v19 offset:18432
    v_mfma_f32_16x16x32_bf16 v[44:47], v[156:159], a[12:15], v[44:47]
    ds_read_b64_tr_b16 v[128:129], v20 offset:16384
    ds_read_b64_tr_b16 v[130:131], v20 offset:18432
    v_mfma_f32_16x16x32_bf16 v[76:79], v[156:159], a[76:79], v[76:79]
    ds_read_b64_tr_b16 v[132:133], v21 offset:16384
    ds_read_b64_tr_b16 v[134:135], v21 offset:18432
    v_mfma_f32_16x16x32_bf16 v[96:99], v[160:163], v[28:31], v[96:99]
    ds_read_b64_tr_b16 v[136:137], v22 offset:16384
    ds_read_b64_tr_b16 v[138:139], v22 offset:18432
    v_mfma_f32_16x16x32_bf16 v[48:51], v[164:167], a[12:15], v[48:51]
    ds_read_b64_tr_b16 v[140:141], v24 offset:16384
    ds_read_b64_tr_b16 v[142:143], v24 offset:18432
    v_mfma_f32_16x16x32_bf16 v[80:83], v[164:167], a[76:79], v[80:83]
    global_load_dwordx4 a[44:47], v5, s[46:47] offset:3072 sc1
    global_load_dwordx4 a[108:111], v25, s[46:47] offset:3072 sc1
    v_mfma_f32_16x16x32_bf16 v[52:55], v[168:171], a[12:15], v[52:55]
    s_add_u32 s46, s46, 4096
    s_addc_u32 s47, s47, 0
    v_mfma_f32_16x16x32_bf16 v[84:87], v[168:171], a[76:79], v[84:87]
    v_mfma_f32_16x16x32_bf16 v[56:59], v[172:175], a[12:15], v[56:59]
    v_mfma_f32_16x16x32_bf16 v[88:91], v[172:175], a[76:79], v[88:91]
    v_mfma_f32_16x16x32_bf16 v[60:63], v[176:179], a[12:15], v[60:63]
    v_mfma_f32_16x16x32_bf16 v[92:95], v[176:179], a[76:79], v[92:95]
    v_mfma_f32_16x16x32_bf16 v[100:103], v[180:183], v[28:31], v[100:103]
    s_waitcnt vmcnt(14) lgkmcnt(0)
    v_mfma_f32_16x16x32_bf16 v[32:35], v[104:107], a[16:19], v[32:35]
    ds_read_b64_tr_b16 v[144:145], v9 offset:20480
    ds_read_b64_tr_b16 v[146:147], v9 offset:22528
    v_mfma_f32_16x16x32_bf16 v[64:67], v[104:107], a[80:83], v[64:67]
    ds_read_b64_tr_b16 v[148:149], v10 offset:20480
    ds_read_b64_tr_b16 v[150:151], v10 offset:22528
    v_mfma_f32_16x16x32_bf16 v[36:39], v[108:111], a[16:19], v[36:39]
    ds_read_b64_tr_b16 v[152:153], v11 offset:20480
    ds_read_b64_tr_b16 v[154:155], v11 offset:22528
    v_mfma_f32_16x16x32_bf16 v[68:71], v[108:111], a[80:83], v[68:71]
    ds_read_b64_tr_b16 v[156:157], v12 offset:20480
    ds_read_b64_tr_b16 v[158:159], v12 offset:22528
    v_mfma_f32_16x16x32_bf16 v[40:43], v[112:115], a[16:19], v[40:43]
    ds_read_b64_tr_b16 v[160:161], v23 offset:20480
    ds_read_b64_tr_b16 v[162:163], v23 offset:22528
    v_mfma_f32_16x16x32_bf16 v[72:75], v[112:115], a[80:83], v[72:75]
    ds_read_b64_tr_b16 v[164:165], v19 offset:20480
    ds_read_b64_tr_b16 v[166:167], v19 offset:22528
    v_mfma_f32_16x16x32_bf16 v[44:47], v[116:119], a[16:19], v[44:47]
    ds_read_b64_tr_b16 v[168:169], v20 offset:20480
    ds_read_b64_tr_b16 v[170:171], v20 offset:22528
    v_mfma_f32_16x16x32_bf16 v[76:79], v[116:119], a[80:83], v[76:79]
    ds_read_b64_tr_b16 v[172:173], v21 offset:20480
    ds_read_b64_tr_b16 v[174:175], v21 offset:22528
    v_mfma_f32_16x16x32_bf16 v[96:99], v[120:123], v[28:31], v[96:99]
    ds_read_b64_tr_b16 v[176:177], v22 offset:20480
    ds_read_b64_tr_b16 v[178:179], v22 offset:22528
    v_mfma_f32_16x16x32_bf16 v[48:51], v[124:127], a[16:19], v[48:51]
    ds_read_b64_tr_b16 v[180:181], v24 offset:20480
    ds_read_b64_tr_b16 v[182:183], v24 offset:22528
    v_mfma_f32_16x16x32_bf16 v[80:83], v[124:127], a[80:83], v[80:83]
    global_load_dwordx4 a[48:51], v5, s[46:47] offset:0 sc1
    global_load_dwordx4 a[112:115], v25, s[46:47] offset:0 sc1
    v_mfma_f32_16x16x32_bf16 v[52:55], v[128:131], a[16:19], v[52:55]
    v_mfma_f32_16x16x32_bf16 v[84:87], v[128:131], a[80:83], v[84:87]
    v_mfma_f32_16x16x32_bf16 v[56:59], v[132:135], a[16:19], v[56:59]
    v_mfma_f32_16x16x32_bf16 v[88:91], v[132:135], a[80:83], v[88:91]
    v_mfma_f32_16x16x32_bf16 v[60:63], v[136:139], a[16:19], v[60:63]
    v_mfma_f32_16x16x32_bf16 v[92:95], v[136:139], a[80:83], v[92:95]
    v_mfma_f32_16x16x32_bf16 v[100:103], v[140:143], v[28:31], v[100:103]
    s_waitcnt vmcnt(14) lgkmcnt(0)
    v_mfma_f32_16x16x32_bf16 v[32:35], v[144:147], a[20:23], v[32:35]
    ds_read_b64_tr_b16 v[104:105], v9 offset:24576
    ds_read_b64_tr_b16 v[106:107], v9 offset:26624
    v_mfma_f32_16x16x32_bf16 v[64:67], v[144:147], a[84:87], v[64:67]
    ds_read_b64_tr_b16 v[108:109], v10 offset:24576
    ds_read_b64_tr_b16 v[110:111], v10 offset:26624
    v_mfma_f32_16x16x32_bf16 v[36:39], v[148:151], a[20:23], v[36:39]
    ds_read_b64_tr_b16 v[112:113], v11 offset:24576
    ds_read_b64_tr_b16 v[114:115], v11 offset:26624
    v_mfma_f32_16x16x32_bf16 v[68:71], v[148:151], a[84:87], v[68:71]
    ds_read_b64_tr_b16 v[116:117], v12 offset:24576
    ds_read_b64_tr_b16 v[118:119], v12 offset:26624
    v_mfma_f32_16x16x32_bf16 v[40:43], v[152:155], a[20:23], v[40:43]
    ds_read_b64_tr_b16 v[120:121], v23 offset:24576
    ds_read_b64_tr_b16 v[122:123], v23 offset:26624
    v_mfma_f32_16x16x32_bf16 v[72:75], v[152:155], a[84:87], v[72:75]
    ds_read_b64_tr_b16 v[124:125], v19 offset:24576
    ds_read_b64_tr_b16 v[126:127], v19 offset:26624
    v_mfma_f32_16x16x32_bf16 v[44:47], v[156:159], a[20:23], v[44:47]
    ds_read_b64_tr_b16 v[128:129], v20 offset:24576
    ds_read_b64_tr_b16 v[130:131], v20 offset:26624
    v_mfma_f32_16x16x32_bf16 v[76:79], v[156:159], a[84:87], v[76:79]
    ds_read_b64_tr_b16 v[132:133], v21 offset:24576
    ds_read_b64_tr_b16 v[134:135], v21 offset:26624
    v_mfma_f32_16x16x32_bf16 v[96:99], v[160:163], v[28:31], v[96:99]
    ds_read_b64_tr_b16 v[136:137], v22 offset:24576
    ds_read_b64_tr_b16 v[138:139], v22 offset:26624
    v_mfma_f32_16x16x32_bf16 v[48:51], v[164:167], a[20:23], v[48:51]
    ds_read_b64_tr_b16 v[140:141], v24 offset:24576
    ds_read_b64_tr_b16 v[142:143], v24 offset:26624
    v_mfma_f32_16x16x32_bf16 v[80:83], v[164:167], a[84:87], v[80:83]
    global_load_dwordx4 a[52:55], v5, s[46:47] offset:1024 sc1
    global_load_dwordx4 a[116:119], v25, s[46:47] offset:1024 sc1
    v_mfma_f32_16x16x32_bf16 v[52:55], v[168:171], a[20:23], v[52:55]
    v_mfma_f32_16x16x32_bf16 v[84:87], v[168:171], a[84:87], v[84:87]
    v_mfma_f32_16x16x32_bf16 v[56:59], v[172:175], a[20:23], v[56:59]
    v_mfma_f32_16x16x32_bf16 v[88:91], v[172:175], a[84:87], v[88:91]
    v_mfma_f32_16x16x32_bf16 v[60:63], v[176:179], a[20:23], v[60:63]
    v_mfma_f32_16x16x32_bf16 v[92:95], v[176:179], a[84:87], v[92:95]
    v_mfma_f32_16x16x32_bf16 v[100:103], v[180:183], v[28:31], v[100:103]
    s_waitcnt vmcnt(14) lgkmcnt(0)
    v_mfma_f32_16x16x32_bf16 v[32:35], v[104:107], a[24:27], v[32:35]
    ds_read_b64_tr_b16 v[144:145], v9 offset:28672
    ds_read_b64_tr_b16 v[146:147], v9 offset:30720
    v_mfma_f32_16x16x32_bf16 v[64:67], v[104:107], a[88:91], v[64:67]
    ds_read_b64_tr_b16 v[148:149], v10 offset:28672
    ds_read_b64_tr_b16 v[150:151], v10 offset:30720
    v_mfma_f32_16x16x32_bf16 v[36:39], v[108:111], a[24:27], v[36:39]
    ds_read_b64_tr_b16 v[152:153], v11 offset:28672
    ds_read_b64_tr_b16 v[154:155], v11 offset:30720
    v_mfma_f32_16x16x32_bf16 v[68:71], v[108:111], a[88:91], v[68:71]
    ds_read_b64_tr_b16 v[156:157], v12 offset:28672
    ds_read_b64_tr_b16 v[158:159], v12 offset:30720
    v_mfma_f32_16x16x32_bf16 v[40:43], v[112:115], a[24:27], v[40:43]
    ds_read_b64_tr_b16 v[160:161], v23 offset:28672
    ds_read_b64_tr_b16 v[162:163], v23 offset:30720
    v_mfma_f32_16x16x32_bf16 v[72:75], v[112:115], a[88:91], v[72:75]
    ds_read_b64_tr_b16 v[164:165], v19 offset:28672
    ds_read_b64_tr_b16 v[166:167], v19 offset:30720
    v_mfma_f32_16x16x32_bf16 v[44:47], v[116:119], a[24:27], v[44:47]
    ds_read_b64_tr_b16 v[168:169], v20 offset:28672
    ds_read_b64_tr_b16 v[170:171], v20 offset:30720
    v_mfma_f32_16x16x32_bf16 v[76:79], v[116:119], a[88:91], v[76:79]
    ds_read_b64_tr_b16 v[172:173], v21 offset:28672
    ds_read_b64_tr_b16 v[174:175], v21 offset:30720
    v_mfma_f32_16x16x32_bf16 v[96:99], v[120:123], v[28:31], v[96:99]
    ds_read_b64_tr_b16 v[176:177], v22 offset:28672
    ds_read_b64_tr_b16 v[178:179], v22 offset:30720
    v_mfma_f32_16x16x32_bf16 v[48:51], v[124:127], a[24:27], v[48:51]
    ds_read_b64_tr_b16 v[180:181], v24 offset:28672
    ds_read_b64_tr_b16 v[182:183], v24 offset:30720
    v_mfma_f32_16x16x32_bf16 v[80:83], v[124:127], a[88:91], v[80:83]
    global_load_dwordx4 a[56:59], v5, s[46:47] offset:2048 sc1
    global_load_dwordx4 a[120:123], v25, s[46:47] offset:2048 sc1
    v_mfma_f32_16x16x32_bf16 v[52:55], v[128:131], a[24:27], v[52:55]
    v_mfma_f32_16x16x32_bf16 v[84:87], v[128:131], a[88:91], v[84:87]
    v_mfma_f32_16x16x32_bf16 v[56:59], v[132:135], a[24:27], v[56:59]
    v_mfma_f32_16x16x32_bf16 v[88:91], v[132:135], a[88:91], v[88:91]
    v_mfma_f32_16x16x32_bf16 v[60:63], v[136:139], a[24:27], v[60:63]
    v_mfma_f32_16x16x32_bf16 v[92:95], v[136:139], a[88:91], v[92:95]
    v_mfma_f32_16x16x32_bf16 v[100:103], v[140:143], v[28:31], v[100:103]
    s_waitcnt vmcnt(14) lgkmcnt(0)
    v_mfma_f32_16x16x32_bf16 v[32:35], v[144:147], a[28:31], v[32:35]
    ds_read_b64_tr_b16 v[104:105], v9 offset:32768
    ds_read_b64_tr_b16 v[106:107], v9 offset:34816
    v_mfma_f32_16x16x32_bf16 v[64:67], v[144:147], a[92:95], v[64:67]
    ds_read_b64_tr_b16 v[108:109], v10 offset:32768
    ds_read_b64_tr_b16 v[110:111], v10 offset:34816
    v_mfma_f32_16x16x32_bf16 v[36:39], v[148:151], a[28:31], v[36:39]
    ds_read_b64_tr_b16 v[112:113], v11 offset:32768
    ds_read_b64_tr_b16 v[114:115], v11 offset:34816
    v_mfma_f32_16x16x32_bf16 v[68:71], v[148:151], a[92:95], v[68:71]
    ds_read_b64_tr_b16 v[116:117], v12 offset:32768
    ds_read_b64_tr_b16 v[118:119], v12 offset:34816
    v_mfma_f32_16x16x32_bf16 v[40:43], v[152:155], a[28:31], v[40:43]
    ds_read_b64_tr_b16 v[120:121], v23 offset:32768
    ds_read_b64_tr_b16 v[122:123], v23 offset:34816
    v_mfma_f32_16x16x32_bf16 v[72:75], v[152:155], a[92:95], v[72:75]
    ds_read_b64_tr_b16 v[124:125], v19 offset:32768
    ds_read_b64_tr_b16 v[126:127], v19 offset:34816
    v_mfma_f32_16x16x32_bf16 v[44:47], v[156:159], a[28:31], v[44:47]
    ds_read_b64_tr_b16 v[128:129], v20 offset:32768
    ds_read_b64_tr_b16 v[130:131], v20 offset:34816
    v_mfma_f32_16x16x32_bf16 v[76:79], v[156:159], a[92:95], v[76:79]
    ds_read_b64_tr_b16 v[132:133], v21 offset:32768
    ds_read_b64_tr_b16 v[134:135], v21 offset:34816
    v_mfma_f32_16x16x32_bf16 v[96:99], v[160:163], v[28:31], v[96:99]
    ds_read_b64_tr_b16 v[136:137], v22 offset:32768
    ds_read_b64_tr_b16 v[138:139], v22 offset:34816
    v_mfma_f32_16x16x32_bf16 v[48:51], v[164:167], a[28:31], v[48:51]
    ds_read_b64_tr_b16 v[140:141], v24 offset:32768
    ds_read_b64_tr_b16 v[142:143], v24 offset:34816
    v_mfma_f32_16x16x32_bf16 v[80:83], v[164:167], a[92:95], v[80:83]
    global_load_dwordx4 a[60:63], v5, s[46:47] offset:3072 sc1
    global_load_dwordx4 a[124:127], v25, s[46:47] offset:3072 sc1
    v_mfma_f32_16x16x32_bf16 v[52:55], v[168:171], a[28:31], v[52:55]
    s_add_u32 s46, s46, 4096
    s_addc_u32 s47, s47, 0
    v_mfma_f32_16x16x32_bf16 v[84:87], v[168:171], a[92:95], v[84:87]
    v_mfma_f32_16x16x32_bf16 v[56:59], v[172:175], a[28:31], v[56:59]
    v_mfma_f32_16x16x32_bf16 v[88:91], v[172:175], a[92:95], v[88:91]
    v_mfma_f32_16x16x32_bf16 v[60:63], v[176:179], a[28:31], v[60:63]
    v_mfma_f32_16x16x32_bf16 v[92:95], v[176:179], a[92:95], v[92:95]
    v_mfma_f32_16x16x32_bf16 v[100:103], v[180:183], v[28:31], v[100:103]
    s_waitcnt vmcnt(14) lgkmcnt(0)
    v_mfma_f32_16x16x32_bf16 v[32:35], v[104:107], a[32:35], v[32:35]
    ds_read_b64_tr_b16 v[144:145], v9 offset:36864
    ds_read_b64_tr_b16 v[146:147], v9 offset:38912
    v_mfma_f32_16x16x32_bf16 v[64:67], v[104:107], a[96:99], v[64:67]
    ds_read_b64_tr_b16 v[148:149], v10 offset:36864
    ds_read_b64_tr_b16 v[150:151], v10 offset:38912
    v_mfma_f32_16x16x32_bf16 v[36:39], v[108:111], a[32:35], v[36:39]
    ds_read_b64_tr_b16 v[152:153], v11 offset:36864
    ds_read_b64_tr_b16 v[154:155], v11 offset:38912
    v_mfma_f32_16x16x32_bf16 v[68:71], v[108:111], a[96:99], v[68:71]
    ds_read_b64_tr_b16 v[156:157], v12 offset:36864
    ds_read_b64_tr_b16 v[158:159], v12 offset:38912
    v_mfma_f32_16x16x32_bf16 v[40:43], v[112:115], a[32:35], v[40:43]
    ds_read_b64_tr_b16 v[160:161], v23 offset:36864
    ds_read_b64_tr_b16 v[162:163], v23 offset:38912
    v_mfma_f32_16x16x32_bf16 v[72:75], v[112:115], a[96:99], v[72:75]
    ds_read_b64_tr_b16 v[164:165], v19 offset:36864
    ds_read_b64_tr_b16 v[166:167], v19 offset:38912
    v_mfma_f32_16x16x32_bf16 v[44:47], v[116:119], a[32:35], v[44:47]
    ds_read_b64_tr_b16 v[168:169], v20 offset:36864
    ds_read_b64_tr_b16 v[170:171], v20 offset:38912
    v_mfma_f32_16x16x32_bf16 v[76:79], v[116:119], a[96:99], v[76:79]
    ds_read_b64_tr_b16 v[172:173], v21 offset:36864
    ds_read_b64_tr_b16 v[174:175], v21 offset:38912
    v_mfma_f32_16x16x32_bf16 v[96:99], v[120:123], v[28:31], v[96:99]
    ds_read_b64_tr_b16 v[176:177], v22 offset:36864
    ds_read_b64_tr_b16 v[178:179], v22 offset:38912
    v_mfma_f32_16x16x32_bf16 v[48:51], v[124:127], a[32:35], v[48:51]
    ds_read_b64_tr_b16 v[180:181], v24 offset:36864
    ds_read_b64_tr_b16 v[182:183], v24 offset:38912
    v_mfma_f32_16x16x32_bf16 v[80:83], v[124:127], a[96:99], v[80:83]
    global_load_dwordx4 a[128:131], v0, s[24:25]
    s_add_u32 s24, s24, 32768
    s_addc_u32 s25, s25, 0
    global_load_dwordx4 a[132:135], v0, s[24:25]
    s_add_u32 s24, s24, 32768
    s_addc_u32 s25, s25, 0
    v_mfma_f32_16x16x32_bf16 v[52:55], v[128:131], a[32:35], v[52:55]
    global_load_dwordx4 a[136:139], v0, s[24:25]
    s_add_u32 s24, s24, 32768
    s_addc_u32 s25, s25, 0
    global_load_dwordx4 a[140:143], v0, s[24:25]
    s_add_u32 s24, s24, 32768
    s_addc_u32 s25, s25, 0
    v_mfma_f32_16x16x32_bf16 v[84:87], v[128:131], a[96:99], v[84:87]
    v_mfma_f32_16x16x32_bf16 v[56:59], v[132:135], a[32:35], v[56:59]
    v_mfma_f32_16x16x32_bf16 v[88:91], v[132:135], a[96:99], v[88:91]
    v_mfma_f32_16x16x32_bf16 v[60:63], v[136:139], a[32:35], v[60:63]
    v_mfma_f32_16x16x32_bf16 v[92:95], v[136:139], a[96:99], v[92:95]
    v_mfma_f32_16x16x32_bf16 v[100:103], v[140:143], v[28:31], v[100:103]
    s_waitcnt vmcnt(16) lgkmcnt(0)
    v_mfma_f32_16x16x32_bf16 v[32:35], v[144:147], a[36:39], v[32:35]
    ds_read_b64_tr_b16 v[104:105], v9 offset:40960
    ds_read_b64_tr_b16 v[106:107], v9 offset:43008
    v_mfma_f32_16x16x32_bf16 v[64:67], v[144:147], a[100:103], v[64:67]
    ds_read_b64_tr_b16 v[108:109], v10 offset:40960
    ds_read_b64_tr_b16 v[110:111], v10 offset:43008
    v_mfma_f32_16x16x32_bf16 v[36:39], v[148:151], a[36:39], v[36:39]
    ds_read_b64_tr_b16 v[112:113], v11 offset:40960
    ds_read_b64_tr_b16 v[114:115], v11 offset:43008
    v_mfma_f32_16x16x32_bf16 v[68:71], v[148:151], a[100:103], v[68:71]
    ds_read_b64_tr_b16 v[116:117], v12 offset:40960
    ds_read_b64_tr_b16 v[118:119], v12 offset:43008
    v_mfma_f32_16x16x32_bf16 v[40:43], v[152:155], a[36:39], v[40:43]
    ds_read_b64_tr_b16 v[120:121], v23 offset:40960
    ds_read_b64_tr_b16 v[122:123], v23 offset:43008
    v_mfma_f32_16x16x32_bf16 v[72:75], v[152:155], a[100:103], v[72:75]
    ds_read_b64_tr_b16 v[124:125], v19 offset:40960
    ds_read_b64_tr_b16 v[126:127], v19 offset:43008
    v_mfma_f32_16x16x32_bf16 v[44:47], v[156:159], a[36:39], v[44:47]
    ds_read_b64_tr_b16 v[128:129], v20 offset:40960
    ds_read_b64_tr_b16 v[130:131], v20 offset:43008
    v_mfma_f32_16x16x32_bf16 v[76:79], v[156:159], a[100:103], v[76:79]
    ds_read_b64_tr_b16 v[132:133], v21 offset:40960
    ds_read_b64_tr_b16 v[134:135], v21 offset:43008
    v_mfma_f32_16x16x32_bf16 v[96:99], v[160:163], v[28:31], v[96:99]
    ds_read_b64_tr_b16 v[136:137], v22 offset:40960
    ds_read_b64_tr_b16 v[138:139], v22 offset:43008
    v_mfma_f32_16x16x32_bf16 v[48:51], v[164:167], a[36:39], v[48:51]
    ds_read_b64_tr_b16 v[140:141], v24 offset:40960
    ds_read_b64_tr_b16 v[142:143], v24 offset:43008
    v_mfma_f32_16x16x32_bf16 v[80:83], v[164:167], a[100:103], v[80:83]
    global_load_dwordx4 a[144:147], v0, s[24:25]
    s_add_u32 s24, s24, 32768
    s_addc_u32 s25, s25, 0
    global_load_dwordx4 a[148:151], v0, s[24:25]
    s_add_u32 s24, s24, 32768
    s_addc_u32 s25, s25, 0
    v_mfma_f32_16x16x32_bf16 v[52:55], v[168:171], a[36:39], v[52:55]
    global_load_dwordx4 a[152:155], v0, s[24:25]
    s_add_u32 s24, s24, 32768
    s_addc_u32 s25, s25, 0
    global_load_dwordx4 a[156:159], v0, s[24:25]
    s_add_u32 s24, s24, 32768
    s_addc_u32 s25, s25, 0
    v_mfma_f32_16x16x32_bf16 v[84:87], v[168:171], a[100:103], v[84:87]
    v_mfma_f32_16x16x32_bf16 v[56:59], v[172:175], a[36:39], v[56:59]
    v_mfma_f32_16x16x32_bf16 v[88:91], v[172:175], a[100:103], v[88:91]
    v_mfma_f32_16x16x32_bf16 v[60:63], v[176:179], a[36:39], v[60:63]
    v_mfma_f32_16x16x32_bf16 v[92:95], v[176:179], a[100:103], v[92:95]
    v_mfma_f32_16x16x32_bf16 v[100:103], v[180:183], v[28:31], v[100:103]
    s_waitcnt vmcnt(18) lgkmcnt(0)
    v_mfma_f32_16x16x32_bf16 v[32:35], v[104:107], a[40:43], v[32:35]
    ds_read_b64_tr_b16 v[144:145], v9 offset:45056
    ds_read_b64_tr_b16 v[146:147], v9 offset:47104
    v_mfma_f32_16x16x32_bf16 v[64:67], v[104:107], a[104:107], v[64:67]
    ds_read_b64_tr_b16 v[148:149], v10 offset:45056
    ds_read_b64_tr_b16 v[150:151], v10 offset:47104
    v_mfma_f32_16x16x32_bf16 v[36:39], v[108:111], a[40:43], v[36:39]
    ds_read_b64_tr_b16 v[152:153], v11 offset:45056
    ds_read_b64_tr_b16 v[154:155], v11 offset:47104
    v_mfma_f32_16x16x32_bf16 v[68:71], v[108:111], a[104:107], v[68:71]
    ds_read_b64_tr_b16 v[156:157], v12 offset:45056
    ds_read_b64_tr_b16 v[158:159], v12 offset:47104
    v_mfma_f32_16x16x32_bf16 v[40:43], v[112:115], a[40:43], v[40:43]
    ds_read_b64_tr_b16 v[160:161], v23 offset:45056
    ds_read_b64_tr_b16 v[162:163], v23 offset:47104
    v_mfma_f32_16x16x32_bf16 v[72:75], v[112:115], a[104:107], v[72:75]
    ds_read_b64_tr_b16 v[164:165], v19 offset:45056
    ds_read_b64_tr_b16 v[166:167], v19 offset:47104
    v_mfma_f32_16x16x32_bf16 v[44:47], v[116:119], a[40:43], v[44:47]
    ds_read_b64_tr_b16 v[168:169], v20 offset:45056
    ds_read_b64_tr_b16 v[170:171], v20 offset:47104
    v_mfma_f32_16x16x32_bf16 v[76:79], v[116:119], a[104:107], v[76:79]
    ds_read_b64_tr_b16 v[172:173], v21 offset:45056
    ds_read_b64_tr_b16 v[174:175], v21 offset:47104
    v_mfma_f32_16x16x32_bf16 v[96:99], v[120:123], v[28:31], v[96:99]
    ds_read_b64_tr_b16 v[176:177], v22 offset:45056
    ds_read_b64_tr_b16 v[178:179], v22 offset:47104
    v_mfma_f32_16x16x32_bf16 v[48:51], v[124:127], a[40:43], v[48:51]
    ds_read_b64_tr_b16 v[180:181], v24 offset:45056
    ds_read_b64_tr_b16 v[182:183], v24 offset:47104
    v_mfma_f32_16x16x32_bf16 v[80:83], v[124:127], a[104:107], v[80:83]
    global_load_dwordx4 a[160:163], v0, s[24:25]
    s_add_u32 s24, s24, 32768
    s_addc_u32 s25, s25, 0
    global_load_dwordx4 a[164:167], v0, s[24:25]
    s_add_u32 s24, s24, 32768
    s_addc_u32 s25, s25, 0
    v_mfma_f32_16x16x32_bf16 v[52:55], v[128:131], a[40:43], v[52:55]
    global_load_dwordx4 a[168:171], v0, s[24:25]
    s_add_u32 s24, s24, 32768
    s_addc_u32 s25, s25, 0
    global_load_dwordx4 a[172:175], v0, s[24:25]
    s_add_u32 s24, s24, 32768
    s_addc_u32 s25, s25, 0
    v_mfma_f32_16x16x32_bf16 v[84:87], v[128:131], a[104:107], v[84:87]
    v_mfma_f32_16x16x32_bf16 v[56:59], v[132:135], a[40:43], v[56:59]
    v_mfma_f32_16x16x32_bf16 v[88:91], v[132:135], a[104:107], v[88:91]
    v_mfma_f32_16x16x32_bf16 v[60:63], v[136:139], a[40:43], v[60:63]
    v_mfma_f32_16x16x32_bf16 v[92:95], v[136:139], a[104:107], v[92:95]
    v_mfma_f32_16x16x32_bf16 v[100:103], v[140:143], v[28:31], v[100:103]
    s_waitcnt vmcnt(20) lgkmcnt(0)
    v_mfma_f32_16x16x32_bf16 v[32:35], v[144:147], a[44:47], v[32:35]
    ds_read_b64_tr_b16 v[104:105], v9 offset:49152
    ds_read_b64_tr_b16 v[106:107], v9 offset:51200
    v_mfma_f32_16x16x32_bf16 v[64:67], v[144:147], a[108:111], v[64:67]
    ds_read_b64_tr_b16 v[108:109], v10 offset:49152
    ds_read_b64_tr_b16 v[110:111], v10 offset:51200
    v_mfma_f32_16x16x32_bf16 v[36:39], v[148:151], a[44:47], v[36:39]
    ds_read_b64_tr_b16 v[112:113], v11 offset:49152
    ds_read_b64_tr_b16 v[114:115], v11 offset:51200
    v_mfma_f32_16x16x32_bf16 v[68:71], v[148:151], a[108:111], v[68:71]
    ds_read_b64_tr_b16 v[116:117], v12 offset:49152
    ds_read_b64_tr_b16 v[118:119], v12 offset:51200
    v_mfma_f32_16x16x32_bf16 v[40:43], v[152:155], a[44:47], v[40:43]
    ds_read_b64_tr_b16 v[120:121], v23 offset:49152
    ds_read_b64_tr_b16 v[122:123], v23 offset:51200
    v_mfma_f32_16x16x32_bf16 v[72:75], v[152:155], a[108:111], v[72:75]
    ds_read_b64_tr_b16 v[124:125], v19 offset:49152
    ds_read_b64_tr_b16 v[126:127], v19 offset:51200
    v_mfma_f32_16x16x32_bf16 v[44:47], v[156:159], a[44:47], v[44:47]
    ds_read_b64_tr_b16 v[128:129], v20 offset:49152
    ds_read_b64_tr_b16 v[130:131], v20 offset:51200
    v_mfma_f32_16x16x32_bf16 v[76:79], v[156:159], a[108:111], v[76:79]
    ds_read_b64_tr_b16 v[132:133], v21 offset:49152
    ds_read_b64_tr_b16 v[134:135], v21 offset:51200
    v_mfma_f32_16x16x32_bf16 v[96:99], v[160:163], v[28:31], v[96:99]
    ds_read_b64_tr_b16 v[136:137], v22 offset:49152
    ds_read_b64_tr_b16 v[138:139], v22 offset:51200
    v_mfma_f32_16x16x32_bf16 v[48:51], v[164:167], a[44:47], v[48:51]
    ds_read_b64_tr_b16 v[140:141], v24 offset:49152
    ds_read_b64_tr_b16 v[142:143], v24 offset:51200
    v_mfma_f32_16x16x32_bf16 v[80:83], v[164:167], a[108:111], v[80:83]
    global_load_dwordx4 a[176:179], v0, s[24:25]
    s_add_u32 s24, s24, 32768
    s_addc_u32 s25, s25, 0
    global_load_dwordx4 a[180:183], v0, s[24:25]
    s_add_u32 s24, s24, 32768
    s_addc_u32 s25, s25, 0
    v_mfma_f32_16x16x32_bf16 v[52:55], v[168:171], a[44:47], v[52:55]
    global_load_dwordx4 a[184:187], v0, s[24:25]
    s_add_u32 s24, s24, 32768
    s_addc_u32 s25, s25, 0
    global_load_dwordx4 a[188:191], v0, s[24:25]
    s_add_u32 s24, s24, 32768
    s_addc_u32 s25, s25, 0
    v_mfma_f32_16x16x32_bf16 v[84:87], v[168:171], a[108:111], v[84:87]
    v_mfma_f32_16x16x32_bf16 v[56:59], v[172:175], a[44:47], v[56:59]
    v_mfma_f32_16x16x32_bf16 v[88:91], v[172:175], a[108:111], v[88:91]
    v_mfma_f32_16x16x32_bf16 v[60:63], v[176:179], a[44:47], v[60:63]
    v_mfma_f32_16x16x32_bf16 v[92:95], v[176:179], a[108:111], v[92:95]
    v_mfma_f32_16x16x32_bf16 v[100:103], v[180:183], v[28:31], v[100:103]
    s_waitcnt vmcnt(22) lgkmcnt(0)
    v_mfma_f32_16x16x32_bf16 v[32:35], v[104:107], a[48:51], v[32:35]
    ds_read_b64_tr_b16 v[144:145], v9 offset:53248
    ds_read_b64_tr_b16 v[146:147], v9 offset:55296
    v_mfma_f32_16x16x32_bf16 v[64:67], v[104:107], a[112:115], v[64:67]
    ds_read_b64_tr_b16 v[148:149], v10 offset:53248
    ds_read_b64_tr_b16 v[150:151], v10 offset:55296
    v_mfma_f32_16x16x32_bf16 v[36:39], v[108:111], a[48:51], v[36:39]
    ds_read_b64_tr_b16 v[152:153], v11 offset:53248
    ds_read_b64_tr_b16 v[154:155], v11 offset:55296
    v_mfma_f32_16x16x32_bf16 v[68:71], v[108:111], a[112:115], v[68:71]
    ds_read_b64_tr_b16 v[156:157], v12 offset:53248
    ds_read_b64_tr_b16 v[158:159], v12 offset:55296
    v_mfma_f32_16x16x32_bf16 v[40:43], v[112:115], a[48:51], v[40:43]
    ds_read_b64_tr_b16 v[160:161], v23 offset:53248
    ds_read_b64_tr_b16 v[162:163], v23 offset:55296
    v_mfma_f32_16x16x32_bf16 v[72:75], v[112:115], a[112:115], v[72:75]
    ds_read_b64_tr_b16 v[164:165], v19 offset:53248
    ds_read_b64_tr_b16 v[166:167], v19 offset:55296
    v_mfma_f32_16x16x32_bf16 v[44:47], v[116:119], a[48:51], v[44:47]
    ds_read_b64_tr_b16 v[168:169], v20 offset:53248
    ds_read_b64_tr_b16 v[170:171], v20 offset:55296
    v_mfma_f32_16x16x32_bf16 v[76:79], v[116:119], a[112:115], v[76:79]
    ds_read_b64_tr_b16 v[172:173], v21 offset:53248
    ds_read_b64_tr_b16 v[174:175], v21 offset:55296
    v_mfma_f32_16x16x32_bf16 v[96:99], v[120:123], v[28:31], v[96:99]
    ds_read_b64_tr_b16 v[176:177], v22 offset:53248
    ds_read_b64_tr_b16 v[178:179], v22 offset:55296
    v_mfma_f32_16x16x32_bf16 v[48:51], v[124:127], a[48:51], v[48:51]
    ds_read_b64_tr_b16 v[180:181], v24 offset:53248
    ds_read_b64_tr_b16 v[182:183], v24 offset:55296
    v_mfma_f32_16x16x32_bf16 v[80:83], v[124:127], a[112:115], v[80:83]
    global_load_dwordx4 a[192:195], v0, s[24:25]
    s_add_u32 s24, s24, 32768
    s_addc_u32 s25, s25, 0
    global_load_dwordx4 a[196:199], v0, s[24:25]
    s_add_u32 s24, s24, 32768
    s_addc_u32 s25, s25, 0
    v_mfma_f32_16x16x32_bf16 v[52:55], v[128:131], a[48:51], v[52:55]
    global_load_dwordx4 a[200:203], v0, s[24:25]
    s_add_u32 s24, s24, 32768
    s_addc_u32 s25, s25, 0
    global_load_dwordx4 a[204:207], v0, s[24:25]
    s_add_u32 s24, s24, 32768
    s_addc_u32 s25, s25, 0
    v_mfma_f32_16x16x32_bf16 v[84:87], v[128:131], a[112:115], v[84:87]
    v_mfma_f32_16x16x32_bf16 v[56:59], v[132:135], a[48:51], v[56:59]
    v_mfma_f32_16x16x32_bf16 v[88:91], v[132:135], a[112:115], v[88:91]
    v_mfma_f32_16x16x32_bf16 v[60:63], v[136:139], a[48:51], v[60:63]
    v_mfma_f32_16x16x32_bf16 v[92:95], v[136:139], a[112:115], v[92:95]
    v_mfma_f32_16x16x32_bf16 v[100:103], v[140:143], v[28:31], v[100:103]
    s_waitcnt vmcnt(24) lgkmcnt(0)
    v_mfma_f32_16x16x32_bf16 v[32:35], v[144:147], a[52:55], v[32:35]
    ds_read_b64_tr_b16 v[104:105], v9 offset:57344
    ds_read_b64_tr_b16 v[106:107], v9 offset:59392
    v_mfma_f32_16x16x32_bf16 v[64:67], v[144:147], a[116:119], v[64:67]
    ds_read_b64_tr_b16 v[108:109], v10 offset:57344
    ds_read_b64_tr_b16 v[110:111], v10 offset:59392
    v_mfma_f32_16x16x32_bf16 v[36:39], v[148:151], a[52:55], v[36:39]
    ds_read_b64_tr_b16 v[112:113], v11 offset:57344
    ds_read_b64_tr_b16 v[114:115], v11 offset:59392
    v_mfma_f32_16x16x32_bf16 v[68:71], v[148:151], a[116:119], v[68:71]
    ds_read_b64_tr_b16 v[116:117], v12 offset:57344
    ds_read_b64_tr_b16 v[118:119], v12 offset:59392
    v_mfma_f32_16x16x32_bf16 v[40:43], v[152:155], a[52:55], v[40:43]
    ds_read_b64_tr_b16 v[120:121], v23 offset:57344
    ds_read_b64_tr_b16 v[122:123], v23 offset:59392
    v_mfma_f32_16x16x32_bf16 v[72:75], v[152:155], a[116:119], v[72:75]
    ds_read_b64_tr_b16 v[124:125], v19 offset:57344
    ds_read_b64_tr_b16 v[126:127], v19 offset:59392
    v_mfma_f32_16x16x32_bf16 v[44:47], v[156:159], a[52:55], v[44:47]
    ds_read_b64_tr_b16 v[128:129], v20 offset:57344
    ds_read_b64_tr_b16 v[130:131], v20 offset:59392
    v_mfma_f32_16x16x32_bf16 v[76:79], v[156:159], a[116:119], v[76:79]
    ds_read_b64_tr_b16 v[132:133], v21 offset:57344
    ds_read_b64_tr_b16 v[134:135], v21 offset:59392
    v_mfma_f32_16x16x32_bf16 v[96:99], v[160:163], v[28:31], v[96:99]
    ds_read_b64_tr_b16 v[136:137], v22 offset:57344
    ds_read_b64_tr_b16 v[138:139], v22 offset:59392
    v_mfma_f32_16x16x32_bf16 v[48:51], v[164:167], a[52:55], v[48:51]
    ds_read_b64_tr_b16 v[140:141], v24 offset:57344
    ds_read_b64_tr_b16 v[142:143], v24 offset:59392
    v_mfma_f32_16x16x32_bf16 v[80:83], v[164:167], a[116:119], v[80:83]
    global_load_dwordx4 a[208:211], v0, s[24:25]
    s_add_u32 s24, s24, 32768
    s_addc_u32 s25, s25, 0
    global_load_dwordx4 a[212:215], v0, s[24:25]
    s_add_u32 s24, s24, 32768
    s_addc_u32 s25, s25, 0
    v_mfma_f32_16x16x32_bf16 v[52:55], v[168:171], a[52:55], v[52:55]
    global_load_dwordx4 a[216:219], v0, s[24:25]
    s_add_u32 s24, s24, 32768
    s_addc_u32 s25, s25, 0
    global_load_dwordx4 a[220:223], v0, s[24:25]
    s_add_u32 s24, s24, 32768
    s_addc_u32 s25, s25, 0
    v_mfma_f32_16x16x32_bf16 v[84:87], v[168:171], a[116:119], v[84:87]
    v_mfma_f32_16x16x32_bf16 v[56:59], v[172:175], a[52:55], v[56:59]
    v_mfma_f32_16x16x32_bf16 v[88:91], v[172:175], a[116:119], v[88:91]
    v_mfma_f32_16x16x32_bf16 v[60:63], v[176:179], a[52:55], v[60:63]
    v_mfma_f32_16x16x32_bf16 v[92:95], v[176:179], a[116:119], v[92:95]
    v_mfma_f32_16x16x32_bf16 v[100:103], v[180:183], v[28:31], v[100:103]
    s_waitcnt vmcnt(26) lgkmcnt(0)
    v_mfma_f32_16x16x32_bf16 v[32:35], v[104:107], a[56:59], v[32:35]
    ds_read_b64_tr_b16 v[144:145], v9 offset:61440
    ds_read_b64_tr_b16 v[146:147], v9 offset:63488
    v_mfma_f32_16x16x32_bf16 v[64:67], v[104:107], a[120:123], v[64:67]
    ds_read_b64_tr_b16 v[148:149], v10 offset:61440
    ds_read_b64_tr_b16 v[150:151], v10 offset:63488
    v_mfma_f32_16x16x32_bf16 v[36:39], v[108:111], a[56:59], v[36:39]
    ds_read_b64_tr_b16 v[152:153], v11 offset:61440
    ds_read_b64_tr_b16 v[154:155], v11 offset:63488
    v_mfma_f32_16x16x32_bf16 v[68:71], v[108:111], a[120:123], v[68:71]
    ds_read_b64_tr_b16 v[156:157], v12 offset:61440
    ds_read_b64_tr_b16 v[158:159], v12 offset:63488
    v_mfma_f32_16x16x32_bf16 v[40:43], v[112:115], a[56:59], v[40:43]
    ds_read_b64_tr_b16 v[160:161], v23 offset:61440
    ds_read_b64_tr_b16 v[162:163], v23 offset:63488
    v_mfma_f32_16x16x32_bf16 v[72:75], v[112:115], a[120:123], v[72:75]
    ds_read_b64_tr_b16 v[164:165], v19 offset:61440
    ds_read_b64_tr_b16 v[166:167], v19 offset:63488
    v_mfma_f32_16x16x32_bf16 v[44:47], v[116:119], a[56:59], v[44:47]
    ds_read_b64_tr_b16 v[168:169], v20 offset:61440
    ds_read_b64_tr_b16 v[170:171], v20 offset:63488
    v_mfma_f32_16x16x32_bf16 v[76:79], v[116:119], a[120:123], v[76:79]
    ds_read_b64_tr_b16 v[172:173], v21 offset:61440
    ds_read_b64_tr_b16 v[174:175], v21 offset:63488
    v_mfma_f32_16x16x32_bf16 v[96:99], v[120:123], v[28:31], v[96:99]
    ds_read_b64_tr_b16 v[176:177], v22 offset:61440
    ds_read_b64_tr_b16 v[178:179], v22 offset:63488
    v_mfma_f32_16x16x32_bf16 v[48:51], v[124:127], a[56:59], v[48:51]
    ds_read_b64_tr_b16 v[180:181], v24 offset:61440
    ds_read_b64_tr_b16 v[182:183], v24 offset:63488
    v_mfma_f32_16x16x32_bf16 v[80:83], v[124:127], a[120:123], v[80:83]
    global_load_dwordx4 a[224:227], v0, s[24:25]
    s_add_u32 s24, s24, 32768
    s_addc_u32 s25, s25, 0
    global_load_dwordx4 a[228:231], v0, s[24:25]
    s_add_u32 s24, s24, 32768
    s_addc_u32 s25, s25, 0
    v_mfma_f32_16x16x32_bf16 v[52:55], v[128:131], a[56:59], v[52:55]
    global_load_dwordx4 a[232:235], v0, s[24:25]
    s_add_u32 s24, s24, 32768
    s_addc_u32 s25, s25, 0
    global_load_dwordx4 a[236:239], v0, s[24:25]
    s_add_u32 s24, s24, 32768
    s_addc_u32 s25, s25, 0
    v_mfma_f32_16x16x32_bf16 v[84:87], v[128:131], a[120:123], v[84:87]
    v_mfma_f32_16x16x32_bf16 v[56:59], v[132:135], a[56:59], v[56:59]
    v_mfma_f32_16x16x32_bf16 v[88:91], v[132:135], a[120:123], v[88:91]
    v_mfma_f32_16x16x32_bf16 v[60:63], v[136:139], a[56:59], v[60:63]
    v_mfma_f32_16x16x32_bf16 v[92:95], v[136:139], a[120:123], v[92:95]
    v_mfma_f32_16x16x32_bf16 v[100:103], v[140:143], v[28:31], v[100:103]
    s_waitcnt vmcnt(28) lgkmcnt(0)
    v_mfma_f32_16x16x32_bf16 v[32:35], v[144:147], a[60:63], v[32:35]
    global_load_dwordx4 a[240:243], v0, s[24:25]
    s_add_u32 s24, s24, 32768
    s_addc_u32 s25, s25, 0
    global_load_dwordx4 a[244:247], v0, s[24:25]
    s_add_u32 s24, s24, 32768
    s_addc_u32 s25, s25, 0
    v_mfma_f32_16x16x32_bf16 v[64:67], v[144:147], a[124:127], v[64:67]
    global_load_dwordx4 a[248:251], v0, s[24:25]
    s_add_u32 s24, s24, 32768
    s_addc_u32 s25, s25, 0
    global_load_dwordx4 a[252:255], v0, s[24:25]
    s_add_u32 s24, s24, 32768
    s_addc_u32 s25, s25, 0
    v_mfma_f32_16x16x32_bf16 v[36:39], v[148:151], a[60:63], v[36:39]
    v_mfma_f32_16x16x32_bf16 v[68:71], v[148:151], a[124:127], v[68:71]
    v_mfma_f32_16x16x32_bf16 v[40:43], v[152:155], a[60:63], v[40:43]
    v_mfma_f32_16x16x32_bf16 v[72:75], v[152:155], a[124:127], v[72:75]
    v_mfma_f32_16x16x32_bf16 v[44:47], v[156:159], a[60:63], v[44:47]
    v_mfma_f32_16x16x32_bf16 v[76:79], v[156:159], a[124:127], v[76:79]
    v_mfma_f32_16x16x32_bf16 v[96:99], v[160:163], v[28:31], v[96:99]
    v_mfma_f32_16x16x32_bf16 v[48:51], v[164:167], a[60:63], v[48:51]
    v_mfma_f32_16x16x32_bf16 v[80:83], v[164:167], a[124:127], v[80:83]
    v_mfma_f32_16x16x32_bf16 v[52:55], v[168:171], a[60:63], v[52:55]
    v_mfma_f32_16x16x32_bf16 v[84:87], v[168:171], a[124:127], v[84:87]
    v_mfma_f32_16x16x32_bf16 v[56:59], v[172:175], a[60:63], v[56:59]
    v_mfma_f32_16x16x32_bf16 v[88:91], v[172:175], a[124:127], v[88:91]
    v_mfma_f32_16x16x32_bf16 v[60:63], v[176:179], a[60:63], v[60:63]
    v_mfma_f32_16x16x32_bf16 v[92:95], v[176:179], a[124:127], v[92:95]
    v_mfma_f32_16x16x32_bf16 v[100:103], v[180:183], v[28:31], v[100:103]
    v_add_u32 v26, 151552, v5
    s_lshl_b32 s10, s3, 10
    v_add_u32 v27, s10, v26
    ds_write_b128 v27, v[96:99] offset:0
    s_nop 3
    ds_write_b128 v27, v[100:103] offset:4096
    s_waitcnt lgkmcnt(0)
    s_barrier
    v_lshl_add_u32 v25, v4, 3, 0
    v_add_u32 v25, 147456, v25
    ds_read_b128 v[184:187], v26 offset:0
    ds_read_b64 v[232:233], v25 offset:0
    ds_read_b128 v[188:191], v26 offset:1024
    ds_read_b64 v[234:235], v25 offset:32
    ds_read_b128 v[192:195], v26 offset:2048
    ds_read_b64 v[236:237], v25 offset:64
    ds_read_b128 v[196:199], v26 offset:3072
    ds_read_b64 v[238:239], v25 offset:96
    v_mov_b32 v20, v14
    v_mov_b32 v21, v15
    v_mov_b32 v22, v16
    v_mov_b32 v23, v17
    s_mul_i32 s13, s45, 56
    s_lshl_b32 s12, s59, 2
    s_add_u32 s12, s12, s13
    s_lshl_b32 s12, s12, 10
    s_add_u32 s12, s12, 10485760
    s_add_u32 s54, s38, s12
    s_addc_u32 s55, s39, 0
    v_add_u32 v18, 57344, v5
    v_mov_b32 v252, 0xbdd2d3e8
    v_mov_b32 v253, 0xc0135761
    v_mov_b32 v254, 1.0
    s_waitcnt lgkmcnt(0)
    v_lshlrev_b32 v200, 16, v232
    v_and_b32 v201, 0xffff0000, v232
    v_lshlrev_b32 v202, 16, v233
    v_and_b32 v203, 0xffff0000, v233
    v_lshlrev_b32 v204, 16, v234
    v_and_b32 v205, 0xffff0000, v234
    v_lshlrev_b32 v206, 16, v235
    v_and_b32 v207, 0xffff0000, v235
    v_lshlrev_b32 v208, 16, v236
    v_and_b32 v209, 0xffff0000, v236
    v_lshlrev_b32 v210, 16, v237
    v_and_b32 v211, 0xffff0000, v237
    v_lshlrev_b32 v212, 16, v238
    v_and_b32 v213, 0xffff0000, v238
    v_lshlrev_b32 v214, 16, v239
    v_and_b32 v215, 0xffff0000, v239
    v_pk_fma_f32 v[240:241], v[184:185], v[22:23], v[200:201] op_sel:[0,1,0] op_sel_hi:[1,1,1] neg_lo:[1,0,0] neg_hi:[1,0,0]
    v_pk_fma_f32 v[242:243], v[186:187], v[22:23], v[202:203] op_sel:[0,1,0] op_sel_hi:[1,1,1] neg_lo:[1,0,0] neg_hi:[1,0,0]
    v_pk_fma_f32 v[244:245], v[184:185], v[20:21], v[200:201] op_sel:[0,1,0] op_sel_hi:[1,1,1] neg_lo:[1,0,0] neg_hi:[1,0,0]
    v_pk_fma_f32 v[246:247], v[186:187], v[20:21], v[202:203] op_sel:[0,1,0] op_sel_hi:[1,1,1] neg_lo:[1,0,0] neg_hi:[1,0,0]
    v_pk_fma_f32 v[32:33], v[32:33], v[22:23], v[240:241] op_sel_hi:[1,0,1]
    global_load_dwordx4 a[0:3], v0, s[24:25]
    s_add_u32 s24, s24, 32768
    s_addc_u32 s25, s25, 0
    v_pk_fma_f32 v[34:35], v[34:35], v[22:23], v[242:243] op_sel_hi:[1,0,1]
    v_pk_fma_f32 v[64:65], v[64:65], v[20:21], v[244:245] op_sel_hi:[1,0,1]
    v_pk_fma_f32 v[66:67], v[66:67], v[20:21], v[246:247] op_sel_hi:[1,0,1]
    v_cvt_pk_bf16_f32 v32, 0, v32
    v_cvt_pk_bf16_f32 v34, 0, v34
    v_cvt_pk_bf16_f32 v64, 0, v64
    v_cvt_pk_bf16_f32 v66, 0, v66
    v_cvt_pk_bf16_f32 v33, 0, v33
    v_cvt_pk_bf16_f32 v35, 0, v35
    v_cvt_pk_bf16_f32 v65, 0, v65
    v_cvt_pk_bf16_f32 v67, 0, v67
    v_pk_mul_f32 v[240:241], v[32:33], v[32:33]
    v_pk_mul_f32 v[242:243], v[34:35], v[34:35]
    v_pk_mul_f32 v[244:245], v[64:65], v[64:65]
    v_pk_mul_f32 v[246:247], v[66:67], v[66:67]
    v_pk_fma_f32 v[240:241], v[240:241], v[252:253], v[252:253] op_sel:[0,0,1] op_sel_hi:[1,0,1]
    v_pk_fma_f32 v[242:243], v[242:243], v[252:253], v[252:253] op_sel:[0,0,1] op_sel_hi:[1,0,1]
    v_pk_fma_f32 v[244:245], v[244:245], v[252:253], v[252:253] op_sel:[0,0,1] op_sel_hi:[1,0,1]
    v_pk_fma_f32 v[246:247], v[246:247], v[252:253], v[252:253] op_sel:[0,0,1] op_sel_hi:[1,0,1]
    v_pk_mul_f32 v[240:241], v[240:241], v[32:33]
    global_load_dwordx4 a[4:7], v0, s[24:25]
    s_add_u32 s24, s24, 32768
    s_addc_u32 s25, s25, 0
    v_pk_mul_f32 v[242:243], v[242:243], v[34:35]
    v_pk_mul_f32 v[244:245], v[244:245], v[64:65]
    v_pk_mul_f32 v[246:247], v[246:247], v[66:67]
    v_exp_f32 v240, v240
    v_exp_f32 v242, v242
    v_exp_f32 v244, v244
    v_exp_f32 v246, v246
    v_exp_f32 v241, v241
    v_exp_f32 v243, v243
    v_exp_f32 v245, v245
    v_exp_f32 v247, v247
    v_pk_add_f32 v[240:241], v[240:241], v[254:255] op_sel_hi:[1,0]
    v_pk_add_f32 v[242:243], v[242:243], v[254:255] op_sel_hi:[1,0]
    v_pk_add_f32 v[244:245], v[244:245], v[254:255] op_sel_hi:[1,0]
    v_pk_add_f32 v[246:247], v[246:247], v[254:255] op_sel_hi:[1,0]
    v_rcp_f32 v240, v240
    v_rcp_f32 v242, v242
    v_rcp_f32 v244, v244
    v_rcp_f32 v246, v246
    v_rcp_f32 v241, v241
    global_load_dwordx4 a[8:11], v0, s[24:25]
    s_add_u32 s24, s24, 32768
    s_addc_u32 s25, s25, 0
    v_rcp_f32 v243, v243
    v_rcp_f32 v245, v245
    v_rcp_f32 v247, v247
    v_pk_mul_f32 v[240:241], v[240:241], v[32:33]
    v_pk_mul_f32 v[242:243], v[242:243], v[34:35]
    v_pk_mul_f32 v[244:245], v[244:245], v[64:65]
    v_pk_mul_f32 v[246:247], v[246:247], v[66:67]
    v_cvt_pk_bf16_f32 v216, v240, v241
    v_cvt_pk_bf16_f32 v217, v242, v243
    v_cvt_pk_bf16_f32 v220, v244, v245
    v_cvt_pk_bf16_f32 v221, v246, v247
    v_pk_fma_f32 v[240:241], v[188:189], v[22:23], v[204:205] op_sel:[0,1,0] op_sel_hi:[1,1,1] neg_lo:[1,0,0] neg_hi:[1,0,0]
    v_pk_fma_f32 v[242:243], v[190:191], v[22:23], v[206:207] op_sel:[0,1,0] op_sel_hi:[1,1,1] neg_lo:[1,0,0] neg_hi:[1,0,0]
    v_pk_fma_f32 v[244:245], v[188:189], v[20:21], v[204:205] op_sel:[0,1,0] op_sel_hi:[1,1,1] neg_lo:[1,0,0] neg_hi:[1,0,0]
    v_pk_fma_f32 v[246:247], v[190:191], v[20:21], v[206:207] op_sel:[0,1,0] op_sel_hi:[1,1,1] neg_lo:[1,0,0] neg_hi:[1,0,0]
    v_pk_fma_f32 v[36:37], v[36:37], v[22:23], v[240:241] op_sel_hi:[1,0,1]
    v_pk_fma_f32 v[38:39], v[38:39], v[22:23], v[242:243] op_sel_hi:[1,0,1]
    v_pk_fma_f32 v[68:69], v[68:69], v[20:21], v[244:245] op_sel_hi:[1,0,1]
    v_pk_fma_f32 v[70:71], v[70:71], v[20:21], v[246:247] op_sel_hi:[1,0,1]
    v_cvt_pk_bf16_f32 v36, 0, v36
    global_load_dwordx4 a[12:15], v0, s[24:25]
    s_add_u32 s24, s24, 32768
    s_addc_u32 s25, s25, 0
    v_cvt_pk_bf16_f32 v38, 0, v38
    v_cvt_pk_bf16_f32 v68, 0, v68
    v_cvt_pk_bf16_f32 v70, 0, v70
    v_cvt_pk_bf16_f32 v37, 0, v37
    v_cvt_pk_bf16_f32 v39, 0, v39
    v_cvt_pk_bf16_f32 v69, 0, v69
    v_cvt_pk_bf16_f32 v71, 0, v71
    v_pk_mul_f32 v[240:241], v[36:37], v[36:37]
    v_pk_mul_f32 v[242:243], v[38:39], v[38:39]
    v_pk_mul_f32 v[244:245], v[68:69], v[68:69]
    v_pk_mul_f32 v[246:247], v[70:71], v[70:71]
    v_pk_fma_f32 v[240:241], v[240:241], v[252:253], v[252:253] op_sel:[0,0,1] op_sel_hi:[1,0,1]
    v_pk_fma_f32 v[242:243], v[242:243], v[252:253], v[252:253] op_sel:[0,0,1] op_sel_hi:[1,0,1]
    v_pk_fma_f32 v[244:245], v[244:245], v[252:253], v[252:253] op_sel:[0,0,1] op_sel_hi:[1,0,1]
    v_pk_fma_f32 v[246:247], v[246:247], v[252:253], v[252:253] op_sel:[0,0,1] op_sel_hi:[1,0,1]
    v_pk_mul_f32 v[240:241], v[240:241], v[36:37]
    v_pk_mul_f32 v[242:243], v[242:243], v[38:39]
    v_pk_mul_f32 v[244:245], v[244:245], v[68:69]
    v_pk_mul_f32 v[246:247], v[246:247], v[70:71]
    v_exp_f32 v240, v240
    global_load_dwordx4 a[16:19], v0, s[24:25]
    s_add_u32 s24, s24, 32768
    s_addc_u32 s25, s25, 0
    v_exp_f32 v242, v242
    v_exp_f32 v244, v244
    v_exp_f32 v246, v246
    v_exp_f32 v241, v241
    v_exp_f32 v243, v243
    v_exp_f32 v245, v245
    v_exp_f32 v247, v247
    v_pk_add_f32 v[240:241], v[240:241], v[254:255] op_sel_hi:[1,0]
    v_pk_add_f32 v[242:243], v[242:243], v[254:255] op_sel_hi:[1,0]
    v_pk_add_f32 v[244:245], v[244:245], v[254:255] op_sel_hi:[1,0]
    v_pk_add_f32 v[246:247], v[246:247], v[254:255] op_sel_hi:[1,0]
    v_rcp_f32 v240, v240
    v_rcp_f32 v242, v242
    v_rcp_f32 v244, v244
    v_rcp_f32 v246, v246
    v_rcp_f32 v241, v241
    v_rcp_f32 v243, v243
    v_rcp_f32 v245, v245
    v_rcp_f32 v247, v247
    v_pk_mul_f32 v[240:241], v[240:241], v[36:37]
    global_load_dwordx4 a[20:23], v0, s[24:25]
    s_add_u32 s24, s24, 32768
    s_addc_u32 s25, s25, 0
    v_pk_mul_f32 v[242:243], v[242:243], v[38:39]
    v_pk_mul_f32 v[244:245], v[244:245], v[68:69]
    v_pk_mul_f32 v[246:247], v[246:247], v[70:71]
    v_cvt_pk_bf16_f32 v218, v240, v241
    v_cvt_pk_bf16_f32 v219, v242, v243
    v_cvt_pk_bf16_f32 v222, v244, v245
    v_cvt_pk_bf16_f32 v223, v246, v247
    s_cmp_eq_u32 s61, 1
    s_cbranch_scc1 sf_interleave_layers__linear_kernel_hedgehog__mixer_channel_mlp__prompt_kernel_67
    global_store_dwordx4 v5, v[216:219], s[54:55] offset:0 sc1
    global_store_dwordx4 v18, v[220:223], s[54:55] offset:0 sc1
    s_branch se_interleave_layers__linear_kernel_hedgehog__mixer_channel_mlp__prompt_kernel_68
sf_interleave_layers__linear_kernel_hedgehog__mixer_channel_mlp__prompt_kernel_67:
    global_store_dwordx4 v5, v[216:219], s[54:55] offset:0
    global_store_dwordx4 v18, v[220:223], s[54:55] offset:0
se_interleave_layers__linear_kernel_hedgehog__mixer_channel_mlp__prompt_kernel_68:
    v_pk_fma_f32 v[240:241], v[192:193], v[22:23], v[208:209] op_sel:[0,1,0] op_sel_hi:[1,1,1] neg_lo:[1,0,0] neg_hi:[1,0,0]
    v_pk_fma_f32 v[242:243], v[194:195], v[22:23], v[210:211] op_sel:[0,1,0] op_sel_hi:[1,1,1] neg_lo:[1,0,0] neg_hi:[1,0,0]
    v_pk_fma_f32 v[244:245], v[192:193], v[20:21], v[208:209] op_sel:[0,1,0] op_sel_hi:[1,1,1] neg_lo:[1,0,0] neg_hi:[1,0,0]
    v_pk_fma_f32 v[246:247], v[194:195], v[20:21], v[210:211] op_sel:[0,1,0] op_sel_hi:[1,1,1] neg_lo:[1,0,0] neg_hi:[1,0,0]
    v_pk_fma_f32 v[40:41], v[40:41], v[22:23], v[240:241] op_sel_hi:[1,0,1]
    v_pk_fma_f32 v[42:43], v[42:43], v[22:23], v[242:243] op_sel_hi:[1,0,1]
    v_pk_fma_f32 v[72:73], v[72:73], v[20:21], v[244:245] op_sel_hi:[1,0,1]
    v_pk_fma_f32 v[74:75], v[74:75], v[20:21], v[246:247] op_sel_hi:[1,0,1]
    v_cvt_pk_bf16_f32 v40, 0, v40
    v_cvt_pk_bf16_f32 v42, 0, v42
    v_cvt_pk_bf16_f32 v72, 0, v72
    v_cvt_pk_bf16_f32 v74, 0, v74
    v_cvt_pk_bf16_f32 v41, 0, v41
    global_load_dwordx4 a[24:27], v0, s[24:25]
    s_add_u32 s24, s24, 32768
    s_addc_u32 s25, s25, 0
    v_cvt_pk_bf16_f32 v43, 0, v43
    v_cvt_pk_bf16_f32 v73, 0, v73
    v_cvt_pk_bf16_f32 v75, 0, v75
    v_pk_mul_f32 v[240:241], v[40:41], v[40:41]
    v_pk_mul_f32 v[242:243], v[42:43], v[42:43]
    v_pk_mul_f32 v[244:245], v[72:73], v[72:73]
    v_pk_mul_f32 v[246:247], v[74:75], v[74:75]
    v_pk_fma_f32 v[240:241], v[240:241], v[252:253], v[252:253] op_sel:[0,0,1] op_sel_hi:[1,0,1]
    v_pk_fma_f32 v[242:243], v[242:243], v[252:253], v[252:253] op_sel:[0,0,1] op_sel_hi:[1,0,1]
    v_pk_fma_f32 v[244:245], v[244:245], v[252:253], v[252:253] op_sel:[0,0,1] op_sel_hi:[1,0,1]
    v_pk_fma_f32 v[246:247], v[246:247], v[252:253], v[252:253] op_sel:[0,0,1] op_sel_hi:[1,0,1]
    v_pk_mul_f32 v[240:241], v[240:241], v[40:41]
    v_pk_mul_f32 v[242:243], v[242:243], v[42:43]
    v_pk_mul_f32 v[244:245], v[244:245], v[72:73]
    v_pk_mul_f32 v[246:247], v[246:247], v[74:75]
    v_exp_f32 v240, v240
    v_exp_f32 v242, v242
    v_exp_f32 v244, v244
    v_exp_f32 v246, v246
    v_exp_f32 v241, v241
    global_load_dwordx4 a[28:31], v0, s[24:25]
    s_add_u32 s24, s24, 32768
    s_addc_u32 s25, s25, 0
    v_exp_f32 v243, v243
    v_exp_f32 v245, v245
    v_exp_f32 v247, v247
    v_pk_add_f32 v[240:241], v[240:241], v[254:255] op_sel_hi:[1,0]
    v_pk_add_f32 v[242:243], v[242:243], v[254:255] op_sel_hi:[1,0]
    v_pk_add_f32 v[244:245], v[244:245], v[254:255] op_sel_hi:[1,0]
    v_pk_add_f32 v[246:247], v[246:247], v[254:255] op_sel_hi:[1,0]
    v_rcp_f32 v240, v240
    v_rcp_f32 v242, v242
    v_rcp_f32 v244, v244
    v_rcp_f32 v246, v246
    v_rcp_f32 v241, v241
    v_rcp_f32 v243, v243
    v_rcp_f32 v245, v245
    v_rcp_f32 v247, v247
    v_pk_mul_f32 v[240:241], v[240:241], v[40:41]
    v_pk_mul_f32 v[242:243], v[242:243], v[42:43]
    v_pk_mul_f32 v[244:245], v[244:245], v[72:73]
    v_pk_mul_f32 v[246:247], v[246:247], v[74:75]
    v_cvt_pk_bf16_f32 v224, v240, v241
    global_load_dwordx4 a[32:35], v0, s[24:25]
    s_add_u32 s24, s24, 32768
    s_addc_u32 s25, s25, 0
    v_cvt_pk_bf16_f32 v225, v242, v243
    v_cvt_pk_bf16_f32 v228, v244, v245
    v_cvt_pk_bf16_f32 v229, v246, v247
    v_pk_fma_f32 v[240:241], v[196:197], v[22:23], v[212:213] op_sel:[0,1,0] op_sel_hi:[1,1,1] neg_lo:[1,0,0] neg_hi:[1,0,0]
    v_pk_fma_f32 v[242:243], v[198:199], v[22:23], v[214:215] op_sel:[0,1,0] op_sel_hi:[1,1,1] neg_lo:[1,0,0] neg_hi:[1,0,0]
    v_pk_fma_f32 v[244:245], v[196:197], v[20:21], v[212:213] op_sel:[0,1,0] op_sel_hi:[1,1,1] neg_lo:[1,0,0] neg_hi:[1,0,0]
    v_pk_fma_f32 v[246:247], v[198:199], v[20:21], v[214:215] op_sel:[0,1,0] op_sel_hi:[1,1,1] neg_lo:[1,0,0] neg_hi:[1,0,0]
    v_pk_fma_f32 v[44:45], v[44:45], v[22:23], v[240:241] op_sel_hi:[1,0,1]
    v_pk_fma_f32 v[46:47], v[46:47], v[22:23], v[242:243] op_sel_hi:[1,0,1]
    v_pk_fma_f32 v[76:77], v[76:77], v[20:21], v[244:245] op_sel_hi:[1,0,1]
    v_pk_fma_f32 v[78:79], v[78:79], v[20:21], v[246:247] op_sel_hi:[1,0,1]
    v_cvt_pk_bf16_f32 v44, 0, v44
    v_cvt_pk_bf16_f32 v46, 0, v46
    v_cvt_pk_bf16_f32 v76, 0, v76
    v_cvt_pk_bf16_f32 v78, 0, v78
    v_cvt_pk_bf16_f32 v45, 0, v45
    v_cvt_pk_bf16_f32 v47, 0, v47
    v_cvt_pk_bf16_f32 v77, 0, v77
    v_cvt_pk_bf16_f32 v79, 0, v79
    v_pk_mul_f32 v[240:241], v[44:45], v[44:45]
    global_load_dwordx4 a[36:39], v0, s[24:25]
    s_add_u32 s24, s24, 32768
    s_addc_u32 s25, s25, 0
    v_pk_mul_f32 v[242:243], v[46:47], v[46:47]
    v_pk_mul_f32 v[244:245], v[76:77], v[76:77]
    v_pk_mul_f32 v[246:247], v[78:79], v[78:79]
    v_pk_fma_f32 v[240:241], v[240:241], v[252:253], v[252:253] op_sel:[0,0,1] op_sel_hi:[1,0,1]
    v_pk_fma_f32 v[242:243], v[242:243], v[252:253], v[252:253] op_sel:[0,0,1] op_sel_hi:[1,0,1]
    v_pk_fma_f32 v[244:245], v[244:245], v[252:253], v[252:253] op_sel:[0,0,1] op_sel_hi:[1,0,1]
    v_pk_fma_f32 v[246:247], v[246:247], v[252:253], v[252:253] op_sel:[0,0,1] op_sel_hi:[1,0,1]
    v_pk_mul_f32 v[240:241], v[240:241], v[44:45]
    v_pk_mul_f32 v[242:243], v[242:243], v[46:47]
    v_pk_mul_f32 v[244:245], v[244:245], v[76:77]
    v_pk_mul_f32 v[246:247], v[246:247], v[78:79]
    v_exp_f32 v240, v240
    v_exp_f32 v242, v242
    v_exp_f32 v244, v244
    v_exp_f32 v246, v246
    v_exp_f32 v241, v241
    v_exp_f32 v243, v243
    v_exp_f32 v245, v245
    v_exp_f32 v247, v247
    v_pk_add_f32 v[240:241], v[240:241], v[254:255] op_sel_hi:[1,0]
    global_load_dwordx4 a[40:43], v0, s[24:25]
    s_add_u32 s24, s24, 32768
    s_addc_u32 s25, s25, 0
    v_pk_add_f32 v[242:243], v[242:243], v[254:255] op_sel_hi:[1,0]
    v_pk_add_f32 v[244:245], v[244:245], v[254:255] op_sel_hi:[1,0]
    v_pk_add_f32 v[246:247], v[246:247], v[254:255] op_sel_hi:[1,0]
    v_rcp_f32 v240, v240
    v_rcp_f32 v242, v242
    v_rcp_f32 v244, v244
    v_rcp_f32 v246, v246
    v_rcp_f32 v241, v241
    v_rcp_f32 v243, v243
    v_rcp_f32 v245, v245
    v_rcp_f32 v247, v247
    v_pk_mul_f32 v[240:241], v[240:241], v[44:45]
    v_pk_mul_f32 v[242:243], v[242:243], v[46:47]
    v_pk_mul_f32 v[244:245], v[244:245], v[76:77]
    v_pk_mul_f32 v[246:247], v[246:247], v[78:79]
    v_cvt_pk_bf16_f32 v226, v240, v241
    v_cvt_pk_bf16_f32 v227, v242, v243
    v_cvt_pk_bf16_f32 v230, v244, v245
    v_cvt_pk_bf16_f32 v231, v246, v247
    s_cmp_eq_u32 s61, 1
    s_cbranch_scc1 sf_interleave_layers__linear_kernel_hedgehog__mixer_channel_mlp__prompt_kernel_69
    global_store_dwordx4 v5, v[224:227], s[54:55] offset:1024 sc1
    global_store_dwordx4 v18, v[228:231], s[54:55] offset:1024 sc1
    s_branch se_interleave_layers__linear_kernel_hedgehog__mixer_channel_mlp__prompt_kernel_70
sf_interleave_layers__linear_kernel_hedgehog__mixer_channel_mlp__prompt_kernel_69:
    global_store_dwordx4 v5, v[224:227], s[54:55] offset:1024
    global_store_dwordx4 v18, v[228:231], s[54:55] offset:1024
se_interleave_layers__linear_kernel_hedgehog__mixer_channel_mlp__prompt_kernel_70:
    global_load_dwordx4 a[44:47], v0, s[24:25]
    s_add_u32 s24, s24, 32768
    s_addc_u32 s25, s25, 0
    ds_read_b128 v[184:187], v26 offset:4096
    ds_read_b64 v[232:233], v25 offset:128
    ds_read_b128 v[188:191], v26 offset:5120
    ds_read_b64 v[234:235], v25 offset:160
    ds_read_b128 v[192:195], v26 offset:6144
    ds_read_b64 v[236:237], v25 offset:192
    ds_read_b128 v[196:199], v26 offset:7168
    ds_read_b64 v[238:239], v25 offset:224
    s_lshl_b32 s48, s3, 10
    v_add_u32 v9, s48, v5
    v_add_u32 v10, 65536, v9
    s_waitcnt vmcnt(16) lgkmcnt(0)
    v_lshlrev_b32 v200, 16, v232
    v_and_b32 v201, 0xffff0000, v232
    v_lshlrev_b32 v202, 16, v233
    v_and_b32 v203, 0xffff0000, v233
    v_lshlrev_b32 v204, 16, v234
    v_and_b32 v205, 0xffff0000, v234
    ds_write_b128 v9, a[128:131] offset:0
    v_lshlrev_b32 v206, 16, v235
    v_and_b32 v207, 0xffff0000, v235
    v_lshlrev_b32 v208, 16, v236
    v_and_b32 v209, 0xffff0000, v236
    v_lshlrev_b32 v210, 16, v237
    ds_write_b128 v9, a[132:135] offset:4096
    v_and_b32 v211, 0xffff0000, v237
    v_lshlrev_b32 v212, 16, v238
    v_and_b32 v213, 0xffff0000, v238
    v_lshlrev_b32 v214, 16, v239
    v_and_b32 v215, 0xffff0000, v239
    v_pk_fma_f32 v[240:241], v[184:185], v[22:23], v[200:201] op_sel:[0,1,0] op_sel_hi:[1,1,1] neg_lo:[1,0,0] neg_hi:[1,0,0]
    ds_write_b128 v9, a[136:139] offset:8192
    v_pk_fma_f32 v[242:243], v[186:187], v[22:23], v[202:203] op_sel:[0,1,0] op_sel_hi:[1,1,1] neg_lo:[1,0,0] neg_hi:[1,0,0]
    v_pk_fma_f32 v[244:245], v[184:185], v[20:21], v[200:201] op_sel:[0,1,0] op_sel_hi:[1,1,1] neg_lo:[1,0,0] neg_hi:[1,0,0]
    v_pk_fma_f32 v[246:247], v[186:187], v[20:21], v[202:203] op_sel:[0,1,0] op_sel_hi:[1,1,1] neg_lo:[1,0,0] neg_hi:[1,0,0]
    v_pk_fma_f32 v[48:49], v[48:49], v[22:23], v[240:241] op_sel_hi:[1,0,1]
    v_pk_fma_f32 v[50:51], v[50:51], v[22:23], v[242:243] op_sel_hi:[1,0,1]
    global_load_dwordx4 a[48:51], v0, s[24:25]
    s_add_u32 s24, s24, 32768
    s_addc_u32 s25, s25, 0
    v_pk_fma_f32 v[80:81], v[80:81], v[20:21], v[244:245] op_sel_hi:[1,0,1]
    v_pk_fma_f32 v[82:83], v[82:83], v[20:21], v[246:247] op_sel_hi:[1,0,1]
    v_cvt_pk_bf16_f32 v48, 0, v48
    v_cvt_pk_bf16_f32 v50, 0, v50
    v_cvt_pk_bf16_f32 v80, 0, v80
    v_cvt_pk_bf16_f32 v82, 0, v82
    ds_write_b128 v9, a[140:143] offset:12288
    v_cvt_pk_bf16_f32 v49, 0, v49
    v_cvt_pk_bf16_f32 v51, 0, v51
    v_cvt_pk_bf16_f32 v81, 0, v81
    v_cvt_pk_bf16_f32 v83, 0, v83
    v_pk_mul_f32 v[240:241], v[48:49], v[48:49]
    ds_write_b128 v9, a[144:147] offset:16384
    v_pk_mul_f32 v[242:243], v[50:51], v[50:51]
    v_pk_mul_f32 v[244:245], v[80:81], v[80:81]
    v_pk_mul_f32 v[246:247], v[82:83], v[82:83]
    v_pk_fma_f32 v[240:241], v[240:241], v[252:253], v[252:253] op_sel:[0,0,1] op_sel_hi:[1,0,1]
    v_pk_fma_f32 v[242:243], v[242:243], v[252:253], v[252:253] op_sel:[0,0,1] op_sel_hi:[1,0,1]
    v_pk_fma_f32 v[244:245], v[244:245], v[252:253], v[252:253] op_sel:[0,0,1] op_sel_hi:[1,0,1]
    ds_write_b128 v9, a[148:151] offset:20480
    v_pk_fma_f32 v[246:247], v[246:247], v[252:253], v[252:253] op_sel:[0,0,1] op_sel_hi:[1,0,1]
    v_pk_mul_f32 v[240:241], v[240:241], v[48:49]
    v_pk_mul_f32 v[242:243], v[242:243], v[50:51]
    v_pk_mul_f32 v[244:245], v[244:245], v[80:81]
    v_pk_mul_f32 v[246:247], v[246:247], v[82:83]
    global_load_dwordx4 a[52:55], v0, s[24:25]
    s_add_u32 s24, s24, 32768
    s_addc_u32 s25, s25, 0
    v_exp_f32 v240, v240
    v_exp_f32 v242, v242
    v_exp_f32 v244, v244
    v_exp_f32 v246, v246
    v_exp_f32 v241, v241
    v_exp_f32 v243, v243
    ds_write_b128 v9, a[152:155] offset:24576
    v_exp_f32 v245, v245
    v_exp_f32 v247, v247
    v_pk_add_f32 v[240:241], v[240:241], v[254:255] op_sel_hi:[1,0]
    v_pk_add_f32 v[242:243], v[242:243], v[254:255] op_sel_hi:[1,0]
    v_pk_add_f32 v[244:245], v[244:245], v[254:255] op_sel_hi:[1,0]
    ds_write_b128 v9, a[156:159] offset:28672
    v_pk_add_f32 v[246:247], v[246:247], v[254:255] op_sel_hi:[1,0]
    v_rcp_f32 v240, v240
    v_rcp_f32 v242, v242
    v_rcp_f32 v244, v244
    v_rcp_f32 v246, v246
    v_rcp_f32 v241, v241
    global_load_dwordx4 a[56:59], v0, s[24:25]
    s_add_u32 s24, s24, 32768
    s_addc_u32 s25, s25, 0
    v_rcp_f32 v243, v243
    v_rcp_f32 v245, v245
    v_rcp_f32 v247, v247
    v_pk_mul_f32 v[240:241], v[240:241], v[48:49]
    v_pk_mul_f32 v[242:243], v[242:243], v[50:51]
    ds_write_b128 v9, a[160:163] offset:32768
    v_pk_mul_f32 v[244:245], v[244:245], v[80:81]
    v_pk_mul_f32 v[246:247], v[246:247], v[82:83]
    v_cvt_pk_bf16_f32 v216, v240, v241
    v_cvt_pk_bf16_f32 v217, v242, v243
    v_cvt_pk_bf16_f32 v220, v244, v245
    v_cvt_pk_bf16_f32 v221, v246, v247
    ds_write_b128 v9, a[164:167] offset:36864
    v_pk_fma_f32 v[240:241], v[188:189], v[22:23], v[204:205] op_sel:[0,1,0] op_sel_hi:[1,1,1] neg_lo:[1,0,0] neg_hi:[1,0,0]
    v_pk_fma_f32 v[242:243], v[190:191], v[22:23], v[206:207] op_sel:[0,1,0] op_sel_hi:[1,1,1] neg_lo:[1,0,0] neg_hi:[1,0,0]
    v_pk_fma_f32 v[244:245], v[188:189], v[20:21], v[204:205] op_sel:[0,1,0] op_sel_hi:[1,1,1] neg_lo:[1,0,0] neg_hi:[1,0,0]
    v_pk_fma_f32 v[246:247], v[190:191], v[20:21], v[206:207] op_sel:[0,1,0] op_sel_hi:[1,1,1] neg_lo:[1,0,0] neg_hi:[1,0,0]
    v_pk_fma_f32 v[52:53], v[52:53], v[22:23], v[240:241] op_sel_hi:[1,0,1]
    ds_write_b128 v9, a[168:171] offset:40960
    v_pk_fma_f32 v[54:55], v[54:55], v[22:23], v[242:243] op_sel_hi:[1,0,1]
    v_pk_fma_f32 v[84:85], v[84:85], v[20:21], v[244:245] op_sel_hi:[1,0,1]
    v_pk_fma_f32 v[86:87], v[86:87], v[20:21], v[246:247] op_sel_hi:[1,0,1]
    v_cvt_pk_bf16_f32 v52, 0, v52
    v_cvt_pk_bf16_f32 v54, 0, v54
    v_cvt_pk_bf16_f32 v84, 0, v84
    global_load_dwordx4 a[60:63], v0, s[24:25]
    s_add_u32 s24, s24, 32768
    s_addc_u32 s25, s25, 0
    v_cvt_pk_bf16_f32 v86, 0, v86
    v_cvt_pk_bf16_f32 v53, 0, v53
    v_cvt_pk_bf16_f32 v55, 0, v55
    v_cvt_pk_bf16_f32 v85, 0, v85
    v_cvt_pk_bf16_f32 v87, 0, v87
    ds_write_b128 v9, a[172:175] offset:45056
    v_pk_mul_f32 v[240:241], v[52:53], v[52:53]
    v_pk_mul_f32 v[242:243], v[54:55], v[54:55]
    v_pk_mul_f32 v[244:245], v[84:85], v[84:85]
    v_pk_mul_f32 v[246:247], v[86:87], v[86:87]
    v_pk_fma_f32 v[240:241], v[240:241], v[252:253], v[252:253] op_sel:[0,0,1] op_sel_hi:[1,0,1]
    v_pk_fma_f32 v[242:243], v[242:243], v[252:253], v[252:253] op_sel:[0,0,1] op_sel_hi:[1,0,1]
    ds_write_b128 v9, a[176:179] offset:49152
    v_pk_fma_f32 v[244:245], v[244:245], v[252:253], v[252:253] op_sel:[0,0,1] op_sel_hi:[1,0,1]
    v_pk_fma_f32 v[246:247], v[246:247], v[252:253], v[252:253] op_sel:[0,0,1] op_sel_hi:[1,0,1]
    v_pk_mul_f32 v[240:241], v[240:241], v[52:53]
    v_pk_mul_f32 v[242:243], v[242:243], v[54:55]
    v_pk_mul_f32 v[244:245], v[244:245], v[84:85]
    ds_write_b128 v9, a[180:183] offset:53248
    v_pk_mul_f32 v[246:247], v[246:247], v[86:87]
    v_exp_f32 v240, v240
    v_exp_f32 v242, v242
    v_exp_f32 v244, v244
    v_exp_f32 v246, v246
    v_exp_f32 v241, v241
    global_load_dwordx4 a[64:67], v0, s[24:25]
    s_add_u32 s24, s24, 32768
    s_addc_u32 s25, s25, 0
    v_exp_f32 v243, v243
    v_exp_f32 v245, v245
    v_exp_f32 v247, v247
    v_pk_add_f32 v[240:241], v[240:241], v[254:255] op_sel_hi:[1,0]
    v_pk_add_f32 v[242:243], v[242:243], v[254:255] op_sel_hi:[1,0]
    ds_write_b128 v9, a[184:187] offset:57344
    v_pk_add_f32 v[244:245], v[244:245], v[254:255] op_sel_hi:[1,0]
    v_pk_add_f32 v[246:247], v[246:247], v[254:255] op_sel_hi:[1,0]
    v_rcp_f32 v240, v240
    v_rcp_f32 v242, v242
    v_rcp_f32 v244, v244
    v_rcp_f32 v246, v246
    ds_write_b128 v9, a[188:191] offset:61440
    v_rcp_f32 v241, v241
    v_rcp_f32 v243, v243
    v_rcp_f32 v245, v245
    v_rcp_f32 v247, v247
    v_pk_mul_f32 v[240:241], v[240:241], v[52:53]
    global_load_dwordx4 a[68:71], v0, s[24:25]
    s_add_u32 s24, s24, 32768
    s_addc_u32 s25, s25, 0
    v_pk_mul_f32 v[242:243], v[242:243], v[54:55]
    v_pk_mul_f32 v[244:245], v[244:245], v[84:85]
    v_pk_mul_f32 v[246:247], v[246:247], v[86:87]
    v_cvt_pk_bf16_f32 v218, v240, v241
    v_cvt_pk_bf16_f32 v219, v242, v243
    v_cvt_pk_bf16_f32 v222, v244, v245
    ds_write_b128 v10, a[192:195] offset:0
    v_cvt_pk_bf16_f32 v223, v246, v247
    s_cmp_eq_u32 s61, 1
    s_cbranch_scc1 sf_interleave_layers__linear_kernel_hedgehog__mixer_channel_mlp__prompt_kernel_71
    global_store_dwordx4 v5, v[216:219], s[54:55] offset:2048 sc1
    global_store_dwordx4 v18, v[220:223], s[54:55] offset:2048 sc1
    s_branch se_interleave_layers__linear_kernel_hedgehog__mixer_channel_mlp__prompt_kernel_72
sf_interleave_layers__linear_kernel_hedgehog__mixer_channel_mlp__prompt_kernel_71:
    global_store_dwordx4 v5, v[216:219], s[54:55] offset:2048
    global_store_dwordx4 v18, v[220:223], s[54:55] offset:2048
se_interleave_layers__linear_kernel_hedgehog__mixer_channel_mlp__prompt_kernel_72:
    v_pk_fma_f32 v[240:241], v[192:193], v[22:23], v[208:209] op_sel:[0,1,0] op_sel_hi:[1,1,1] neg_lo:[1,0,0] neg_hi:[1,0,0]
    v_pk_fma_f32 v[242:243], v[194:195], v[22:23], v[210:211] op_sel:[0,1,0] op_sel_hi:[1,1,1] neg_lo:[1,0,0] neg_hi:[1,0,0]
    v_pk_fma_f32 v[244:245], v[192:193], v[20:21], v[208:209] op_sel:[0,1,0] op_sel_hi:[1,1,1] neg_lo:[1,0,0] neg_hi:[1,0,0]
    ds_write_b128 v10, a[196:199] offset:4096
    v_pk_fma_f32 v[246:247], v[194:195], v[20:21], v[210:211] op_sel:[0,1,0] op_sel_hi:[1,1,1] neg_lo:[1,0,0] neg_hi:[1,0,0]
    v_pk_fma_f32 v[56:57], v[56:57], v[22:23], v[240:241] op_sel_hi:[1,0,1]
    v_pk_fma_f32 v[58:59], v[58:59], v[22:23], v[242:243] op_sel_hi:[1,0,1]
    v_pk_fma_f32 v[88:89], v[88:89], v[20:21], v[244:245] op_sel_hi:[1,0,1]
    v_pk_fma_f32 v[90:91], v[90:91], v[20:21], v[246:247] op_sel_hi:[1,0,1]
    v_cvt_pk_bf16_f32 v56, 0, v56
    ds_write_b128 v10, a[200:203] offset:8192
    v_cvt_pk_bf16_f32 v58, 0, v58
    v_cvt_pk_bf16_f32 v88, 0, v88
    v_cvt_pk_bf16_f32 v90, 0, v90
    v_cvt_pk_bf16_f32 v57, 0, v57
    v_cvt_pk_bf16_f32 v59, 0, v59
    global_load_dwordx4 a[72:75], v0, s[24:25]
    s_add_u32 s24, s24, 32768
    s_addc_u32 s25, s25, 0
    v_cvt_pk_bf16_f32 v89, 0, v89
    v_cvt_pk_bf16_f32 v91, 0, v91
    v_pk_mul_f32 v[240:241], v[56:57], v[56:57]
    v_pk_mul_f32 v[242:243], v[58:59], v[58:59]
    v_pk_mul_f32 v[244:245], v[88:89], v[88:89]
    v_pk_mul_f32 v[246:247], v[90:91], v[90:91]
    ds_write_b128 v10, a[204:207] offset:12288
    v_pk_fma_f32 v[240:241], v[240:241], v[252:253], v[252:253] op_sel:[0,0,1] op_sel_hi:[1,0,1]
    v_pk_fma_f32 v[242:243], v[242:243], v[252:253], v[252:253] op_sel:[0,0,1] op_sel_hi:[1,0,1]
    v_pk_fma_f32 v[244:245], v[244:245], v[252:253], v[252:253] op_sel:[0,0,1] op_sel_hi:[1,0,1]
    v_pk_fma_f32 v[246:247], v[246:247], v[252:253], v[252:253] op_sel:[0,0,1] op_sel_hi:[1,0,1]
    v_pk_mul_f32 v[240:241], v[240:241], v[56:57]
    ds_write_b128 v10, a[208:211] offset:16384
    v_pk_mul_f32 v[242:243], v[242:243], v[58:59]
    v_pk_mul_f32 v[244:245], v[244:245], v[88:89]
    v_pk_mul_f32 v[246:247], v[246:247], v[90:91]
    v_exp_f32 v240, v240
    v_exp_f32 v242, v242
    v_exp_f32 v244, v244
    ds_write_b128 v10, a[212:215] offset:20480
    v_exp_f32 v246, v246
    v_exp_f32 v241, v241
    v_exp_f32 v243, v243
    v_exp_f32 v245, v245
    v_exp_f32 v247, v247
    global_load_dwordx4 a[76:79], v0, s[24:25]
    s_add_u32 s24, s24, 32768
    s_addc_u32 s25, s25, 0
    v_pk_add_f32 v[240:241], v[240:241], v[254:255] op_sel_hi:[1,0]
    v_pk_add_f32 v[242:243], v[242:243], v[254:255] op_sel_hi:[1,0]
    v_pk_add_f32 v[244:245], v[244:245], v[254:255] op_sel_hi:[1,0]
    v_pk_add_f32 v[246:247], v[246:247], v[254:255] op_sel_hi:[1,0]
    v_rcp_f32 v240, v240
    v_rcp_f32 v242, v242
    ds_write_b128 v10, a[216:219] offset:24576
    v_rcp_f32 v244, v244
    v_rcp_f32 v246, v246
    v_rcp_f32 v241, v241
    v_rcp_f32 v243, v243
    v_rcp_f32 v245, v245
    ds_write_b128 v10, a[220:223] offset:28672
    v_rcp_f32 v247, v247
    v_pk_mul_f32 v[240:241], v[240:241], v[56:57]
    v_pk_mul_f32 v[242:243], v[242:243], v[58:59]
    v_pk_mul_f32 v[244:245], v[244:245], v[88:89]
    v_pk_mul_f32 v[246:247], v[246:247], v[90:91]
    v_cvt_pk_bf16_f32 v224, v240, v241
    global_load_dwordx4 a[80:83], v0, s[24:25]
    s_add_u32 s24, s24, 32768
    s_addc_u32 s25, s25, 0
    v_cvt_pk_bf16_f32 v225, v242, v243
    v_cvt_pk_bf16_f32 v228, v244, v245
    v_cvt_pk_bf16_f32 v229, v246, v247
    v_pk_fma_f32 v[240:241], v[196:197], v[22:23], v[212:213] op_sel:[0,1,0] op_sel_hi:[1,1,1] neg_lo:[1,0,0] neg_hi:[1,0,0]
    v_pk_fma_f32 v[242:243], v[198:199], v[22:23], v[214:215] op_sel:[0,1,0] op_sel_hi:[1,1,1] neg_lo:[1,0,0] neg_hi:[1,0,0]
    ds_write_b128 v10, a[224:227] offset:32768
    v_pk_fma_f32 v[244:245], v[196:197], v[20:21], v[212:213] op_sel:[0,1,0] op_sel_hi:[1,1,1] neg_lo:[1,0,0] neg_hi:[1,0,0]
    v_pk_fma_f32 v[246:247], v[198:199], v[20:21], v[214:215] op_sel:[0,1,0] op_sel_hi:[1,1,1] neg_lo:[1,0,0] neg_hi:[1,0,0]
    v_pk_fma_f32 v[60:61], v[60:61], v[22:23], v[240:241] op_sel_hi:[1,0,1]
    v_pk_fma_f32 v[62:63], v[62:63], v[22:23], v[242:243] op_sel_hi:[1,0,1]
    v_pk_fma_f32 v[92:93], v[92:93], v[20:21], v[244:245] op_sel_hi:[1,0,1]
    v_pk_fma_f32 v[94:95], v[94:95], v[20:21], v[246:247] op_sel_hi:[1,0,1]
    ds_write_b128 v10, a[228:231] offset:36864
    v_cvt_pk_bf16_f32 v60, 0, v60
    v_cvt_pk_bf16_f32 v62, 0, v62
    v_cvt_pk_bf16_f32 v92, 0, v92
    v_cvt_pk_bf16_f32 v94, 0, v94
    v_cvt_pk_bf16_f32 v61, 0, v61
    ds_write_b128 v10, a[232:235] offset:40960
    v_cvt_pk_bf16_f32 v63, 0, v63
    v_cvt_pk_bf16_f32 v93, 0, v93
    v_cvt_pk_bf16_f32 v95, 0, v95
    v_pk_mul_f32 v[240:241], v[60:61], v[60:61]
    v_pk_mul_f32 v[242:243], v[62:63], v[62:63]
    v_pk_mul_f32 v[244:245], v[92:93], v[92:93]
    global_load_dwordx4 a[84:87], v0, s[24:25]
    s_add_u32 s24, s24, 32768
    s_addc_u32 s25, s25, 0
    v_pk_mul_f32 v[246:247], v[94:95], v[94:95]
    v_pk_fma_f32 v[240:241], v[240:241], v[252:253], v[252:253] op_sel:[0,0,1] op_sel_hi:[1,0,1]
    v_pk_fma_f32 v[242:243], v[242:243], v[252:253], v[252:253] op_sel:[0,0,1] op_sel_hi:[1,0,1]
    v_pk_fma_f32 v[244:245], v[244:245], v[252:253], v[252:253] op_sel:[0,0,1] op_sel_hi:[1,0,1]
    v_pk_fma_f32 v[246:247], v[246:247], v[252:253], v[252:253] op_sel:[0,0,1] op_sel_hi:[1,0,1]
    ds_write_b128 v10, a[236:239] offset:45056
    v_pk_mul_f32 v[240:241], v[240:241], v[60:61]
    v_pk_mul_f32 v[242:243], v[242:243], v[62:63]
    v_pk_mul_f32 v[244:245], v[244:245], v[92:93]
    v_pk_mul_f32 v[246:247], v[246:247], v[94:95]
    v_exp_f32 v240, v240
    v_exp_f32 v242, v242
    ds_write_b128 v10, a[240:243] offset:49152
    v_exp_f32 v244, v244
    v_exp_f32 v246, v246
    v_exp_f32 v241, v241
    v_exp_f32 v243, v243
    v_exp_f32 v245, v245
    ds_write_b128 v10, a[244:247] offset:53248
    v_exp_f32 v247, v247
    v_pk_add_f32 v[240:241], v[240:241], v[254:255] op_sel_hi:[1,0]
    v_pk_add_f32 v[242:243], v[242:243], v[254:255] op_sel_hi:[1,0]
    v_pk_add_f32 v[244:245], v[244:245], v[254:255] op_sel_hi:[1,0]
    v_pk_add_f32 v[246:247], v[246:247], v[254:255] op_sel_hi:[1,0]
    v_rcp_f32 v240, v240
    global_load_dwordx4 a[88:91], v0, s[24:25]
    s_add_u32 s24, s24, 32768
    s_addc_u32 s25, s25, 0
    v_rcp_f32 v242, v242
    v_rcp_f32 v244, v244
    v_rcp_f32 v246, v246
    v_rcp_f32 v241, v241
    v_rcp_f32 v243, v243
    ds_write_b128 v10, a[248:251] offset:57344
    v_rcp_f32 v245, v245
    v_rcp_f32 v247, v247
    v_pk_mul_f32 v[240:241], v[240:241], v[60:61]
    v_pk_mul_f32 v[242:243], v[242:243], v[62:63]
    v_pk_mul_f32 v[244:245], v[244:245], v[92:93]
    v_pk_mul_f32 v[246:247], v[246:247], v[94:95]
    ds_write_b128 v10, a[252:255] offset:61440
    v_cvt_pk_bf16_f32 v226, v240, v241
    v_cvt_pk_bf16_f32 v227, v242, v243
    v_cvt_pk_bf16_f32 v230, v244, v245
    v_cvt_pk_bf16_f32 v231, v246, v247
    s_cmp_eq_u32 s61, 1
    s_cbranch_scc1 sf_interleave_layers__linear_kernel_hedgehog__mixer_channel_mlp__prompt_kernel_73
    global_store_dwordx4 v5, v[224:227], s[54:55] offset:3072 sc1
    global_store_dwordx4 v18, v[228:231], s[54:55] offset:3072 sc1
    s_branch se_interleave_layers__linear_kernel_hedgehog__mixer_channel_mlp__prompt_kernel_74
sf_interleave_layers__linear_kernel_hedgehog__mixer_channel_mlp__prompt_kernel_73:
    global_store_dwordx4 v5, v[224:227], s[54:55] offset:3072
    global_store_dwordx4 v18, v[228:231], s[54:55] offset:3072
se_interleave_layers__linear_kernel_hedgehog__mixer_channel_mlp__prompt_kernel_74:
    global_load_dwordx4 a[92:95], v0, s[24:25]
    s_add_u32 s24, s24, 32768
    s_addc_u32 s25, s25, 0
    s_branch p3d_interleave_layers__linear_kernel_hedgehog__mixer_channel_mlp__prompt_kernel_63
p3i_interleave_layers__linear_kernel_hedgehog__mixer_channel_mlp__prompt_kernel_62:
    s_nop 15
    s_nop 3
    s_waitcnt vmcnt(0) lgkmcnt(0)
    s_barrier
    s_cmp_lg_u32 s9, 0
    s_cbranch_scc1 wz_interleave_layers__linear_kernel_hedgehog__mixer_channel_mlp__prompt_kernel_75
    s_and_b32 s11, s59, 1
    s_lshl_b32 s10, s58, 17
    s_lshl_b32 s12, s11, 16
    s_add_u32 s10, s10, s12
    s_lshl_b32 s12, s3, 14
    s_add_u32 s10, s10, s12
    s_add_u32 s10, s10, 4194304
    s_add_u32 s46, s38, s10
    s_addc_u32 s47, s39, 0
    global_load_dwordx4 v[32:35], v5, s[46:47] offset:0
    global_load_dwordx4 v[36:39], v5, s[46:47] offset:1024
    global_load_dwordx4 v[40:43], v5, s[46:47] offset:2048
    global_load_dwordx4 v[44:47], v5, s[46:47] offset:3072
    s_add_u32 s46, s46, 4096
    s_addc_u32 s47, s47, 0
    global_load_dwordx4 v[48:51], v5, s[46:47] offset:0
    global_load_dwordx4 v[52:55], v5, s[46:47] offset:1024
    global_load_dwordx4 v[56:59], v5, s[46:47] offset:2048
    global_load_dwordx4 v[60:63], v5, s[46:47] offset:3072
    s_add_u32 s46, s46, 4096
    s_addc_u32 s47, s47, 0
    global_load_dwordx4 v[32:35], v5, s[46:47] offset:0
    global_load_dwordx4 v[36:39], v5, s[46:47] offset:1024
    global_load_dwordx4 v[40:43], v5, s[46:47] offset:2048
    global_load_dwordx4 v[44:47], v5, s[46:47] offset:3072
    s_add_u32 s46, s46, 4096
    s_addc_u32 s47, s47, 0
    global_load_dwordx4 v[48:51], v5, s[46:47] offset:0
    global_load_dwordx4 v[52:55], v5, s[46:47] offset:1024
    global_load_dwordx4 v[56:59], v5, s[46:47] offset:2048
    global_load_dwordx4 v[60:63], v5, s[46:47] offset:3072
    s_add_u32 s46, s46, 4096
    s_addc_u32 s47, s47, 0
    s_lshl_b32 s10, s58, 14
    s_lshl_b32 s12, s11, 13
    s_add_u32 s10, s10, s12
    s_lshl_b32 s12, s3, 11
    s_add_u32 s10, s10, s12
    s_add_u32 s10, s10, 18350080
    s_add_u32 s46, s38, s10
    s_addc_u32 s47, s39, 0
    global_load_dwordx4 v[64:67], v5, s[46:47]
    global_load_dwordx4 v[68:71], v5, s[46:47] offset:1024
    s_waitcnt vmcnt(16)
wz_interleave_layers__linear_kernel_hedgehog__mixer_channel_mlp__prompt_kernel_75:
    v_lshrrev_b32 v15, 3, v1
    v_and_b32 v16, 7, v1
    v_lshrrev_b32 v17, 1, v16
    v_lshrrev_b32 v18, 1, v15
    v_and_b32 v18, 3, v18
    v_xor_b32 v17, v17, v18
    v_and_b32 v16, 1, v16
    v_lshlrev_b32 v16, 4, v16
    v_lshl_add_u32 v16, v17, 5, v16
    v_mul_u32_u24 v0, 1024, v15
    v_add_u32 v0, v0, v16
    s_lshl_b32 s11, s3, 13
    s_lshr_b32 s12, s59, 1
    s_lshl_b32 s12, s12, 7
    s_add_u32 s11, s11, s12
    s_add_u32 s24, s30, s11
    s_addc_u32 s25, s31, 0
    global_load_dwordx4 a[128:131], v0, s[24:25]
    s_add_u32 s24, s24, 32768
    s_addc_u32 s25, s25, 0
    global_load_dwordx4 a[132:135], v0, s[24:25]
    s_add_u32 s24, s24, 32768
    s_addc_u32 s25, s25, 0
    global_load_dwordx4 a[136:139], v0, s[24:25]
    s_add_u32 s24, s24, 32768
    s_addc_u32 s25, s25, 0
    global_load_dwordx4 a[140:143], v0, s[24:25]
    s_add_u32 s24, s24, 32768
    s_addc_u32 s25, s25, 0
    global_load_dwordx4 a[144:147], v0, s[24:25]
    s_add_u32 s24, s24, 32768
    s_addc_u32 s25, s25, 0
    global_load_dwordx4 a[148:151], v0, s[24:25]
    s_add_u32 s24, s24, 32768
    s_addc_u32 s25, s25, 0
    global_load_dwordx4 a[152:155], v0, s[24:25]
    s_add_u32 s24, s24, 32768
    s_addc_u32 s25, s25, 0
    global_load_dwordx4 a[156:159], v0, s[24:25]
    s_add_u32 s24, s24, 32768
    s_addc_u32 s25, s25, 0
    global_load_dwordx4 a[160:163], v0, s[24:25]
    s_add_u32 s24, s24, 32768
    s_addc_u32 s25, s25, 0
    global_load_dwordx4 a[164:167], v0, s[24:25]
    s_add_u32 s24, s24, 32768
    s_addc_u32 s25, s25, 0
    global_load_dwordx4 a[168:171], v0, s[24:25]
    s_add_u32 s24, s24, 32768
    s_addc_u32 s25, s25, 0
    global_load_dwordx4 a[172:175], v0, s[24:25]
    s_add_u32 s24, s24, 32768
    s_addc_u32 s25, s25, 0
    global_load_dwordx4 a[176:179], v0, s[24:25]
    s_add_u32 s24, s24, 32768
    s_addc_u32 s25, s25, 0
    global_load_dwordx4 a[180:183], v0, s[24:25]
    s_add_u32 s24, s24, 32768
    s_addc_u32 s25, s25, 0
    global_load_dwordx4 a[184:187], v0, s[24:25]
    s_add_u32 s24, s24, 32768
    s_addc_u32 s25, s25, 0
    global_load_dwordx4 a[188:191], v0, s[24:25]
    s_add_u32 s24, s24, 32768
    s_addc_u32 s25, s25, 0
    global_load_dwordx4 a[192:195], v0, s[24:25]
    s_add_u32 s24, s24, 32768
    s_addc_u32 s25, s25, 0
    global_load_dwordx4 a[196:199], v0, s[24:25]
    s_add_u32 s24, s24, 32768
    s_addc_u32 s25, s25, 0
    global_load_dwordx4 a[200:203], v0, s[24:25]
    s_add_u32 s24, s24, 32768
    s_addc_u32 s25, s25, 0
    global_load_dwordx4 a[204:207], v0, s[24:25]
    s_add_u32 s24, s24, 32768
    s_addc_u32 s25, s25, 0
    global_load_dwordx4 a[208:211], v0, s[24:25]
    s_add_u32 s24, s24, 32768
    s_addc_u32 s25, s25, 0
    global_load_dwordx4 a[212:215], v0, s[24:25]
    s_add_u32 s24, s24, 32768
    s_addc_u32 s25, s25, 0
    global_load_dwordx4 a[216:219], v0, s[24:25]
    s_add_u32 s24, s24, 32768
    s_addc_u32 s25, s25, 0
    global_load_dwordx4 a[220:223], v0, s[24:25]
    s_add_u32 s24, s24, 32768
    s_addc_u32 s25, s25, 0
    global_load_dwordx4 a[224:227], v0, s[24:25]
    s_add_u32 s24, s24, 32768
    s_addc_u32 s25, s25, 0
    global_load_dwordx4 a[228:231], v0, s[24:25]
    s_add_u32 s24, s24, 32768
    s_addc_u32 s25, s25, 0
    global_load_dwordx4 a[232:235], v0, s[24:25]
    s_add_u32 s24, s24, 32768
    s_addc_u32 s25, s25, 0
    global_load_dwordx4 a[236:239], v0, s[24:25]
    s_add_u32 s24, s24, 32768
    s_addc_u32 s25, s25, 0
    global_load_dwordx4 a[240:243], v0, s[24:25]
    s_add_u32 s24, s24, 32768
    s_addc_u32 s25, s25, 0
    global_load_dwordx4 a[244:247], v0, s[24:25]
    s_add_u32 s24, s24, 32768
    s_addc_u32 s25, s25, 0
    global_load_dwordx4 a[248:251], v0, s[24:25]
    s_add_u32 s24, s24, 32768
    s_addc_u32 s25, s25, 0
    global_load_dwordx4 a[252:255], v0, s[24:25]
    s_add_u32 s24, s24, 32768
    s_addc_u32 s25, s25, 0
    global_load_dwordx4 a[0:3], v0, s[24:25]
    s_add_u32 s24, s24, 32768
    s_addc_u32 s25, s25, 0
    global_load_dwordx4 a[4:7], v0, s[24:25]
    s_add_u32 s24, s24, 32768
    s_addc_u32 s25, s25, 0
    global_load_dwordx4 a[8:11], v0, s[24:25]
    s_add_u32 s24, s24, 32768
    s_addc_u32 s25, s25, 0
    global_load_dwordx4 a[12:15], v0, s[24:25]
    s_add_u32 s24, s24, 32768
    s_addc_u32 s25, s25, 0
    global_load_dwordx4 a[16:19], v0, s[24:25]
    s_add_u32 s24, s24, 32768
    s_addc_u32 s25, s25, 0
    global_load_dwordx4 a[20:23], v0, s[24:25]
    s_add_u32 s24, s24, 32768
    s_addc_u32 s25, s25, 0
    global_load_dwordx4 a[24:27], v0, s[24:25]
    s_add_u32 s24, s24, 32768
    s_addc_u32 s25, s25, 0
    global_load_dwordx4 a[28:31], v0, s[24:25]
    s_add_u32 s24, s24, 32768
    s_addc_u32 s25, s25, 0
    global_load_dwordx4 a[32:35], v0, s[24:25]
    s_add_u32 s24, s24, 32768
    s_addc_u32 s25, s25, 0
    global_load_dwordx4 a[36:39], v0, s[24:25]
    s_add_u32 s24, s24, 32768
    s_addc_u32 s25, s25, 0
    global_load_dwordx4 a[40:43], v0, s[24:25]
    s_add_u32 s24, s24, 32768
    s_addc_u32 s25, s25, 0
    global_load_dwordx4 a[44:47], v0, s[24:25]
    s_add_u32 s24, s24, 32768
    s_addc_u32 s25, s25, 0
    global_load_dwordx4 a[48:51], v0, s[24:25]
    s_add_u32 s24, s24, 32768
    s_addc_u32 s25, s25, 0
    global_load_dwordx4 a[52:55], v0, s[24:25]
    s_add_u32 s24, s24, 32768
    s_addc_u32 s25, s25, 0
    global_load_dwordx4 a[56:59], v0, s[24:25]
    s_add_u32 s24, s24, 32768
    s_addc_u32 s25, s25, 0
    global_load_dwordx4 a[60:63], v0, s[24:25]
    s_add_u32 s24, s24, 32768
    s_addc_u32 s25, s25, 0
    global_load_dwordx4 a[64:67], v0, s[24:25]
    s_add_u32 s24, s24, 32768
    s_addc_u32 s25, s25, 0
    global_load_dwordx4 a[68:71], v0, s[24:25]
    s_add_u32 s24, s24, 32768
    s_addc_u32 s25, s25, 0
    global_load_dwordx4 a[72:75], v0, s[24:25]
    s_add_u32 s24, s24, 32768
    s_addc_u32 s25, s25, 0
    global_load_dwordx4 a[76:79], v0, s[24:25]
    s_add_u32 s24, s24, 32768
    s_addc_u32 s25, s25, 0
    global_load_dwordx4 a[80:83], v0, s[24:25]
    s_add_u32 s24, s24, 32768
    s_addc_u32 s25, s25, 0
    global_load_dwordx4 a[84:87], v0, s[24:25]
    s_add_u32 s24, s24, 32768
    s_addc_u32 s25, s25, 0
    global_load_dwordx4 a[88:91], v0, s[24:25]
    s_add_u32 s24, s24, 32768
    s_addc_u32 s25, s25, 0
    global_load_dwordx4 a[92:95], v0, s[24:25]
    s_add_u32 s24, s24, 32768
    s_addc_u32 s25, s25, 0
    s_waitcnt vmcnt(0)
    s_lshl_b32 s48, s3, 10
    v_add_u32 v9, s48, v5
    v_add_u32 v10, 65536, v9
    ds_write_b128 v9, a[128:131] offset:0
    ds_write_b128 v9, a[132:135] offset:4096
    ds_write_b128 v9, a[136:139] offset:8192
    ds_write_b128 v9, a[140:143] offset:12288
    ds_write_b128 v9, a[144:147] offset:16384
    ds_write_b128 v9, a[148:151] offset:20480
    ds_write_b128 v9, a[152:155] offset:24576
    ds_write_b128 v9, a[156:159] offset:28672
    ds_write_b128 v9, a[160:163] offset:32768
    ds_write_b128 v9, a[164:167] offset:36864
    ds_write_b128 v9, a[168:171] offset:40960
    ds_write_b128 v9, a[172:175] offset:45056
    ds_write_b128 v9, a[176:179] offset:49152
    ds_write_b128 v9, a[180:183] offset:53248
    ds_write_b128 v9, a[184:187] offset:57344
    ds_write_b128 v9, a[188:191] offset:61440
    ds_write_b128 v10, a[192:195] offset:0
    ds_write_b128 v10, a[196:199] offset:4096
    ds_write_b128 v10, a[200:203] offset:8192
    ds_write_b128 v10, a[204:207] offset:12288
    ds_write_b128 v10, a[208:211] offset:16384
    ds_write_b128 v10, a[212:215] offset:20480
    ds_write_b128 v10, a[216:219] offset:24576
    ds_write_b128 v10, a[220:223] offset:28672
    ds_write_b128 v10, a[224:227] offset:32768
    ds_write_b128 v10, a[228:231] offset:36864
    ds_write_b128 v10, a[232:235] offset:40960
    ds_write_b128 v10, a[236:239] offset:45056
    ds_write_b128 v10, a[240:243] offset:49152
    ds_write_b128 v10, a[244:247] offset:53248
    ds_write_b128 v10, a[248:251] offset:57344
    ds_write_b128 v10, a[252:255] offset:61440
p3d_interleave_layers__linear_kernel_hedgehog__mixer_channel_mlp__prompt_kernel_63:
    s_nop 15
    s_nop 3
    s_waitcnt vmcnt(0)
    s_barrier
    s_cmp_lg_u32 s3, 0
    s_cbranch_scc1 sg_interleave_layers__linear_kernel_hedgehog__mixer_channel_mlp__prompt_kernel_76
    s_mov_b64 exec, 1
    s_lshl_b32 s10, s58, 10
    s_cmp_eq_u32 s61, 1
    s_cbranch_scc1 sgf_interleave_layers__linear_kernel_hedgehog__mixer_channel_mlp__prompt_kernel_77
    v_mov_b32 v2, s10
    v_mov_b32 v26, 1
    global_atomic_add v2, v26, s[62:63] offset:256 sc1
    s_branch sge_interleave_layers__linear_kernel_hedgehog__mixer_channel_mlp__prompt_kernel_78
sgf_interleave_layers__linear_kernel_hedgehog__mixer_channel_mlp__prompt_kernel_77:
    s_lshl_b32 s11, s59, 2
    s_add_u32 s10, s10, s11
    v_mov_b32 v2, s10
    s_add_u32 s11, s8, 1
    v_mov_b32 v26, s11
    global_store_dword v2, v26, s[62:63] offset:512
sge_interleave_layers__linear_kernel_hedgehog__mixer_channel_mlp__prompt_kernel_78:
    s_mov_b64 exec, -1
sg_interleave_layers__linear_kernel_hedgehog__mixer_channel_mlp__prompt_kernel_76:
    s_add_u32 s8, s8, 1
    s_lshl_b32 s10, s58, 3
    s_and_b32 s11, s59, 1
    s_lshl_b32 s11, s11, 2
    s_add_u32 s10, s10, s11
    s_and_b32 s11, s3, 1
    s_lshl_b32 s11, s11, 1
    s_add_u32 s10, s10, s11
    s_lshr_b32 s6, s3, 1
    s_add_u32 s45, s10, s6
    s_lshr_b32 s7, s59, 1
    s_mul_i32 s10, s10, 57344
    s_lshl_b32 s11, s6, 10
    s_add_u32 s10, s10, s11
    s_add_u32 s10, s10, 10485760
    s_add_u32 s46, s38, s10
    s_addc_u32 s47, s39, 0
    v_add_u32 v24, 57344, v5
    v_lshrrev_b32 v16, 1, v8
    v_and_b32 v16, 3, v16
    v_lshlrev_b32 v18, 7, v8
    v_lshl_add_u32 v18, v7, 3, v18
    v_xor_b32 v17, 0, v16
    v_lshl_add_u32 v9, v17, 5, v18
    v_xor_b32 v17, 1, v16
    v_lshl_add_u32 v10, v17, 5, v18
    v_xor_b32 v17, 2, v16
    v_lshl_add_u32 v11, v17, 5, v18
    v_xor_b32 v17, 3, v16
    v_lshl_add_u32 v12, v17, 5, v18
    s_lshl_b32 s10, s6, 12
    v_add_u32 v9, s10, v9
    v_add_u32 v19, 65536, v9
    v_add_u32 v10, s10, v10
    v_add_u32 v20, 65536, v10
    v_add_u32 v11, s10, v11
    v_add_u32 v21, 65536, v11
    v_add_u32 v12, s10, v12
    v_add_u32 v22, 65536, v12
    s_lshl_b32 s48, s3, 10
    v_add_u32 v13, s48, v5
    v_add_u32 v14, 65536, v13
    v_mov_b32 v23, 0x3f803f80
    s_cmp_lg_u32 s3, 0
    s_cbranch_scc1 wt_interleave_layers__linear_kernel_hedgehog__mixer_channel_mlp__prompt_kernel_79
    s_mov_b64 exec, 0xffff
    s_lshl_b32 s10, s58, 10
    s_cmp_eq_u32 s61, 1
    s_cselect_b32 s11, 2, 1
    s_cselect_b32 s12, 4, 0
    s_cselect_b32 s13, 1, 16
    s_mul_i32 s13, s13, s8
    s_lshl_b32 s11, s11, 8
    s_add_u32 s10, s10, s11
    v_mul_u32_u24 v2, s12, v1
    v_add_u32 v2, s10, v2
    v_mov_b32 v27, s13
    s_mov_b32 s15, 0
pp_interleave_layers__linear_kernel_hedgehog__mixer_channel_mlp__prompt_kernel_80:
    global_load_dword v26, v2, s[62:63] sc1
    s_waitcnt vmcnt(0)
    v_cmp_gt_u32 vcc, v27, v26
    s_nop 4
    s_cbranch_vccz pq_interleave_layers__linear_kernel_hedgehog__mixer_channel_mlp__prompt_kernel_81
    s_sleep 1
    s_add_u32 s15, s15, 1
    s_cmp_lt_u32 s15, 400000
    s_cbranch_scc1 pp_interleave_layers__linear_kernel_hedgehog__mixer_channel_mlp__prompt_kernel_80
pq_interleave_layers__linear_kernel_hedgehog__mixer_channel_mlp__prompt_kernel_81:
    s_mov_b64 exec, -1
wt_interleave_layers__linear_kernel_hedgehog__mixer_channel_mlp__prompt_kernel_79:
    s_waitcnt vmcnt(0) lgkmcnt(0)
    s_barrier
    global_load_dwordx4 v[128:131], v5, s[46:47] offset:0 sc1
    global_load_dwordx4 v[132:135], v24, s[46:47] offset:0 sc1
    global_load_dwordx4 v[136:139], v5, s[46:47] offset:2048 sc1
    global_load_dwordx4 v[140:143], v24, s[46:47] offset:2048 sc1
    s_add_u32 s46, s46, 4096
    s_addc_u32 s47, s47, 0
    global_load_dwordx4 v[144:147], v5, s[46:47] offset:0 sc1
    global_load_dwordx4 v[148:151], v24, s[46:47] offset:0 sc1
    global_load_dwordx4 v[152:155], v5, s[46:47] offset:2048 sc1
    global_load_dwordx4 v[156:159], v24, s[46:47] offset:2048 sc1
    s_add_u32 s46, s46, 4096
    s_addc_u32 s47, s47, 0
    global_load_dwordx4 v[160:163], v5, s[46:47] offset:0 sc1
    global_load_dwordx4 v[164:167], v24, s[46:47] offset:0 sc1
    global_load_dwordx4 v[168:171], v5, s[46:47] offset:2048 sc1
    global_load_dwordx4 v[172:175], v24, s[46:47] offset:2048 sc1
    s_add_u32 s46, s46, 4096
    s_addc_u32 s47, s47, 0
    global_load_dwordx4 v[176:179], v5, s[46:47] offset:0 sc1
    global_load_dwordx4 v[180:183], v24, s[46:47] offset:0 sc1
    global_load_dwordx4 v[184:187], v5, s[46:47] offset:2048 sc1
    global_load_dwordx4 v[188:191], v24, s[46:47] offset:2048 sc1
    s_add_u32 s46, s46, 4096
    s_addc_u32 s47, s47, 0
    global_load_dwordx4 v[192:195], v5, s[46:47] offset:0 sc1
    global_load_dwordx4 v[196:199], v24, s[46:47] offset:0 sc1
    global_load_dwordx4 v[200:203], v5, s[46:47] offset:2048 sc1
    global_load_dwordx4 v[204:207], v24, s[46:47] offset:2048 sc1
    s_add_u32 s46, s46, 4096
    s_addc_u32 s47, s47, 0
    global_load_dwordx4 v[208:211], v5, s[46:47] offset:0 sc1
    global_load_dwordx4 v[212:215], v24, s[46:47] offset:0 sc1
    s_waitcnt vmcnt(63) lgkmcnt(0)
    ds_read_b64_tr_b16 v[96:97], v9 offset:0
    ds_read_b64_tr_b16 v[98:99], v9 offset:2048
    ds_read_b64_tr_b16 v[100:101], v10 offset:0
    ds_read_b64_tr_b16 v[102:103], v10 offset:2048
    ds_read_b64_tr_b16 v[104:105], v11 offset:0
    ds_read_b64_tr_b16 v[106:107], v11 offset:2048
    ds_read_b64_tr_b16 v[108:109], v12 offset:0
    ds_read_b64_tr_b16 v[110:111], v12 offset:2048
    global_load_dwordx4 v[216:219], v5, s[46:47] offset:2048 sc1
    global_load_dwordx4 v[220:223], v24, s[46:47] offset:2048 sc1
    s_add_u32 s46, s46, 4096
    s_addc_u32 s47, s47, 0
    s_waitcnt vmcnt(22) lgkmcnt(0)
    v_mfma_f32_16x16x32_bf16 v[64:67], v[96:99], v[128:131], 0
    ds_read_b64_tr_b16 v[112:113], v9 offset:8192
    ds_read_b64_tr_b16 v[114:115], v9 offset:10240
    v_mfma_f32_16x16x32_bf16 v[80:83], v[96:99], v[132:135], 0
    ds_read_b64_tr_b16 v[116:117], v10 offset:8192
    ds_read_b64_tr_b16 v[118:119], v10 offset:10240
    v_mfma_f32_16x16x32_bf16 v[68:71], v[100:103], v[128:131], 0
    ds_read_b64_tr_b16 v[120:121], v11 offset:8192
    ds_read_b64_tr_b16 v[122:123], v11 offset:10240
    v_mfma_f32_16x16x32_bf16 v[84:87], v[100:103], v[132:135], 0
    ds_read_b64_tr_b16 v[124:125], v12 offset:8192
    ds_read_b64_tr_b16 v[126:127], v12 offset:10240
    v_mfma_f32_16x16x32_bf16 v[72:75], v[104:107], v[128:131], 0
    global_load_dwordx4 v[224:227], v5, s[46:47] offset:0 sc1
    global_load_dwordx4 v[228:231], v24, s[46:47] offset:0 sc1
    v_mfma_f32_16x16x32_bf16 v[88:91], v[104:107], v[132:135], 0
    v_mfma_f32_16x16x32_bf16 v[76:79], v[108:111], v[128:131], 0
    v_mfma_f32_16x16x32_bf16 v[92:95], v[108:111], v[132:135], 0
    s_waitcnt vmcnt(22) lgkmcnt(0)
    v_mfma_f32_16x16x32_bf16 v[64:67], v[112:115], v[136:139], v[64:67]
    ds_read_b64_tr_b16 v[96:97], v9 offset:16384
    ds_read_b64_tr_b16 v[98:99], v9 offset:18432
    v_mfma_f32_16x16x32_bf16 v[80:83], v[112:115], v[140:143], v[80:83]
    ds_read_b64_tr_b16 v[100:101], v10 offset:16384
    ds_read_b64_tr_b16 v[102:103], v10 offset:18432
    v_mfma_f32_16x16x32_bf16 v[68:71], v[116:119], v[136:139], v[68:71]
    ds_read_b64_tr_b16 v[104:105], v11 offset:16384
    ds_read_b64_tr_b16 v[106:107], v11 offset:18432
    v_mfma_f32_16x16x32_bf16 v[84:87], v[116:119], v[140:143], v[84:87]
    ds_read_b64_tr_b16 v[108:109], v12 offset:16384
    ds_read_b64_tr_b16 v[110:111], v12 offset:18432
    v_mfma_f32_16x16x32_bf16 v[72:75], v[120:123], v[136:139], v[72:75]
    global_load_dwordx4 v[128:131], v5, s[46:47] offset:2048 sc1
    global_load_dwordx4 v[132:135], v24, s[46:47] offset:2048 sc1
    v_mfma_f32_16x16x32_bf16 v[88:91], v[120:123], v[140:143], v[88:91]
    s_add_u32 s46, s46, 4096
    s_addc_u32 s47, s47, 0
    v_mfma_f32_16x16x32_bf16 v[76:79], v[124:127], v[136:139], v[76:79]
    v_mfma_f32_16x16x32_bf16 v[92:95], v[124:127], v[140:143], v[92:95]
    s_waitcnt vmcnt(22) lgkmcnt(0)
    v_mfma_f32_16x16x32_bf16 v[64:67], v[96:99], v[144:147], v[64:67]
    ds_read_b64_tr_b16 v[112:113], v9 offset:24576
    ds_read_b64_tr_b16 v[114:115], v9 offset:26624
    v_mfma_f32_16x16x32_bf16 v[80:83], v[96:99], v[148:151], v[80:83]
    ds_read_b64_tr_b16 v[116:117], v10 offset:24576
    ds_read_b64_tr_b16 v[118:119], v10 offset:26624
    v_mfma_f32_16x16x32_bf16 v[68:71], v[100:103], v[144:147], v[68:71]
    ds_read_b64_tr_b16 v[120:121], v11 offset:24576
    ds_read_b64_tr_b16 v[122:123], v11 offset:26624
    v_mfma_f32_16x16x32_bf16 v[84:87], v[100:103], v[148:151], v[84:87]
    ds_read_b64_tr_b16 v[124:125], v12 offset:24576
    ds_read_b64_tr_b16 v[126:127], v12 offset:26624
    v_mfma_f32_16x16x32_bf16 v[72:75], v[104:107], v[144:147], v[72:75]
    global_load_dwordx4 v[136:139], v5, s[46:47] offset:0 sc1
    global_load_dwordx4 v[140:143], v24, s[46:47] offset:0 sc1
    v_mfma_f32_16x16x32_bf16 v[88:91], v[104:107], v[148:151], v[88:91]
    v_mfma_f32_16x16x32_bf16 v[76:79], v[108:111], v[144:147], v[76:79]
    v_mfma_f32_16x16x32_bf16 v[92:95], v[108:111], v[148:151], v[92:95]
    s_waitcnt vmcnt(22) lgkmcnt(0)
    v_mfma_f32_16x16x32_bf16 v[64:67], v[112:115], v[152:155], v[64:67]
    ds_read_b64_tr_b16 v[96:97], v9 offset:32768
    ds_read_b64_tr_b16 v[98:99], v9 offset:34816
    v_mfma_f32_16x16x32_bf16 v[80:83], v[112:115], v[156:159], v[80:83]
    ds_read_b64_tr_b16 v[100:101], v10 offset:32768
    ds_read_b64_tr_b16 v[102:103], v10 offset:34816
    v_mfma_f32_16x16x32_bf16 v[68:71], v[116:119], v[152:155], v[68:71]
    ds_read_b64_tr_b16 v[104:105], v11 offset:32768
    ds_read_b64_tr_b16 v[106:107], v11 offset:34816
    v_mfma_f32_16x16x32_bf16 v[84:87], v[116:119], v[156:159], v[84:87]
    ds_read_b64_tr_b16 v[108:109], v12 offset:32768
    ds_read_b64_tr_b16 v[110:111], v12 offset:34816
    v_mfma_f32_16x16x32_bf16 v[72:75], v[120:123], v[152:155], v[72:75]
    global_load_dwordx4 v[144:147], v5, s[46:47] offset:2048 sc1
    global_load_dwordx4 v[148:151], v24, s[46:47] offset:2048 sc1
    v_mfma_f32_16x16x32_bf16 v[88:91], v[120:123], v[156:159], v[88:91]
    s_add_u32 s46, s46, 4096
    s_addc_u32 s47, s47, 0
    v_mfma_f32_16x16x32_bf16 v[76:79], v[124:127], v[152:155], v[76:79]
    v_mfma_f32_16x16x32_bf16 v[92:95], v[124:127], v[156:159], v[92:95]
    s_waitcnt vmcnt(22) lgkmcnt(0)
    s_barrier
    v_mfma_f32_16x16x32_bf16 v[64:67], v[96:99], v[160:163], v[64:67]
    ds_read_b64_tr_b16 v[112:113], v9 offset:40960
    ds_read_b64_tr_b16 v[114:115], v9 offset:43008
    v_mfma_f32_16x16x32_bf16 v[80:83], v[96:99], v[164:167], v[80:83]
    ds_read_b64_tr_b16 v[116:117], v10 offset:40960
    ds_read_b64_tr_b16 v[118:119], v10 offset:43008
    v_mfma_f32_16x16x32_bf16 v[68:71], v[100:103], v[160:163], v[68:71]
    ds_read_b64_tr_b16 v[120:121], v11 offset:40960
    ds_read_b64_tr_b16 v[122:123], v11 offset:43008
    v_mfma_f32_16x16x32_bf16 v[84:87], v[100:103], v[164:167], v[84:87]
    ds_read_b64_tr_b16 v[124:125], v12 offset:40960
    ds_read_b64_tr_b16 v[126:127], v12 offset:43008
    v_mfma_f32_16x16x32_bf16 v[72:75], v[104:107], v[160:163], v[72:75]
    ds_write_b128 v13, a[0:3] offset:0
    ds_write_b128 v13, a[4:7] offset:4096
    v_mfma_f32_16x16x32_bf16 v[88:91], v[104:107], v[164:167], v[88:91]
    ds_write_b128 v13, a[8:11] offset:8192
    ds_write_b128 v13, a[12:15] offset:12288
    v_mfma_f32_16x16x32_bf16 v[76:79], v[108:111], v[160:163], v[76:79]
    ds_write_b128 v13, a[16:19] offset:16384
    ds_write_b128 v13, a[20:23] offset:20480
    v_mfma_f32_16x16x32_bf16 v[92:95], v[108:111], v[164:167], v[92:95]
    ds_write_b128 v13, a[24:27] offset:24576
    ds_write_b128 v13, a[28:31] offset:28672
    global_load_dwordx4 v[152:155], v5, s[46:47] offset:0 sc1
    global_load_dwordx4 v[156:159], v24, s[46:47] offset:0 sc1
    s_waitcnt vmcnt(22) lgkmcnt(0)
    v_mfma_f32_16x16x32_bf16 v[64:67], v[112:115], v[168:171], v[64:67]
    ds_read_b64_tr_b16 v[96:97], v9 offset:49152
    ds_read_b64_tr_b16 v[98:99], v9 offset:51200
    v_mfma_f32_16x16x32_bf16 v[80:83], v[112:115], v[172:175], v[80:83]
    ds_read_b64_tr_b16 v[100:101], v10 offset:49152
    ds_read_b64_tr_b16 v[102:103], v10 offset:51200
    v_mfma_f32_16x16x32_bf16 v[68:71], v[116:119], v[168:171], v[68:71]
    ds_read_b64_tr_b16 v[104:105], v11 offset:49152
    ds_read_b64_tr_b16 v[106:107], v11 offset:51200
    v_mfma_f32_16x16x32_bf16 v[84:87], v[116:119], v[172:175], v[84:87]
    ds_read_b64_tr_b16 v[108:109], v12 offset:49152
    ds_read_b64_tr_b16 v[110:111], v12 offset:51200
    v_mfma_f32_16x16x32_bf16 v[72:75], v[120:123], v[168:171], v[72:75]
    global_load_dwordx4 v[160:163], v5, s[46:47] offset:2048 sc1
    global_load_dwordx4 v[164:167], v24, s[46:47] offset:2048 sc1
    v_mfma_f32_16x16x32_bf16 v[88:91], v[120:123], v[172:175], v[88:91]
    s_add_u32 s46, s46, 4096
    s_addc_u32 s47, s47, 0
    v_mfma_f32_16x16x32_bf16 v[76:79], v[124:127], v[168:171], v[76:79]
    v_mfma_f32_16x16x32_bf16 v[92:95], v[124:127], v[172:175], v[92:95]
    s_waitcnt vmcnt(22) lgkmcnt(0)
    v_mfma_f32_16x16x32_bf16 v[64:67], v[96:99], v[176:179], v[64:67]
    ds_read_b64_tr_b16 v[112:113], v9 offset:57344
    ds_read_b64_tr_b16 v[114:115], v9 offset:59392
    v_mfma_f32_16x16x32_bf16 v[80:83], v[96:99], v[180:183], v[80:83]
    ds_read_b64_tr_b16 v[116:117], v10 offset:57344
    ds_read_b64_tr_b16 v[118:119], v10 offset:59392
    v_mfma_f32_16x16x32_bf16 v[68:71], v[100:103], v[176:179], v[68:71]
    ds_read_b64_tr_b16 v[120:121], v11 offset:57344
    ds_read_b64_tr_b16 v[122:123], v11 offset:59392
    v_mfma_f32_16x16x32_bf16 v[84:87], v[100:103], v[180:183], v[84:87]
    ds_read_b64_tr_b16 v[124:125], v12 offset:57344
    ds_read_b64_tr_b16 v[126:127], v12 offset:59392
    v_mfma_f32_16x16x32_bf16 v[72:75], v[104:107], v[176:179], v[72:75]
    global_load_dwordx4 v[168:171], v5, s[46:47] offset:0 sc1
    global_load_dwordx4 v[172:175], v24, s[46:47] offset:0 sc1
    v_mfma_f32_16x16x32_bf16 v[88:91], v[104:107], v[180:183], v[88:91]
    v_mfma_f32_16x16x32_bf16 v[76:79], v[108:111], v[176:179], v[76:79]
    v_mfma_f32_16x16x32_bf16 v[92:95], v[108:111], v[180:183], v[92:95]
    s_waitcnt vmcnt(22) lgkmcnt(0)
    v_mfma_f32_16x16x32_bf16 v[64:67], v[112:115], v[184:187], v[64:67]
    ds_read_b64_tr_b16 v[96:97], v19 offset:0
    ds_read_b64_tr_b16 v[98:99], v19 offset:2048
    v_mfma_f32_16x16x32_bf16 v[80:83], v[112:115], v[188:191], v[80:83]
    ds_read_b64_tr_b16 v[100:101], v20 offset:0
    ds_read_b64_tr_b16 v[102:103], v20 offset:2048
    v_mfma_f32_16x16x32_bf16 v[68:71], v[116:119], v[184:187], v[68:71]
    ds_read_b64_tr_b16 v[104:105], v21 offset:0
    ds_read_b64_tr_b16 v[106:107], v21 offset:2048
    v_mfma_f32_16x16x32_bf16 v[84:87], v[116:119], v[188:191], v[84:87]
    ds_read_b64_tr_b16 v[108:109], v22 offset:0
    ds_read_b64_tr_b16 v[110:111], v22 offset:2048
    v_mfma_f32_16x16x32_bf16 v[72:75], v[120:123], v[184:187], v[72:75]
    global_load_dwordx4 v[176:179], v5, s[46:47] offset:2048 sc1
    global_load_dwordx4 v[180:183], v24, s[46:47] offset:2048 sc1
    v_mfma_f32_16x16x32_bf16 v[88:91], v[120:123], v[188:191], v[88:91]
    s_add_u32 s46, s46, 4096
    s_addc_u32 s47, s47, 0
    v_mfma_f32_16x16x32_bf16 v[76:79], v[124:127], v[184:187], v[76:79]
    v_mfma_f32_16x16x32_bf16 v[92:95], v[124:127], v[188:191], v[92:95]
    s_waitcnt vmcnt(22) lgkmcnt(0)
    s_barrier
    v_mfma_f32_16x16x32_bf16 v[64:67], v[96:99], v[192:195], v[64:67]
    ds_read_b64_tr_b16 v[112:113], v19 offset:8192
    ds_read_b64_tr_b16 v[114:115], v19 offset:10240
    v_mfma_f32_16x16x32_bf16 v[80:83], v[96:99], v[196:199], v[80:83]
    ds_read_b64_tr_b16 v[116:117], v20 offset:8192
    ds_read_b64_tr_b16 v[118:119], v20 offset:10240
    v_mfma_f32_16x16x32_bf16 v[68:71], v[100:103], v[192:195], v[68:71]
    ds_read_b64_tr_b16 v[120:121], v21 offset:8192
    ds_read_b64_tr_b16 v[122:123], v21 offset:10240
    v_mfma_f32_16x16x32_bf16 v[84:87], v[100:103], v[196:199], v[84:87]
    ds_read_b64_tr_b16 v[124:125], v22 offset:8192
    ds_read_b64_tr_b16 v[126:127], v22 offset:10240
    v_mfma_f32_16x16x32_bf16 v[72:75], v[104:107], v[192:195], v[72:75]
    ds_write_b128 v13, a[32:35] offset:32768
    ds_write_b128 v13, a[36:39] offset:36864
    v_mfma_f32_16x16x32_bf16 v[88:91], v[104:107], v[196:199], v[88:91]
    ds_write_b128 v13, a[40:43] offset:40960
    ds_write_b128 v13, a[44:47] offset:45056
    v_mfma_f32_16x16x32_bf16 v[76:79], v[108:111], v[192:195], v[76:79]
    ds_write_b128 v13, a[48:51] offset:49152
    ds_write_b128 v13, a[52:55] offset:53248
    v_mfma_f32_16x16x32_bf16 v[92:95], v[108:111], v[196:199], v[92:95]
    ds_write_b128 v13, a[56:59] offset:57344
    ds_write_b128 v13, a[60:63] offset:61440
    global_load_dwordx4 v[184:187], v5, s[46:47] offset:0 sc1
    global_load_dwordx4 v[188:191], v24, s[46:47] offset:0 sc1
    s_waitcnt vmcnt(22) lgkmcnt(0)
    v_mfma_f32_16x16x32_bf16 v[64:67], v[112:115], v[200:203], v[64:67]
    ds_read_b64_tr_b16 v[96:97], v19 offset:16384
    ds_read_b64_tr_b16 v[98:99], v19 offset:18432
    v_mfma_f32_16x16x32_bf16 v[80:83], v[112:115], v[204:207], v[80:83]
    ds_read_b64_tr_b16 v[100:101], v20 offset:16384
    ds_read_b64_tr_b16 v[102:103], v20 offset:18432
    v_mfma_f32_16x16x32_bf16 v[68:71], v[116:119], v[200:203], v[68:71]
    ds_read_b64_tr_b16 v[104:105], v21 offset:16384
    ds_read_b64_tr_b16 v[106:107], v21 offset:18432
    v_mfma_f32_16x16x32_bf16 v[84:87], v[116:119], v[204:207], v[84:87]
    ds_read_b64_tr_b16 v[108:109], v22 offset:16384
    ds_read_b64_tr_b16 v[110:111], v22 offset:18432
    v_mfma_f32_16x16x32_bf16 v[72:75], v[120:123], v[200:203], v[72:75]
    global_load_dwordx4 v[192:195], v5, s[46:47] offset:2048 sc1
    global_load_dwordx4 v[196:199], v24, s[46:47] offset:2048 sc1
    v_mfma_f32_16x16x32_bf16 v[88:91], v[120:123], v[204:207], v[88:91]
    s_add_u32 s46, s46, 4096
    s_addc_u32 s47, s47, 0
    v_mfma_f32_16x16x32_bf16 v[76:79], v[124:127], v[200:203], v[76:79]
    v_mfma_f32_16x16x32_bf16 v[92:95], v[124:127], v[204:207], v[92:95]
    s_waitcnt vmcnt(22) lgkmcnt(0)
    v_mfma_f32_16x16x32_bf16 v[64:67], v[96:99], v[208:211], v[64:67]
    ds_read_b64_tr_b16 v[112:113], v19 offset:24576
    ds_read_b64_tr_b16 v[114:115], v19 offset:26624
    v_mfma_f32_16x16x32_bf16 v[80:83], v[96:99], v[212:215], v[80:83]
    ds_read_b64_tr_b16 v[116:117], v20 offset:24576
    ds_read_b64_tr_b16 v[118:119], v20 offset:26624
    v_mfma_f32_16x16x32_bf16 v[68:71], v[100:103], v[208:211], v[68:71]
    ds_read_b64_tr_b16 v[120:121], v21 offset:24576
    ds_read_b64_tr_b16 v[122:123], v21 offset:26624
    v_mfma_f32_16x16x32_bf16 v[84:87], v[100:103], v[212:215], v[84:87]
    ds_read_b64_tr_b16 v[124:125], v22 offset:24576
    ds_read_b64_tr_b16 v[126:127], v22 offset:26624
    v_mfma_f32_16x16x32_bf16 v[72:75], v[104:107], v[208:211], v[72:75]
    global_load_dwordx4 v[200:203], v5, s[46:47] offset:0 sc1
    global_load_dwordx4 v[204:207], v24, s[46:47] offset:0 sc1
    v_mfma_f32_16x16x32_bf16 v[88:91], v[104:107], v[212:215], v[88:91]
    v_mfma_f32_16x16x32_bf16 v[76:79], v[108:111], v[208:211], v[76:79]
    v_mfma_f32_16x16x32_bf16 v[92:95], v[108:111], v[212:215], v[92:95]
    s_waitcnt vmcnt(22) lgkmcnt(0)
    v_lshrrev_b32 v15, 3, v1
    v_and_b32 v16, 7, v1
    v_lshrrev_b32 v17, 1, v16
    v_lshrrev_b32 v18, 1, v15
    v_and_b32 v18, 3, v18
    v_xor_b32 v17, v17, v18
    v_and_b32 v16, 1, v16
    v_lshlrev_b32 v16, 4, v16
    v_lshl_add_u32 v16, v17, 5, v16
    v_mul_u32_u24 v0, 3072, v15
    v_add_u32 v0, v0, v16
    s_lshl_b32 s10, s59, 7
    s_add_u32 s4, s10, 1024
    s_add_u32 s5, s10, 2048
    s_sub_u32 s11, s10, 1024
    s_cmp_ge_u32 s59, 8
    s_cselect_b32 s4, s11, s4
    s_cselect_b32 s5, s11, s5
    s_mul_i32 s11, s3, 24576
    s_add_u32 s12, s11, s4
    s_add_u32 s24, s18, s12
    s_addc_u32 s25, s19, 0
    s_add_u32 s12, s11, s5
    s_add_u32 s100, s18, s12
    s_addc_u32 s101, s19, 0
    s_cmp_eq_u32 s9, 0
    s_cselect_b64 s[14:15], -1, 1
    v_mfma_f32_16x16x32_bf16 v[64:67], v[112:115], v[216:219], v[64:67]
    ds_read_b64_tr_b16 v[96:97], v19 offset:32768
    ds_read_b64_tr_b16 v[98:99], v19 offset:34816
    v_mfma_f32_16x16x32_bf16 v[80:83], v[112:115], v[220:223], v[80:83]
    ds_read_b64_tr_b16 v[100:101], v20 offset:32768
    ds_read_b64_tr_b16 v[102:103], v20 offset:34816
    v_mfma_f32_16x16x32_bf16 v[68:71], v[116:119], v[216:219], v[68:71]
    ds_read_b64_tr_b16 v[104:105], v21 offset:32768
    ds_read_b64_tr_b16 v[106:107], v21 offset:34816
    v_mfma_f32_16x16x32_bf16 v[84:87], v[116:119], v[220:223], v[84:87]
    ds_read_b64_tr_b16 v[108:109], v22 offset:32768
    ds_read_b64_tr_b16 v[110:111], v22 offset:34816
    v_mfma_f32_16x16x32_bf16 v[72:75], v[120:123], v[216:219], v[72:75]
    global_load_dwordx4 v[208:211], v5, s[46:47] offset:2048 sc1
    global_load_dwordx4 v[212:215], v24, s[46:47] offset:2048 sc1
    v_mfma_f32_16x16x32_bf16 v[88:91], v[120:123], v[220:223], v[88:91]
    s_add_u32 s46, s46, 4096
    s_addc_u32 s47, s47, 0
    v_mfma_f32_16x16x32_bf16 v[76:79], v[124:127], v[216:219], v[76:79]
    s_mov_b64 exec, s[14:15]
    global_load_dwordx4 a[128:131], v0, s[24:25]
    s_mov_b64 exec, -1
    s_add_u32 s24, s24, 98304
    s_addc_u32 s25, s25, 0
    s_mov_b64 exec, s[14:15]
    global_load_dwordx4 a[132:135], v0, s[24:25]
    s_mov_b64 exec, -1
    s_add_u32 s24, s24, 98304
    s_addc_u32 s25, s25, 0
    v_mfma_f32_16x16x32_bf16 v[92:95], v[124:127], v[220:223], v[92:95]
    s_waitcnt vmcnt(24) lgkmcnt(0)
    s_barrier
    v_mfma_f32_16x16x32_bf16 v[64:67], v[96:99], v[224:227], v[64:67]
    ds_read_b64_tr_b16 v[112:113], v19 offset:40960
    ds_read_b64_tr_b16 v[114:115], v19 offset:43008
    v_mfma_f32_16x16x32_bf16 v[80:83], v[96:99], v[228:231], v[80:83]
    ds_read_b64_tr_b16 v[116:117], v20 offset:40960
    ds_read_b64_tr_b16 v[118:119], v20 offset:43008
    v_mfma_f32_16x16x32_bf16 v[68:71], v[100:103], v[224:227], v[68:71]
    ds_read_b64_tr_b16 v[120:121], v21 offset:40960
    ds_read_b64_tr_b16 v[122:123], v21 offset:43008
    v_mfma_f32_16x16x32_bf16 v[84:87], v[100:103], v[228:231], v[84:87]
    ds_read_b64_tr_b16 v[124:125], v22 offset:40960
    ds_read_b64_tr_b16 v[126:127], v22 offset:43008
    v_mfma_f32_16x16x32_bf16 v[72:75], v[104:107], v[224:227], v[72:75]
    ds_write_b128 v14, a[64:67] offset:0
    ds_write_b128 v14, a[68:71] offset:4096
    v_mfma_f32_16x16x32_bf16 v[88:91], v[104:107], v[228:231], v[88:91]
    ds_write_b128 v14, a[72:75] offset:8192
    ds_write_b128 v14, a[76:79] offset:12288
    v_mfma_f32_16x16x32_bf16 v[76:79], v[108:111], v[224:227], v[76:79]
    ds_write_b128 v14, a[80:83] offset:16384
    ds_write_b128 v14, a[84:87] offset:20480
    v_mfma_f32_16x16x32_bf16 v[92:95], v[108:111], v[228:231], v[92:95]
    ds_write_b128 v14, a[88:91] offset:24576
    ds_write_b128 v14, a[92:95] offset:28672
    global_load_dwordx4 v[216:219], v5, s[46:47] offset:0 sc1
    global_load_dwordx4 v[220:223], v24, s[46:47] offset:0 sc1
    s_mov_b64 exec, s[14:15]
    global_load_dwordx4 a[136:139], v0, s[24:25]
    s_mov_b64 exec, -1
    s_add_u32 s24, s24, 98304
    s_addc_u32 s25, s25, 0
    s_mov_b64 exec, s[14:15]
    global_load_dwordx4 a[140:143], v0, s[24:25]
    s_mov_b64 exec, -1
    s_add_u32 s24, s24, 98304
    s_addc_u32 s25, s25, 0
    s_waitcnt vmcnt(26) lgkmcnt(0)
    v_mfma_f32_16x16x32_bf16 v[64:67], v[112:115], v[128:131], v[64:67]
    ds_read_b64_tr_b16 v[96:97], v19 offset:49152
    ds_read_b64_tr_b16 v[98:99], v19 offset:51200
    v_mfma_f32_16x16x32_bf16 v[80:83], v[112:115], v[132:135], v[80:83]
    ds_read_b64_tr_b16 v[100:101], v20 offset:49152
    ds_read_b64_tr_b16 v[102:103], v20 offset:51200
    v_mfma_f32_16x16x32_bf16 v[68:71], v[116:119], v[128:131], v[68:71]
    ds_read_b64_tr_b16 v[104:105], v21 offset:49152
    ds_read_b64_tr_b16 v[106:107], v21 offset:51200
    v_mfma_f32_16x16x32_bf16 v[84:87], v[116:119], v[132:135], v[84:87]
    ds_read_b64_tr_b16 v[108:109], v22 offset:49152
    ds_read_b64_tr_b16 v[110:111], v22 offset:51200
    v_mfma_f32_16x16x32_bf16 v[72:75], v[120:123], v[128:131], v[72:75]
    global_load_dwordx4 v[224:227], v5, s[46:47] offset:2048 sc1
    global_load_dwordx4 v[228:231], v24, s[46:47] offset:2048 sc1
    v_mfma_f32_16x16x32_bf16 v[88:91], v[120:123], v[132:135], v[88:91]
    s_add_u32 s46, s46, 4096
    s_addc_u32 s47, s47, 0
    v_mfma_f32_16x16x32_bf16 v[76:79], v[124:127], v[128:131], v[76:79]
    s_mov_b64 exec, s[14:15]
    global_load_dwordx4 a[144:147], v0, s[24:25]
    s_mov_b64 exec, -1
    s_add_u32 s24, s24, 98304
    s_addc_u32 s25, s25, 0
    s_mov_b64 exec, s[14:15]
    global_load_dwordx4 a[148:151], v0, s[24:25]
    s_mov_b64 exec, -1
    s_add_u32 s24, s24, 98304
    s_addc_u32 s25, s25, 0
    v_mfma_f32_16x16x32_bf16 v[92:95], v[124:127], v[132:135], v[92:95]
    s_waitcnt vmcnt(28) lgkmcnt(0)
    s_barrier
    v_mfma_f32_16x16x32_bf16 v[64:67], v[96:99], v[136:139], v[64:67]
    ds_read_b64_tr_b16 v[112:113], v19 offset:57344
    ds_read_b64_tr_b16 v[114:115], v19 offset:59392
    v_mfma_f32_16x16x32_bf16 v[80:83], v[96:99], v[140:143], v[80:83]
    ds_read_b64_tr_b16 v[116:117], v20 offset:57344
    ds_read_b64_tr_b16 v[118:119], v20 offset:59392
    v_mfma_f32_16x16x32_bf16 v[68:71], v[100:103], v[136:139], v[68:71]
    ds_read_b64_tr_b16 v[120:121], v21 offset:57344
    ds_read_b64_tr_b16 v[122:123], v21 offset:59392
    v_mfma_f32_16x16x32_bf16 v[84:87], v[100:103], v[140:143], v[84:87]
    ds_read_b64_tr_b16 v[124:125], v22 offset:57344
    ds_read_b64_tr_b16 v[126:127], v22 offset:59392
    v_mfma_f32_16x16x32_bf16 v[72:75], v[104:107], v[136:139], v[72:75]
    global_load_dwordx4 v[128:131], v5, s[46:47] offset:0 sc1
    global_load_dwordx4 v[132:135], v24, s[46:47] offset:0 sc1
    v_mfma_f32_16x16x32_bf16 v[88:91], v[104:107], v[140:143], v[88:91]
    s_mov_b64 exec, s[14:15]
    global_load_dwordx4 a[152:155], v0, s[24:25]
    s_mov_b64 exec, -1
    s_add_u32 s24, s24, 98304
    s_addc_u32 s25, s25, 0
    s_mov_b64 exec, s[14:15]
    global_load_dwordx4 a[156:159], v0, s[24:25]
    s_mov_b64 exec, -1
    s_add_u32 s24, s24, 98304
    s_addc_u32 s25, s25, 0
    v_mfma_f32_16x16x32_bf16 v[76:79], v[108:111], v[136:139], v[76:79]
    v_mfma_f32_16x16x32_bf16 v[92:95], v[108:111], v[140:143], v[92:95]
    s_waitcnt vmcnt(30) lgkmcnt(0)
    v_mfma_f32_16x16x32_bf16 v[64:67], v[112:115], v[144:147], v[64:67]
    ds_read_b64_tr_b16 v[96:97], v9 offset:0
    ds_read_b64_tr_b16 v[98:99], v9 offset:2048
    v_mfma_f32_16x16x32_bf16 v[80:83], v[112:115], v[148:151], v[80:83]
    ds_read_b64_tr_b16 v[100:101], v10 offset:0
    ds_read_b64_tr_b16 v[102:103], v10 offset:2048
    v_mfma_f32_16x16x32_bf16 v[68:71], v[116:119], v[144:147], v[68:71]
    ds_read_b64_tr_b16 v[104:105], v11 offset:0
    ds_read_b64_tr_b16 v[106:107], v11 offset:2048
    v_mfma_f32_16x16x32_bf16 v[84:87], v[116:119], v[148:151], v[84:87]
    ds_read_b64_tr_b16 v[108:109], v12 offset:0
    ds_read_b64_tr_b16 v[110:111], v12 offset:2048
    v_mfma_f32_16x16x32_bf16 v[72:75], v[120:123], v[144:147], v[72:75]
    global_load_dwordx4 v[136:139], v5, s[46:47] offset:2048 sc1
    global_load_dwordx4 v[140:143], v24, s[46:47] offset:2048 sc1
    v_mfma_f32_16x16x32_bf16 v[88:91], v[120:123], v[148:151], v[88:91]
    s_add_u32 s46, s46, 4096
    s_addc_u32 s47, s47, 0
    v_mfma_f32_16x16x32_bf16 v[76:79], v[124:127], v[144:147], v[76:79]
    s_mov_b64 exec, s[14:15]
    global_load_dwordx4 a[160:163], v0, s[24:25]
    s_mov_b64 exec, -1
    s_add_u32 s24, s24, 98304
    s_addc_u32 s25, s25, 0
    s_mov_b64 exec, s[14:15]
    global_load_dwordx4 a[164:167], v0, s[24:25]
    s_mov_b64 exec, -1
    s_add_u32 s24, s24, 98304
    s_addc_u32 s25, s25, 0
    v_mfma_f32_16x16x32_bf16 v[92:95], v[124:127], v[148:151], v[92:95]
    s_waitcnt vmcnt(32) lgkmcnt(0)
    v_mfma_f32_16x16x32_bf16 v[64:67], v[96:99], v[152:155], v[64:67]
    ds_read_b64_tr_b16 v[112:113], v9 offset:8192
    ds_read_b64_tr_b16 v[114:115], v9 offset:10240
    v_mfma_f32_16x16x32_bf16 v[80:83], v[96:99], v[156:159], v[80:83]
    ds_read_b64_tr_b16 v[116:117], v10 offset:8192
    ds_read_b64_tr_b16 v[118:119], v10 offset:10240
    v_mfma_f32_16x16x32_bf16 v[68:71], v[100:103], v[152:155], v[68:71]
    ds_read_b64_tr_b16 v[120:121], v11 offset:8192
    ds_read_b64_tr_b16 v[122:123], v11 offset:10240
    v_mfma_f32_16x16x32_bf16 v[84:87], v[100:103], v[156:159], v[84:87]
    ds_read_b64_tr_b16 v[124:125], v12 offset:8192
    ds_read_b64_tr_b16 v[126:127], v12 offset:10240
    v_mfma_f32_16x16x32_bf16 v[72:75], v[104:107], v[152:155], v[72:75]
    s_lshl_b32 s10, s45, 4
    s_lshl_b32 s11, s7, 1
    v_mfma_f32_16x16x32_bf16 v[88:91], v[104:107], v[156:159], v[88:91]
    s_add_u32 s10, s10, s11
    s_lshl_b32 s49, s10, 10
    v_mfma_f32_16x16x32_bf16 v[76:79], v[108:111], v[152:155], v[76:79]
    s_add_u32 s10, s49, 2097152
    s_add_u32 s52, s38, s10
    v_mfma_f32_16x16x32_bf16 v[92:95], v[108:111], v[156:159], v[92:95]
    s_addc_u32 s53, s39, 0
    global_load_dwordx4 v[48:51], v5, s[52:53] sc1
    global_load_dwordx4 v[52:55], v5, s[52:53] offset:1024 sc1
    s_lshl_b32 s10, s7, 7
    s_add_u32 s54, s32, s10
    s_addc_u32 s55, s33, 0
    v_lshlrev_b32 v2, 3, v4
    global_load_dwordx2 v[56:57], v2, s[54:55] offset:0
    global_load_dwordx2 v[58:59], v2, s[54:55] offset:32
    global_load_dwordx2 v[60:61], v2, s[54:55] offset:64
    global_load_dwordx2 v[62:63], v2, s[54:55] offset:96
    s_mov_b64 exec, s[14:15]
    global_load_dwordx4 a[168:171], v0, s[24:25]
    s_mov_b64 exec, -1
    s_add_u32 s24, s24, 98304
    s_addc_u32 s25, s25, 0
    s_mov_b64 exec, s[14:15]
    global_load_dwordx4 a[172:175], v0, s[24:25]
    s_mov_b64 exec, -1
    s_add_u32 s24, s24, 98304
    s_addc_u32 s25, s25, 0
    s_waitcnt vmcnt(38) lgkmcnt(0)
    v_mfma_f32_16x16x32_bf16 v[64:67], v[112:115], v[160:163], v[64:67]
    ds_read_b64_tr_b16 v[96:97], v9 offset:16384
    ds_read_b64_tr_b16 v[98:99], v9 offset:18432
    v_mfma_f32_16x16x32_bf16 v[80:83], v[112:115], v[164:167], v[80:83]
    ds_read_b64_tr_b16 v[100:101], v10 offset:16384
    ds_read_b64_tr_b16 v[102:103], v10 offset:18432
    v_mfma_f32_16x16x32_bf16 v[68:71], v[116:119], v[160:163], v[68:71]
    ds_read_b64_tr_b16 v[104:105], v11 offset:16384
    ds_read_b64_tr_b16 v[106:107], v11 offset:18432
    v_mfma_f32_16x16x32_bf16 v[84:87], v[116:119], v[164:167], v[84:87]
    ds_read_b64_tr_b16 v[108:109], v12 offset:16384
    ds_read_b64_tr_b16 v[110:111], v12 offset:18432
    v_mfma_f32_16x16x32_bf16 v[72:75], v[120:123], v[160:163], v[72:75]
    s_mov_b64 exec, s[14:15]
    global_load_dwordx4 a[176:179], v0, s[24:25]
    s_mov_b64 exec, -1
    s_add_u32 s24, s24, 98304
    s_addc_u32 s25, s25, 0
    s_mov_b64 exec, s[14:15]
    global_load_dwordx4 a[180:183], v0, s[24:25]
    s_mov_b64 exec, -1
    s_add_u32 s24, s24, 98304
    s_addc_u32 s25, s25, 0
    v_mfma_f32_16x16x32_bf16 v[88:91], v[120:123], v[164:167], v[88:91]
    v_mfma_f32_16x16x32_bf16 v[76:79], v[124:127], v[160:163], v[76:79]
    v_mfma_f32_16x16x32_bf16 v[92:95], v[124:127], v[164:167], v[92:95]
    s_waitcnt vmcnt(38) lgkmcnt(0)
    v_mfma_f32_16x16x32_bf16 v[64:67], v[96:99], v[168:171], v[64:67]
    ds_read_b64_tr_b16 v[112:113], v9 offset:24576
    ds_read_b64_tr_b16 v[114:115], v9 offset:26624
    v_mfma_f32_16x16x32_bf16 v[80:83], v[96:99], v[172:175], v[80:83]
    ds_read_b64_tr_b16 v[116:117], v10 offset:24576
    ds_read_b64_tr_b16 v[118:119], v10 offset:26624
    v_mfma_f32_16x16x32_bf16 v[68:71], v[100:103], v[168:171], v[68:71]
    ds_read_b64_tr_b16 v[120:121], v11 offset:24576
    ds_read_b64_tr_b16 v[122:123], v11 offset:26624
    v_mfma_f32_16x16x32_bf16 v[84:87], v[100:103], v[172:175], v[84:87]
    ds_read_b64_tr_b16 v[124:125], v12 offset:24576
    ds_read_b64_tr_b16 v[126:127], v12 offset:26624
    v_mfma_f32_16x16x32_bf16 v[72:75], v[104:107], v[168:171], v[72:75]
    s_mov_b64 exec, s[14:15]
    global_load_dwordx4 a[184:187], v0, s[24:25]
    s_mov_b64 exec, -1
    s_add_u32 s24, s24, 98304
    s_addc_u32 s25, s25, 0
    s_mov_b64 exec, s[14:15]
    global_load_dwordx4 a[188:191], v0, s[24:25]
    s_mov_b64 exec, -1
    s_add_u32 s24, s24, 98304
    s_addc_u32 s25, s25, 0
    v_mfma_f32_16x16x32_bf16 v[88:91], v[104:107], v[172:175], v[88:91]
    v_mfma_f32_16x16x32_bf16 v[76:79], v[108:111], v[168:171], v[76:79]
    v_mfma_f32_16x16x32_bf16 v[92:95], v[108:111], v[172:175], v[92:95]
    s_waitcnt vmcnt(38) lgkmcnt(0)
    v_mfma_f32_16x16x32_bf16 v[64:67], v[112:115], v[176:179], v[64:67]
    ds_read_b64_tr_b16 v[96:97], v9 offset:32768
    ds_read_b64_tr_b16 v[98:99], v9 offset:34816
    v_mfma_f32_16x16x32_bf16 v[80:83], v[112:115], v[180:183], v[80:83]
    ds_read_b64_tr_b16 v[100:101], v10 offset:32768
    ds_read_b64_tr_b16 v[102:103], v10 offset:34816
    v_mfma_f32_16x16x32_bf16 v[68:71], v[116:119], v[176:179], v[68:71]
    ds_read_b64_tr_b16 v[104:105], v11 offset:32768
    ds_read_b64_tr_b16 v[106:107], v11 offset:34816
    v_mfma_f32_16x16x32_bf16 v[84:87], v[116:119], v[180:183], v[84:87]
    ds_read_b64_tr_b16 v[108:109], v12 offset:32768
    ds_read_b64_tr_b16 v[110:111], v12 offset:34816
    v_mfma_f32_16x16x32_bf16 v[72:75], v[120:123], v[176:179], v[72:75]
    s_mov_b64 exec, s[14:15]
    global_load_dwordx4 a[192:195], v0, s[100:101]
    s_mov_b64 exec, -1
    s_add_u32 s100, s100, 98304
    s_addc_u32 s101, s101, 0
    s_mov_b64 exec, s[14:15]
    global_load_dwordx4 a[196:199], v0, s[100:101]
    s_mov_b64 exec, -1
    s_add_u32 s100, s100, 98304
    s_addc_u32 s101, s101, 0
    v_mfma_f32_16x16x32_bf16 v[88:91], v[120:123], v[180:183], v[88:91]
    v_mfma_f32_16x16x32_bf16 v[76:79], v[124:127], v[176:179], v[76:79]
    v_mfma_f32_16x16x32_bf16 v[92:95], v[124:127], v[180:183], v[92:95]
    s_waitcnt vmcnt(38) lgkmcnt(0)
    v_mfma_f32_16x16x32_bf16 v[64:67], v[96:99], v[184:187], v[64:67]
    ds_read_b64_tr_b16 v[112:113], v9 offset:40960
    ds_read_b64_tr_b16 v[114:115], v9 offset:43008
    v_mfma_f32_16x16x32_bf16 v[80:83], v[96:99], v[188:191], v[80:83]
    ds_read_b64_tr_b16 v[116:117], v10 offset:40960
    ds_read_b64_tr_b16 v[118:119], v10 offset:43008
    v_mfma_f32_16x16x32_bf16 v[68:71], v[100:103], v[184:187], v[68:71]
    ds_read_b64_tr_b16 v[120:121], v11 offset:40960
    ds_read_b64_tr_b16 v[122:123], v11 offset:43008
    v_mfma_f32_16x16x32_bf16 v[84:87], v[100:103], v[188:191], v[84:87]
    ds_read_b64_tr_b16 v[124:125], v12 offset:40960
    ds_read_b64_tr_b16 v[126:127], v12 offset:43008
    v_mfma_f32_16x16x32_bf16 v[72:75], v[104:107], v[184:187], v[72:75]
    s_mov_b64 exec, s[14:15]
    global_load_dwordx4 a[200:203], v0, s[100:101]
    s_mov_b64 exec, -1
    s_add_u32 s100, s100, 98304
    s_addc_u32 s101, s101, 0
    s_mov_b64 exec, s[14:15]
    global_load_dwordx4 a[204:207], v0, s[100:101]
    s_mov_b64 exec, -1
    s_add_u32 s100, s100, 98304
    s_addc_u32 s101, s101, 0
    v_mfma_f32_16x16x32_bf16 v[88:91], v[104:107], v[188:191], v[88:91]
    v_mfma_f32_16x16x32_bf16 v[76:79], v[108:111], v[184:187], v[76:79]
    v_mfma_f32_16x16x32_bf16 v[92:95], v[108:111], v[188:191], v[92:95]
    s_waitcnt vmcnt(38) lgkmcnt(0)
    v_mfma_f32_16x16x32_bf16 v[64:67], v[112:115], v[192:195], v[64:67]
    ds_read_b64_tr_b16 v[96:97], v9 offset:49152
    ds_read_b64_tr_b16 v[98:99], v9 offset:51200
    v_mfma_f32_16x16x32_bf16 v[80:83], v[112:115], v[196:199], v[80:83]
    ds_read_b64_tr_b16 v[100:101], v10 offset:49152
    ds_read_b64_tr_b16 v[102:103], v10 offset:51200
    v_mfma_f32_16x16x32_bf16 v[68:71], v[116:119], v[192:195], v[68:71]
    ds_read_b64_tr_b16 v[104:105], v11 offset:49152
    ds_read_b64_tr_b16 v[106:107], v11 offset:51200
    v_mfma_f32_16x16x32_bf16 v[84:87], v[116:119], v[196:199], v[84:87]
    ds_read_b64_tr_b16 v[108:109], v12 offset:49152
    ds_read_b64_tr_b16 v[110:111], v12 offset:51200
    v_mfma_f32_16x16x32_bf16 v[72:75], v[120:123], v[192:195], v[72:75]
    s_mov_b64 exec, s[14:15]
    global_load_dwordx4 a[208:211], v0, s[100:101]
    s_mov_b64 exec, -1
    s_add_u32 s100, s100, 98304
    s_addc_u32 s101, s101, 0
    s_mov_b64 exec, s[14:15]
    global_load_dwordx4 a[212:215], v0, s[100:101]
    s_mov_b64 exec, -1
    s_add_u32 s100, s100, 98304
    s_addc_u32 s101, s101, 0
    v_mfma_f32_16x16x32_bf16 v[88:91], v[120:123], v[196:199], v[88:91]
    v_mfma_f32_16x16x32_bf16 v[76:79], v[124:127], v[192:195], v[76:79]
    v_mfma_f32_16x16x32_bf16 v[92:95], v[124:127], v[196:199], v[92:95]
    s_waitcnt vmcnt(38) lgkmcnt(0)
    v_mfma_f32_16x16x32_bf16 v[64:67], v[96:99], v[200:203], v[64:67]
    ds_read_b64_tr_b16 v[112:113], v9 offset:57344
    ds_read_b64_tr_b16 v[114:115], v9 offset:59392
    v_mfma_f32_16x16x32_bf16 v[80:83], v[96:99], v[204:207], v[80:83]
    ds_read_b64_tr_b16 v[116:117], v10 offset:57344
    ds_read_b64_tr_b16 v[118:119], v10 offset:59392
    v_mfma_f32_16x16x32_bf16 v[68:71], v[100:103], v[200:203], v[68:71]
    ds_read_b64_tr_b16 v[120:121], v11 offset:57344
    ds_read_b64_tr_b16 v[122:123], v11 offset:59392
    v_mfma_f32_16x16x32_bf16 v[84:87], v[100:103], v[204:207], v[84:87]
    ds_read_b64_tr_b16 v[124:125], v12 offset:57344
    ds_read_b64_tr_b16 v[126:127], v12 offset:59392
    v_mfma_f32_16x16x32_bf16 v[72:75], v[104:107], v[200:203], v[72:75]
    s_mov_b64 exec, s[14:15]
    global_load_dwordx4 a[216:219], v0, s[100:101]
    s_mov_b64 exec, -1
    s_add_u32 s100, s100, 98304
    s_addc_u32 s101, s101, 0
    s_mov_b64 exec, s[14:15]
    global_load_dwordx4 a[220:223], v0, s[100:101]
    s_mov_b64 exec, -1
    s_add_u32 s100, s100, 98304
    s_addc_u32 s101, s101, 0
    v_mfma_f32_16x16x32_bf16 v[88:91], v[104:107], v[204:207], v[88:91]
    v_mfma_f32_16x16x32_bf16 v[76:79], v[108:111], v[200:203], v[76:79]
    v_mfma_f32_16x16x32_bf16 v[92:95], v[108:111], v[204:207], v[92:95]
    s_waitcnt vmcnt(38) lgkmcnt(0)
    v_mfma_f32_16x16x32_bf16 v[64:67], v[112:115], v[208:211], v[64:67]
    ds_read_b64_tr_b16 v[96:97], v19 offset:0
    ds_read_b64_tr_b16 v[98:99], v19 offset:2048
    v_mfma_f32_16x16x32_bf16 v[80:83], v[112:115], v[212:215], v[80:83]
    ds_read_b64_tr_b16 v[100:101], v20 offset:0
    ds_read_b64_tr_b16 v[102:103], v20 offset:2048
    v_mfma_f32_16x16x32_bf16 v[68:71], v[116:119], v[208:211], v[68:71]
    ds_read_b64_tr_b16 v[104:105], v21 offset:0
    ds_read_b64_tr_b16 v[106:107], v21 offset:2048
    v_mfma_f32_16x16x32_bf16 v[84:87], v[116:119], v[212:215], v[84:87]
    ds_read_b64_tr_b16 v[108:109], v22 offset:0
    ds_read_b64_tr_b16 v[110:111], v22 offset:2048
    v_mfma_f32_16x16x32_bf16 v[72:75], v[120:123], v[208:211], v[72:75]
    s_mov_b64 exec, s[14:15]
    global_load_dwordx4 a[224:227], v0, s[100:101]
    s_mov_b64 exec, -1
    s_add_u32 s100, s100, 98304
    s_addc_u32 s101, s101, 0
    s_mov_b64 exec, s[14:15]
    global_load_dwordx4 a[228:231], v0, s[100:101]
    s_mov_b64 exec, -1
    s_add_u32 s100, s100, 98304
    s_addc_u32 s101, s101, 0
    v_mfma_f32_16x16x32_bf16 v[88:91], v[120:123], v[212:215], v[88:91]
    v_mfma_f32_16x16x32_bf16 v[76:79], v[124:127], v[208:211], v[76:79]
    v_mfma_f32_16x16x32_bf16 v[92:95], v[124:127], v[212:215], v[92:95]
    s_waitcnt vmcnt(36) lgkmcnt(0)
    v_mfma_f32_16x16x32_bf16 v[64:67], v[96:99], v[216:219], v[64:67]
    ds_read_b64_tr_b16 v[112:113], v19 offset:8192
    ds_read_b64_tr_b16 v[114:115], v19 offset:10240
    v_mfma_f32_16x16x32_bf16 v[80:83], v[96:99], v[220:223], v[80:83]
    ds_read_b64_tr_b16 v[116:117], v20 offset:8192
    ds_read_b64_tr_b16 v[118:119], v20 offset:10240
    v_mfma_f32_16x16x32_bf16 v[68:71], v[100:103], v[216:219], v[68:71]
    ds_read_b64_tr_b16 v[120:121], v21 offset:8192
    ds_read_b64_tr_b16 v[122:123], v21 offset:10240
    v_mfma_f32_16x16x32_bf16 v[84:87], v[100:103], v[220:223], v[84:87]
    ds_read_b64_tr_b16 v[124:125], v22 offset:8192
    ds_read_b64_tr_b16 v[126:127], v22 offset:10240
    v_mfma_f32_16x16x32_bf16 v[72:75], v[104:107], v[216:219], v[72:75]
    s_mov_b64 exec, s[14:15]
    global_load_dwordx4 a[232:235], v0, s[100:101]
    s_mov_b64 exec, -1
    s_add_u32 s100, s100, 98304
    s_addc_u32 s101, s101, 0
    s_mov_b64 exec, s[14:15]
    global_load_dwordx4 a[236:239], v0, s[100:101]
    s_mov_b64 exec, -1
    s_add_u32 s100, s100, 98304
    s_addc_u32 s101, s101, 0
    v_mfma_f32_16x16x32_bf16 v[88:91], v[104:107], v[220:223], v[88:91]
    v_mfma_f32_16x16x32_bf16 v[76:79], v[108:111], v[216:219], v[76:79]
    v_mfma_f32_16x16x32_bf16 v[92:95], v[108:111], v[220:223], v[92:95]
    s_waitcnt vmcnt(34) lgkmcnt(0)
    v_mfma_f32_16x16x32_bf16 v[64:67], v[112:115], v[224:227], v[64:67]
    ds_read_b64_tr_b16 v[96:97], v19 offset:16384
    ds_read_b64_tr_b16 v[98:99], v19 offset:18432
    v_mfma_f32_16x16x32_bf16 v[80:83], v[112:115], v[228:231], v[80:83]
    ds_read_b64_tr_b16 v[100:101], v20 offset:16384
    ds_read_b64_tr_b16 v[102:103], v20 offset:18432
    v_mfma_f32_16x16x32_bf16 v[68:71], v[116:119], v[224:227], v[68:71]
    ds_read_b64_tr_b16 v[104:105], v21 offset:16384
    ds_read_b64_tr_b16 v[106:107], v21 offset:18432
    v_mfma_f32_16x16x32_bf16 v[84:87], v[116:119], v[228:231], v[84:87]
    ds_read_b64_tr_b16 v[108:109], v22 offset:16384
    ds_read_b64_tr_b16 v[110:111], v22 offset:18432
    v_mfma_f32_16x16x32_bf16 v[72:75], v[120:123], v[224:227], v[72:75]
    s_mov_b64 exec, s[14:15]
    global_load_dwordx4 a[240:243], v0, s[100:101]
    s_mov_b64 exec, -1
    s_add_u32 s100, s100, 98304
    s_addc_u32 s101, s101, 0
    s_mov_b64 exec, s[14:15]
    global_load_dwordx4 a[244:247], v0, s[100:101]
    s_mov_b64 exec, -1
    s_add_u32 s100, s100, 98304
    s_addc_u32 s101, s101, 0
    v_mfma_f32_16x16x32_bf16 v[88:91], v[120:123], v[228:231], v[88:91]
    v_mfma_f32_16x16x32_bf16 v[76:79], v[124:127], v[224:227], v[76:79]
    v_mfma_f32_16x16x32_bf16 v[92:95], v[124:127], v[228:231], v[92:95]
    s_waitcnt vmcnt(32) lgkmcnt(0)
    v_mfma_f32_16x16x32_bf16 v[64:67], v[96:99], v[128:131], v[64:67]
    ds_read_b64_tr_b16 v[112:113], v19 offset:24576
    ds_read_b64_tr_b16 v[114:115], v19 offset:26624
    v_mfma_f32_16x16x32_bf16 v[80:83], v[96:99], v[132:135], v[80:83]
    ds_read_b64_tr_b16 v[116:117], v20 offset:24576
    ds_read_b64_tr_b16 v[118:119], v20 offset:26624
    v_mfma_f32_16x16x32_bf16 v[68:71], v[100:103], v[128:131], v[68:71]
    ds_read_b64_tr_b16 v[120:121], v21 offset:24576
    ds_read_b64_tr_b16 v[122:123], v21 offset:26624
    v_mfma_f32_16x16x32_bf16 v[84:87], v[100:103], v[132:135], v[84:87]
    ds_read_b64_tr_b16 v[124:125], v22 offset:24576
    ds_read_b64_tr_b16 v[126:127], v22 offset:26624
    v_mfma_f32_16x16x32_bf16 v[72:75], v[104:107], v[128:131], v[72:75]
    s_mov_b64 exec, s[14:15]
    global_load_dwordx4 a[248:251], v0, s[100:101]
    s_mov_b64 exec, -1
    s_add_u32 s100, s100, 98304
    s_addc_u32 s101, s101, 0
    s_mov_b64 exec, s[14:15]
    global_load_dwordx4 a[252:255], v0, s[100:101]
    s_mov_b64 exec, -1
    s_add_u32 s100, s100, 98304
    s_addc_u32 s101, s101, 0
    v_mfma_f32_16x16x32_bf16 v[88:91], v[104:107], v[132:135], v[88:91]
    v_mfma_f32_16x16x32_bf16 v[76:79], v[108:111], v[128:131], v[76:79]
    v_mfma_f32_16x16x32_bf16 v[92:95], v[108:111], v[132:135], v[92:95]
    s_waitcnt vmcnt(30) lgkmcnt(0)
    s_barrier
    v_mfma_f32_16x16x32_bf16 v[64:67], v[112:115], v[136:139], v[64:67]
    v_mfma_f32_16x16x32_bf16 v[80:83], v[112:115], v[140:143], v[80:83]
    v_mfma_f32_16x16x32_bf16 v[68:71], v[116:119], v[136:139], v[68:71]
    v_mfma_f32_16x16x32_bf16 v[84:87], v[116:119], v[140:143], v[84:87]
    v_mfma_f32_16x16x32_bf16 v[72:75], v[120:123], v[136:139], v[72:75]
    v_mfma_f32_16x16x32_bf16 v[88:91], v[120:123], v[140:143], v[88:91]
    v_mfma_f32_16x16x32_bf16 v[76:79], v[124:127], v[136:139], v[76:79]
    v_mfma_f32_16x16x32_bf16 v[92:95], v[124:127], v[140:143], v[92:95]
    s_lshl_b32 s10, s3, 12
    s_add_u32 s10, s10, 147456
    v_add_u32 v15, s10, v5
    s_xor_b32 s10, s10, 8192
    v_add_u32 v16, s10, v5
    s_cmp_eq_u32 s6, 1
    s_cbranch_scc1 xh_interleave_layers__linear_kernel_hedgehog__mixer_channel_mlp__prompt_kernel_82
    ds_write_b128 v15, v[80:83] offset:0
    ds_write_b128 v15, v[84:87] offset:1024
    ds_write_b128 v15, v[88:91] offset:2048
    ds_write_b128 v15, v[92:95] offset:3072
    v_mov_b32 v232, v64
    v_mov_b32 v233, v65
    v_mov_b32 v234, v66
    v_mov_b32 v235, v67
    v_mov_b32 v236, v68
    v_mov_b32 v237, v69
    v_mov_b32 v238, v70
    v_mov_b32 v239, v71
    v_mov_b32 v240, v72
    v_mov_b32 v241, v73
    v_mov_b32 v242, v74
    v_mov_b32 v243, v75
    v_mov_b32 v244, v76
    v_mov_b32 v245, v77
    v_mov_b32 v246, v78
    v_mov_b32 v247, v79
    s_branch xh_interleave_layers__linear_kernel_hedgehog__mixer_channel_mlp__prompt_kernel_83
xh_interleave_layers__linear_kernel_hedgehog__mixer_channel_mlp__prompt_kernel_82:
    ds_write_b128 v15, v[64:67] offset:0
    ds_write_b128 v15, v[68:71] offset:1024
    ds_write_b128 v15, v[72:75] offset:2048
    ds_write_b128 v15, v[76:79] offset:3072
    v_mov_b32 v232, v80
    v_mov_b32 v233, v81
    v_mov_b32 v234, v82
    v_mov_b32 v235, v83
    v_mov_b32 v236, v84
    v_mov_b32 v237, v85
    v_mov_b32 v238, v86
    v_mov_b32 v239, v87
    v_mov_b32 v240, v88
    v_mov_b32 v241, v89
    v_mov_b32 v242, v90
    v_mov_b32 v243, v91
    v_mov_b32 v244, v92
    v_mov_b32 v245, v93
    v_mov_b32 v246, v94
    v_mov_b32 v247, v95
xh_interleave_layers__linear_kernel_hedgehog__mixer_channel_mlp__prompt_kernel_83:
    s_waitcnt lgkmcnt(0)
    s_barrier
    ds_read_b128 v[96:99], v16 offset:0
    ds_read_b128 v[100:103], v16 offset:1024
    ds_read_b128 v[104:107], v16 offset:2048
    ds_read_b128 v[108:111], v16 offset:3072
    s_waitcnt vmcnt(22) lgkmcnt(0)
    v_pk_add_f32 v[232:233], v[232:233], v[96:97]
    v_pk_add_f32 v[234:235], v[234:235], v[98:99]
    v_pk_add_f32 v[236:237], v[236:237], v[100:101]
    v_pk_add_f32 v[238:239], v[238:239], v[102:103]
    v_pk_add_f32 v[240:241], v[240:241], v[104:105]
    v_pk_add_f32 v[242:243], v[242:243], v[106:107]
    v_pk_add_f32 v[244:245], v[244:245], v[108:109]
    v_pk_add_f32 v[246:247], v[246:247], v[110:111]
    v_cvt_pk_bf16_f32 v232, 0, v232
    v_cvt_pk_bf16_f32 v233, 0, v233
    v_lshlrev_b32 v26, 16, v56
    v_and_b32 v27, 0xffff0000, v56
    v_pk_add_f32 v[232:233], v[232:233], v[26:27]
    v_cvt_pk_bf16_f32 v232, 0, v232
    v_cvt_pk_bf16_f32 v233, 0, v233
    v_lshlrev_b32 v28, 16, v48
    v_and_b32 v29, 0xffff0000, v48
    v_pk_add_f32 v[232:233], v[232:233], v[28:29]
    v_cvt_pk_bf16_f32 v64, v232, v233
    v_cvt_pk_bf16_f32 v234, 0, v234
    v_cvt_pk_bf16_f32 v235, 0, v235
    v_lshlrev_b32 v26, 16, v57
    v_and_b32 v27, 0xffff0000, v57
    v_pk_add_f32 v[234:235], v[234:235], v[26:27]
    v_cvt_pk_bf16_f32 v234, 0, v234
    v_cvt_pk_bf16_f32 v235, 0, v235
    v_lshlrev_b32 v28, 16, v49
    v_and_b32 v29, 0xffff0000, v49
    v_pk_add_f32 v[234:235], v[234:235], v[28:29]
    v_cvt_pk_bf16_f32 v65, v234, v235
    v_cvt_pk_bf16_f32 v236, 0, v236
    v_cvt_pk_bf16_f32 v237, 0, v237
    v_lshlrev_b32 v26, 16, v58
    v_and_b32 v27, 0xffff0000, v58
    v_pk_add_f32 v[236:237], v[236:237], v[26:27]
    v_cvt_pk_bf16_f32 v236, 0, v236
    v_cvt_pk_bf16_f32 v237, 0, v237
    v_lshlrev_b32 v28, 16, v50
    v_and_b32 v29, 0xffff0000, v50
    v_pk_add_f32 v[236:237], v[236:237], v[28:29]
    v_cvt_pk_bf16_f32 v66, v236, v237
    v_cvt_pk_bf16_f32 v238, 0, v238
    v_cvt_pk_bf16_f32 v239, 0, v239
    v_lshlrev_b32 v26, 16, v59
    v_and_b32 v27, 0xffff0000, v59
    v_pk_add_f32 v[238:239], v[238:239], v[26:27]
    v_cvt_pk_bf16_f32 v238, 0, v238
    v_cvt_pk_bf16_f32 v239, 0, v239
    v_lshlrev_b32 v28, 16, v51
    v_and_b32 v29, 0xffff0000, v51
    v_pk_add_f32 v[238:239], v[238:239], v[28:29]
    v_cvt_pk_bf16_f32 v67, v238, v239
    v_cvt_pk_bf16_f32 v240, 0, v240
    v_cvt_pk_bf16_f32 v241, 0, v241
    v_lshlrev_b32 v26, 16, v60
    v_and_b32 v27, 0xffff0000, v60
    v_pk_add_f32 v[240:241], v[240:241], v[26:27]
    v_cvt_pk_bf16_f32 v240, 0, v240
    v_cvt_pk_bf16_f32 v241, 0, v241
    v_lshlrev_b32 v28, 16, v52
    v_and_b32 v29, 0xffff0000, v52
    v_pk_add_f32 v[240:241], v[240:241], v[28:29]
    v_cvt_pk_bf16_f32 v68, v240, v241
    v_cvt_pk_bf16_f32 v242, 0, v242
    v_cvt_pk_bf16_f32 v243, 0, v243
    v_lshlrev_b32 v26, 16, v61
    v_and_b32 v27, 0xffff0000, v61
    v_pk_add_f32 v[242:243], v[242:243], v[26:27]
    v_cvt_pk_bf16_f32 v242, 0, v242
    v_cvt_pk_bf16_f32 v243, 0, v243
    v_lshlrev_b32 v28, 16, v53
    v_and_b32 v29, 0xffff0000, v53
    v_pk_add_f32 v[242:243], v[242:243], v[28:29]
    v_cvt_pk_bf16_f32 v69, v242, v243
    v_cvt_pk_bf16_f32 v244, 0, v244
    v_cvt_pk_bf16_f32 v245, 0, v245
    v_lshlrev_b32 v26, 16, v62
    v_and_b32 v27, 0xffff0000, v62
    v_pk_add_f32 v[244:245], v[244:245], v[26:27]
    v_cvt_pk_bf16_f32 v244, 0, v244
    v_cvt_pk_bf16_f32 v245, 0, v245
    v_lshlrev_b32 v28, 16, v54
    v_and_b32 v29, 0xffff0000, v54
    v_pk_add_f32 v[244:245], v[244:245], v[28:29]
    v_cvt_pk_bf16_f32 v70, v244, v245
    v_cvt_pk_bf16_f32 v246, 0, v246
    v_cvt_pk_bf16_f32 v247, 0, v247
    v_lshlrev_b32 v26, 16, v63
    v_and_b32 v27, 0xffff0000, v63
    v_pk_add_f32 v[246:247], v[246:247], v[26:27]
    v_cvt_pk_bf16_f32 v246, 0, v246
    v_cvt_pk_bf16_f32 v247, 0, v247
    v_lshlrev_b32 v28, 16, v55
    v_and_b32 v29, 0xffff0000, v55
    v_pk_add_f32 v[246:247], v[246:247], v[28:29]
    v_cvt_pk_bf16_f32 v71, v246, v247
    s_cmp_eq_u32 s9, 0
    s_cbranch_scc1 p4a_interleave_layers__linear_kernel_hedgehog__mixer_channel_mlp__prompt_kernel_84
    s_lshl_b32 s10, s3, 12
    v_mul_u32_u24 v20, 144, v3
    v_lshl_add_u32 v20, v4, 3, v20
    v_add_u32 v20, s10, v20
    ds_write_b64 v20, v[64:65] offset:0
    ds_write_b64 v20, v[66:67] offset:32
    ds_write_b64 v20, v[68:69] offset:64
    ds_write_b64 v20, v[70:71] offset:96
    v_lshrrev_b32 v21, 2, v1
    v_and_b32 v22, 3, v1
    v_mul_u32_u24 v23, 144, v21
    v_lshl_add_u32 v23, v22, 4, v23
    v_add_u32 v23, s10, v23
    s_waitcnt lgkmcnt(0)
    ds_read_b128 v[24:27], v23
    ds_read_b128 v[28:31], v23 offset:64
    v_lshlrev_b32 v21, 10, v21
    v_lshl_add_u32 v21, v22, 4, v21
    s_lshl_b32 s10, s45, 14
    s_lshl_b32 s11, s7, 7
    s_add_u32 s10, s10, s11
    s_add_u32 s54, s34, s10
    s_addc_u32 s55, s35, 0
    s_waitcnt lgkmcnt(0)
    global_store_dwordx4 v21, v[24:27], s[54:55]
    global_store_dwordx4 v21, v[28:31], s[54:55] offset:64
    s_branch L_fin_interleave_layers__linear_kernel_hedgehog__mixer_channel_mlp__prompt_kernel
p4a_interleave_layers__linear_kernel_hedgehog__mixer_channel_mlp__prompt_kernel_84:
    s_nop 15
    s_nop 3
    s_add_u32 s10, s49, 4194304
    s_add_u32 s54, s38, s10
    s_addc_u32 s55, s39, 0
    s_cmp_eq_u32 s61, 1
    s_cbranch_scc1 sf_interleave_layers__linear_kernel_hedgehog__mixer_channel_mlp__prompt_kernel_85
    global_store_dwordx4 v5, v[64:67], s[54:55] sc1
    global_store_dwordx4 v5, v[68:71], s[54:55] offset:1024 sc1
    s_branch se_interleave_layers__linear_kernel_hedgehog__mixer_channel_mlp__prompt_kernel_86
sf_interleave_layers__linear_kernel_hedgehog__mixer_channel_mlp__prompt_kernel_85:
    global_store_dwordx4 v5, v[64:67], s[54:55]
    global_store_dwordx4 v5, v[68:71], s[54:55] offset:1024
se_interleave_layers__linear_kernel_hedgehog__mixer_channel_mlp__prompt_kernel_86:
    s_lshr_b32 s12, s7, 1
    s_lshl_b32 s11, s12, 8
    s_and_b32 s12, s7, 1
    s_lshl_b32 s12, s12, 3
    s_add_u32 s11, s11, s12
    s_lshl_b32 s12, s45, 11
    s_add_u32 s11, s11, s12
    s_add_u32 s11, s11, 18350080
    s_add_u32 s56, s38, s11
    s_addc_u32 s57, s39, 0
    v_mov_b32 v24, 0
    v_mov_b32 v25, 0
    v_dot2_f32_bf16 v24, v64, v23, v24
    v_dot2_f32_bf16 v25, v64, v64, v25
    v_dot2_f32_bf16 v24, v65, v23, v24
    v_dot2_f32_bf16 v25, v65, v65, v25
    v_dot2_f32_bf16 v24, v66, v23, v24
    v_dot2_f32_bf16 v25, v66, v66, v25
    v_dot2_f32_bf16 v24, v67, v23, v24
    v_dot2_f32_bf16 v25, v67, v67, v25
    v_dot2_f32_bf16 v24, v68, v23, v24
    v_dot2_f32_bf16 v25, v68, v68, v25
    v_dot2_f32_bf16 v24, v69, v23, v24
    v_dot2_f32_bf16 v25, v69, v69, v25
    v_dot2_f32_bf16 v24, v70, v23, v24
    v_dot2_f32_bf16 v25, v70, v70, v25
    v_dot2_f32_bf16 v24, v71, v23, v24
    v_dot2_f32_bf16 v25, v71, v71, v25
    s_nop 1
    v_mov_b32 v28, v24
    s_nop 1
    v_permlane32_swap_b32 v24, v28
    v_add_f32 v24, v24, v28
    v_mov_b32 v28, v24
    s_nop 1
    v_permlane16_swap_b32 v24, v28
    v_add_f32 v24, v24, v28
    v_mov_b32 v29, v25
    s_nop 1
    v_permlane32_swap_b32 v25, v29
    v_add_f32 v25, v25, v29
    v_mov_b32 v29, v25
    s_nop 1
    v_permlane16_swap_b32 v25, v29
    v_add_f32 v25, v25, v29
    s_mov_b64 exec, 0xffff
    s_cmp_eq_u32 s61, 1
    s_cbranch_scc1 sf_interleave_layers__linear_kernel_hedgehog__mixer_channel_mlp__prompt_kernel_87
    global_store_dwordx2 v5, v[24:25], s[56:57] sc1
    s_branch se_interleave_layers__linear_kernel_hedgehog__mixer_channel_mlp__prompt_kernel_88
sf_interleave_layers__linear_kernel_hedgehog__mixer_channel_mlp__prompt_kernel_87:
    global_store_dwordx2 v5, v[24:25], s[56:57]
se_interleave_layers__linear_kernel_hedgehog__mixer_channel_mlp__prompt_kernel_88:
    s_mov_b64 exec, -1
    s_waitcnt vmcnt(0)
    s_barrier
    s_cmp_lg_u32 s3, 0
    s_cbranch_scc1 sg_interleave_layers__linear_kernel_hedgehog__mixer_channel_mlp__prompt_kernel_89
    s_mov_b64 exec, 1
    s_lshl_b32 s10, s58, 10
    s_cmp_eq_u32 s61, 1
    s_cbranch_scc1 sgf_interleave_layers__linear_kernel_hedgehog__mixer_channel_mlp__prompt_kernel_90
    v_mov_b32 v2, s10
    v_mov_b32 v26, 1
    global_atomic_add v2, v26, s[62:63] offset:256 sc1
    s_branch sge_interleave_layers__linear_kernel_hedgehog__mixer_channel_mlp__prompt_kernel_91
sgf_interleave_layers__linear_kernel_hedgehog__mixer_channel_mlp__prompt_kernel_90:
    s_lshl_b32 s11, s59, 2
    s_add_u32 s10, s10, s11
    v_mov_b32 v2, s10
    s_add_u32 s11, s8, 1
    v_mov_b32 v26, s11
    global_store_dword v2, v26, s[62:63] offset:512
sge_interleave_layers__linear_kernel_hedgehog__mixer_channel_mlp__prompt_kernel_91:
    s_mov_b64 exec, -1
sg_interleave_layers__linear_kernel_hedgehog__mixer_channel_mlp__prompt_kernel_89:
    s_add_u32 s8, s8, 1
    s_lshl_b32 s48, s3, 10
    v_add_u32 v9, s48, v5
    v_add_u32 v10, 65536, v9
    ds_write_b128 v9, a[128:131] offset:0
    ds_write_b128 v9, a[132:135] offset:4096
    ds_write_b128 v9, a[136:139] offset:8192
    ds_write_b128 v9, a[140:143] offset:12288
    ds_write_b128 v9, a[144:147] offset:16384
    ds_write_b128 v9, a[148:151] offset:20480
    ds_write_b128 v9, a[152:155] offset:24576
    ds_write_b128 v9, a[156:159] offset:28672
    ds_write_b128 v9, a[160:163] offset:32768
    ds_write_b128 v9, a[164:167] offset:36864
    ds_write_b128 v9, a[168:171] offset:40960
    ds_write_b128 v9, a[172:175] offset:45056
    ds_write_b128 v9, a[176:179] offset:49152
    ds_write_b128 v9, a[180:183] offset:53248
    ds_write_b128 v9, a[184:187] offset:57344
    ds_write_b128 v9, a[188:191] offset:61440
    ds_write_b128 v10, a[192:195] offset:0
    ds_write_b128 v10, a[196:199] offset:4096
    ds_write_b128 v10, a[200:203] offset:8192
    ds_write_b128 v10, a[204:207] offset:12288
    ds_write_b128 v10, a[208:211] offset:16384
    ds_write_b128 v10, a[212:215] offset:20480
    ds_write_b128 v10, a[216:219] offset:24576
    ds_write_b128 v10, a[220:223] offset:28672
    ds_write_b128 v10, a[224:227] offset:32768
    ds_write_b128 v10, a[228:231] offset:36864
    ds_write_b128 v10, a[232:235] offset:40960
    ds_write_b128 v10, a[236:239] offset:45056
    ds_write_b128 v10, a[240:243] offset:49152
    ds_write_b128 v10, a[244:247] offset:53248
    ds_write_b128 v10, a[248:251] offset:57344
    ds_write_b128 v10, a[252:255] offset:61440
    s_and_b32 s10, s59, 7
    s_lshl_b32 s10, s10, 11
    s_and_b32 s11, s3, 1
    s_lshl_b32 s11, s11, 10
    s_add_u32 s10, s10, s11
    s_add_u32 s52, s20, s10
    s_addc_u32 s53, s21, 0
    s_add_u32 m0, s11, 147456
    s_nop 0
    global_load_lds_dwordx4 v5, s[52:53]
    s_cmp_ge_u32 s59, 8
    s_cbranch_scc1 p1q_interleave_layers__linear_kernel_hedgehog__mixer_channel_mlp__prompt_kernel_92
    s_lshl_b32 s10, s58, 3
    s_lshl_b32 s11, s3, 1
    s_add_u32 s45, s10, s11
    s_lshl_b32 s12, s45, 14
    s_add_u32 s12, s12, 4194304
    s_add_u32 s46, s38, s12
    s_addc_u32 s47, s39, 0
    v_add_u32 v25, 16384, v5
    s_lshl_b32 s10, s45, 11
    s_add_u32 s10, s10, 18350080
    s_add_u32 s50, s38, s10
    s_addc_u32 s51, s39, 0
    v_lshrrev_b32 v16, 1, v3
    s_and_b32 s10, s3, 1
    s_lshl_b32 s10, s10, 2
    v_add_u32 v0, s10, v4
    v_xor_b32 v0, v16, v0
    v_and_b32 v17, 1, v1
    v_lshlrev_b32 v17, 4, v17
    v_lshl_add_u32 v17, v4, 10, v17
    v_lshl_add_u32 v0, v0, 5, v17
    s_lshl_b32 s10, s3, 12
    s_lshr_b32 s11, s59, 2
    s_lshl_b32 s11, s11, 8
    s_add_u32 s10, s10, s11
    s_add_u32 s24, s22, s10
    s_addc_u32 s25, s23, 0
    v_lshrrev_b32 v16, 1, v8
    v_and_b32 v16, 3, v16
    v_lshlrev_b32 v18, 7, v8
    v_lshl_add_u32 v18, v7, 3, v18
    v_xor_b32 v17, 0, v16
    v_lshl_add_u32 v9, v17, 5, v18
    v_xor_b32 v17, 1, v16
    v_lshl_add_u32 v10, v17, 5, v18
    v_xor_b32 v17, 2, v16
    v_lshl_add_u32 v11, v17, 5, v18
    v_xor_b32 v17, 3, v16
    v_lshl_add_u32 v12, v17, 5, v18
    v_add_u32 v19, 65536, v9
    v_add_u32 v20, 65536, v10
    v_add_u32 v21, 65536, v11
    v_add_u32 v22, 65536, v12
    v_xor_b32 v17, s3, v16
    v_lshl_add_u32 v23, v17, 5, v18
    v_add_u32 v24, 65536, v23
    v_mov_b32 v28, 0x3f803f80
    v_mov_b32 v29, 0x3f803f80
    v_mov_b32 v30, 0x3f803f80
    v_mov_b32 v31, 0x3f803f80
    s_cmp_lg_u32 s3, 0
    s_cbranch_scc1 wt_interleave_layers__linear_kernel_hedgehog__mixer_channel_mlp__prompt_kernel_94
    s_mov_b64 exec, 0xffff
    s_lshl_b32 s10, s58, 10
    s_cmp_eq_u32 s61, 1
    s_cselect_b32 s11, 2, 1
    s_cselect_b32 s12, 4, 0
    s_cselect_b32 s13, 1, 16
    s_mul_i32 s13, s13, s8
    s_lshl_b32 s11, s11, 8
    s_add_u32 s10, s10, s11
    v_mul_u32_u24 v2, s12, v1
    v_add_u32 v2, s10, v2
    v_mov_b32 v27, s13
    s_mov_b32 s15, 0
pp_interleave_layers__linear_kernel_hedgehog__mixer_channel_mlp__prompt_kernel_95:
    global_load_dword v26, v2, s[62:63] sc1
    s_waitcnt vmcnt(0)
    v_cmp_gt_u32 vcc, v27, v26
    s_nop 4
    s_cbranch_vccz pq_interleave_layers__linear_kernel_hedgehog__mixer_channel_mlp__prompt_kernel_96
    s_sleep 1
    s_add_u32 s15, s15, 1
    s_cmp_lt_u32 s15, 400000
    s_cbranch_scc1 pp_interleave_layers__linear_kernel_hedgehog__mixer_channel_mlp__prompt_kernel_95
pq_interleave_layers__linear_kernel_hedgehog__mixer_channel_mlp__prompt_kernel_96:
    s_mov_b64 exec, -1
wt_interleave_layers__linear_kernel_hedgehog__mixer_channel_mlp__prompt_kernel_94:
    s_waitcnt vmcnt(0) lgkmcnt(0)
    s_barrier
    global_load_dwordx4 v[184:187], v5, s[50:51] offset:0 sc1
    global_load_dwordx4 v[192:195], v5, s[50:51] offset:2048 sc1
    global_load_dwordx4 a[0:3], v5, s[46:47] offset:0 sc1
    global_load_dwordx4 a[64:67], v25, s[46:47] offset:0 sc1
    global_load_dwordx4 a[4:7], v5, s[46:47] offset:1024 sc1
    global_load_dwordx4 a[68:71], v25, s[46:47] offset:1024 sc1
    global_load_dwordx4 a[8:11], v5, s[46:47] offset:2048 sc1
    global_load_dwordx4 a[72:75], v25, s[46:47] offset:2048 sc1
    global_load_dwordx4 a[12:15], v5, s[46:47] offset:3072 sc1
    global_load_dwordx4 a[76:79], v25, s[46:47] offset:3072 sc1
    s_add_u32 s46, s46, 4096
    s_addc_u32 s47, s47, 0
    global_load_dwordx4 a[16:19], v5, s[46:47] offset:0 sc1
    global_load_dwordx4 a[80:83], v25, s[46:47] offset:0 sc1
    global_load_dwordx4 a[20:23], v5, s[46:47] offset:1024 sc1
    global_load_dwordx4 a[84:87], v25, s[46:47] offset:1024 sc1
    global_load_dwordx4 a[24:27], v5, s[46:47] offset:2048 sc1
    global_load_dwordx4 a[88:91], v25, s[46:47] offset:2048 sc1
    global_load_dwordx4 a[28:31], v5, s[46:47] offset:3072 sc1
    global_load_dwordx4 a[92:95], v25, s[46:47] offset:3072 sc1
    s_add_u32 s46, s46, 4096
    s_addc_u32 s47, s47, 0
    ds_read_b64_tr_b16 v[104:105], v9 offset:0
    ds_read_b64_tr_b16 v[106:107], v9 offset:2048
    ds_read_b64_tr_b16 v[108:109], v10 offset:0
    ds_read_b64_tr_b16 v[110:111], v10 offset:2048
    ds_read_b64_tr_b16 v[112:113], v11 offset:0
    ds_read_b64_tr_b16 v[114:115], v11 offset:2048
    ds_read_b64_tr_b16 v[116:117], v12 offset:0
    ds_read_b64_tr_b16 v[118:119], v12 offset:2048
    ds_read_b64_tr_b16 v[120:121], v23 offset:0
    ds_read_b64_tr_b16 v[122:123], v23 offset:2048
    ds_read_b64_tr_b16 v[124:125], v19 offset:0
    ds_read_b64_tr_b16 v[126:127], v19 offset:2048
    ds_read_b64_tr_b16 v[128:129], v20 offset:0
    ds_read_b64_tr_b16 v[130:131], v20 offset:2048
    ds_read_b64_tr_b16 v[132:133], v21 offset:0
    ds_read_b64_tr_b16 v[134:135], v21 offset:2048
    ds_read_b64_tr_b16 v[136:137], v22 offset:0
    ds_read_b64_tr_b16 v[138:139], v22 offset:2048
    ds_read_b64_tr_b16 v[140:141], v24 offset:0
    ds_read_b64_tr_b16 v[142:143], v24 offset:2048
    s_waitcnt vmcnt(16)
    v_pk_add_f32 v[184:185], v[184:185], v[186:187]
    v_pk_add_f32 v[192:193], v[192:193], v[194:195]
    s_nop 0
    v_permlane32_swap_b32 v184, v185
    v_permlane32_swap_b32 v192, v193
    v_add_f32 v184, v184, v185
    v_add_f32 v192, v192, v193
    s_nop 1
    v_permlane16_swap_b32 v184, v192
    v_add_f32 v184, v184, v192
    v_mov_b32 v192, v184
    s_nop 1
    v_permlane16_swap_b32 v184, v192
    v_mov_b32 v185, v184
    v_mov_b32 v193, v192
    s_nop 0
    v_permlane32_swap_b32 v184, v185
    v_permlane32_swap_b32 v192, v193
    v_mul_f32 v184, 0x3b000000, v184
    v_mul_f32 v192, 0x3b000000, v192
    v_mul_f32 v185, 0x3b000000, v185
    v_mul_f32 v193, 0x3b000000, v193
    v_fma_f32 v185, -v184, v184, v185
    v_fma_f32 v193, -v192, v192, v193
    v_max_f32 v185, 0, v185
    v_max_f32 v193, 0, v193
    v_cvt_pk_bf16_f32 v186, 0, v184
    v_cvt_pk_bf16_f32 v194, 0, v192
    v_cvt_pk_bf16_f32 v187, 0, v185
    v_cvt_pk_bf16_f32 v195, 0, v193
    v_add_f32 v187, 0x3727c5ac, v187
    v_add_f32 v195, 0x3727c5ac, v195
    v_cvt_pk_bf16_f32 v187, 0, v187
    v_cvt_pk_bf16_f32 v195, 0, v195
    v_sqrt_f32 v187, v187
    v_sqrt_f32 v195, v195
    v_cvt_pk_bf16_f32 v187, 0, v187
    v_cvt_pk_bf16_f32 v195, 0, v195
    v_rcp_f32 v16, v187
    v_rcp_f32 v14, v195
    v_mul_f32 v17, v186, v16
    v_mul_f32 v15, v194, v14
    s_waitcnt vmcnt(14) lgkmcnt(0)
    v_mfma_f32_16x16x32_bf16 v[32:35], v[104:107], a[0:3], 0
    ds_read_b64_tr_b16 v[144:145], v9 offset:4096
    ds_read_b64_tr_b16 v[146:147], v9 offset:6144
    v_mfma_f32_16x16x32_bf16 v[64:67], v[104:107], a[64:67], 0
    ds_read_b64_tr_b16 v[148:149], v10 offset:4096
    ds_read_b64_tr_b16 v[150:151], v10 offset:6144
    v_mfma_f32_16x16x32_bf16 v[36:39], v[108:111], a[0:3], 0
    ds_read_b64_tr_b16 v[152:153], v11 offset:4096
    ds_read_b64_tr_b16 v[154:155], v11 offset:6144
    v_mfma_f32_16x16x32_bf16 v[68:71], v[108:111], a[64:67], 0
    ds_read_b64_tr_b16 v[156:157], v12 offset:4096
    ds_read_b64_tr_b16 v[158:159], v12 offset:6144
    v_mfma_f32_16x16x32_bf16 v[40:43], v[112:115], a[0:3], 0
    ds_read_b64_tr_b16 v[160:161], v23 offset:4096
    ds_read_b64_tr_b16 v[162:163], v23 offset:6144
    v_mfma_f32_16x16x32_bf16 v[72:75], v[112:115], a[64:67], 0
    ds_read_b64_tr_b16 v[164:165], v19 offset:4096
    ds_read_b64_tr_b16 v[166:167], v19 offset:6144
    v_mfma_f32_16x16x32_bf16 v[44:47], v[116:119], a[0:3], 0
    ds_read_b64_tr_b16 v[168:169], v20 offset:4096
    ds_read_b64_tr_b16 v[170:171], v20 offset:6144
    v_mfma_f32_16x16x32_bf16 v[76:79], v[116:119], a[64:67], 0
    ds_read_b64_tr_b16 v[172:173], v21 offset:4096
    ds_read_b64_tr_b16 v[174:175], v21 offset:6144
    v_mfma_f32_16x16x32_bf16 v[96:99], v[120:123], v[28:31], 0
    ds_read_b64_tr_b16 v[176:177], v22 offset:4096
    ds_read_b64_tr_b16 v[178:179], v22 offset:6144
    v_mfma_f32_16x16x32_bf16 v[48:51], v[124:127], a[0:3], 0
    ds_read_b64_tr_b16 v[180:181], v24 offset:4096
    ds_read_b64_tr_b16 v[182:183], v24 offset:6144
    v_mfma_f32_16x16x32_bf16 v[80:83], v[124:127], a[64:67], 0
    global_load_dwordx4 a[32:35], v5, s[46:47] offset:0 sc1
    global_load_dwordx4 a[96:99], v25, s[46:47] offset:0 sc1
    v_mfma_f32_16x16x32_bf16 v[52:55], v[128:131], a[0:3], 0
    v_mfma_f32_16x16x32_bf16 v[84:87], v[128:131], a[64:67], 0
    v_mfma_f32_16x16x32_bf16 v[56:59], v[132:135], a[0:3], 0
    v_mfma_f32_16x16x32_bf16 v[88:91], v[132:135], a[64:67], 0
    v_mfma_f32_16x16x32_bf16 v[60:63], v[136:139], a[0:3], 0
    v_mfma_f32_16x16x32_bf16 v[92:95], v[136:139], a[64:67], 0
    v_mfma_f32_16x16x32_bf16 v[100:103], v[140:143], v[28:31], 0
    s_waitcnt vmcnt(14) lgkmcnt(0)
    v_mfma_f32_16x16x32_bf16 v[32:35], v[144:147], a[4:7], v[32:35]
    ds_read_b64_tr_b16 v[104:105], v9 offset:8192
    ds_read_b64_tr_b16 v[106:107], v9 offset:10240
    v_mfma_f32_16x16x32_bf16 v[64:67], v[144:147], a[68:71], v[64:67]
    ds_read_b64_tr_b16 v[108:109], v10 offset:8192
    ds_read_b64_tr_b16 v[110:111], v10 offset:10240
    v_mfma_f32_16x16x32_bf16 v[36:39], v[148:151], a[4:7], v[36:39]
    ds_read_b64_tr_b16 v[112:113], v11 offset:8192
    ds_read_b64_tr_b16 v[114:115], v11 offset:10240
    v_mfma_f32_16x16x32_bf16 v[68:71], v[148:151], a[68:71], v[68:71]
    ds_read_b64_tr_b16 v[116:117], v12 offset:8192
    ds_read_b64_tr_b16 v[118:119], v12 offset:10240
    v_mfma_f32_16x16x32_bf16 v[40:43], v[152:155], a[4:7], v[40:43]
    ds_read_b64_tr_b16 v[120:121], v23 offset:8192
    ds_read_b64_tr_b16 v[122:123], v23 offset:10240
    v_mfma_f32_16x16x32_bf16 v[72:75], v[152:155], a[68:71], v[72:75]
    ds_read_b64_tr_b16 v[124:125], v19 offset:8192
    ds_read_b64_tr_b16 v[126:127], v19 offset:10240
    v_mfma_f32_16x16x32_bf16 v[44:47], v[156:159], a[4:7], v[44:47]
    ds_read_b64_tr_b16 v[128:129], v20 offset:8192
    ds_read_b64_tr_b16 v[130:131], v20 offset:10240
    v_mfma_f32_16x16x32_bf16 v[76:79], v[156:159], a[68:71], v[76:79]
    ds_read_b64_tr_b16 v[132:133], v21 offset:8192
    ds_read_b64_tr_b16 v[134:135], v21 offset:10240
    v_mfma_f32_16x16x32_bf16 v[96:99], v[160:163], v[28:31], v[96:99]
    ds_read_b64_tr_b16 v[136:137], v22 offset:8192
    ds_read_b64_tr_b16 v[138:139], v22 offset:10240
    v_mfma_f32_16x16x32_bf16 v[48:51], v[164:167], a[4:7], v[48:51]
    ds_read_b64_tr_b16 v[140:141], v24 offset:8192
    ds_read_b64_tr_b16 v[142:143], v24 offset:10240
    v_mfma_f32_16x16x32_bf16 v[80:83], v[164:167], a[68:71], v[80:83]
    global_load_dwordx4 a[36:39], v5, s[46:47] offset:1024 sc1
    global_load_dwordx4 a[100:103], v25, s[46:47] offset:1024 sc1
    v_mfma_f32_16x16x32_bf16 v[52:55], v[168:171], a[4:7], v[52:55]
    v_mfma_f32_16x16x32_bf16 v[84:87], v[168:171], a[68:71], v[84:87]
    v_mfma_f32_16x16x32_bf16 v[56:59], v[172:175], a[4:7], v[56:59]
    v_mfma_f32_16x16x32_bf16 v[88:91], v[172:175], a[68:71], v[88:91]
    v_mfma_f32_16x16x32_bf16 v[60:63], v[176:179], a[4:7], v[60:63]
    v_mfma_f32_16x16x32_bf16 v[92:95], v[176:179], a[68:71], v[92:95]
    v_mfma_f32_16x16x32_bf16 v[100:103], v[180:183], v[28:31], v[100:103]
    s_waitcnt vmcnt(14) lgkmcnt(0)
    v_mfma_f32_16x16x32_bf16 v[32:35], v[104:107], a[8:11], v[32:35]
    ds_read_b64_tr_b16 v[144:145], v9 offset:12288
    ds_read_b64_tr_b16 v[146:147], v9 offset:14336
    v_mfma_f32_16x16x32_bf16 v[64:67], v[104:107], a[72:75], v[64:67]
    ds_read_b64_tr_b16 v[148:149], v10 offset:12288
    ds_read_b64_tr_b16 v[150:151], v10 offset:14336
    v_mfma_f32_16x16x32_bf16 v[36:39], v[108:111], a[8:11], v[36:39]
    ds_read_b64_tr_b16 v[152:153], v11 offset:12288
    ds_read_b64_tr_b16 v[154:155], v11 offset:14336
    v_mfma_f32_16x16x32_bf16 v[68:71], v[108:111], a[72:75], v[68:71]
    ds_read_b64_tr_b16 v[156:157], v12 offset:12288
    ds_read_b64_tr_b16 v[158:159], v12 offset:14336
    v_mfma_f32_16x16x32_bf16 v[40:43], v[112:115], a[8:11], v[40:43]
    ds_read_b64_tr_b16 v[160:161], v23 offset:12288
    ds_read_b64_tr_b16 v[162:163], v23 offset:14336
    v_mfma_f32_16x16x32_bf16 v[72:75], v[112:115], a[72:75], v[72:75]
    ds_read_b64_tr_b16 v[164:165], v19 offset:12288
    ds_read_b64_tr_b16 v[166:167], v19 offset:14336
    v_mfma_f32_16x16x32_bf16 v[44:47], v[116:119], a[8:11], v[44:47]
    ds_read_b64_tr_b16 v[168:169], v20 offset:12288
    ds_read_b64_tr_b16 v[170:171], v20 offset:14336
    v_mfma_f32_16x16x32_bf16 v[76:79], v[116:119], a[72:75], v[76:79]
    ds_read_b64_tr_b16 v[172:173], v21 offset:12288
    ds_read_b64_tr_b16 v[174:175], v21 offset:14336
    v_mfma_f32_16x16x32_bf16 v[96:99], v[120:123], v[28:31], v[96:99]
    ds_read_b64_tr_b16 v[176:177], v22 offset:12288
    ds_read_b64_tr_b16 v[178:179], v22 offset:14336
    v_mfma_f32_16x16x32_bf16 v[48:51], v[124:127], a[8:11], v[48:51]
    ds_read_b64_tr_b16 v[180:181], v24 offset:12288
    ds_read_b64_tr_b16 v[182:183], v24 offset:14336
    v_mfma_f32_16x16x32_bf16 v[80:83], v[124:127], a[72:75], v[80:83]
    global_load_dwordx4 a[40:43], v5, s[46:47] offset:2048 sc1
    global_load_dwordx4 a[104:107], v25, s[46:47] offset:2048 sc1
    v_mfma_f32_16x16x32_bf16 v[52:55], v[128:131], a[8:11], v[52:55]
    v_mfma_f32_16x16x32_bf16 v[84:87], v[128:131], a[72:75], v[84:87]
    v_mfma_f32_16x16x32_bf16 v[56:59], v[132:135], a[8:11], v[56:59]
    v_mfma_f32_16x16x32_bf16 v[88:91], v[132:135], a[72:75], v[88:91]
    v_mfma_f32_16x16x32_bf16 v[60:63], v[136:139], a[8:11], v[60:63]
    v_mfma_f32_16x16x32_bf16 v[92:95], v[136:139], a[72:75], v[92:95]
    v_mfma_f32_16x16x32_bf16 v[100:103], v[140:143], v[28:31], v[100:103]
    s_waitcnt vmcnt(14) lgkmcnt(0)
    v_mfma_f32_16x16x32_bf16 v[32:35], v[144:147], a[12:15], v[32:35]
    ds_read_b64_tr_b16 v[104:105], v9 offset:16384
    ds_read_b64_tr_b16 v[106:107], v9 offset:18432
    v_mfma_f32_16x16x32_bf16 v[64:67], v[144:147], a[76:79], v[64:67]
    ds_read_b64_tr_b16 v[108:109], v10 offset:16384
    ds_read_b64_tr_b16 v[110:111], v10 offset:18432
    v_mfma_f32_16x16x32_bf16 v[36:39], v[148:151], a[12:15], v[36:39]
    ds_read_b64_tr_b16 v[112:113], v11 offset:16384
    ds_read_b64_tr_b16 v[114:115], v11 offset:18432
    v_mfma_f32_16x16x32_bf16 v[68:71], v[148:151], a[76:79], v[68:71]
    ds_read_b64_tr_b16 v[116:117], v12 offset:16384
    ds_read_b64_tr_b16 v[118:119], v12 offset:18432
    v_mfma_f32_16x16x32_bf16 v[40:43], v[152:155], a[12:15], v[40:43]
    ds_read_b64_tr_b16 v[120:121], v23 offset:16384
    ds_read_b64_tr_b16 v[122:123], v23 offset:18432
    v_mfma_f32_16x16x32_bf16 v[72:75], v[152:155], a[76:79], v[72:75]
    ds_read_b64_tr_b16 v[124:125], v19 offset:16384
    ds_read_b64_tr_b16 v[126:127], v19 offset:18432
    v_mfma_f32_16x16x32_bf16 v[44:47], v[156:159], a[12:15], v[44:47]
    ds_read_b64_tr_b16 v[128:129], v20 offset:16384
    ds_read_b64_tr_b16 v[130:131], v20 offset:18432
    v_mfma_f32_16x16x32_bf16 v[76:79], v[156:159], a[76:79], v[76:79]
    ds_read_b64_tr_b16 v[132:133], v21 offset:16384
    ds_read_b64_tr_b16 v[134:135], v21 offset:18432
    v_mfma_f32_16x16x32_bf16 v[96:99], v[160:163], v[28:31], v[96:99]
    ds_read_b64_tr_b16 v[136:137], v22 offset:16384
    ds_read_b64_tr_b16 v[138:139], v22 offset:18432
    v_mfma_f32_16x16x32_bf16 v[48:51], v[164:167], a[12:15], v[48:51]
    ds_read_b64_tr_b16 v[140:141], v24 offset:16384
    ds_read_b64_tr_b16 v[142:143], v24 offset:18432
    v_mfma_f32_16x16x32_bf16 v[80:83], v[164:167], a[76:79], v[80:83]
    global_load_dwordx4 a[44:47], v5, s[46:47] offset:3072 sc1
    global_load_dwordx4 a[108:111], v25, s[46:47] offset:3072 sc1
    v_mfma_f32_16x16x32_bf16 v[52:55], v[168:171], a[12:15], v[52:55]
    s_add_u32 s46, s46, 4096
    s_addc_u32 s47, s47, 0
    v_mfma_f32_16x16x32_bf16 v[84:87], v[168:171], a[76:79], v[84:87]
    v_mfma_f32_16x16x32_bf16 v[56:59], v[172:175], a[12:15], v[56:59]
    v_mfma_f32_16x16x32_bf16 v[88:91], v[172:175], a[76:79], v[88:91]
    v_mfma_f32_16x16x32_bf16 v[60:63], v[176:179], a[12:15], v[60:63]
    v_mfma_f32_16x16x32_bf16 v[92:95], v[176:179], a[76:79], v[92:95]
    v_mfma_f32_16x16x32_bf16 v[100:103], v[180:183], v[28:31], v[100:103]
    s_waitcnt vmcnt(14) lgkmcnt(0)
    v_mfma_f32_16x16x32_bf16 v[32:35], v[104:107], a[16:19], v[32:35]
    ds_read_b64_tr_b16 v[144:145], v9 offset:20480
    ds_read_b64_tr_b16 v[146:147], v9 offset:22528
    v_mfma_f32_16x16x32_bf16 v[64:67], v[104:107], a[80:83], v[64:67]
    ds_read_b64_tr_b16 v[148:149], v10 offset:20480
    ds_read_b64_tr_b16 v[150:151], v10 offset:22528
    v_mfma_f32_16x16x32_bf16 v[36:39], v[108:111], a[16:19], v[36:39]
    ds_read_b64_tr_b16 v[152:153], v11 offset:20480
    ds_read_b64_tr_b16 v[154:155], v11 offset:22528
    v_mfma_f32_16x16x32_bf16 v[68:71], v[108:111], a[80:83], v[68:71]
    ds_read_b64_tr_b16 v[156:157], v12 offset:20480
    ds_read_b64_tr_b16 v[158:159], v12 offset:22528
    v_mfma_f32_16x16x32_bf16 v[40:43], v[112:115], a[16:19], v[40:43]
    ds_read_b64_tr_b16 v[160:161], v23 offset:20480
    ds_read_b64_tr_b16 v[162:163], v23 offset:22528
    v_mfma_f32_16x16x32_bf16 v[72:75], v[112:115], a[80:83], v[72:75]
    ds_read_b64_tr_b16 v[164:165], v19 offset:20480
    ds_read_b64_tr_b16 v[166:167], v19 offset:22528
    v_mfma_f32_16x16x32_bf16 v[44:47], v[116:119], a[16:19], v[44:47]
    ds_read_b64_tr_b16 v[168:169], v20 offset:20480
    ds_read_b64_tr_b16 v[170:171], v20 offset:22528
    v_mfma_f32_16x16x32_bf16 v[76:79], v[116:119], a[80:83], v[76:79]
    ds_read_b64_tr_b16 v[172:173], v21 offset:20480
    ds_read_b64_tr_b16 v[174:175], v21 offset:22528
    v_mfma_f32_16x16x32_bf16 v[96:99], v[120:123], v[28:31], v[96:99]
    ds_read_b64_tr_b16 v[176:177], v22 offset:20480
    ds_read_b64_tr_b16 v[178:179], v22 offset:22528
    v_mfma_f32_16x16x32_bf16 v[48:51], v[124:127], a[16:19], v[48:51]
    ds_read_b64_tr_b16 v[180:181], v24 offset:20480
    ds_read_b64_tr_b16 v[182:183], v24 offset:22528
    v_mfma_f32_16x16x32_bf16 v[80:83], v[124:127], a[80:83], v[80:83]
    global_load_dwordx4 a[48:51], v5, s[46:47] offset:0 sc1
    global_load_dwordx4 a[112:115], v25, s[46:47] offset:0 sc1
    v_mfma_f32_16x16x32_bf16 v[52:55], v[128:131], a[16:19], v[52:55]
    v_mfma_f32_16x16x32_bf16 v[84:87], v[128:131], a[80:83], v[84:87]
    v_mfma_f32_16x16x32_bf16 v[56:59], v[132:135], a[16:19], v[56:59]
    v_mfma_f32_16x16x32_bf16 v[88:91], v[132:135], a[80:83], v[88:91]
    v_mfma_f32_16x16x32_bf16 v[60:63], v[136:139], a[16:19], v[60:63]
    v_mfma_f32_16x16x32_bf16 v[92:95], v[136:139], a[80:83], v[92:95]
    v_mfma_f32_16x16x32_bf16 v[100:103], v[140:143], v[28:31], v[100:103]
    s_waitcnt vmcnt(14) lgkmcnt(0)
    v_mfma_f32_16x16x32_bf16 v[32:35], v[144:147], a[20:23], v[32:35]
    ds_read_b64_tr_b16 v[104:105], v9 offset:24576
    ds_read_b64_tr_b16 v[106:107], v9 offset:26624
    v_mfma_f32_16x16x32_bf16 v[64:67], v[144:147], a[84:87], v[64:67]
    ds_read_b64_tr_b16 v[108:109], v10 offset:24576
    ds_read_b64_tr_b16 v[110:111], v10 offset:26624
    v_mfma_f32_16x16x32_bf16 v[36:39], v[148:151], a[20:23], v[36:39]
    ds_read_b64_tr_b16 v[112:113], v11 offset:24576
    ds_read_b64_tr_b16 v[114:115], v11 offset:26624
    v_mfma_f32_16x16x32_bf16 v[68:71], v[148:151], a[84:87], v[68:71]
    ds_read_b64_tr_b16 v[116:117], v12 offset:24576
    ds_read_b64_tr_b16 v[118:119], v12 offset:26624
    v_mfma_f32_16x16x32_bf16 v[40:43], v[152:155], a[20:23], v[40:43]
    ds_read_b64_tr_b16 v[120:121], v23 offset:24576
    ds_read_b64_tr_b16 v[122:123], v23 offset:26624
    v_mfma_f32_16x16x32_bf16 v[72:75], v[152:155], a[84:87], v[72:75]
    ds_read_b64_tr_b16 v[124:125], v19 offset:24576
    ds_read_b64_tr_b16 v[126:127], v19 offset:26624
    v_mfma_f32_16x16x32_bf16 v[44:47], v[156:159], a[20:23], v[44:47]
    ds_read_b64_tr_b16 v[128:129], v20 offset:24576
    ds_read_b64_tr_b16 v[130:131], v20 offset:26624
    v_mfma_f32_16x16x32_bf16 v[76:79], v[156:159], a[84:87], v[76:79]
    ds_read_b64_tr_b16 v[132:133], v21 offset:24576
    ds_read_b64_tr_b16 v[134:135], v21 offset:26624
    v_mfma_f32_16x16x32_bf16 v[96:99], v[160:163], v[28:31], v[96:99]
    ds_read_b64_tr_b16 v[136:137], v22 offset:24576
    ds_read_b64_tr_b16 v[138:139], v22 offset:26624
    v_mfma_f32_16x16x32_bf16 v[48:51], v[164:167], a[20:23], v[48:51]
    ds_read_b64_tr_b16 v[140:141], v24 offset:24576
    ds_read_b64_tr_b16 v[142:143], v24 offset:26624
    v_mfma_f32_16x16x32_bf16 v[80:83], v[164:167], a[84:87], v[80:83]
    global_load_dwordx4 a[52:55], v5, s[46:47] offset:1024 sc1
    global_load_dwordx4 a[116:119], v25, s[46:47] offset:1024 sc1
    v_mfma_f32_16x16x32_bf16 v[52:55], v[168:171], a[20:23], v[52:55]
    v_mfma_f32_16x16x32_bf16 v[84:87], v[168:171], a[84:87], v[84:87]
    v_mfma_f32_16x16x32_bf16 v[56:59], v[172:175], a[20:23], v[56:59]
    v_mfma_f32_16x16x32_bf16 v[88:91], v[172:175], a[84:87], v[88:91]
    v_mfma_f32_16x16x32_bf16 v[60:63], v[176:179], a[20:23], v[60:63]
    v_mfma_f32_16x16x32_bf16 v[92:95], v[176:179], a[84:87], v[92:95]
    v_mfma_f32_16x16x32_bf16 v[100:103], v[180:183], v[28:31], v[100:103]
    s_waitcnt vmcnt(14) lgkmcnt(0)
    v_mfma_f32_16x16x32_bf16 v[32:35], v[104:107], a[24:27], v[32:35]
    ds_read_b64_tr_b16 v[144:145], v9 offset:28672
    ds_read_b64_tr_b16 v[146:147], v9 offset:30720
    v_mfma_f32_16x16x32_bf16 v[64:67], v[104:107], a[88:91], v[64:67]
    ds_read_b64_tr_b16 v[148:149], v10 offset:28672
    ds_read_b64_tr_b16 v[150:151], v10 offset:30720
    v_mfma_f32_16x16x32_bf16 v[36:39], v[108:111], a[24:27], v[36:39]
    ds_read_b64_tr_b16 v[152:153], v11 offset:28672
    ds_read_b64_tr_b16 v[154:155], v11 offset:30720
    v_mfma_f32_16x16x32_bf16 v[68:71], v[108:111], a[88:91], v[68:71]
    ds_read_b64_tr_b16 v[156:157], v12 offset:28672
    ds_read_b64_tr_b16 v[158:159], v12 offset:30720
    v_mfma_f32_16x16x32_bf16 v[40:43], v[112:115], a[24:27], v[40:43]
    ds_read_b64_tr_b16 v[160:161], v23 offset:28672
    ds_read_b64_tr_b16 v[162:163], v23 offset:30720
    v_mfma_f32_16x16x32_bf16 v[72:75], v[112:115], a[88:91], v[72:75]
    ds_read_b64_tr_b16 v[164:165], v19 offset:28672
    ds_read_b64_tr_b16 v[166:167], v19 offset:30720
    v_mfma_f32_16x16x32_bf16 v[44:47], v[116:119], a[24:27], v[44:47]
    ds_read_b64_tr_b16 v[168:169], v20 offset:28672
    ds_read_b64_tr_b16 v[170:171], v20 offset:30720
    v_mfma_f32_16x16x32_bf16 v[76:79], v[116:119], a[88:91], v[76:79]
    ds_read_b64_tr_b16 v[172:173], v21 offset:28672
    ds_read_b64_tr_b16 v[174:175], v21 offset:30720
    v_mfma_f32_16x16x32_bf16 v[96:99], v[120:123], v[28:31], v[96:99]
    ds_read_b64_tr_b16 v[176:177], v22 offset:28672
    ds_read_b64_tr_b16 v[178:179], v22 offset:30720
    v_mfma_f32_16x16x32_bf16 v[48:51], v[124:127], a[24:27], v[48:51]
    ds_read_b64_tr_b16 v[180:181], v24 offset:28672
    ds_read_b64_tr_b16 v[182:183], v24 offset:30720
    v_mfma_f32_16x16x32_bf16 v[80:83], v[124:127], a[88:91], v[80:83]
    global_load_dwordx4 a[56:59], v5, s[46:47] offset:2048 sc1
    global_load_dwordx4 a[120:123], v25, s[46:47] offset:2048 sc1
    v_mfma_f32_16x16x32_bf16 v[52:55], v[128:131], a[24:27], v[52:55]
    v_mfma_f32_16x16x32_bf16 v[84:87], v[128:131], a[88:91], v[84:87]
    v_mfma_f32_16x16x32_bf16 v[56:59], v[132:135], a[24:27], v[56:59]
    v_mfma_f32_16x16x32_bf16 v[88:91], v[132:135], a[88:91], v[88:91]
    v_mfma_f32_16x16x32_bf16 v[60:63], v[136:139], a[24:27], v[60:63]
    v_mfma_f32_16x16x32_bf16 v[92:95], v[136:139], a[88:91], v[92:95]
    v_mfma_f32_16x16x32_bf16 v[100:103], v[140:143], v[28:31], v[100:103]
    s_waitcnt vmcnt(14) lgkmcnt(0)
    v_mfma_f32_16x16x32_bf16 v[32:35], v[144:147], a[28:31], v[32:35]
    ds_read_b64_tr_b16 v[104:105], v9 offset:32768
    ds_read_b64_tr_b16 v[106:107], v9 offset:34816
    v_mfma_f32_16x16x32_bf16 v[64:67], v[144:147], a[92:95], v[64:67]
    ds_read_b64_tr_b16 v[108:109], v10 offset:32768
    ds_read_b64_tr_b16 v[110:111], v10 offset:34816
    v_mfma_f32_16x16x32_bf16 v[36:39], v[148:151], a[28:31], v[36:39]
    ds_read_b64_tr_b16 v[112:113], v11 offset:32768
    ds_read_b64_tr_b16 v[114:115], v11 offset:34816
    v_mfma_f32_16x16x32_bf16 v[68:71], v[148:151], a[92:95], v[68:71]
    ds_read_b64_tr_b16 v[116:117], v12 offset:32768
    ds_read_b64_tr_b16 v[118:119], v12 offset:34816
    v_mfma_f32_16x16x32_bf16 v[40:43], v[152:155], a[28:31], v[40:43]
    ds_read_b64_tr_b16 v[120:121], v23 offset:32768
    ds_read_b64_tr_b16 v[122:123], v23 offset:34816
    v_mfma_f32_16x16x32_bf16 v[72:75], v[152:155], a[92:95], v[72:75]
    ds_read_b64_tr_b16 v[124:125], v19 offset:32768
    ds_read_b64_tr_b16 v[126:127], v19 offset:34816
    v_mfma_f32_16x16x32_bf16 v[44:47], v[156:159], a[28:31], v[44:47]
    ds_read_b64_tr_b16 v[128:129], v20 offset:32768
    ds_read_b64_tr_b16 v[130:131], v20 offset:34816
    v_mfma_f32_16x16x32_bf16 v[76:79], v[156:159], a[92:95], v[76:79]
    ds_read_b64_tr_b16 v[132:133], v21 offset:32768
    ds_read_b64_tr_b16 v[134:135], v21 offset:34816
    v_mfma_f32_16x16x32_bf16 v[96:99], v[160:163], v[28:31], v[96:99]
    ds_read_b64_tr_b16 v[136:137], v22 offset:32768
    ds_read_b64_tr_b16 v[138:139], v22 offset:34816
    v_mfma_f32_16x16x32_bf16 v[48:51], v[164:167], a[28:31], v[48:51]
    ds_read_b64_tr_b16 v[140:141], v24 offset:32768
    ds_read_b64_tr_b16 v[142:143], v24 offset:34816
    v_mfma_f32_16x16x32_bf16 v[80:83], v[164:167], a[92:95], v[80:83]
    global_load_dwordx4 a[60:63], v5, s[46:47] offset:3072 sc1
    global_load_dwordx4 a[124:127], v25, s[46:47] offset:3072 sc1
    v_mfma_f32_16x16x32_bf16 v[52:55], v[168:171], a[28:31], v[52:55]
    s_add_u32 s46, s46, 4096
    s_addc_u32 s47, s47, 0
    v_mfma_f32_16x16x32_bf16 v[84:87], v[168:171], a[92:95], v[84:87]
    v_mfma_f32_16x16x32_bf16 v[56:59], v[172:175], a[28:31], v[56:59]
    v_mfma_f32_16x16x32_bf16 v[88:91], v[172:175], a[92:95], v[88:91]
    v_mfma_f32_16x16x32_bf16 v[60:63], v[176:179], a[28:31], v[60:63]
    v_mfma_f32_16x16x32_bf16 v[92:95], v[176:179], a[92:95], v[92:95]
    v_mfma_f32_16x16x32_bf16 v[100:103], v[180:183], v[28:31], v[100:103]
    s_waitcnt vmcnt(14) lgkmcnt(0)
    v_mfma_f32_16x16x32_bf16 v[32:35], v[104:107], a[32:35], v[32:35]
    ds_read_b64_tr_b16 v[144:145], v9 offset:36864
    ds_read_b64_tr_b16 v[146:147], v9 offset:38912
    v_mfma_f32_16x16x32_bf16 v[64:67], v[104:107], a[96:99], v[64:67]
    ds_read_b64_tr_b16 v[148:149], v10 offset:36864
    ds_read_b64_tr_b16 v[150:151], v10 offset:38912
    v_mfma_f32_16x16x32_bf16 v[36:39], v[108:111], a[32:35], v[36:39]
    ds_read_b64_tr_b16 v[152:153], v11 offset:36864
    ds_read_b64_tr_b16 v[154:155], v11 offset:38912
    v_mfma_f32_16x16x32_bf16 v[68:71], v[108:111], a[96:99], v[68:71]
    ds_read_b64_tr_b16 v[156:157], v12 offset:36864
    ds_read_b64_tr_b16 v[158:159], v12 offset:38912
    v_mfma_f32_16x16x32_bf16 v[40:43], v[112:115], a[32:35], v[40:43]
    ds_read_b64_tr_b16 v[160:161], v23 offset:36864
    ds_read_b64_tr_b16 v[162:163], v23 offset:38912
    v_mfma_f32_16x16x32_bf16 v[72:75], v[112:115], a[96:99], v[72:75]
    ds_read_b64_tr_b16 v[164:165], v19 offset:36864
    ds_read_b64_tr_b16 v[166:167], v19 offset:38912
    v_mfma_f32_16x16x32_bf16 v[44:47], v[116:119], a[32:35], v[44:47]
    ds_read_b64_tr_b16 v[168:169], v20 offset:36864
    ds_read_b64_tr_b16 v[170:171], v20 offset:38912
    v_mfma_f32_16x16x32_bf16 v[76:79], v[116:119], a[96:99], v[76:79]
    ds_read_b64_tr_b16 v[172:173], v21 offset:36864
    ds_read_b64_tr_b16 v[174:175], v21 offset:38912
    v_mfma_f32_16x16x32_bf16 v[96:99], v[120:123], v[28:31], v[96:99]
    ds_read_b64_tr_b16 v[176:177], v22 offset:36864
    ds_read_b64_tr_b16 v[178:179], v22 offset:38912
    v_mfma_f32_16x16x32_bf16 v[48:51], v[124:127], a[32:35], v[48:51]
    ds_read_b64_tr_b16 v[180:181], v24 offset:36864
    ds_read_b64_tr_b16 v[182:183], v24 offset:38912
    v_mfma_f32_16x16x32_bf16 v[80:83], v[124:127], a[96:99], v[80:83]
    global_load_dwordx4 a[128:131], v0, s[24:25]
    s_add_u32 s24, s24, 16384
    s_addc_u32 s25, s25, 0
    global_load_dwordx4 a[132:135], v0, s[24:25]
    s_add_u32 s24, s24, 16384
    s_addc_u32 s25, s25, 0
    v_mfma_f32_16x16x32_bf16 v[52:55], v[128:131], a[32:35], v[52:55]
    global_load_dwordx4 a[136:139], v0, s[24:25]
    s_add_u32 s24, s24, 16384
    s_addc_u32 s25, s25, 0
    global_load_dwordx4 a[140:143], v0, s[24:25]
    s_add_u32 s24, s24, 16384
    s_addc_u32 s25, s25, 0
    v_mfma_f32_16x16x32_bf16 v[84:87], v[128:131], a[96:99], v[84:87]
    v_mfma_f32_16x16x32_bf16 v[56:59], v[132:135], a[32:35], v[56:59]
    v_mfma_f32_16x16x32_bf16 v[88:91], v[132:135], a[96:99], v[88:91]
    v_mfma_f32_16x16x32_bf16 v[60:63], v[136:139], a[32:35], v[60:63]
    v_mfma_f32_16x16x32_bf16 v[92:95], v[136:139], a[96:99], v[92:95]
    v_mfma_f32_16x16x32_bf16 v[100:103], v[140:143], v[28:31], v[100:103]
    s_waitcnt vmcnt(16) lgkmcnt(0)
    v_mfma_f32_16x16x32_bf16 v[32:35], v[144:147], a[36:39], v[32:35]
    ds_read_b64_tr_b16 v[104:105], v9 offset:40960
    ds_read_b64_tr_b16 v[106:107], v9 offset:43008
    v_mfma_f32_16x16x32_bf16 v[64:67], v[144:147], a[100:103], v[64:67]
    ds_read_b64_tr_b16 v[108:109], v10 offset:40960
    ds_read_b64_tr_b16 v[110:111], v10 offset:43008
    v_mfma_f32_16x16x32_bf16 v[36:39], v[148:151], a[36:39], v[36:39]
    ds_read_b64_tr_b16 v[112:113], v11 offset:40960
    ds_read_b64_tr_b16 v[114:115], v11 offset:43008
    v_mfma_f32_16x16x32_bf16 v[68:71], v[148:151], a[100:103], v[68:71]
    ds_read_b64_tr_b16 v[116:117], v12 offset:40960
    ds_read_b64_tr_b16 v[118:119], v12 offset:43008
    v_mfma_f32_16x16x32_bf16 v[40:43], v[152:155], a[36:39], v[40:43]
    ds_read_b64_tr_b16 v[120:121], v23 offset:40960
    ds_read_b64_tr_b16 v[122:123], v23 offset:43008
    v_mfma_f32_16x16x32_bf16 v[72:75], v[152:155], a[100:103], v[72:75]
    ds_read_b64_tr_b16 v[124:125], v19 offset:40960
    ds_read_b64_tr_b16 v[126:127], v19 offset:43008
    v_mfma_f32_16x16x32_bf16 v[44:47], v[156:159], a[36:39], v[44:47]
    ds_read_b64_tr_b16 v[128:129], v20 offset:40960
    ds_read_b64_tr_b16 v[130:131], v20 offset:43008
    v_mfma_f32_16x16x32_bf16 v[76:79], v[156:159], a[100:103], v[76:79]
    ds_read_b64_tr_b16 v[132:133], v21 offset:40960
    ds_read_b64_tr_b16 v[134:135], v21 offset:43008
    v_mfma_f32_16x16x32_bf16 v[96:99], v[160:163], v[28:31], v[96:99]
    ds_read_b64_tr_b16 v[136:137], v22 offset:40960
    ds_read_b64_tr_b16 v[138:139], v22 offset:43008
    v_mfma_f32_16x16x32_bf16 v[48:51], v[164:167], a[36:39], v[48:51]
    ds_read_b64_tr_b16 v[140:141], v24 offset:40960
    ds_read_b64_tr_b16 v[142:143], v24 offset:43008
    v_mfma_f32_16x16x32_bf16 v[80:83], v[164:167], a[100:103], v[80:83]
    global_load_dwordx4 a[144:147], v0, s[24:25]
    s_add_u32 s24, s24, 16384
    s_addc_u32 s25, s25, 0
    global_load_dwordx4 a[148:151], v0, s[24:25]
    s_add_u32 s24, s24, 16384
    s_addc_u32 s25, s25, 0
    v_mfma_f32_16x16x32_bf16 v[52:55], v[168:171], a[36:39], v[52:55]
    global_load_dwordx4 a[152:155], v0, s[24:25]
    s_add_u32 s24, s24, 16384
    s_addc_u32 s25, s25, 0
    global_load_dwordx4 a[156:159], v0, s[24:25]
    s_add_u32 s24, s24, 16384
    s_addc_u32 s25, s25, 0
    v_mfma_f32_16x16x32_bf16 v[84:87], v[168:171], a[100:103], v[84:87]
    v_mfma_f32_16x16x32_bf16 v[56:59], v[172:175], a[36:39], v[56:59]
    v_mfma_f32_16x16x32_bf16 v[88:91], v[172:175], a[100:103], v[88:91]
    v_mfma_f32_16x16x32_bf16 v[60:63], v[176:179], a[36:39], v[60:63]
    v_mfma_f32_16x16x32_bf16 v[92:95], v[176:179], a[100:103], v[92:95]
    v_mfma_f32_16x16x32_bf16 v[100:103], v[180:183], v[28:31], v[100:103]
    s_waitcnt vmcnt(18) lgkmcnt(0)
    v_mfma_f32_16x16x32_bf16 v[32:35], v[104:107], a[40:43], v[32:35]
    ds_read_b64_tr_b16 v[144:145], v9 offset:45056
    ds_read_b64_tr_b16 v[146:147], v9 offset:47104
    v_mfma_f32_16x16x32_bf16 v[64:67], v[104:107], a[104:107], v[64:67]
    ds_read_b64_tr_b16 v[148:149], v10 offset:45056
    ds_read_b64_tr_b16 v[150:151], v10 offset:47104
    v_mfma_f32_16x16x32_bf16 v[36:39], v[108:111], a[40:43], v[36:39]
    ds_read_b64_tr_b16 v[152:153], v11 offset:45056
    ds_read_b64_tr_b16 v[154:155], v11 offset:47104
    v_mfma_f32_16x16x32_bf16 v[68:71], v[108:111], a[104:107], v[68:71]
    ds_read_b64_tr_b16 v[156:157], v12 offset:45056
    ds_read_b64_tr_b16 v[158:159], v12 offset:47104
    v_mfma_f32_16x16x32_bf16 v[40:43], v[112:115], a[40:43], v[40:43]
    ds_read_b64_tr_b16 v[160:161], v23 offset:45056
    ds_read_b64_tr_b16 v[162:163], v23 offset:47104
    v_mfma_f32_16x16x32_bf16 v[72:75], v[112:115], a[104:107], v[72:75]
    ds_read_b64_tr_b16 v[164:165], v19 offset:45056
    ds_read_b64_tr_b16 v[166:167], v19 offset:47104
    v_mfma_f32_16x16x32_bf16 v[44:47], v[116:119], a[40:43], v[44:47]
    ds_read_b64_tr_b16 v[168:169], v20 offset:45056
    ds_read_b64_tr_b16 v[170:171], v20 offset:47104
    v_mfma_f32_16x16x32_bf16 v[76:79], v[116:119], a[104:107], v[76:79]
    ds_read_b64_tr_b16 v[172:173], v21 offset:45056
    ds_read_b64_tr_b16 v[174:175], v21 offset:47104
    v_mfma_f32_16x16x32_bf16 v[96:99], v[120:123], v[28:31], v[96:99]
    ds_read_b64_tr_b16 v[176:177], v22 offset:45056
    ds_read_b64_tr_b16 v[178:179], v22 offset:47104
    v_mfma_f32_16x16x32_bf16 v[48:51], v[124:127], a[40:43], v[48:51]
    ds_read_b64_tr_b16 v[180:181], v24 offset:45056
    ds_read_b64_tr_b16 v[182:183], v24 offset:47104
    v_mfma_f32_16x16x32_bf16 v[80:83], v[124:127], a[104:107], v[80:83]
    global_load_dwordx4 a[160:163], v0, s[24:25]
    s_add_u32 s24, s24, 16384
    s_addc_u32 s25, s25, 0
    global_load_dwordx4 a[164:167], v0, s[24:25]
    s_add_u32 s24, s24, 16384
    s_addc_u32 s25, s25, 0
    v_mfma_f32_16x16x32_bf16 v[52:55], v[128:131], a[40:43], v[52:55]
    global_load_dwordx4 a[168:171], v0, s[24:25]
    s_add_u32 s24, s24, 16384
    s_addc_u32 s25, s25, 0
    global_load_dwordx4 a[172:175], v0, s[24:25]
    s_add_u32 s24, s24, 16384
    s_addc_u32 s25, s25, 0
    v_mfma_f32_16x16x32_bf16 v[84:87], v[128:131], a[104:107], v[84:87]
    v_mfma_f32_16x16x32_bf16 v[56:59], v[132:135], a[40:43], v[56:59]
    v_mfma_f32_16x16x32_bf16 v[88:91], v[132:135], a[104:107], v[88:91]
    v_mfma_f32_16x16x32_bf16 v[60:63], v[136:139], a[40:43], v[60:63]
    v_mfma_f32_16x16x32_bf16 v[92:95], v[136:139], a[104:107], v[92:95]
    v_mfma_f32_16x16x32_bf16 v[100:103], v[140:143], v[28:31], v[100:103]
    s_waitcnt vmcnt(20) lgkmcnt(0)
    v_mfma_f32_16x16x32_bf16 v[32:35], v[144:147], a[44:47], v[32:35]
    ds_read_b64_tr_b16 v[104:105], v9 offset:49152
    ds_read_b64_tr_b16 v[106:107], v9 offset:51200
    v_mfma_f32_16x16x32_bf16 v[64:67], v[144:147], a[108:111], v[64:67]
    ds_read_b64_tr_b16 v[108:109], v10 offset:49152
    ds_read_b64_tr_b16 v[110:111], v10 offset:51200
    v_mfma_f32_16x16x32_bf16 v[36:39], v[148:151], a[44:47], v[36:39]
    ds_read_b64_tr_b16 v[112:113], v11 offset:49152
    ds_read_b64_tr_b16 v[114:115], v11 offset:51200
    v_mfma_f32_16x16x32_bf16 v[68:71], v[148:151], a[108:111], v[68:71]
    ds_read_b64_tr_b16 v[116:117], v12 offset:49152
    ds_read_b64_tr_b16 v[118:119], v12 offset:51200
    v_mfma_f32_16x16x32_bf16 v[40:43], v[152:155], a[44:47], v[40:43]
    ds_read_b64_tr_b16 v[120:121], v23 offset:49152
    ds_read_b64_tr_b16 v[122:123], v23 offset:51200
    v_mfma_f32_16x16x32_bf16 v[72:75], v[152:155], a[108:111], v[72:75]
    ds_read_b64_tr_b16 v[124:125], v19 offset:49152
    ds_read_b64_tr_b16 v[126:127], v19 offset:51200
    v_mfma_f32_16x16x32_bf16 v[44:47], v[156:159], a[44:47], v[44:47]
    ds_read_b64_tr_b16 v[128:129], v20 offset:49152
    ds_read_b64_tr_b16 v[130:131], v20 offset:51200
    v_mfma_f32_16x16x32_bf16 v[76:79], v[156:159], a[108:111], v[76:79]
    ds_read_b64_tr_b16 v[132:133], v21 offset:49152
    ds_read_b64_tr_b16 v[134:135], v21 offset:51200
    v_mfma_f32_16x16x32_bf16 v[96:99], v[160:163], v[28:31], v[96:99]
    ds_read_b64_tr_b16 v[136:137], v22 offset:49152
    ds_read_b64_tr_b16 v[138:139], v22 offset:51200
    v_mfma_f32_16x16x32_bf16 v[48:51], v[164:167], a[44:47], v[48:51]
    ds_read_b64_tr_b16 v[140:141], v24 offset:49152
    ds_read_b64_tr_b16 v[142:143], v24 offset:51200
    v_mfma_f32_16x16x32_bf16 v[80:83], v[164:167], a[108:111], v[80:83]
    global_load_dwordx4 a[176:179], v0, s[24:25]
    s_add_u32 s24, s24, 16384
    s_addc_u32 s25, s25, 0
    global_load_dwordx4 a[180:183], v0, s[24:25]
    s_add_u32 s24, s24, 16384
    s_addc_u32 s25, s25, 0
    v_mfma_f32_16x16x32_bf16 v[52:55], v[168:171], a[44:47], v[52:55]
    global_load_dwordx4 a[184:187], v0, s[24:25]
    s_add_u32 s24, s24, 16384
    s_addc_u32 s25, s25, 0
    global_load_dwordx4 a[188:191], v0, s[24:25]
    s_add_u32 s24, s24, 16384
    s_addc_u32 s25, s25, 0
    v_mfma_f32_16x16x32_bf16 v[84:87], v[168:171], a[108:111], v[84:87]
    v_mfma_f32_16x16x32_bf16 v[56:59], v[172:175], a[44:47], v[56:59]
    v_mfma_f32_16x16x32_bf16 v[88:91], v[172:175], a[108:111], v[88:91]
    v_mfma_f32_16x16x32_bf16 v[60:63], v[176:179], a[44:47], v[60:63]
    v_mfma_f32_16x16x32_bf16 v[92:95], v[176:179], a[108:111], v[92:95]
    v_mfma_f32_16x16x32_bf16 v[100:103], v[180:183], v[28:31], v[100:103]
    s_waitcnt vmcnt(22) lgkmcnt(0)
    v_mfma_f32_16x16x32_bf16 v[32:35], v[104:107], a[48:51], v[32:35]
    ds_read_b64_tr_b16 v[144:145], v9 offset:53248
    ds_read_b64_tr_b16 v[146:147], v9 offset:55296
    v_mfma_f32_16x16x32_bf16 v[64:67], v[104:107], a[112:115], v[64:67]
    ds_read_b64_tr_b16 v[148:149], v10 offset:53248
    ds_read_b64_tr_b16 v[150:151], v10 offset:55296
    v_mfma_f32_16x16x32_bf16 v[36:39], v[108:111], a[48:51], v[36:39]
    ds_read_b64_tr_b16 v[152:153], v11 offset:53248
    ds_read_b64_tr_b16 v[154:155], v11 offset:55296
    v_mfma_f32_16x16x32_bf16 v[68:71], v[108:111], a[112:115], v[68:71]
    ds_read_b64_tr_b16 v[156:157], v12 offset:53248
    ds_read_b64_tr_b16 v[158:159], v12 offset:55296
    v_mfma_f32_16x16x32_bf16 v[40:43], v[112:115], a[48:51], v[40:43]
    ds_read_b64_tr_b16 v[160:161], v23 offset:53248
    ds_read_b64_tr_b16 v[162:163], v23 offset:55296
    v_mfma_f32_16x16x32_bf16 v[72:75], v[112:115], a[112:115], v[72:75]
    ds_read_b64_tr_b16 v[164:165], v19 offset:53248
    ds_read_b64_tr_b16 v[166:167], v19 offset:55296
    v_mfma_f32_16x16x32_bf16 v[44:47], v[116:119], a[48:51], v[44:47]
    ds_read_b64_tr_b16 v[168:169], v20 offset:53248
    ds_read_b64_tr_b16 v[170:171], v20 offset:55296
    v_mfma_f32_16x16x32_bf16 v[76:79], v[116:119], a[112:115], v[76:79]
    ds_read_b64_tr_b16 v[172:173], v21 offset:53248
    ds_read_b64_tr_b16 v[174:175], v21 offset:55296
    v_mfma_f32_16x16x32_bf16 v[96:99], v[120:123], v[28:31], v[96:99]
    ds_read_b64_tr_b16 v[176:177], v22 offset:53248
    ds_read_b64_tr_b16 v[178:179], v22 offset:55296
    v_mfma_f32_16x16x32_bf16 v[48:51], v[124:127], a[48:51], v[48:51]
    ds_read_b64_tr_b16 v[180:181], v24 offset:53248
    ds_read_b64_tr_b16 v[182:183], v24 offset:55296
    v_mfma_f32_16x16x32_bf16 v[80:83], v[124:127], a[112:115], v[80:83]
    global_load_dwordx4 a[192:195], v0, s[24:25]
    s_add_u32 s24, s24, 16384
    s_addc_u32 s25, s25, 0
    global_load_dwordx4 a[196:199], v0, s[24:25]
    s_add_u32 s24, s24, 16384
    s_addc_u32 s25, s25, 0
    v_mfma_f32_16x16x32_bf16 v[52:55], v[128:131], a[48:51], v[52:55]
    global_load_dwordx4 a[200:203], v0, s[24:25]
    s_add_u32 s24, s24, 16384
    s_addc_u32 s25, s25, 0
    global_load_dwordx4 a[204:207], v0, s[24:25]
    s_add_u32 s24, s24, 16384
    s_addc_u32 s25, s25, 0
    v_mfma_f32_16x16x32_bf16 v[84:87], v[128:131], a[112:115], v[84:87]
    v_mfma_f32_16x16x32_bf16 v[56:59], v[132:135], a[48:51], v[56:59]
    v_mfma_f32_16x16x32_bf16 v[88:91], v[132:135], a[112:115], v[88:91]
    v_mfma_f32_16x16x32_bf16 v[60:63], v[136:139], a[48:51], v[60:63]
    v_mfma_f32_16x16x32_bf16 v[92:95], v[136:139], a[112:115], v[92:95]
    v_mfma_f32_16x16x32_bf16 v[100:103], v[140:143], v[28:31], v[100:103]
    s_waitcnt vmcnt(24) lgkmcnt(0)
    v_mfma_f32_16x16x32_bf16 v[32:35], v[144:147], a[52:55], v[32:35]
    ds_read_b64_tr_b16 v[104:105], v9 offset:57344
    ds_read_b64_tr_b16 v[106:107], v9 offset:59392
    v_mfma_f32_16x16x32_bf16 v[64:67], v[144:147], a[116:119], v[64:67]
    ds_read_b64_tr_b16 v[108:109], v10 offset:57344
    ds_read_b64_tr_b16 v[110:111], v10 offset:59392
    v_mfma_f32_16x16x32_bf16 v[36:39], v[148:151], a[52:55], v[36:39]
    ds_read_b64_tr_b16 v[112:113], v11 offset:57344
    ds_read_b64_tr_b16 v[114:115], v11 offset:59392
    v_mfma_f32_16x16x32_bf16 v[68:71], v[148:151], a[116:119], v[68:71]
    ds_read_b64_tr_b16 v[116:117], v12 offset:57344
    ds_read_b64_tr_b16 v[118:119], v12 offset:59392
    v_mfma_f32_16x16x32_bf16 v[40:43], v[152:155], a[52:55], v[40:43]
    ds_read_b64_tr_b16 v[120:121], v23 offset:57344
    ds_read_b64_tr_b16 v[122:123], v23 offset:59392
    v_mfma_f32_16x16x32_bf16 v[72:75], v[152:155], a[116:119], v[72:75]
    ds_read_b64_tr_b16 v[124:125], v19 offset:57344
    ds_read_b64_tr_b16 v[126:127], v19 offset:59392
    v_mfma_f32_16x16x32_bf16 v[44:47], v[156:159], a[52:55], v[44:47]
    ds_read_b64_tr_b16 v[128:129], v20 offset:57344
    ds_read_b64_tr_b16 v[130:131], v20 offset:59392
    v_mfma_f32_16x16x32_bf16 v[76:79], v[156:159], a[116:119], v[76:79]
    ds_read_b64_tr_b16 v[132:133], v21 offset:57344
    ds_read_b64_tr_b16 v[134:135], v21 offset:59392
    v_mfma_f32_16x16x32_bf16 v[96:99], v[160:163], v[28:31], v[96:99]
    ds_read_b64_tr_b16 v[136:137], v22 offset:57344
    ds_read_b64_tr_b16 v[138:139], v22 offset:59392
    v_mfma_f32_16x16x32_bf16 v[48:51], v[164:167], a[52:55], v[48:51]
    ds_read_b64_tr_b16 v[140:141], v24 offset:57344
    ds_read_b64_tr_b16 v[142:143], v24 offset:59392
    v_mfma_f32_16x16x32_bf16 v[80:83], v[164:167], a[116:119], v[80:83]
    global_load_dwordx4 a[208:211], v0, s[24:25]
    s_add_u32 s24, s24, 16384
    s_addc_u32 s25, s25, 0
    global_load_dwordx4 a[212:215], v0, s[24:25]
    s_add_u32 s24, s24, 16384
    s_addc_u32 s25, s25, 0
    v_mfma_f32_16x16x32_bf16 v[52:55], v[168:171], a[52:55], v[52:55]
    global_load_dwordx4 a[216:219], v0, s[24:25]
    s_add_u32 s24, s24, 16384
    s_addc_u32 s25, s25, 0
    global_load_dwordx4 a[220:223], v0, s[24:25]
    s_add_u32 s24, s24, 16384
    s_addc_u32 s25, s25, 0
    v_mfma_f32_16x16x32_bf16 v[84:87], v[168:171], a[116:119], v[84:87]
    v_mfma_f32_16x16x32_bf16 v[56:59], v[172:175], a[52:55], v[56:59]
    v_mfma_f32_16x16x32_bf16 v[88:91], v[172:175], a[116:119], v[88:91]
    v_mfma_f32_16x16x32_bf16 v[60:63], v[176:179], a[52:55], v[60:63]
    v_mfma_f32_16x16x32_bf16 v[92:95], v[176:179], a[116:119], v[92:95]
    v_mfma_f32_16x16x32_bf16 v[100:103], v[180:183], v[28:31], v[100:103]
    s_waitcnt vmcnt(26) lgkmcnt(0)
    v_mfma_f32_16x16x32_bf16 v[32:35], v[104:107], a[56:59], v[32:35]
    ds_read_b64_tr_b16 v[144:145], v9 offset:61440
    ds_read_b64_tr_b16 v[146:147], v9 offset:63488
    v_mfma_f32_16x16x32_bf16 v[64:67], v[104:107], a[120:123], v[64:67]
    ds_read_b64_tr_b16 v[148:149], v10 offset:61440
    ds_read_b64_tr_b16 v[150:151], v10 offset:63488
    v_mfma_f32_16x16x32_bf16 v[36:39], v[108:111], a[56:59], v[36:39]
    ds_read_b64_tr_b16 v[152:153], v11 offset:61440
    ds_read_b64_tr_b16 v[154:155], v11 offset:63488
    v_mfma_f32_16x16x32_bf16 v[68:71], v[108:111], a[120:123], v[68:71]
    ds_read_b64_tr_b16 v[156:157], v12 offset:61440
    ds_read_b64_tr_b16 v[158:159], v12 offset:63488
    v_mfma_f32_16x16x32_bf16 v[40:43], v[112:115], a[56:59], v[40:43]
    ds_read_b64_tr_b16 v[160:161], v23 offset:61440
    ds_read_b64_tr_b16 v[162:163], v23 offset:63488
    v_mfma_f32_16x16x32_bf16 v[72:75], v[112:115], a[120:123], v[72:75]
    ds_read_b64_tr_b16 v[164:165], v19 offset:61440
    ds_read_b64_tr_b16 v[166:167], v19 offset:63488
    v_mfma_f32_16x16x32_bf16 v[44:47], v[116:119], a[56:59], v[44:47]
    ds_read_b64_tr_b16 v[168:169], v20 offset:61440
    ds_read_b64_tr_b16 v[170:171], v20 offset:63488
    v_mfma_f32_16x16x32_bf16 v[76:79], v[116:119], a[120:123], v[76:79]
    ds_read_b64_tr_b16 v[172:173], v21 offset:61440
    ds_read_b64_tr_b16 v[174:175], v21 offset:63488
    v_mfma_f32_16x16x32_bf16 v[96:99], v[120:123], v[28:31], v[96:99]
    ds_read_b64_tr_b16 v[176:177], v22 offset:61440
    ds_read_b64_tr_b16 v[178:179], v22 offset:63488
    v_mfma_f32_16x16x32_bf16 v[48:51], v[124:127], a[56:59], v[48:51]
    ds_read_b64_tr_b16 v[180:181], v24 offset:61440
    ds_read_b64_tr_b16 v[182:183], v24 offset:63488
    v_mfma_f32_16x16x32_bf16 v[80:83], v[124:127], a[120:123], v[80:83]
    global_load_dwordx4 a[224:227], v0, s[24:25]
    s_add_u32 s24, s24, 16384
    s_addc_u32 s25, s25, 0
    global_load_dwordx4 a[228:231], v0, s[24:25]
    s_add_u32 s24, s24, 16384
    s_addc_u32 s25, s25, 0
    v_mfma_f32_16x16x32_bf16 v[52:55], v[128:131], a[56:59], v[52:55]
    global_load_dwordx4 a[232:235], v0, s[24:25]
    s_add_u32 s24, s24, 16384
    s_addc_u32 s25, s25, 0
    global_load_dwordx4 a[236:239], v0, s[24:25]
    s_add_u32 s24, s24, 16384
    s_addc_u32 s25, s25, 0
    v_mfma_f32_16x16x32_bf16 v[84:87], v[128:131], a[120:123], v[84:87]
    v_mfma_f32_16x16x32_bf16 v[56:59], v[132:135], a[56:59], v[56:59]
    v_mfma_f32_16x16x32_bf16 v[88:91], v[132:135], a[120:123], v[88:91]
    v_mfma_f32_16x16x32_bf16 v[60:63], v[136:139], a[56:59], v[60:63]
    v_mfma_f32_16x16x32_bf16 v[92:95], v[136:139], a[120:123], v[92:95]
    v_mfma_f32_16x16x32_bf16 v[100:103], v[140:143], v[28:31], v[100:103]
    s_waitcnt vmcnt(28) lgkmcnt(0)
    v_mfma_f32_16x16x32_bf16 v[32:35], v[144:147], a[60:63], v[32:35]
    global_load_dwordx4 a[240:243], v0, s[24:25]
    s_add_u32 s24, s24, 16384
    s_addc_u32 s25, s25, 0
    global_load_dwordx4 a[244:247], v0, s[24:25]
    s_add_u32 s24, s24, 16384
    s_addc_u32 s25, s25, 0
    v_mfma_f32_16x16x32_bf16 v[64:67], v[144:147], a[124:127], v[64:67]
    global_load_dwordx4 a[248:251], v0, s[24:25]
    s_add_u32 s24, s24, 16384
    s_addc_u32 s25, s25, 0
    global_load_dwordx4 a[252:255], v0, s[24:25]
    s_add_u32 s24, s24, 16384
    s_addc_u32 s25, s25, 0
    v_mfma_f32_16x16x32_bf16 v[36:39], v[148:151], a[60:63], v[36:39]
    v_mfma_f32_16x16x32_bf16 v[68:71], v[148:151], a[124:127], v[68:71]
    v_mfma_f32_16x16x32_bf16 v[40:43], v[152:155], a[60:63], v[40:43]
    v_mfma_f32_16x16x32_bf16 v[72:75], v[152:155], a[124:127], v[72:75]
    v_mfma_f32_16x16x32_bf16 v[44:47], v[156:159], a[60:63], v[44:47]
    v_mfma_f32_16x16x32_bf16 v[76:79], v[156:159], a[124:127], v[76:79]
    v_mfma_f32_16x16x32_bf16 v[96:99], v[160:163], v[28:31], v[96:99]
    v_mfma_f32_16x16x32_bf16 v[48:51], v[164:167], a[60:63], v[48:51]
    v_mfma_f32_16x16x32_bf16 v[80:83], v[164:167], a[124:127], v[80:83]
    v_mfma_f32_16x16x32_bf16 v[52:55], v[168:171], a[60:63], v[52:55]
    v_mfma_f32_16x16x32_bf16 v[84:87], v[168:171], a[124:127], v[84:87]
    v_mfma_f32_16x16x32_bf16 v[56:59], v[172:175], a[60:63], v[56:59]
    v_mfma_f32_16x16x32_bf16 v[88:91], v[172:175], a[124:127], v[88:91]
    v_mfma_f32_16x16x32_bf16 v[60:63], v[176:179], a[60:63], v[60:63]
    v_mfma_f32_16x16x32_bf16 v[92:95], v[176:179], a[124:127], v[92:95]
    v_mfma_f32_16x16x32_bf16 v[100:103], v[180:183], v[28:31], v[100:103]
    v_add_u32 v26, 151552, v5
    s_lshl_b32 s10, s3, 10
    v_add_u32 v27, s10, v26
    ds_write_b128 v27, v[96:99] offset:0
    s_nop 3
    ds_write_b128 v27, v[100:103] offset:4096
    s_waitcnt lgkmcnt(0)
    s_barrier
    v_mov_b32 v250, v14
    v_mov_b32 v251, v15
    v_mov_b32 v252, v16
    v_mov_b32 v253, v17
    v_mov_b32 v248, 0x3fb8aa3b
    v_lshlrev_b32 v10, 5, v8
    v_lshl_add_u32 v10, v7, 3, v10
    v_add_u32 v10, 147456, v10
    s_lshl_b32 s10, s45, 5
    s_and_b32 s11, s59, 7
    s_lshl_b32 s11, s11, 2
    s_add_u32 s10, s10, s11
    s_lshl_b32 s10, s10, 10
    s_add_u32 s10, s10, 6291456
    s_add_u32 s54, s38, s10
    s_addc_u32 s55, s39, 0
    v_add_u32 v12, 32768, v5
    s_lshl_b32 s10, s3, 5
    v_add_u32 v11, s10, v3
    v_lshlrev_b32 v11, 5, v11
    v_lshl_add_u32 v11, v4, 3, v11
    ds_read_b128 v[184:187], v26 offset:0
    ds_read_b64_tr_b16 v[200:201], v10 offset:0
    ds_read_b128 v[188:191], v26 offset:1024
    ds_read_b64_tr_b16 v[202:203], v10 offset:512
    ds_read_b128 v[192:195], v26 offset:2048
    ds_read_b64_tr_b16 v[204:205], v10 offset:1024
    ds_read_b128 v[196:199], v26 offset:3072
    ds_read_b64_tr_b16 v[206:207], v10 offset:1536
    s_waitcnt lgkmcnt(0)
    v_mul_f32 v32, v32, v252
    v_mul_f32 v64, v64, v250
    v_mul_f32 v36, v36, v252
    v_mul_f32 v68, v68, v250
    v_mul_f32 v33, v33, v252
    v_mul_f32 v65, v65, v250
    v_mul_f32 v37, v37, v252
    v_mul_f32 v69, v69, v250
    v_mul_f32 v34, v34, v252
    v_mul_f32 v66, v66, v250
    v_mul_f32 v38, v38, v252
    v_mul_f32 v70, v70, v250
    v_mul_f32 v35, v35, v252
    v_mul_f32 v67, v67, v250
    v_mul_f32 v39, v39, v252
    v_mul_f32 v71, v71, v250
    v_fma_f32 v32, -v184, v253, v32
    v_fma_f32 v64, -v184, v251, v64
    v_fma_f32 v36, -v188, v253, v36
    v_fma_f32 v68, -v188, v251, v68
    v_fma_f32 v33, -v185, v253, v33
    v_fma_f32 v65, -v185, v251, v65
    v_fma_f32 v37, -v189, v253, v37
    v_fma_f32 v69, -v189, v251, v69
    v_fma_f32 v34, -v186, v253, v34
    v_fma_f32 v66, -v186, v251, v66
    v_fma_f32 v38, -v190, v253, v38
    v_fma_f32 v70, -v190, v251, v70
    v_fma_f32 v35, -v187, v253, v35
    v_fma_f32 v67, -v187, v251, v67
    v_fma_f32 v39, -v191, v253, v39
    v_fma_f32 v71, -v191, v251, v71
    v_cvt_pk_bf16_f32 v208, v32, v33
    v_cvt_pk_bf16_f32 v104, v64, v65
    v_cvt_pk_bf16_f32 v210, v36, v37
    v_cvt_pk_bf16_f32 v106, v68, v69
    v_cvt_pk_bf16_f32 v209, v34, v35
    v_cvt_pk_bf16_f32 v105, v66, v67
    v_cvt_pk_bf16_f32 v211, v38, v39
    v_cvt_pk_bf16_f32 v107, v70, v71
    v_mfma_f32_16x16x16_bf16 v[212:215], v[200:201], v[208:209], 0
    v_mfma_f32_16x16x16_bf16 v[108:111], v[200:201], v[104:105], 0
    v_mfma_f32_16x16x16_bf16 v[216:219], v[202:203], v[210:211], 0
    v_mfma_f32_16x16x16_bf16 v[112:115], v[202:203], v[106:107], 0
    s_nop 4
    v_cvt_pk_bf16_f32 v212, 0, v212
    v_cvt_pk_bf16_f32 v108, 0, v108
    v_cvt_pk_bf16_f32 v213, 0, v213
    v_cvt_pk_bf16_f32 v109, 0, v109
    v_cvt_pk_bf16_f32 v214, 0, v214
    v_cvt_pk_bf16_f32 v110, 0, v110
    v_cvt_pk_bf16_f32 v215, 0, v215
    v_cvt_pk_bf16_f32 v111, 0, v111
    v_cvt_pk_bf16_f32 v216, 0, v216
    v_cvt_pk_bf16_f32 v112, 0, v112
    v_cvt_pk_bf16_f32 v217, 0, v217
    v_cvt_pk_bf16_f32 v113, 0, v113
    v_cvt_pk_bf16_f32 v218, 0, v218
    v_cvt_pk_bf16_f32 v114, 0, v114
    v_cvt_pk_bf16_f32 v219, 0, v219
    v_cvt_pk_bf16_f32 v115, 0, v115
    v_max3_f32 v236, v212, v213, v214
    v_max3_f32 v132, v108, v109, v110
    v_max3_f32 v237, -v212, -v213, -v214
    v_max3_f32 v133, -v108, -v109, -v110
    v_max3_f32 v238, v216, v217, v218
    v_max3_f32 v134, v112, v113, v114
    v_max3_f32 v239, -v216, -v217, -v218
    v_max3_f32 v135, -v112, -v113, -v114
    v_max_f32 v236, v236, v215
    v_max_f32 v132, v132, v111
    v_max_f32 v237, v237, -v215
    v_max_f32 v133, v133, -v111
    v_max_f32 v238, v238, v219
    v_max_f32 v134, v134, v115
    v_max_f32 v239, v239, -v219
    v_max_f32 v135, v135, -v115
    v_permlane32_swap_b32 v236, v237
    v_permlane32_swap_b32 v132, v133
    v_permlane32_swap_b32 v238, v239
    v_permlane32_swap_b32 v134, v135
    v_max_f32 v236, v236, v237
    v_max_f32 v132, v132, v133
    v_max_f32 v238, v238, v239
    v_max_f32 v134, v134, v135
    s_nop 0
    v_permlane16_swap_b32 v236, v238
    v_permlane16_swap_b32 v132, v134
    v_max_f32 v236, v236, v238
    v_max_f32 v132, v132, v134
    v_mov_b32 v238, v236
    v_mov_b32 v134, v132
    s_nop 0
    v_permlane16_swap_b32 v236, v238
    v_permlane16_swap_b32 v132, v134
    v_mov_b32 v237, v236
    v_mov_b32 v133, v132
    v_mov_b32 v239, v238
    v_mov_b32 v135, v134
    v_permlane32_swap_b32 v236, v237
    v_permlane32_swap_b32 v132, v133
    v_permlane32_swap_b32 v238, v239
    v_permlane32_swap_b32 v134, v135
    v_mul_f32 v236, v236, v248
    v_mul_f32 v132, v132, v248
    v_mul_f32 v237, v237, v248
    v_mul_f32 v133, v133, v248
    v_mul_f32 v238, v238, v248
    v_mul_f32 v134, v134, v248
    v_mul_f32 v239, v239, v248
    v_mul_f32 v135, v135, v248
    v_fma_f32 v220, v212, v248, -v236
    v_fma_f32 v116, v108, v248, -v132
    v_fma_f32 v224, -v212, v248, -v237
    v_fma_f32 v120, -v108, v248, -v133
    v_fma_f32 v221, v213, v248, -v236
    v_fma_f32 v117, v109, v248, -v132
    v_fma_f32 v225, -v213, v248, -v237
    v_fma_f32 v121, -v109, v248, -v133
    v_fma_f32 v222, v214, v248, -v236
    v_fma_f32 v118, v110, v248, -v132
    v_fma_f32 v226, -v214, v248, -v237
    v_fma_f32 v122, -v110, v248, -v133
    v_fma_f32 v223, v215, v248, -v236
    v_fma_f32 v119, v111, v248, -v132
    v_fma_f32 v227, -v215, v248, -v237
    v_fma_f32 v123, -v111, v248, -v133
    v_fma_f32 v228, v216, v248, -v238
    v_fma_f32 v124, v112, v248, -v134
    v_fma_f32 v232, -v216, v248, -v239
    v_fma_f32 v128, -v112, v248, -v135
    v_fma_f32 v229, v217, v248, -v238
    v_fma_f32 v125, v113, v248, -v134
    v_fma_f32 v233, -v217, v248, -v239
    v_fma_f32 v129, -v113, v248, -v135
    v_fma_f32 v230, v218, v248, -v238
    v_fma_f32 v126, v114, v248, -v134
    v_fma_f32 v234, -v218, v248, -v239
    v_fma_f32 v130, -v114, v248, -v135
    v_fma_f32 v231, v219, v248, -v238
    v_fma_f32 v127, v115, v248, -v134
    v_fma_f32 v235, -v219, v248, -v239
    v_fma_f32 v131, -v115, v248, -v135
    v_exp_f32 v220, v220
    v_exp_f32 v116, v116
    v_exp_f32 v221, v221
    v_exp_f32 v117, v117
    v_exp_f32 v222, v222
    v_exp_f32 v118, v118
    v_exp_f32 v223, v223
    v_exp_f32 v119, v119
    v_exp_f32 v224, v224
    v_exp_f32 v120, v120
    v_exp_f32 v225, v225
    v_exp_f32 v121, v121
    v_exp_f32 v226, v226
    v_exp_f32 v122, v122
    v_exp_f32 v227, v227
    v_exp_f32 v123, v123
    v_exp_f32 v228, v228
    v_exp_f32 v124, v124
    v_exp_f32 v229, v229
    v_exp_f32 v125, v125
    v_exp_f32 v230, v230
    v_exp_f32 v126, v126
    v_exp_f32 v231, v231
    v_exp_f32 v127, v127
    v_exp_f32 v232, v232
    v_exp_f32 v128, v128
    v_exp_f32 v233, v233
    v_exp_f32 v129, v129
    v_exp_f32 v234, v234
    v_exp_f32 v130, v130
    v_exp_f32 v235, v235
    v_exp_f32 v131, v131
    v_add_f32 v236, v220, v221
    v_add_f32 v132, v116, v117
    v_add_f32 v212, v222, v223
    v_add_f32 v108, v118, v119
    v_add_f32 v237, v224, v225
    v_add_f32 v133, v120, v121
    v_add_f32 v213, v226, v227
    v_add_f32 v109, v122, v123
    v_add_f32 v238, v228, v229
    v_add_f32 v134, v124, v125
    v_add_f32 v214, v230, v231
    v_add_f32 v110, v126, v127
    v_add_f32 v239, v232, v233
    v_add_f32 v135, v128, v129
    v_add_f32 v215, v234, v235
    v_add_f32 v111, v130, v131
    v_add_f32 v236, v236, v212
    v_add_f32 v132, v132, v108
    v_add_f32 v237, v237, v213
    v_add_f32 v133, v133, v109
    v_add_f32 v238, v238, v214
    v_add_f32 v134, v134, v110
    v_add_f32 v239, v239, v215
    v_add_f32 v135, v135, v111
    v_permlane32_swap_b32 v236, v237
    v_permlane32_swap_b32 v132, v133
    v_permlane32_swap_b32 v238, v239
    v_permlane32_swap_b32 v134, v135
    v_add_f32 v236, v236, v237
    v_add_f32 v132, v132, v133
    v_add_f32 v238, v238, v239
    v_add_f32 v134, v134, v135
    s_nop 0
    v_permlane16_swap_b32 v236, v238
    v_permlane16_swap_b32 v132, v134
    v_add_f32 v236, v236, v238
    v_add_f32 v132, v132, v134
    v_mov_b32 v238, v236
    v_mov_b32 v134, v132
    s_nop 0
    v_permlane16_swap_b32 v236, v238
    v_permlane16_swap_b32 v132, v134
    v_mov_b32 v237, v236
    v_mov_b32 v133, v132
    v_mov_b32 v239, v238
    v_mov_b32 v135, v134
    v_permlane32_swap_b32 v236, v237
    v_permlane32_swap_b32 v132, v133
    v_permlane32_swap_b32 v238, v239
    v_permlane32_swap_b32 v134, v135
    v_rcp_f32 v236, v236
    v_rcp_f32 v132, v132
    v_rcp_f32 v237, v237
    v_rcp_f32 v133, v133
    v_rcp_f32 v238, v238
    v_rcp_f32 v134, v134
    v_rcp_f32 v239, v239
    v_rcp_f32 v135, v135
    v_pk_mul_f32 v[220:221], v[220:221], v[236:237] op_sel:[0,0] op_sel_hi:[1,0]
    v_pk_mul_f32 v[116:117], v[116:117], v[132:133] op_sel:[0,0] op_sel_hi:[1,0]
    v_pk_mul_f32 v[222:223], v[222:223], v[236:237] op_sel:[0,0] op_sel_hi:[1,0]
    v_pk_mul_f32 v[118:119], v[118:119], v[132:133] op_sel:[0,0] op_sel_hi:[1,0]
    v_pk_mul_f32 v[224:225], v[224:225], v[236:237] op_sel:[0,1] op_sel_hi:[1,1]
    v_pk_mul_f32 v[120:121], v[120:121], v[132:133] op_sel:[0,1] op_sel_hi:[1,1]
    v_pk_mul_f32 v[226:227], v[226:227], v[236:237] op_sel:[0,1] op_sel_hi:[1,1]
    v_pk_mul_f32 v[122:123], v[122:123], v[132:133] op_sel:[0,1] op_sel_hi:[1,1]
    v_pk_mul_f32 v[228:229], v[228:229], v[238:239] op_sel:[0,0] op_sel_hi:[1,0]
    v_pk_mul_f32 v[124:125], v[124:125], v[134:135] op_sel:[0,0] op_sel_hi:[1,0]
    v_pk_mul_f32 v[230:231], v[230:231], v[238:239] op_sel:[0,0] op_sel_hi:[1,0]
    v_pk_mul_f32 v[126:127], v[126:127], v[134:135] op_sel:[0,0] op_sel_hi:[1,0]
    v_pk_mul_f32 v[232:233], v[232:233], v[238:239] op_sel:[0,1] op_sel_hi:[1,1]
    v_pk_mul_f32 v[128:129], v[128:129], v[134:135] op_sel:[0,1] op_sel_hi:[1,1]
    v_pk_mul_f32 v[234:235], v[234:235], v[238:239] op_sel:[0,1] op_sel_hi:[1,1]
    v_pk_mul_f32 v[130:131], v[130:131], v[134:135] op_sel:[0,1] op_sel_hi:[1,1]
    v_cvt_pk_bf16_f32 v240, v220, v221
    v_cvt_pk_bf16_f32 v136, v116, v117
    v_cvt_pk_bf16_f32 v241, v222, v223
    v_cvt_pk_bf16_f32 v137, v118, v119
    v_cvt_pk_bf16_f32 v242, v224, v225
    v_cvt_pk_bf16_f32 v138, v120, v121
    v_cvt_pk_bf16_f32 v243, v226, v227
    v_cvt_pk_bf16_f32 v139, v122, v123
    v_cvt_pk_bf16_f32 v244, v228, v229
    v_cvt_pk_bf16_f32 v140, v124, v125
    v_cvt_pk_bf16_f32 v245, v230, v231
    v_cvt_pk_bf16_f32 v141, v126, v127
    v_cvt_pk_bf16_f32 v246, v232, v233
    v_cvt_pk_bf16_f32 v142, v128, v129
    v_cvt_pk_bf16_f32 v247, v234, v235
    v_cvt_pk_bf16_f32 v143, v130, v131
    ds_write_b64 v11, v[240:241] offset:0
    ds_write_b64 v11, v[136:137] offset:512
    ds_write_b64 v11, v[242:243] offset:4096
    ds_write_b64 v11, v[138:139] offset:4608
    ds_write_b64 v11, v[244:245] offset:12288
    ds_write_b64 v11, v[140:141] offset:12800
    ds_write_b64 v11, v[246:247] offset:16384
    ds_write_b64 v11, v[142:143] offset:16896
    v_mul_f32 v40, v40, v252
    v_mul_f32 v72, v72, v250
    v_mul_f32 v44, v44, v252
    v_mul_f32 v76, v76, v250
    v_mul_f32 v41, v41, v252
    v_mul_f32 v73, v73, v250
    v_mul_f32 v45, v45, v252
    v_mul_f32 v77, v77, v250
    v_mul_f32 v42, v42, v252
    v_mul_f32 v74, v74, v250
    v_mul_f32 v46, v46, v252
    v_mul_f32 v78, v78, v250
    v_mul_f32 v43, v43, v252
    v_mul_f32 v75, v75, v250
    v_mul_f32 v47, v47, v252
    v_mul_f32 v79, v79, v250
    v_fma_f32 v40, -v192, v253, v40
    v_fma_f32 v72, -v192, v251, v72
    v_fma_f32 v44, -v196, v253, v44
    v_fma_f32 v76, -v196, v251, v76
    v_fma_f32 v41, -v193, v253, v41
    v_fma_f32 v73, -v193, v251, v73
    v_fma_f32 v45, -v197, v253, v45
    v_fma_f32 v77, -v197, v251, v77
    v_fma_f32 v42, -v194, v253, v42
    v_fma_f32 v74, -v194, v251, v74
    v_fma_f32 v46, -v198, v253, v46
    v_fma_f32 v78, -v198, v251, v78
    v_fma_f32 v43, -v195, v253, v43
    v_fma_f32 v75, -v195, v251, v75
    v_fma_f32 v47, -v199, v253, v47
    v_fma_f32 v79, -v199, v251, v79
    v_cvt_pk_bf16_f32 v208, v40, v41
    v_cvt_pk_bf16_f32 v104, v72, v73
    v_cvt_pk_bf16_f32 v210, v44, v45
    v_cvt_pk_bf16_f32 v106, v76, v77
    v_cvt_pk_bf16_f32 v209, v42, v43
    v_cvt_pk_bf16_f32 v105, v74, v75
    v_cvt_pk_bf16_f32 v211, v46, v47
    v_cvt_pk_bf16_f32 v107, v78, v79
    v_mfma_f32_16x16x16_bf16 v[212:215], v[204:205], v[208:209], 0
    v_mfma_f32_16x16x16_bf16 v[108:111], v[204:205], v[104:105], 0
    v_mfma_f32_16x16x16_bf16 v[216:219], v[206:207], v[210:211], 0
    v_mfma_f32_16x16x16_bf16 v[112:115], v[206:207], v[106:107], 0
    s_nop 4
    v_cvt_pk_bf16_f32 v212, 0, v212
    v_cvt_pk_bf16_f32 v108, 0, v108
    v_cvt_pk_bf16_f32 v213, 0, v213
    v_cvt_pk_bf16_f32 v109, 0, v109
    v_cvt_pk_bf16_f32 v214, 0, v214
    v_cvt_pk_bf16_f32 v110, 0, v110
    v_cvt_pk_bf16_f32 v215, 0, v215
    v_cvt_pk_bf16_f32 v111, 0, v111
    v_cvt_pk_bf16_f32 v216, 0, v216
    v_cvt_pk_bf16_f32 v112, 0, v112
    v_cvt_pk_bf16_f32 v217, 0, v217
    v_cvt_pk_bf16_f32 v113, 0, v113
    v_cvt_pk_bf16_f32 v218, 0, v218
    v_cvt_pk_bf16_f32 v114, 0, v114
    v_cvt_pk_bf16_f32 v219, 0, v219
    v_cvt_pk_bf16_f32 v115, 0, v115
    v_max3_f32 v236, v212, v213, v214
    v_max3_f32 v132, v108, v109, v110
    v_max3_f32 v237, -v212, -v213, -v214
    v_max3_f32 v133, -v108, -v109, -v110
    v_max3_f32 v238, v216, v217, v218
    v_max3_f32 v134, v112, v113, v114
    v_max3_f32 v239, -v216, -v217, -v218
    v_max3_f32 v135, -v112, -v113, -v114
    v_max_f32 v236, v236, v215
    v_max_f32 v132, v132, v111
    v_max_f32 v237, v237, -v215
    v_max_f32 v133, v133, -v111
    v_max_f32 v238, v238, v219
    v_max_f32 v134, v134, v115
    v_max_f32 v239, v239, -v219
    v_max_f32 v135, v135, -v115
    v_permlane32_swap_b32 v236, v237
    v_permlane32_swap_b32 v132, v133
    v_permlane32_swap_b32 v238, v239
    v_permlane32_swap_b32 v134, v135
    v_max_f32 v236, v236, v237
    v_max_f32 v132, v132, v133
    v_max_f32 v238, v238, v239
    v_max_f32 v134, v134, v135
    s_nop 0
    v_permlane16_swap_b32 v236, v238
    v_permlane16_swap_b32 v132, v134
    v_max_f32 v236, v236, v238
    v_max_f32 v132, v132, v134
    v_mov_b32 v238, v236
    v_mov_b32 v134, v132
    s_nop 0
    v_permlane16_swap_b32 v236, v238
    v_permlane16_swap_b32 v132, v134
    v_mov_b32 v237, v236
    v_mov_b32 v133, v132
    v_mov_b32 v239, v238
    v_mov_b32 v135, v134
    v_permlane32_swap_b32 v236, v237
    v_permlane32_swap_b32 v132, v133
    v_permlane32_swap_b32 v238, v239
    v_permlane32_swap_b32 v134, v135
    v_mul_f32 v236, v236, v248
    v_mul_f32 v132, v132, v248
    v_mul_f32 v237, v237, v248
    v_mul_f32 v133, v133, v248
    v_mul_f32 v238, v238, v248
    v_mul_f32 v134, v134, v248
    v_mul_f32 v239, v239, v248
    v_mul_f32 v135, v135, v248
    v_fma_f32 v220, v212, v248, -v236
    v_fma_f32 v116, v108, v248, -v132
    v_fma_f32 v224, -v212, v248, -v237
    v_fma_f32 v120, -v108, v248, -v133
    v_fma_f32 v221, v213, v248, -v236
    v_fma_f32 v117, v109, v248, -v132
    v_fma_f32 v225, -v213, v248, -v237
    v_fma_f32 v121, -v109, v248, -v133
    v_fma_f32 v222, v214, v248, -v236
    v_fma_f32 v118, v110, v248, -v132
    v_fma_f32 v226, -v214, v248, -v237
    v_fma_f32 v122, -v110, v248, -v133
    v_fma_f32 v223, v215, v248, -v236
    v_fma_f32 v119, v111, v248, -v132
    v_fma_f32 v227, -v215, v248, -v237
    v_fma_f32 v123, -v111, v248, -v133
    v_fma_f32 v228, v216, v248, -v238
    v_fma_f32 v124, v112, v248, -v134
    v_fma_f32 v232, -v216, v248, -v239
    v_fma_f32 v128, -v112, v248, -v135
    v_fma_f32 v229, v217, v248, -v238
    v_fma_f32 v125, v113, v248, -v134
    v_fma_f32 v233, -v217, v248, -v239
    v_fma_f32 v129, -v113, v248, -v135
    v_fma_f32 v230, v218, v248, -v238
    v_fma_f32 v126, v114, v248, -v134
    v_fma_f32 v234, -v218, v248, -v239
    v_fma_f32 v130, -v114, v248, -v135
    v_fma_f32 v231, v219, v248, -v238
    v_fma_f32 v127, v115, v248, -v134
    v_fma_f32 v235, -v219, v248, -v239
    v_fma_f32 v131, -v115, v248, -v135
    v_exp_f32 v220, v220
    v_exp_f32 v116, v116
    v_exp_f32 v221, v221
    v_exp_f32 v117, v117
    v_exp_f32 v222, v222
    v_exp_f32 v118, v118
    v_exp_f32 v223, v223
    v_exp_f32 v119, v119
    v_exp_f32 v224, v224
    v_exp_f32 v120, v120
    v_exp_f32 v225, v225
    v_exp_f32 v121, v121
    v_exp_f32 v226, v226
    v_exp_f32 v122, v122
    v_exp_f32 v227, v227
    v_exp_f32 v123, v123
    v_exp_f32 v228, v228
    v_exp_f32 v124, v124
    v_exp_f32 v229, v229
    v_exp_f32 v125, v125
    v_exp_f32 v230, v230
    v_exp_f32 v126, v126
    v_exp_f32 v231, v231
    v_exp_f32 v127, v127
    v_exp_f32 v232, v232
    v_exp_f32 v128, v128
    v_exp_f32 v233, v233
    v_exp_f32 v129, v129
    v_exp_f32 v234, v234
    v_exp_f32 v130, v130
    v_exp_f32 v235, v235
    v_exp_f32 v131, v131
    v_add_f32 v236, v220, v221
    v_add_f32 v132, v116, v117
    v_add_f32 v212, v222, v223
    v_add_f32 v108, v118, v119
    v_add_f32 v237, v224, v225
    v_add_f32 v133, v120, v121
    v_add_f32 v213, v226, v227
    v_add_f32 v109, v122, v123
    v_add_f32 v238, v228, v229
    v_add_f32 v134, v124, v125
    v_add_f32 v214, v230, v231
    v_add_f32 v110, v126, v127
    v_add_f32 v239, v232, v233
    v_add_f32 v135, v128, v129
    v_add_f32 v215, v234, v235
    v_add_f32 v111, v130, v131
    v_add_f32 v236, v236, v212
    v_add_f32 v132, v132, v108
    v_add_f32 v237, v237, v213
    v_add_f32 v133, v133, v109
    v_add_f32 v238, v238, v214
    v_add_f32 v134, v134, v110
    v_add_f32 v239, v239, v215
    v_add_f32 v135, v135, v111
    v_permlane32_swap_b32 v236, v237
    v_permlane32_swap_b32 v132, v133
    v_permlane32_swap_b32 v238, v239
    v_permlane32_swap_b32 v134, v135
    v_add_f32 v236, v236, v237
    v_add_f32 v132, v132, v133
    v_add_f32 v238, v238, v239
    v_add_f32 v134, v134, v135
    s_nop 0
    v_permlane16_swap_b32 v236, v238
    v_permlane16_swap_b32 v132, v134
    v_add_f32 v236, v236, v238
    v_add_f32 v132, v132, v134
    v_mov_b32 v238, v236
    v_mov_b32 v134, v132
    s_nop 0
    v_permlane16_swap_b32 v236, v238
    v_permlane16_swap_b32 v132, v134
    v_mov_b32 v237, v236
    v_mov_b32 v133, v132
    v_mov_b32 v239, v238
    v_mov_b32 v135, v134
    v_permlane32_swap_b32 v236, v237
    v_permlane32_swap_b32 v132, v133
    v_permlane32_swap_b32 v238, v239
    v_permlane32_swap_b32 v134, v135
    v_rcp_f32 v236, v236
    v_rcp_f32 v132, v132
    v_rcp_f32 v237, v237
    v_rcp_f32 v133, v133
    v_rcp_f32 v238, v238
    v_rcp_f32 v134, v134
    v_rcp_f32 v239, v239
    v_rcp_f32 v135, v135
    v_pk_mul_f32 v[220:221], v[220:221], v[236:237] op_sel:[0,0] op_sel_hi:[1,0]
    v_pk_mul_f32 v[116:117], v[116:117], v[132:133] op_sel:[0,0] op_sel_hi:[1,0]
    v_pk_mul_f32 v[222:223], v[222:223], v[236:237] op_sel:[0,0] op_sel_hi:[1,0]
    v_pk_mul_f32 v[118:119], v[118:119], v[132:133] op_sel:[0,0] op_sel_hi:[1,0]
    v_pk_mul_f32 v[224:225], v[224:225], v[236:237] op_sel:[0,1] op_sel_hi:[1,1]
    v_pk_mul_f32 v[120:121], v[120:121], v[132:133] op_sel:[0,1] op_sel_hi:[1,1]
    v_pk_mul_f32 v[226:227], v[226:227], v[236:237] op_sel:[0,1] op_sel_hi:[1,1]
    v_pk_mul_f32 v[122:123], v[122:123], v[132:133] op_sel:[0,1] op_sel_hi:[1,1]
    v_pk_mul_f32 v[228:229], v[228:229], v[238:239] op_sel:[0,0] op_sel_hi:[1,0]
    v_pk_mul_f32 v[124:125], v[124:125], v[134:135] op_sel:[0,0] op_sel_hi:[1,0]
    v_pk_mul_f32 v[230:231], v[230:231], v[238:239] op_sel:[0,0] op_sel_hi:[1,0]
    v_pk_mul_f32 v[126:127], v[126:127], v[134:135] op_sel:[0,0] op_sel_hi:[1,0]
    v_pk_mul_f32 v[232:233], v[232:233], v[238:239] op_sel:[0,1] op_sel_hi:[1,1]
    v_pk_mul_f32 v[128:129], v[128:129], v[134:135] op_sel:[0,1] op_sel_hi:[1,1]
    v_pk_mul_f32 v[234:235], v[234:235], v[238:239] op_sel:[0,1] op_sel_hi:[1,1]
    v_pk_mul_f32 v[130:131], v[130:131], v[134:135] op_sel:[0,1] op_sel_hi:[1,1]
    v_cvt_pk_bf16_f32 v240, v220, v221
    v_cvt_pk_bf16_f32 v136, v116, v117
    v_cvt_pk_bf16_f32 v241, v222, v223
    v_cvt_pk_bf16_f32 v137, v118, v119
    v_cvt_pk_bf16_f32 v242, v224, v225
    v_cvt_pk_bf16_f32 v138, v120, v121
    v_cvt_pk_bf16_f32 v243, v226, v227
    v_cvt_pk_bf16_f32 v139, v122, v123
    v_cvt_pk_bf16_f32 v244, v228, v229
    v_cvt_pk_bf16_f32 v140, v124, v125
    v_cvt_pk_bf16_f32 v245, v230, v231
    v_cvt_pk_bf16_f32 v141, v126, v127
    v_cvt_pk_bf16_f32 v246, v232, v233
    v_cvt_pk_bf16_f32 v142, v128, v129
    v_cvt_pk_bf16_f32 v247, v234, v235
    v_cvt_pk_bf16_f32 v143, v130, v131
    ds_write_b64 v11, v[240:241] offset:24576
    ds_write_b64 v11, v[136:137] offset:25088
    ds_write_b64 v11, v[242:243] offset:28672
    ds_write_b64 v11, v[138:139] offset:29184
    ds_write_b64 v11, v[244:245] offset:36864
    ds_write_b64 v11, v[140:141] offset:37376
    ds_write_b64 v11, v[246:247] offset:40960
    ds_write_b64 v11, v[142:143] offset:41472
    ds_read_b128 v[184:187], v26 offset:4096
    ds_read_b128 v[188:191], v26 offset:5120
    ds_read_b128 v[192:195], v26 offset:6144
    ds_read_b128 v[196:199], v26 offset:7168
    s_waitcnt lgkmcnt(0)
    v_mul_f32 v48, v48, v252
    v_mul_f32 v52, v52, v252
    v_mul_f32 v56, v56, v252
    v_mul_f32 v60, v60, v252
    v_mul_f32 v49, v49, v252
    v_mul_f32 v53, v53, v252
    v_mul_f32 v57, v57, v252
    v_mul_f32 v61, v61, v252
    v_mul_f32 v50, v50, v252
    v_mul_f32 v54, v54, v252
    v_mul_f32 v58, v58, v252
    v_mul_f32 v62, v62, v252
    v_mul_f32 v51, v51, v252
    v_mul_f32 v55, v55, v252
    v_mul_f32 v59, v59, v252
    v_mul_f32 v63, v63, v252
    v_fma_f32 v48, -v184, v253, v48
    v_fma_f32 v52, -v188, v253, v52
    v_fma_f32 v56, -v192, v253, v56
    v_fma_f32 v60, -v196, v253, v60
    v_fma_f32 v49, -v185, v253, v49
    v_fma_f32 v53, -v189, v253, v53
    v_fma_f32 v57, -v193, v253, v57
    v_fma_f32 v61, -v197, v253, v61
    v_fma_f32 v50, -v186, v253, v50
    v_fma_f32 v54, -v190, v253, v54
    v_fma_f32 v58, -v194, v253, v58
    v_fma_f32 v62, -v198, v253, v62
    v_fma_f32 v51, -v187, v253, v51
    v_fma_f32 v55, -v191, v253, v55
    v_fma_f32 v59, -v195, v253, v59
    v_fma_f32 v63, -v199, v253, v63
    v_cvt_pk_bf16_f32 v220, v48, v49
    v_cvt_pk_bf16_f32 v222, v52, v53
    v_cvt_pk_bf16_f32 v224, v56, v57
    v_cvt_pk_bf16_f32 v226, v60, v61
    v_cvt_pk_bf16_f32 v221, v50, v51
    v_cvt_pk_bf16_f32 v223, v54, v55
    v_cvt_pk_bf16_f32 v225, v58, v59
    v_cvt_pk_bf16_f32 v227, v62, v63
    ds_write_b64 v11, v[220:221] offset:8192
    ds_write_b64 v11, v[222:223] offset:20480
    ds_write_b64 v11, v[224:225] offset:32768
    ds_write_b64 v11, v[226:227] offset:45056
    v_mul_f32 v80, v80, v250
    v_mul_f32 v84, v84, v250
    v_mul_f32 v88, v88, v250
    v_mul_f32 v92, v92, v250
    v_mul_f32 v81, v81, v250
    v_mul_f32 v85, v85, v250
    v_mul_f32 v89, v89, v250
    v_mul_f32 v93, v93, v250
    v_mul_f32 v82, v82, v250
    v_mul_f32 v86, v86, v250
    v_mul_f32 v90, v90, v250
    v_mul_f32 v94, v94, v250
    v_mul_f32 v83, v83, v250
    v_mul_f32 v87, v87, v250
    v_mul_f32 v91, v91, v250
    v_mul_f32 v95, v95, v250
    v_fma_f32 v80, -v184, v251, v80
    v_fma_f32 v84, -v188, v251, v84
    v_fma_f32 v88, -v192, v251, v88
    v_fma_f32 v92, -v196, v251, v92
    v_fma_f32 v81, -v185, v251, v81
    v_fma_f32 v85, -v189, v251, v85
    v_fma_f32 v89, -v193, v251, v89
    v_fma_f32 v93, -v197, v251, v93
    v_fma_f32 v82, -v186, v251, v82
    v_fma_f32 v86, -v190, v251, v86
    v_fma_f32 v90, -v194, v251, v90
    v_fma_f32 v94, -v198, v251, v94
    v_fma_f32 v83, -v187, v251, v83
    v_fma_f32 v87, -v191, v251, v87
    v_fma_f32 v91, -v195, v251, v91
    v_fma_f32 v95, -v199, v251, v95
    v_cvt_pk_bf16_f32 v228, v80, v81
    v_cvt_pk_bf16_f32 v230, v84, v85
    v_cvt_pk_bf16_f32 v232, v88, v89
    v_cvt_pk_bf16_f32 v234, v92, v93
    v_cvt_pk_bf16_f32 v229, v82, v83
    v_cvt_pk_bf16_f32 v231, v86, v87
    v_cvt_pk_bf16_f32 v233, v90, v91
    v_cvt_pk_bf16_f32 v235, v94, v95
    ds_write_b64 v11, v[228:229] offset:8704
    ds_write_b64 v11, v[230:231] offset:20992
    ds_write_b64 v11, v[232:233] offset:33280
    ds_write_b64 v11, v[234:235] offset:45568
    s_waitcnt lgkmcnt(0)
    s_barrier
    s_mul_i32 s12, s3, 12288
    v_lshlrev_b32 v24, 5, v8
    v_lshl_add_u32 v24, v7, 3, v24
    v_add_u32 v24, s12, v24
    ds_read_b64_tr_b16 v[104:105], v24 offset:0
    ds_read_b64_tr_b16 v[120:121], v24 offset:4096
    ds_read_b64_tr_b16 v[136:137], v24 offset:8192
    ds_read_b64_tr_b16 v[106:107], v24 offset:512
    ds_read_b64_tr_b16 v[122:123], v24 offset:4608
    ds_read_b64_tr_b16 v[138:139], v24 offset:8704
    ds_read_b64_tr_b16 v[108:109], v24 offset:1024
    ds_read_b64_tr_b16 v[124:125], v24 offset:5120
    ds_read_b64_tr_b16 v[140:141], v24 offset:9216
    ds_read_b64_tr_b16 v[110:111], v24 offset:1536
    ds_read_b64_tr_b16 v[126:127], v24 offset:5632
    ds_read_b64_tr_b16 v[142:143], v24 offset:9728
    ds_read_b64_tr_b16 v[112:113], v24 offset:2048
    ds_read_b64_tr_b16 v[128:129], v24 offset:6144
    ds_read_b64_tr_b16 v[144:145], v24 offset:10240
    ds_read_b64_tr_b16 v[114:115], v24 offset:2560
    ds_read_b64_tr_b16 v[130:131], v24 offset:6656
    ds_read_b64_tr_b16 v[146:147], v24 offset:10752
    ds_read_b64_tr_b16 v[116:117], v24 offset:3072
    ds_read_b64_tr_b16 v[132:133], v24 offset:7168
    ds_read_b64_tr_b16 v[148:149], v24 offset:11264
    ds_read_b64_tr_b16 v[118:119], v24 offset:3584
    ds_read_b64_tr_b16 v[134:135], v24 offset:7680
    ds_read_b64_tr_b16 v[150:151], v24 offset:11776
    s_lshl_b32 s10, s59, 2
    s_add_u32 s10, s10, s3
    s_lshl_b32 s14, s10, 11
    s_add_u32 s14, s14, 17956864
    s_add_u32 s54, s38, s14
    s_addc_u32 s55, s39, 0
    s_lshl_b32 s14, s10, 7
    s_add_u32 s14, s14, 18022400
    s_add_u32 s56, s38, s14
    s_addc_u32 s57, s39, 0
    v_lshlrev_b32 v25, 2, v1
    s_waitcnt lgkmcnt(0)
    s_barrier
    v_mfma_f32_16x16x32_bf16 v[32:35], v[104:107], v[136:139], 0
    v_mfma_f32_16x16x32_bf16 v[40:43], v[28:31], v[104:107], 0
    v_mfma_f32_16x16x32_bf16 v[36:39], v[120:123], v[136:139], 0
    v_mfma_f32_16x16x32_bf16 v[44:47], v[28:31], v[120:123], 0
    v_mfma_f32_16x16x32_bf16 v[32:35], v[108:111], v[140:143], v[32:35]
    v_mfma_f32_16x16x32_bf16 v[40:43], v[28:31], v[108:111], v[40:43]
    v_mfma_f32_16x16x32_bf16 v[36:39], v[124:127], v[140:143], v[36:39]
    v_mfma_f32_16x16x32_bf16 v[44:47], v[28:31], v[124:127], v[44:47]
    v_mfma_f32_16x16x32_bf16 v[32:35], v[112:115], v[144:147], v[32:35]
    v_mfma_f32_16x16x32_bf16 v[40:43], v[28:31], v[112:115], v[40:43]
    v_mfma_f32_16x16x32_bf16 v[36:39], v[128:131], v[144:147], v[36:39]
    v_mfma_f32_16x16x32_bf16 v[44:47], v[28:31], v[128:131], v[44:47]
    v_mfma_f32_16x16x32_bf16 v[32:35], v[116:119], v[148:151], v[32:35]
    v_mfma_f32_16x16x32_bf16 v[40:43], v[28:31], v[116:119], v[40:43]
    v_mfma_f32_16x16x32_bf16 v[36:39], v[132:135], v[148:151], v[36:39]
    v_mfma_f32_16x16x32_bf16 v[44:47], v[28:31], v[132:135], v[44:47]
    s_nop 4
    global_atomic_add_f32 v25, v32, s[54:55] offset:0
    global_atomic_add_f32 v25, v33, s[54:55] offset:256
    global_atomic_add_f32 v25, v34, s[54:55] offset:512
    global_atomic_add_f32 v25, v35, s[54:55] offset:768
    global_atomic_add_f32 v25, v36, s[54:55] offset:1024
    global_atomic_add_f32 v25, v37, s[54:55] offset:1280
    global_atomic_add_f32 v25, v38, s[54:55] offset:1536
    global_atomic_add_f32 v25, v39, s[54:55] offset:1792
    s_mov_b64 exec, 0xffff
    global_atomic_add_f32 v25, v40, s[56:57]
    global_atomic_add_f32 v25, v44, s[56:57] offset:64
    s_mov_b64 exec, -1
    s_waitcnt vmcnt(0)
    s_branch p1d_interleave_layers__linear_kernel_hedgehog__mixer_channel_mlp__prompt_kernel_93
p1q_interleave_layers__linear_kernel_hedgehog__mixer_channel_mlp__prompt_kernel_92:
    s_nop 15
    s_nop 3
    s_lshl_b32 s10, s58, 3
    s_lshl_b32 s11, s3, 1
    s_add_u32 s45, s10, s11
    s_lshl_b32 s12, s45, 14
    s_add_u32 s12, s12, 4194304
    s_add_u32 s46, s38, s12
    s_addc_u32 s47, s39, 0
    v_add_u32 v25, 16384, v5
    s_lshl_b32 s10, s45, 11
    s_add_u32 s10, s10, 18350080
    s_add_u32 s50, s38, s10
    s_addc_u32 s51, s39, 0
    v_lshrrev_b32 v16, 1, v3
    s_and_b32 s10, s3, 1
    s_lshl_b32 s10, s10, 2
    v_add_u32 v0, s10, v4
    v_xor_b32 v0, v16, v0
    v_and_b32 v17, 1, v1
    v_lshlrev_b32 v17, 4, v17
    v_lshl_add_u32 v17, v4, 10, v17
    v_lshl_add_u32 v0, v0, 5, v17
    s_lshl_b32 s10, s3, 12
    s_lshr_b32 s11, s59, 2
    s_lshl_b32 s11, s11, 8
    s_add_u32 s10, s10, s11
    s_add_u32 s24, s22, s10
    s_addc_u32 s25, s23, 0
    v_lshrrev_b32 v16, 1, v8
    v_and_b32 v16, 3, v16
    v_lshlrev_b32 v18, 7, v8
    v_lshl_add_u32 v18, v7, 3, v18
    v_xor_b32 v17, 0, v16
    v_lshl_add_u32 v9, v17, 5, v18
    v_xor_b32 v17, 1, v16
    v_lshl_add_u32 v10, v17, 5, v18
    v_xor_b32 v17, 2, v16
    v_lshl_add_u32 v11, v17, 5, v18
    v_xor_b32 v17, 3, v16
    v_lshl_add_u32 v12, v17, 5, v18
    v_add_u32 v19, 65536, v9
    v_add_u32 v20, 65536, v10
    v_add_u32 v21, 65536, v11
    v_add_u32 v22, 65536, v12
    v_xor_b32 v17, s3, v16
    v_lshl_add_u32 v23, v17, 5, v18
    v_add_u32 v24, 65536, v23
    v_mov_b32 v28, 0x3f803f80
    v_mov_b32 v29, 0x3f803f80
    v_mov_b32 v30, 0x3f803f80
    v_mov_b32 v31, 0x3f803f80
    s_cmp_lg_u32 s3, 0
    s_cbranch_scc1 wt_interleave_layers__linear_kernel_hedgehog__mixer_channel_mlp__prompt_kernel_97
    s_mov_b64 exec, 0xffff
    s_lshl_b32 s10, s58, 10
    s_cmp_eq_u32 s61, 1
    s_cselect_b32 s11, 2, 1
    s_cselect_b32 s12, 4, 0
    s_cselect_b32 s13, 1, 16
    s_mul_i32 s13, s13, s8
    s_lshl_b32 s11, s11, 8
    s_add_u32 s10, s10, s11
    v_mul_u32_u24 v2, s12, v1
    v_add_u32 v2, s10, v2
    v_mov_b32 v27, s13
    s_mov_b32 s15, 0
pp_interleave_layers__linear_kernel_hedgehog__mixer_channel_mlp__prompt_kernel_98:
    global_load_dword v26, v2, s[62:63] sc1
    s_waitcnt vmcnt(0)
    v_cmp_gt_u32 vcc, v27, v26
    s_nop 4
    s_cbranch_vccz pq_interleave_layers__linear_kernel_hedgehog__mixer_channel_mlp__prompt_kernel_99
    s_sleep 1
    s_add_u32 s15, s15, 1
    s_cmp_lt_u32 s15, 400000
    s_cbranch_scc1 pp_interleave_layers__linear_kernel_hedgehog__mixer_channel_mlp__prompt_kernel_98
pq_interleave_layers__linear_kernel_hedgehog__mixer_channel_mlp__prompt_kernel_99:
    s_mov_b64 exec, -1
wt_interleave_layers__linear_kernel_hedgehog__mixer_channel_mlp__prompt_kernel_97:
    s_waitcnt vmcnt(0) lgkmcnt(0)
    s_barrier
    global_load_dwordx4 v[184:187], v5, s[50:51] offset:0 sc1
    global_load_dwordx4 v[192:195], v5, s[50:51] offset:2048 sc1
    global_load_dwordx4 a[0:3], v5, s[46:47] offset:0 sc1
    global_load_dwordx4 a[64:67], v25, s[46:47] offset:0 sc1
    global_load_dwordx4 a[4:7], v5, s[46:47] offset:1024 sc1
    global_load_dwordx4 a[68:71], v25, s[46:47] offset:1024 sc1
    global_load_dwordx4 a[8:11], v5, s[46:47] offset:2048 sc1
    global_load_dwordx4 a[72:75], v25, s[46:47] offset:2048 sc1
    global_load_dwordx4 a[12:15], v5, s[46:47] offset:3072 sc1
    global_load_dwordx4 a[76:79], v25, s[46:47] offset:3072 sc1
    s_add_u32 s46, s46, 4096
    s_addc_u32 s47, s47, 0
    global_load_dwordx4 a[16:19], v5, s[46:47] offset:0 sc1
    global_load_dwordx4 a[80:83], v25, s[46:47] offset:0 sc1
    global_load_dwordx4 a[20:23], v5, s[46:47] offset:1024 sc1
    global_load_dwordx4 a[84:87], v25, s[46:47] offset:1024 sc1
    global_load_dwordx4 a[24:27], v5, s[46:47] offset:2048 sc1
    global_load_dwordx4 a[88:91], v25, s[46:47] offset:2048 sc1
    global_load_dwordx4 a[28:31], v5, s[46:47] offset:3072 sc1
    global_load_dwordx4 a[92:95], v25, s[46:47] offset:3072 sc1
    s_add_u32 s46, s46, 4096
    s_addc_u32 s47, s47, 0
    ds_read_b64_tr_b16 v[104:105], v9 offset:0
    ds_read_b64_tr_b16 v[106:107], v9 offset:2048
    ds_read_b64_tr_b16 v[108:109], v10 offset:0
    ds_read_b64_tr_b16 v[110:111], v10 offset:2048
    ds_read_b64_tr_b16 v[112:113], v11 offset:0
    ds_read_b64_tr_b16 v[114:115], v11 offset:2048
    ds_read_b64_tr_b16 v[116:117], v12 offset:0
    ds_read_b64_tr_b16 v[118:119], v12 offset:2048
    ds_read_b64_tr_b16 v[120:121], v23 offset:0
    ds_read_b64_tr_b16 v[122:123], v23 offset:2048
    s_waitcnt vmcnt(16)
    v_pk_add_f32 v[184:185], v[184:185], v[186:187]
    v_pk_add_f32 v[192:193], v[192:193], v[194:195]
    s_nop 0
    v_permlane32_swap_b32 v184, v185
    v_permlane32_swap_b32 v192, v193
    v_add_f32 v184, v184, v185
    v_add_f32 v192, v192, v193
    s_nop 1
    v_permlane16_swap_b32 v184, v192
    v_add_f32 v184, v184, v192
    v_mov_b32 v192, v184
    s_nop 1
    v_permlane16_swap_b32 v184, v192
    v_mov_b32 v185, v184
    v_mov_b32 v193, v192
    s_nop 0
    v_permlane32_swap_b32 v184, v185
    v_permlane32_swap_b32 v192, v193
    v_mul_f32 v184, 0x3b000000, v184
    v_mul_f32 v192, 0x3b000000, v192
    v_mul_f32 v185, 0x3b000000, v185
    v_mul_f32 v193, 0x3b000000, v193
    v_fma_f32 v185, -v184, v184, v185
    v_fma_f32 v193, -v192, v192, v193
    v_max_f32 v185, 0, v185
    v_max_f32 v193, 0, v193
    v_cvt_pk_bf16_f32 v186, 0, v184
    v_cvt_pk_bf16_f32 v194, 0, v192
    v_cvt_pk_bf16_f32 v187, 0, v185
    v_cvt_pk_bf16_f32 v195, 0, v193
    v_add_f32 v187, 0x3727c5ac, v187
    v_add_f32 v195, 0x3727c5ac, v195
    v_cvt_pk_bf16_f32 v187, 0, v187
    v_cvt_pk_bf16_f32 v195, 0, v195
    v_sqrt_f32 v187, v187
    v_sqrt_f32 v195, v195
    v_cvt_pk_bf16_f32 v187, 0, v187
    v_cvt_pk_bf16_f32 v195, 0, v195
    v_rcp_f32 v16, v187
    v_rcp_f32 v14, v195
    v_mul_f32 v17, v186, v16
    v_mul_f32 v15, v194, v14
    s_waitcnt vmcnt(14) lgkmcnt(0)
    v_mfma_f32_16x16x32_bf16 v[32:35], v[104:107], a[0:3], 0
    ds_read_b64_tr_b16 v[144:145], v9 offset:4096
    ds_read_b64_tr_b16 v[146:147], v9 offset:6144
    v_mfma_f32_16x16x32_bf16 v[64:67], v[104:107], a[64:67], 0
    ds_read_b64_tr_b16 v[148:149], v10 offset:4096
    ds_read_b64_tr_b16 v[150:151], v10 offset:6144
    v_mfma_f32_16x16x32_bf16 v[36:39], v[108:111], a[0:3], 0
    ds_read_b64_tr_b16 v[152:153], v11 offset:4096
    ds_read_b64_tr_b16 v[154:155], v11 offset:6144
    v_mfma_f32_16x16x32_bf16 v[68:71], v[108:111], a[64:67], 0
    ds_read_b64_tr_b16 v[156:157], v12 offset:4096
    ds_read_b64_tr_b16 v[158:159], v12 offset:6144
    v_mfma_f32_16x16x32_bf16 v[40:43], v[112:115], a[0:3], 0
    ds_read_b64_tr_b16 v[160:161], v23 offset:4096
    ds_read_b64_tr_b16 v[162:163], v23 offset:6144
    v_mfma_f32_16x16x32_bf16 v[72:75], v[112:115], a[64:67], 0
    global_load_dwordx4 a[32:35], v5, s[46:47] offset:0 sc1
    global_load_dwordx4 a[96:99], v25, s[46:47] offset:0 sc1
    v_mfma_f32_16x16x32_bf16 v[44:47], v[116:119], a[0:3], 0
    v_mfma_f32_16x16x32_bf16 v[76:79], v[116:119], a[64:67], 0
    v_mfma_f32_16x16x32_bf16 v[96:99], v[120:123], v[28:31], 0
    s_waitcnt vmcnt(14) lgkmcnt(0)
    v_mfma_f32_16x16x32_bf16 v[32:35], v[144:147], a[4:7], v[32:35]
    ds_read_b64_tr_b16 v[104:105], v9 offset:8192
    ds_read_b64_tr_b16 v[106:107], v9 offset:10240
    v_mfma_f32_16x16x32_bf16 v[64:67], v[144:147], a[68:71], v[64:67]
    ds_read_b64_tr_b16 v[108:109], v10 offset:8192
    ds_read_b64_tr_b16 v[110:111], v10 offset:10240
    v_mfma_f32_16x16x32_bf16 v[36:39], v[148:151], a[4:7], v[36:39]
    ds_read_b64_tr_b16 v[112:113], v11 offset:8192
    ds_read_b64_tr_b16 v[114:115], v11 offset:10240
    v_mfma_f32_16x16x32_bf16 v[68:71], v[148:151], a[68:71], v[68:71]
    ds_read_b64_tr_b16 v[116:117], v12 offset:8192
    ds_read_b64_tr_b16 v[118:119], v12 offset:10240
    v_mfma_f32_16x16x32_bf16 v[40:43], v[152:155], a[4:7], v[40:43]
    ds_read_b64_tr_b16 v[120:121], v23 offset:8192
    ds_read_b64_tr_b16 v[122:123], v23 offset:10240
    v_mfma_f32_16x16x32_bf16 v[72:75], v[152:155], a[68:71], v[72:75]
    global_load_dwordx4 a[36:39], v5, s[46:47] offset:1024 sc1
    global_load_dwordx4 a[100:103], v25, s[46:47] offset:1024 sc1
    v_mfma_f32_16x16x32_bf16 v[44:47], v[156:159], a[4:7], v[44:47]
    v_mfma_f32_16x16x32_bf16 v[76:79], v[156:159], a[68:71], v[76:79]
    v_mfma_f32_16x16x32_bf16 v[96:99], v[160:163], v[28:31], v[96:99]
    s_waitcnt vmcnt(14) lgkmcnt(0)
    v_mfma_f32_16x16x32_bf16 v[32:35], v[104:107], a[8:11], v[32:35]
    ds_read_b64_tr_b16 v[144:145], v9 offset:12288
    ds_read_b64_tr_b16 v[146:147], v9 offset:14336
    v_mfma_f32_16x16x32_bf16 v[64:67], v[104:107], a[72:75], v[64:67]
    ds_read_b64_tr_b16 v[148:149], v10 offset:12288
    ds_read_b64_tr_b16 v[150:151], v10 offset:14336
    v_mfma_f32_16x16x32_bf16 v[36:39], v[108:111], a[8:11], v[36:39]
    ds_read_b64_tr_b16 v[152:153], v11 offset:12288
    ds_read_b64_tr_b16 v[154:155], v11 offset:14336
    v_mfma_f32_16x16x32_bf16 v[68:71], v[108:111], a[72:75], v[68:71]
    ds_read_b64_tr_b16 v[156:157], v12 offset:12288
    ds_read_b64_tr_b16 v[158:159], v12 offset:14336
    v_mfma_f32_16x16x32_bf16 v[40:43], v[112:115], a[8:11], v[40:43]
    ds_read_b64_tr_b16 v[160:161], v23 offset:12288
    ds_read_b64_tr_b16 v[162:163], v23 offset:14336
    v_mfma_f32_16x16x32_bf16 v[72:75], v[112:115], a[72:75], v[72:75]
    global_load_dwordx4 a[40:43], v5, s[46:47] offset:2048 sc1
    global_load_dwordx4 a[104:107], v25, s[46:47] offset:2048 sc1
    v_mfma_f32_16x16x32_bf16 v[44:47], v[116:119], a[8:11], v[44:47]
    v_mfma_f32_16x16x32_bf16 v[76:79], v[116:119], a[72:75], v[76:79]
    v_mfma_f32_16x16x32_bf16 v[96:99], v[120:123], v[28:31], v[96:99]
    s_waitcnt vmcnt(14) lgkmcnt(0)
    v_mfma_f32_16x16x32_bf16 v[32:35], v[144:147], a[12:15], v[32:35]
    ds_read_b64_tr_b16 v[104:105], v9 offset:16384
    ds_read_b64_tr_b16 v[106:107], v9 offset:18432
    v_mfma_f32_16x16x32_bf16 v[64:67], v[144:147], a[76:79], v[64:67]
    ds_read_b64_tr_b16 v[108:109], v10 offset:16384
    ds_read_b64_tr_b16 v[110:111], v10 offset:18432
    v_mfma_f32_16x16x32_bf16 v[36:39], v[148:151], a[12:15], v[36:39]
    ds_read_b64_tr_b16 v[112:113], v11 offset:16384
    ds_read_b64_tr_b16 v[114:115], v11 offset:18432
    v_mfma_f32_16x16x32_bf16 v[68:71], v[148:151], a[76:79], v[68:71]
    ds_read_b64_tr_b16 v[116:117], v12 offset:16384
    ds_read_b64_tr_b16 v[118:119], v12 offset:18432
    v_mfma_f32_16x16x32_bf16 v[40:43], v[152:155], a[12:15], v[40:43]
    ds_read_b64_tr_b16 v[120:121], v23 offset:16384
    ds_read_b64_tr_b16 v[122:123], v23 offset:18432
    v_mfma_f32_16x16x32_bf16 v[72:75], v[152:155], a[76:79], v[72:75]
    global_load_dwordx4 a[44:47], v5, s[46:47] offset:3072 sc1
    global_load_dwordx4 a[108:111], v25, s[46:47] offset:3072 sc1
    v_mfma_f32_16x16x32_bf16 v[44:47], v[156:159], a[12:15], v[44:47]
    s_add_u32 s46, s46, 4096
    s_addc_u32 s47, s47, 0
    v_mfma_f32_16x16x32_bf16 v[76:79], v[156:159], a[76:79], v[76:79]
    v_mfma_f32_16x16x32_bf16 v[96:99], v[160:163], v[28:31], v[96:99]
    s_waitcnt vmcnt(14) lgkmcnt(0)
    v_mfma_f32_16x16x32_bf16 v[32:35], v[104:107], a[16:19], v[32:35]
    ds_read_b64_tr_b16 v[144:145], v9 offset:20480
    ds_read_b64_tr_b16 v[146:147], v9 offset:22528
    v_mfma_f32_16x16x32_bf16 v[64:67], v[104:107], a[80:83], v[64:67]
    ds_read_b64_tr_b16 v[148:149], v10 offset:20480
    ds_read_b64_tr_b16 v[150:151], v10 offset:22528
    v_mfma_f32_16x16x32_bf16 v[36:39], v[108:111], a[16:19], v[36:39]
    ds_read_b64_tr_b16 v[152:153], v11 offset:20480
    ds_read_b64_tr_b16 v[154:155], v11 offset:22528
    v_mfma_f32_16x16x32_bf16 v[68:71], v[108:111], a[80:83], v[68:71]
    ds_read_b64_tr_b16 v[156:157], v12 offset:20480
    ds_read_b64_tr_b16 v[158:159], v12 offset:22528
    v_mfma_f32_16x16x32_bf16 v[40:43], v[112:115], a[16:19], v[40:43]
    ds_read_b64_tr_b16 v[160:161], v23 offset:20480
    ds_read_b64_tr_b16 v[162:163], v23 offset:22528
    v_mfma_f32_16x16x32_bf16 v[72:75], v[112:115], a[80:83], v[72:75]
    global_load_dwordx4 a[48:51], v5, s[46:47] offset:0 sc1
    global_load_dwordx4 a[112:115], v25, s[46:47] offset:0 sc1
    v_mfma_f32_16x16x32_bf16 v[44:47], v[116:119], a[16:19], v[44:47]
    v_mfma_f32_16x16x32_bf16 v[76:79], v[116:119], a[80:83], v[76:79]
    v_mfma_f32_16x16x32_bf16 v[96:99], v[120:123], v[28:31], v[96:99]
    s_waitcnt vmcnt(14) lgkmcnt(0)
    v_mfma_f32_16x16x32_bf16 v[32:35], v[144:147], a[20:23], v[32:35]
    ds_read_b64_tr_b16 v[104:105], v9 offset:24576
    ds_read_b64_tr_b16 v[106:107], v9 offset:26624
    v_mfma_f32_16x16x32_bf16 v[64:67], v[144:147], a[84:87], v[64:67]
    ds_read_b64_tr_b16 v[108:109], v10 offset:24576
    ds_read_b64_tr_b16 v[110:111], v10 offset:26624
    v_mfma_f32_16x16x32_bf16 v[36:39], v[148:151], a[20:23], v[36:39]
    ds_read_b64_tr_b16 v[112:113], v11 offset:24576
    ds_read_b64_tr_b16 v[114:115], v11 offset:26624
    v_mfma_f32_16x16x32_bf16 v[68:71], v[148:151], a[84:87], v[68:71]
    ds_read_b64_tr_b16 v[116:117], v12 offset:24576
    ds_read_b64_tr_b16 v[118:119], v12 offset:26624
    v_mfma_f32_16x16x32_bf16 v[40:43], v[152:155], a[20:23], v[40:43]
    ds_read_b64_tr_b16 v[120:121], v23 offset:24576
    ds_read_b64_tr_b16 v[122:123], v23 offset:26624
    v_mfma_f32_16x16x32_bf16 v[72:75], v[152:155], a[84:87], v[72:75]
    global_load_dwordx4 a[52:55], v5, s[46:47] offset:1024 sc1
    global_load_dwordx4 a[116:119], v25, s[46:47] offset:1024 sc1
    v_mfma_f32_16x16x32_bf16 v[44:47], v[156:159], a[20:23], v[44:47]
    v_mfma_f32_16x16x32_bf16 v[76:79], v[156:159], a[84:87], v[76:79]
    v_mfma_f32_16x16x32_bf16 v[96:99], v[160:163], v[28:31], v[96:99]
    s_waitcnt vmcnt(14) lgkmcnt(0)
    v_mfma_f32_16x16x32_bf16 v[32:35], v[104:107], a[24:27], v[32:35]
    ds_read_b64_tr_b16 v[144:145], v9 offset:28672
    ds_read_b64_tr_b16 v[146:147], v9 offset:30720
    v_mfma_f32_16x16x32_bf16 v[64:67], v[104:107], a[88:91], v[64:67]
    ds_read_b64_tr_b16 v[148:149], v10 offset:28672
    ds_read_b64_tr_b16 v[150:151], v10 offset:30720
    v_mfma_f32_16x16x32_bf16 v[36:39], v[108:111], a[24:27], v[36:39]
    ds_read_b64_tr_b16 v[152:153], v11 offset:28672
    ds_read_b64_tr_b16 v[154:155], v11 offset:30720
    v_mfma_f32_16x16x32_bf16 v[68:71], v[108:111], a[88:91], v[68:71]
    ds_read_b64_tr_b16 v[156:157], v12 offset:28672
    ds_read_b64_tr_b16 v[158:159], v12 offset:30720
    v_mfma_f32_16x16x32_bf16 v[40:43], v[112:115], a[24:27], v[40:43]
    ds_read_b64_tr_b16 v[160:161], v23 offset:28672
    ds_read_b64_tr_b16 v[162:163], v23 offset:30720
    v_mfma_f32_16x16x32_bf16 v[72:75], v[112:115], a[88:91], v[72:75]
    global_load_dwordx4 a[56:59], v5, s[46:47] offset:2048 sc1
    global_load_dwordx4 a[120:123], v25, s[46:47] offset:2048 sc1
    v_mfma_f32_16x16x32_bf16 v[44:47], v[116:119], a[24:27], v[44:47]
    v_mfma_f32_16x16x32_bf16 v[76:79], v[116:119], a[88:91], v[76:79]
    v_mfma_f32_16x16x32_bf16 v[96:99], v[120:123], v[28:31], v[96:99]
    s_waitcnt vmcnt(14) lgkmcnt(0)
    v_mfma_f32_16x16x32_bf16 v[32:35], v[144:147], a[28:31], v[32:35]
    ds_read_b64_tr_b16 v[104:105], v9 offset:32768
    ds_read_b64_tr_b16 v[106:107], v9 offset:34816
    v_mfma_f32_16x16x32_bf16 v[64:67], v[144:147], a[92:95], v[64:67]
    ds_read_b64_tr_b16 v[108:109], v10 offset:32768
    ds_read_b64_tr_b16 v[110:111], v10 offset:34816
    v_mfma_f32_16x16x32_bf16 v[36:39], v[148:151], a[28:31], v[36:39]
    ds_read_b64_tr_b16 v[112:113], v11 offset:32768
    ds_read_b64_tr_b16 v[114:115], v11 offset:34816
    v_mfma_f32_16x16x32_bf16 v[68:71], v[148:151], a[92:95], v[68:71]
    ds_read_b64_tr_b16 v[116:117], v12 offset:32768
    ds_read_b64_tr_b16 v[118:119], v12 offset:34816
    v_mfma_f32_16x16x32_bf16 v[40:43], v[152:155], a[28:31], v[40:43]
    ds_read_b64_tr_b16 v[120:121], v23 offset:32768
    ds_read_b64_tr_b16 v[122:123], v23 offset:34816
    v_mfma_f32_16x16x32_bf16 v[72:75], v[152:155], a[92:95], v[72:75]
    global_load_dwordx4 a[60:63], v5, s[46:47] offset:3072 sc1
    global_load_dwordx4 a[124:127], v25, s[46:47] offset:3072 sc1
    v_mfma_f32_16x16x32_bf16 v[44:47], v[156:159], a[28:31], v[44:47]
    s_add_u32 s46, s46, 4096
    s_addc_u32 s47, s47, 0
    v_mfma_f32_16x16x32_bf16 v[76:79], v[156:159], a[92:95], v[76:79]
    v_mfma_f32_16x16x32_bf16 v[96:99], v[160:163], v[28:31], v[96:99]
    s_waitcnt vmcnt(14) lgkmcnt(0)
    v_mfma_f32_16x16x32_bf16 v[32:35], v[104:107], a[32:35], v[32:35]
    ds_read_b64_tr_b16 v[144:145], v9 offset:36864
    ds_read_b64_tr_b16 v[146:147], v9 offset:38912
    v_mfma_f32_16x16x32_bf16 v[64:67], v[104:107], a[96:99], v[64:67]
    ds_read_b64_tr_b16 v[148:149], v10 offset:36864
    ds_read_b64_tr_b16 v[150:151], v10 offset:38912
    v_mfma_f32_16x16x32_bf16 v[36:39], v[108:111], a[32:35], v[36:39]
    ds_read_b64_tr_b16 v[152:153], v11 offset:36864
    ds_read_b64_tr_b16 v[154:155], v11 offset:38912
    v_mfma_f32_16x16x32_bf16 v[68:71], v[108:111], a[96:99], v[68:71]
    ds_read_b64_tr_b16 v[156:157], v12 offset:36864
    ds_read_b64_tr_b16 v[158:159], v12 offset:38912
    v_mfma_f32_16x16x32_bf16 v[40:43], v[112:115], a[32:35], v[40:43]
    ds_read_b64_tr_b16 v[160:161], v23 offset:36864
    ds_read_b64_tr_b16 v[162:163], v23 offset:38912
    v_mfma_f32_16x16x32_bf16 v[72:75], v[112:115], a[96:99], v[72:75]
    global_load_dwordx4 a[128:131], v0, s[24:25]
    s_add_u32 s24, s24, 16384
    s_addc_u32 s25, s25, 0
    global_load_dwordx4 a[132:135], v0, s[24:25]
    s_add_u32 s24, s24, 16384
    s_addc_u32 s25, s25, 0
    v_mfma_f32_16x16x32_bf16 v[44:47], v[116:119], a[32:35], v[44:47]
    global_load_dwordx4 a[136:139], v0, s[24:25]
    s_add_u32 s24, s24, 16384
    s_addc_u32 s25, s25, 0
    global_load_dwordx4 a[140:143], v0, s[24:25]
    s_add_u32 s24, s24, 16384
    s_addc_u32 s25, s25, 0
    v_mfma_f32_16x16x32_bf16 v[76:79], v[116:119], a[96:99], v[76:79]
    v_mfma_f32_16x16x32_bf16 v[96:99], v[120:123], v[28:31], v[96:99]
    s_waitcnt vmcnt(16) lgkmcnt(0)
    v_mfma_f32_16x16x32_bf16 v[32:35], v[144:147], a[36:39], v[32:35]
    ds_read_b64_tr_b16 v[104:105], v9 offset:40960
    ds_read_b64_tr_b16 v[106:107], v9 offset:43008
    v_mfma_f32_16x16x32_bf16 v[64:67], v[144:147], a[100:103], v[64:67]
    ds_read_b64_tr_b16 v[108:109], v10 offset:40960
    ds_read_b64_tr_b16 v[110:111], v10 offset:43008
    v_mfma_f32_16x16x32_bf16 v[36:39], v[148:151], a[36:39], v[36:39]
    ds_read_b64_tr_b16 v[112:113], v11 offset:40960
    ds_read_b64_tr_b16 v[114:115], v11 offset:43008
    v_mfma_f32_16x16x32_bf16 v[68:71], v[148:151], a[100:103], v[68:71]
    ds_read_b64_tr_b16 v[116:117], v12 offset:40960
    ds_read_b64_tr_b16 v[118:119], v12 offset:43008
    v_mfma_f32_16x16x32_bf16 v[40:43], v[152:155], a[36:39], v[40:43]
    ds_read_b64_tr_b16 v[120:121], v23 offset:40960
    ds_read_b64_tr_b16 v[122:123], v23 offset:43008
    v_mfma_f32_16x16x32_bf16 v[72:75], v[152:155], a[100:103], v[72:75]
    global_load_dwordx4 a[144:147], v0, s[24:25]
    s_add_u32 s24, s24, 16384
    s_addc_u32 s25, s25, 0
    global_load_dwordx4 a[148:151], v0, s[24:25]
    s_add_u32 s24, s24, 16384
    s_addc_u32 s25, s25, 0
    v_mfma_f32_16x16x32_bf16 v[44:47], v[156:159], a[36:39], v[44:47]
    global_load_dwordx4 a[152:155], v0, s[24:25]
    s_add_u32 s24, s24, 16384
    s_addc_u32 s25, s25, 0
    global_load_dwordx4 a[156:159], v0, s[24:25]
    s_add_u32 s24, s24, 16384
    s_addc_u32 s25, s25, 0
    v_mfma_f32_16x16x32_bf16 v[76:79], v[156:159], a[100:103], v[76:79]
    v_mfma_f32_16x16x32_bf16 v[96:99], v[160:163], v[28:31], v[96:99]
    s_waitcnt vmcnt(18) lgkmcnt(0)
    v_mfma_f32_16x16x32_bf16 v[32:35], v[104:107], a[40:43], v[32:35]
    ds_read_b64_tr_b16 v[144:145], v9 offset:45056
    ds_read_b64_tr_b16 v[146:147], v9 offset:47104
    v_mfma_f32_16x16x32_bf16 v[64:67], v[104:107], a[104:107], v[64:67]
    ds_read_b64_tr_b16 v[148:149], v10 offset:45056
    ds_read_b64_tr_b16 v[150:151], v10 offset:47104
    v_mfma_f32_16x16x32_bf16 v[36:39], v[108:111], a[40:43], v[36:39]
    ds_read_b64_tr_b16 v[152:153], v11 offset:45056
    ds_read_b64_tr_b16 v[154:155], v11 offset:47104
    v_mfma_f32_16x16x32_bf16 v[68:71], v[108:111], a[104:107], v[68:71]
    ds_read_b64_tr_b16 v[156:157], v12 offset:45056
    ds_read_b64_tr_b16 v[158:159], v12 offset:47104
    v_mfma_f32_16x16x32_bf16 v[40:43], v[112:115], a[40:43], v[40:43]
    ds_read_b64_tr_b16 v[160:161], v23 offset:45056
    ds_read_b64_tr_b16 v[162:163], v23 offset:47104
    v_mfma_f32_16x16x32_bf16 v[72:75], v[112:115], a[104:107], v[72:75]
    global_load_dwordx4 a[160:163], v0, s[24:25]
    s_add_u32 s24, s24, 16384
    s_addc_u32 s25, s25, 0
    global_load_dwordx4 a[164:167], v0, s[24:25]
    s_add_u32 s24, s24, 16384
    s_addc_u32 s25, s25, 0
    v_mfma_f32_16x16x32_bf16 v[44:47], v[116:119], a[40:43], v[44:47]
    global_load_dwordx4 a[168:171], v0, s[24:25]
    s_add_u32 s24, s24, 16384
    s_addc_u32 s25, s25, 0
    global_load_dwordx4 a[172:175], v0, s[24:25]
    s_add_u32 s24, s24, 16384
    s_addc_u32 s25, s25, 0
    v_mfma_f32_16x16x32_bf16 v[76:79], v[116:119], a[104:107], v[76:79]
    v_mfma_f32_16x16x32_bf16 v[96:99], v[120:123], v[28:31], v[96:99]
    s_waitcnt vmcnt(20) lgkmcnt(0)
    v_mfma_f32_16x16x32_bf16 v[32:35], v[144:147], a[44:47], v[32:35]
    ds_read_b64_tr_b16 v[104:105], v9 offset:49152
    ds_read_b64_tr_b16 v[106:107], v9 offset:51200
    v_mfma_f32_16x16x32_bf16 v[64:67], v[144:147], a[108:111], v[64:67]
    ds_read_b64_tr_b16 v[108:109], v10 offset:49152
    ds_read_b64_tr_b16 v[110:111], v10 offset:51200
    v_mfma_f32_16x16x32_bf16 v[36:39], v[148:151], a[44:47], v[36:39]
    ds_read_b64_tr_b16 v[112:113], v11 offset:49152
    ds_read_b64_tr_b16 v[114:115], v11 offset:51200
    v_mfma_f32_16x16x32_bf16 v[68:71], v[148:151], a[108:111], v[68:71]
    ds_read_b64_tr_b16 v[116:117], v12 offset:49152
    ds_read_b64_tr_b16 v[118:119], v12 offset:51200
    v_mfma_f32_16x16x32_bf16 v[40:43], v[152:155], a[44:47], v[40:43]
    ds_read_b64_tr_b16 v[120:121], v23 offset:49152
    ds_read_b64_tr_b16 v[122:123], v23 offset:51200
    v_mfma_f32_16x16x32_bf16 v[72:75], v[152:155], a[108:111], v[72:75]
    global_load_dwordx4 a[176:179], v0, s[24:25]
    s_add_u32 s24, s24, 16384
    s_addc_u32 s25, s25, 0
    global_load_dwordx4 a[180:183], v0, s[24:25]
    s_add_u32 s24, s24, 16384
    s_addc_u32 s25, s25, 0
    v_mfma_f32_16x16x32_bf16 v[44:47], v[156:159], a[44:47], v[44:47]
    global_load_dwordx4 a[184:187], v0, s[24:25]
    s_add_u32 s24, s24, 16384
    s_addc_u32 s25, s25, 0
    global_load_dwordx4 a[188:191], v0, s[24:25]
    s_add_u32 s24, s24, 16384
    s_addc_u32 s25, s25, 0
    v_mfma_f32_16x16x32_bf16 v[76:79], v[156:159], a[108:111], v[76:79]
    v_mfma_f32_16x16x32_bf16 v[96:99], v[160:163], v[28:31], v[96:99]
    s_waitcnt vmcnt(22) lgkmcnt(0)
    v_mfma_f32_16x16x32_bf16 v[32:35], v[104:107], a[48:51], v[32:35]
    ds_read_b64_tr_b16 v[144:145], v9 offset:53248
    ds_read_b64_tr_b16 v[146:147], v9 offset:55296
    v_mfma_f32_16x16x32_bf16 v[64:67], v[104:107], a[112:115], v[64:67]
    ds_read_b64_tr_b16 v[148:149], v10 offset:53248
    ds_read_b64_tr_b16 v[150:151], v10 offset:55296
    v_mfma_f32_16x16x32_bf16 v[36:39], v[108:111], a[48:51], v[36:39]
    ds_read_b64_tr_b16 v[152:153], v11 offset:53248
    ds_read_b64_tr_b16 v[154:155], v11 offset:55296
    v_mfma_f32_16x16x32_bf16 v[68:71], v[108:111], a[112:115], v[68:71]
    ds_read_b64_tr_b16 v[156:157], v12 offset:53248
    ds_read_b64_tr_b16 v[158:159], v12 offset:55296
    v_mfma_f32_16x16x32_bf16 v[40:43], v[112:115], a[48:51], v[40:43]
    ds_read_b64_tr_b16 v[160:161], v23 offset:53248
    ds_read_b64_tr_b16 v[162:163], v23 offset:55296
    v_mfma_f32_16x16x32_bf16 v[72:75], v[112:115], a[112:115], v[72:75]
    global_load_dwordx4 a[192:195], v0, s[24:25]
    s_add_u32 s24, s24, 16384
    s_addc_u32 s25, s25, 0
    global_load_dwordx4 a[196:199], v0, s[24:25]
    s_add_u32 s24, s24, 16384
    s_addc_u32 s25, s25, 0
    v_mfma_f32_16x16x32_bf16 v[44:47], v[116:119], a[48:51], v[44:47]
    global_load_dwordx4 a[200:203], v0, s[24:25]
    s_add_u32 s24, s24, 16384
    s_addc_u32 s25, s25, 0
    global_load_dwordx4 a[204:207], v0, s[24:25]
    s_add_u32 s24, s24, 16384
    s_addc_u32 s25, s25, 0
    v_mfma_f32_16x16x32_bf16 v[76:79], v[116:119], a[112:115], v[76:79]
    v_mfma_f32_16x16x32_bf16 v[96:99], v[120:123], v[28:31], v[96:99]
    s_waitcnt vmcnt(24) lgkmcnt(0)
    v_mfma_f32_16x16x32_bf16 v[32:35], v[144:147], a[52:55], v[32:35]
    ds_read_b64_tr_b16 v[104:105], v9 offset:57344
    ds_read_b64_tr_b16 v[106:107], v9 offset:59392
    v_mfma_f32_16x16x32_bf16 v[64:67], v[144:147], a[116:119], v[64:67]
    ds_read_b64_tr_b16 v[108:109], v10 offset:57344
    ds_read_b64_tr_b16 v[110:111], v10 offset:59392
    v_mfma_f32_16x16x32_bf16 v[36:39], v[148:151], a[52:55], v[36:39]
    ds_read_b64_tr_b16 v[112:113], v11 offset:57344
    ds_read_b64_tr_b16 v[114:115], v11 offset:59392
    v_mfma_f32_16x16x32_bf16 v[68:71], v[148:151], a[116:119], v[68:71]
    ds_read_b64_tr_b16 v[116:117], v12 offset:57344
    ds_read_b64_tr_b16 v[118:119], v12 offset:59392
    v_mfma_f32_16x16x32_bf16 v[40:43], v[152:155], a[52:55], v[40:43]
    ds_read_b64_tr_b16 v[120:121], v23 offset:57344
    ds_read_b64_tr_b16 v[122:123], v23 offset:59392
    v_mfma_f32_16x16x32_bf16 v[72:75], v[152:155], a[116:119], v[72:75]
    global_load_dwordx4 a[208:211], v0, s[24:25]
    s_add_u32 s24, s24, 16384
    s_addc_u32 s25, s25, 0
    global_load_dwordx4 a[212:215], v0, s[24:25]
    s_add_u32 s24, s24, 16384
    s_addc_u32 s25, s25, 0
    v_mfma_f32_16x16x32_bf16 v[44:47], v[156:159], a[52:55], v[44:47]
    global_load_dwordx4 a[216:219], v0, s[24:25]
    s_add_u32 s24, s24, 16384
    s_addc_u32 s25, s25, 0
    global_load_dwordx4 a[220:223], v0, s[24:25]
    s_add_u32 s24, s24, 16384
    s_addc_u32 s25, s25, 0
    v_mfma_f32_16x16x32_bf16 v[76:79], v[156:159], a[116:119], v[76:79]
    v_mfma_f32_16x16x32_bf16 v[96:99], v[160:163], v[28:31], v[96:99]
    s_waitcnt vmcnt(26) lgkmcnt(0)
    v_mfma_f32_16x16x32_bf16 v[32:35], v[104:107], a[56:59], v[32:35]
    ds_read_b64_tr_b16 v[144:145], v9 offset:61440
    ds_read_b64_tr_b16 v[146:147], v9 offset:63488
    v_mfma_f32_16x16x32_bf16 v[64:67], v[104:107], a[120:123], v[64:67]
    ds_read_b64_tr_b16 v[148:149], v10 offset:61440
    ds_read_b64_tr_b16 v[150:151], v10 offset:63488
    v_mfma_f32_16x16x32_bf16 v[36:39], v[108:111], a[56:59], v[36:39]
    ds_read_b64_tr_b16 v[152:153], v11 offset:61440
    ds_read_b64_tr_b16 v[154:155], v11 offset:63488
    v_mfma_f32_16x16x32_bf16 v[68:71], v[108:111], a[120:123], v[68:71]
    ds_read_b64_tr_b16 v[156:157], v12 offset:61440
    ds_read_b64_tr_b16 v[158:159], v12 offset:63488
    v_mfma_f32_16x16x32_bf16 v[40:43], v[112:115], a[56:59], v[40:43]
    ds_read_b64_tr_b16 v[160:161], v23 offset:61440
    ds_read_b64_tr_b16 v[162:163], v23 offset:63488
    v_mfma_f32_16x16x32_bf16 v[72:75], v[112:115], a[120:123], v[72:75]
    global_load_dwordx4 a[224:227], v0, s[24:25]
    s_add_u32 s24, s24, 16384
    s_addc_u32 s25, s25, 0
    global_load_dwordx4 a[228:231], v0, s[24:25]
    s_add_u32 s24, s24, 16384
    s_addc_u32 s25, s25, 0
    v_mfma_f32_16x16x32_bf16 v[44:47], v[116:119], a[56:59], v[44:47]
    global_load_dwordx4 a[232:235], v0, s[24:25]
    s_add_u32 s24, s24, 16384
    s_addc_u32 s25, s25, 0
    global_load_dwordx4 a[236:239], v0, s[24:25]
    s_add_u32 s24, s24, 16384
    s_addc_u32 s25, s25, 0
    v_mfma_f32_16x16x32_bf16 v[76:79], v[116:119], a[120:123], v[76:79]
    v_mfma_f32_16x16x32_bf16 v[96:99], v[120:123], v[28:31], v[96:99]
    s_waitcnt vmcnt(28) lgkmcnt(0)
    v_mfma_f32_16x16x32_bf16 v[32:35], v[144:147], a[60:63], v[32:35]
    global_load_dwordx4 a[240:243], v0, s[24:25]
    s_add_u32 s24, s24, 16384
    s_addc_u32 s25, s25, 0
    global_load_dwordx4 a[244:247], v0, s[24:25]
    s_add_u32 s24, s24, 16384
    s_addc_u32 s25, s25, 0
    v_mfma_f32_16x16x32_bf16 v[64:67], v[144:147], a[124:127], v[64:67]
    global_load_dwordx4 a[248:251], v0, s[24:25]
    s_add_u32 s24, s24, 16384
    s_addc_u32 s25, s25, 0
    global_load_dwordx4 a[252:255], v0, s[24:25]
    s_add_u32 s24, s24, 16384
    s_addc_u32 s25, s25, 0
    v_mfma_f32_16x16x32_bf16 v[36:39], v[148:151], a[60:63], v[36:39]
    v_mfma_f32_16x16x32_bf16 v[68:71], v[148:151], a[124:127], v[68:71]
    v_mfma_f32_16x16x32_bf16 v[40:43], v[152:155], a[60:63], v[40:43]
    v_mfma_f32_16x16x32_bf16 v[72:75], v[152:155], a[124:127], v[72:75]
    v_mfma_f32_16x16x32_bf16 v[44:47], v[156:159], a[60:63], v[44:47]
    v_mfma_f32_16x16x32_bf16 v[76:79], v[156:159], a[124:127], v[76:79]
    v_mfma_f32_16x16x32_bf16 v[96:99], v[160:163], v[28:31], v[96:99]
    v_add_u32 v26, 151552, v5
    s_lshl_b32 s10, s3, 10
    v_add_u32 v27, s10, v26
    s_nop 4
    ds_write_b128 v27, v[96:99] offset:0
    s_waitcnt lgkmcnt(0)
    s_barrier
    v_mov_b32 v250, v14
    v_mov_b32 v251, v15
    v_mov_b32 v252, v16
    v_mov_b32 v253, v17
    v_mov_b32 v248, 0x3fb8aa3b
    v_lshlrev_b32 v10, 5, v8
    v_lshl_add_u32 v10, v7, 3, v10
    v_add_u32 v10, 147456, v10
    s_lshl_b32 s10, s45, 5
    s_and_b32 s11, s59, 7
    s_lshl_b32 s11, s11, 2
    s_add_u32 s10, s10, s11
    s_lshl_b32 s10, s10, 10
    s_add_u32 s10, s10, 6291456
    s_add_u32 s54, s38, s10
    s_addc_u32 s55, s39, 0
    v_add_u32 v12, 32768, v5
    s_lshl_b32 s10, s3, 5
    v_add_u32 v11, s10, v3
    v_lshlrev_b32 v11, 5, v11
    v_lshl_add_u32 v11, v4, 3, v11
    ds_read_b128 v[184:187], v26 offset:0
    ds_read_b64_tr_b16 v[200:201], v10 offset:0
    ds_read_b128 v[188:191], v26 offset:1024
    ds_read_b64_tr_b16 v[202:203], v10 offset:512
    ds_read_b128 v[192:195], v26 offset:2048
    ds_read_b64_tr_b16 v[204:205], v10 offset:1024
    ds_read_b128 v[196:199], v26 offset:3072
    ds_read_b64_tr_b16 v[206:207], v10 offset:1536
    s_waitcnt lgkmcnt(0)
    v_mul_f32 v32, v32, v252
    v_mul_f32 v64, v64, v250
    v_mul_f32 v36, v36, v252
    v_mul_f32 v68, v68, v250
    v_mul_f32 v33, v33, v252
    v_mul_f32 v65, v65, v250
    v_mul_f32 v37, v37, v252
    v_mul_f32 v69, v69, v250
    v_mul_f32 v34, v34, v252
    v_mul_f32 v66, v66, v250
    v_mul_f32 v38, v38, v252
    v_mul_f32 v70, v70, v250
    v_mul_f32 v35, v35, v252
    v_mul_f32 v67, v67, v250
    v_mul_f32 v39, v39, v252
    v_mul_f32 v71, v71, v250
    v_fma_f32 v32, -v184, v253, v32
    v_fma_f32 v64, -v184, v251, v64
    v_fma_f32 v36, -v188, v253, v36
    v_fma_f32 v68, -v188, v251, v68
    v_fma_f32 v33, -v185, v253, v33
    v_fma_f32 v65, -v185, v251, v65
    v_fma_f32 v37, -v189, v253, v37
    v_fma_f32 v69, -v189, v251, v69
    v_fma_f32 v34, -v186, v253, v34
    v_fma_f32 v66, -v186, v251, v66
    v_fma_f32 v38, -v190, v253, v38
    v_fma_f32 v70, -v190, v251, v70
    v_fma_f32 v35, -v187, v253, v35
    v_fma_f32 v67, -v187, v251, v67
    v_fma_f32 v39, -v191, v253, v39
    v_fma_f32 v71, -v191, v251, v71
    v_cvt_pk_bf16_f32 v208, v32, v33
    v_cvt_pk_bf16_f32 v104, v64, v65
    v_cvt_pk_bf16_f32 v210, v36, v37
    v_cvt_pk_bf16_f32 v106, v68, v69
    v_cvt_pk_bf16_f32 v209, v34, v35
    v_cvt_pk_bf16_f32 v105, v66, v67
    v_cvt_pk_bf16_f32 v211, v38, v39
    v_cvt_pk_bf16_f32 v107, v70, v71
    v_mfma_f32_16x16x16_bf16 v[212:215], v[200:201], v[208:209], 0
    v_mfma_f32_16x16x16_bf16 v[108:111], v[200:201], v[104:105], 0
    v_mfma_f32_16x16x16_bf16 v[216:219], v[202:203], v[210:211], 0
    v_mfma_f32_16x16x16_bf16 v[112:115], v[202:203], v[106:107], 0
    s_nop 4
    v_cvt_pk_bf16_f32 v212, 0, v212
    v_cvt_pk_bf16_f32 v108, 0, v108
    v_cvt_pk_bf16_f32 v213, 0, v213
    v_cvt_pk_bf16_f32 v109, 0, v109
    v_cvt_pk_bf16_f32 v214, 0, v214
    v_cvt_pk_bf16_f32 v110, 0, v110
    v_cvt_pk_bf16_f32 v215, 0, v215
    v_cvt_pk_bf16_f32 v111, 0, v111
    v_cvt_pk_bf16_f32 v216, 0, v216
    v_cvt_pk_bf16_f32 v112, 0, v112
    v_cvt_pk_bf16_f32 v217, 0, v217
    v_cvt_pk_bf16_f32 v113, 0, v113
    v_cvt_pk_bf16_f32 v218, 0, v218
    v_cvt_pk_bf16_f32 v114, 0, v114
    v_cvt_pk_bf16_f32 v219, 0, v219
    v_cvt_pk_bf16_f32 v115, 0, v115
    v_max3_f32 v236, v212, v213, v214
    v_max3_f32 v132, v108, v109, v110
    v_max3_f32 v237, -v212, -v213, -v214
    v_max3_f32 v133, -v108, -v109, -v110
    v_max3_f32 v238, v216, v217, v218
    v_max3_f32 v134, v112, v113, v114
    v_max3_f32 v239, -v216, -v217, -v218
    v_max3_f32 v135, -v112, -v113, -v114
    v_max_f32 v236, v236, v215
    v_max_f32 v132, v132, v111
    v_max_f32 v237, v237, -v215
    v_max_f32 v133, v133, -v111
    v_max_f32 v238, v238, v219
    v_max_f32 v134, v134, v115
    v_max_f32 v239, v239, -v219
    v_max_f32 v135, v135, -v115
    v_permlane32_swap_b32 v236, v237
    v_permlane32_swap_b32 v132, v133
    v_permlane32_swap_b32 v238, v239
    v_permlane32_swap_b32 v134, v135
    v_max_f32 v236, v236, v237
    v_max_f32 v132, v132, v133
    v_max_f32 v238, v238, v239
    v_max_f32 v134, v134, v135
    s_nop 0
    v_permlane16_swap_b32 v236, v238
    v_permlane16_swap_b32 v132, v134
    v_max_f32 v236, v236, v238
    v_max_f32 v132, v132, v134
    v_mov_b32 v238, v236
    v_mov_b32 v134, v132
    s_nop 0
    v_permlane16_swap_b32 v236, v238
    v_permlane16_swap_b32 v132, v134
    v_mov_b32 v237, v236
    v_mov_b32 v133, v132
    v_mov_b32 v239, v238
    v_mov_b32 v135, v134
    v_permlane32_swap_b32 v236, v237
    v_permlane32_swap_b32 v132, v133
    v_permlane32_swap_b32 v238, v239
    v_permlane32_swap_b32 v134, v135
    v_mul_f32 v236, v236, v248
    v_mul_f32 v132, v132, v248
    v_mul_f32 v237, v237, v248
    v_mul_f32 v133, v133, v248
    v_mul_f32 v238, v238, v248
    v_mul_f32 v134, v134, v248
    v_mul_f32 v239, v239, v248
    v_mul_f32 v135, v135, v248
    v_fma_f32 v220, v212, v248, -v236
    v_fma_f32 v116, v108, v248, -v132
    v_fma_f32 v224, -v212, v248, -v237
    v_fma_f32 v120, -v108, v248, -v133
    v_fma_f32 v221, v213, v248, -v236
    v_fma_f32 v117, v109, v248, -v132
    v_fma_f32 v225, -v213, v248, -v237
    v_fma_f32 v121, -v109, v248, -v133
    v_fma_f32 v222, v214, v248, -v236
    v_fma_f32 v118, v110, v248, -v132
    v_fma_f32 v226, -v214, v248, -v237
    v_fma_f32 v122, -v110, v248, -v133
    v_fma_f32 v223, v215, v248, -v236
    v_fma_f32 v119, v111, v248, -v132
    v_fma_f32 v227, -v215, v248, -v237
    v_fma_f32 v123, -v111, v248, -v133
    v_fma_f32 v228, v216, v248, -v238
    v_fma_f32 v124, v112, v248, -v134
    v_fma_f32 v232, -v216, v248, -v239
    v_fma_f32 v128, -v112, v248, -v135
    v_fma_f32 v229, v217, v248, -v238
    v_fma_f32 v125, v113, v248, -v134
    v_fma_f32 v233, -v217, v248, -v239
    v_fma_f32 v129, -v113, v248, -v135
    v_fma_f32 v230, v218, v248, -v238
    v_fma_f32 v126, v114, v248, -v134
    v_fma_f32 v234, -v218, v248, -v239
    v_fma_f32 v130, -v114, v248, -v135
    v_fma_f32 v231, v219, v248, -v238
    v_fma_f32 v127, v115, v248, -v134
    v_fma_f32 v235, -v219, v248, -v239
    v_fma_f32 v131, -v115, v248, -v135
    v_exp_f32 v220, v220
    v_exp_f32 v116, v116
    v_exp_f32 v221, v221
    v_exp_f32 v117, v117
    v_exp_f32 v222, v222
    v_exp_f32 v118, v118
    v_exp_f32 v223, v223
    v_exp_f32 v119, v119
    v_exp_f32 v224, v224
    v_exp_f32 v120, v120
    v_exp_f32 v225, v225
    v_exp_f32 v121, v121
    v_exp_f32 v226, v226
    v_exp_f32 v122, v122
    v_exp_f32 v227, v227
    v_exp_f32 v123, v123
    v_exp_f32 v228, v228
    v_exp_f32 v124, v124
    v_exp_f32 v229, v229
    v_exp_f32 v125, v125
    v_exp_f32 v230, v230
    v_exp_f32 v126, v126
    v_exp_f32 v231, v231
    v_exp_f32 v127, v127
    v_exp_f32 v232, v232
    v_exp_f32 v128, v128
    v_exp_f32 v233, v233
    v_exp_f32 v129, v129
    v_exp_f32 v234, v234
    v_exp_f32 v130, v130
    v_exp_f32 v235, v235
    v_exp_f32 v131, v131
    v_add_f32 v236, v220, v221
    v_add_f32 v132, v116, v117
    v_add_f32 v212, v222, v223
    v_add_f32 v108, v118, v119
    v_add_f32 v237, v224, v225
    v_add_f32 v133, v120, v121
    v_add_f32 v213, v226, v227
    v_add_f32 v109, v122, v123
    v_add_f32 v238, v228, v229
    v_add_f32 v134, v124, v125
    v_add_f32 v214, v230, v231
    v_add_f32 v110, v126, v127
    v_add_f32 v239, v232, v233
    v_add_f32 v135, v128, v129
    v_add_f32 v215, v234, v235
    v_add_f32 v111, v130, v131
    v_add_f32 v236, v236, v212
    v_add_f32 v132, v132, v108
    v_add_f32 v237, v237, v213
    v_add_f32 v133, v133, v109
    v_add_f32 v238, v238, v214
    v_add_f32 v134, v134, v110
    v_add_f32 v239, v239, v215
    v_add_f32 v135, v135, v111
    v_permlane32_swap_b32 v236, v237
    v_permlane32_swap_b32 v132, v133
    v_permlane32_swap_b32 v238, v239
    v_permlane32_swap_b32 v134, v135
    v_add_f32 v236, v236, v237
    v_add_f32 v132, v132, v133
    v_add_f32 v238, v238, v239
    v_add_f32 v134, v134, v135
    s_nop 0
    v_permlane16_swap_b32 v236, v238
    v_permlane16_swap_b32 v132, v134
    v_add_f32 v236, v236, v238
    v_add_f32 v132, v132, v134
    v_mov_b32 v238, v236
    v_mov_b32 v134, v132
    s_nop 0
    v_permlane16_swap_b32 v236, v238
    v_permlane16_swap_b32 v132, v134
    v_mov_b32 v237, v236
    v_mov_b32 v133, v132
    v_mov_b32 v239, v238
    v_mov_b32 v135, v134
    v_permlane32_swap_b32 v236, v237
    v_permlane32_swap_b32 v132, v133
    v_permlane32_swap_b32 v238, v239
    v_permlane32_swap_b32 v134, v135
    v_rcp_f32 v236, v236
    v_rcp_f32 v132, v132
    v_rcp_f32 v237, v237
    v_rcp_f32 v133, v133
    v_rcp_f32 v238, v238
    v_rcp_f32 v134, v134
    v_rcp_f32 v239, v239
    v_rcp_f32 v135, v135
    v_pk_mul_f32 v[220:221], v[220:221], v[236:237] op_sel:[0,0] op_sel_hi:[1,0]
    v_pk_mul_f32 v[116:117], v[116:117], v[132:133] op_sel:[0,0] op_sel_hi:[1,0]
    v_pk_mul_f32 v[222:223], v[222:223], v[236:237] op_sel:[0,0] op_sel_hi:[1,0]
    v_pk_mul_f32 v[118:119], v[118:119], v[132:133] op_sel:[0,0] op_sel_hi:[1,0]
    v_pk_mul_f32 v[224:225], v[224:225], v[236:237] op_sel:[0,1] op_sel_hi:[1,1]
    v_pk_mul_f32 v[120:121], v[120:121], v[132:133] op_sel:[0,1] op_sel_hi:[1,1]
    v_pk_mul_f32 v[226:227], v[226:227], v[236:237] op_sel:[0,1] op_sel_hi:[1,1]
    v_pk_mul_f32 v[122:123], v[122:123], v[132:133] op_sel:[0,1] op_sel_hi:[1,1]
    v_pk_mul_f32 v[228:229], v[228:229], v[238:239] op_sel:[0,0] op_sel_hi:[1,0]
    v_pk_mul_f32 v[124:125], v[124:125], v[134:135] op_sel:[0,0] op_sel_hi:[1,0]
    v_pk_mul_f32 v[230:231], v[230:231], v[238:239] op_sel:[0,0] op_sel_hi:[1,0]
    v_pk_mul_f32 v[126:127], v[126:127], v[134:135] op_sel:[0,0] op_sel_hi:[1,0]
    v_pk_mul_f32 v[232:233], v[232:233], v[238:239] op_sel:[0,1] op_sel_hi:[1,1]
    v_pk_mul_f32 v[128:129], v[128:129], v[134:135] op_sel:[0,1] op_sel_hi:[1,1]
    v_pk_mul_f32 v[234:235], v[234:235], v[238:239] op_sel:[0,1] op_sel_hi:[1,1]
    v_pk_mul_f32 v[130:131], v[130:131], v[134:135] op_sel:[0,1] op_sel_hi:[1,1]
    v_cvt_pk_bf16_f32 v240, v220, v221
    v_cvt_pk_bf16_f32 v136, v116, v117
    v_cvt_pk_bf16_f32 v241, v222, v223
    v_cvt_pk_bf16_f32 v137, v118, v119
    v_cvt_pk_bf16_f32 v242, v224, v225
    v_cvt_pk_bf16_f32 v138, v120, v121
    v_cvt_pk_bf16_f32 v243, v226, v227
    v_cvt_pk_bf16_f32 v139, v122, v123
    v_cvt_pk_bf16_f32 v244, v228, v229
    v_cvt_pk_bf16_f32 v140, v124, v125
    v_cvt_pk_bf16_f32 v245, v230, v231
    v_cvt_pk_bf16_f32 v141, v126, v127
    v_cvt_pk_bf16_f32 v246, v232, v233
    v_cvt_pk_bf16_f32 v142, v128, v129
    v_cvt_pk_bf16_f32 v247, v234, v235
    v_cvt_pk_bf16_f32 v143, v130, v131
    s_cmp_eq_u32 s61, 1
    s_cbranch_scc1 sf_interleave_layers__linear_kernel_hedgehog__mixer_channel_mlp__prompt_kernel_100
    global_store_dwordx4 v5, v[240:243], s[54:55] offset:0 sc1
    s_branch se_interleave_layers__linear_kernel_hedgehog__mixer_channel_mlp__prompt_kernel_101
sf_interleave_layers__linear_kernel_hedgehog__mixer_channel_mlp__prompt_kernel_100:
    global_store_dwordx4 v5, v[240:243], s[54:55] offset:0
se_interleave_layers__linear_kernel_hedgehog__mixer_channel_mlp__prompt_kernel_101:
    s_cmp_eq_u32 s61, 1
    s_cbranch_scc1 sf_interleave_layers__linear_kernel_hedgehog__mixer_channel_mlp__prompt_kernel_102
    global_store_dwordx4 v12, v[136:139], s[54:55] offset:0 sc1
    s_branch se_interleave_layers__linear_kernel_hedgehog__mixer_channel_mlp__prompt_kernel_103
sf_interleave_layers__linear_kernel_hedgehog__mixer_channel_mlp__prompt_kernel_102:
    global_store_dwordx4 v12, v[136:139], s[54:55] offset:0
se_interleave_layers__linear_kernel_hedgehog__mixer_channel_mlp__prompt_kernel_103:
    s_cmp_eq_u32 s61, 1
    s_cbranch_scc1 sf_interleave_layers__linear_kernel_hedgehog__mixer_channel_mlp__prompt_kernel_104
    global_store_dwordx4 v5, v[244:247], s[54:55] offset:1024 sc1
    s_branch se_interleave_layers__linear_kernel_hedgehog__mixer_channel_mlp__prompt_kernel_105
sf_interleave_layers__linear_kernel_hedgehog__mixer_channel_mlp__prompt_kernel_104:
    global_store_dwordx4 v5, v[244:247], s[54:55] offset:1024
se_interleave_layers__linear_kernel_hedgehog__mixer_channel_mlp__prompt_kernel_105:
    s_cmp_eq_u32 s61, 1
    s_cbranch_scc1 sf_interleave_layers__linear_kernel_hedgehog__mixer_channel_mlp__prompt_kernel_106
    global_store_dwordx4 v12, v[140:143], s[54:55] offset:1024 sc1
    s_branch se_interleave_layers__linear_kernel_hedgehog__mixer_channel_mlp__prompt_kernel_107
sf_interleave_layers__linear_kernel_hedgehog__mixer_channel_mlp__prompt_kernel_106:
    global_store_dwordx4 v12, v[140:143], s[54:55] offset:1024
se_interleave_layers__linear_kernel_hedgehog__mixer_channel_mlp__prompt_kernel_107:
    v_mul_f32 v40, v40, v252
    v_mul_f32 v72, v72, v250
    v_mul_f32 v44, v44, v252
    v_mul_f32 v76, v76, v250
    v_mul_f32 v41, v41, v252
    v_mul_f32 v73, v73, v250
    v_mul_f32 v45, v45, v252
    v_mul_f32 v77, v77, v250
    v_mul_f32 v42, v42, v252
    v_mul_f32 v74, v74, v250
    v_mul_f32 v46, v46, v252
    v_mul_f32 v78, v78, v250
    v_mul_f32 v43, v43, v252
    v_mul_f32 v75, v75, v250
    v_mul_f32 v47, v47, v252
    v_mul_f32 v79, v79, v250
    v_fma_f32 v40, -v192, v253, v40
    v_fma_f32 v72, -v192, v251, v72
    v_fma_f32 v44, -v196, v253, v44
    v_fma_f32 v76, -v196, v251, v76
    v_fma_f32 v41, -v193, v253, v41
    v_fma_f32 v73, -v193, v251, v73
    v_fma_f32 v45, -v197, v253, v45
    v_fma_f32 v77, -v197, v251, v77
    v_fma_f32 v42, -v194, v253, v42
    v_fma_f32 v74, -v194, v251, v74
    v_fma_f32 v46, -v198, v253, v46
    v_fma_f32 v78, -v198, v251, v78
    v_fma_f32 v43, -v195, v253, v43
    v_fma_f32 v75, -v195, v251, v75
    v_fma_f32 v47, -v199, v253, v47
    v_fma_f32 v79, -v199, v251, v79
    v_cvt_pk_bf16_f32 v208, v40, v41
    v_cvt_pk_bf16_f32 v104, v72, v73
    v_cvt_pk_bf16_f32 v210, v44, v45
    v_cvt_pk_bf16_f32 v106, v76, v77
    v_cvt_pk_bf16_f32 v209, v42, v43
    v_cvt_pk_bf16_f32 v105, v74, v75
    v_cvt_pk_bf16_f32 v211, v46, v47
    v_cvt_pk_bf16_f32 v107, v78, v79
    v_mfma_f32_16x16x16_bf16 v[212:215], v[204:205], v[208:209], 0
    v_mfma_f32_16x16x16_bf16 v[108:111], v[204:205], v[104:105], 0
    v_mfma_f32_16x16x16_bf16 v[216:219], v[206:207], v[210:211], 0
    v_mfma_f32_16x16x16_bf16 v[112:115], v[206:207], v[106:107], 0
    s_nop 4
    v_cvt_pk_bf16_f32 v212, 0, v212
    v_cvt_pk_bf16_f32 v108, 0, v108
    v_cvt_pk_bf16_f32 v213, 0, v213
    v_cvt_pk_bf16_f32 v109, 0, v109
    v_cvt_pk_bf16_f32 v214, 0, v214
    v_cvt_pk_bf16_f32 v110, 0, v110
    v_cvt_pk_bf16_f32 v215, 0, v215
    v_cvt_pk_bf16_f32 v111, 0, v111
    v_cvt_pk_bf16_f32 v216, 0, v216
    v_cvt_pk_bf16_f32 v112, 0, v112
    v_cvt_pk_bf16_f32 v217, 0, v217
    v_cvt_pk_bf16_f32 v113, 0, v113
    v_cvt_pk_bf16_f32 v218, 0, v218
    v_cvt_pk_bf16_f32 v114, 0, v114
    v_cvt_pk_bf16_f32 v219, 0, v219
    v_cvt_pk_bf16_f32 v115, 0, v115
    v_max3_f32 v236, v212, v213, v214
    v_max3_f32 v132, v108, v109, v110
    v_max3_f32 v237, -v212, -v213, -v214
    v_max3_f32 v133, -v108, -v109, -v110
    v_max3_f32 v238, v216, v217, v218
    v_max3_f32 v134, v112, v113, v114
    v_max3_f32 v239, -v216, -v217, -v218
    v_max3_f32 v135, -v112, -v113, -v114
    v_max_f32 v236, v236, v215
    v_max_f32 v132, v132, v111
    v_max_f32 v237, v237, -v215
    v_max_f32 v133, v133, -v111
    v_max_f32 v238, v238, v219
    v_max_f32 v134, v134, v115
    v_max_f32 v239, v239, -v219
    v_max_f32 v135, v135, -v115
    v_permlane32_swap_b32 v236, v237
    v_permlane32_swap_b32 v132, v133
    v_permlane32_swap_b32 v238, v239
    v_permlane32_swap_b32 v134, v135
    v_max_f32 v236, v236, v237
    v_max_f32 v132, v132, v133
    v_max_f32 v238, v238, v239
    v_max_f32 v134, v134, v135
    s_nop 0
    v_permlane16_swap_b32 v236, v238
    v_permlane16_swap_b32 v132, v134
    v_max_f32 v236, v236, v238
    v_max_f32 v132, v132, v134
    v_mov_b32 v238, v236
    v_mov_b32 v134, v132
    s_nop 0
    v_permlane16_swap_b32 v236, v238
    v_permlane16_swap_b32 v132, v134
    v_mov_b32 v237, v236
    v_mov_b32 v133, v132
    v_mov_b32 v239, v238
    v_mov_b32 v135, v134
    v_permlane32_swap_b32 v236, v237
    v_permlane32_swap_b32 v132, v133
    v_permlane32_swap_b32 v238, v239
    v_permlane32_swap_b32 v134, v135
    v_mul_f32 v236, v236, v248
    v_mul_f32 v132, v132, v248
    v_mul_f32 v237, v237, v248
    v_mul_f32 v133, v133, v248
    v_mul_f32 v238, v238, v248
    v_mul_f32 v134, v134, v248
    v_mul_f32 v239, v239, v248
    v_mul_f32 v135, v135, v248
    v_fma_f32 v220, v212, v248, -v236
    v_fma_f32 v116, v108, v248, -v132
    v_fma_f32 v224, -v212, v248, -v237
    v_fma_f32 v120, -v108, v248, -v133
    v_fma_f32 v221, v213, v248, -v236
    v_fma_f32 v117, v109, v248, -v132
    v_fma_f32 v225, -v213, v248, -v237
    v_fma_f32 v121, -v109, v248, -v133
    v_fma_f32 v222, v214, v248, -v236
    v_fma_f32 v118, v110, v248, -v132
    v_fma_f32 v226, -v214, v248, -v237
    v_fma_f32 v122, -v110, v248, -v133
    v_fma_f32 v223, v215, v248, -v236
    v_fma_f32 v119, v111, v248, -v132
    v_fma_f32 v227, -v215, v248, -v237
    v_fma_f32 v123, -v111, v248, -v133
    v_fma_f32 v228, v216, v248, -v238
    v_fma_f32 v124, v112, v248, -v134
    v_fma_f32 v232, -v216, v248, -v239
    v_fma_f32 v128, -v112, v248, -v135
    v_fma_f32 v229, v217, v248, -v238
    v_fma_f32 v125, v113, v248, -v134
    v_fma_f32 v233, -v217, v248, -v239
    v_fma_f32 v129, -v113, v248, -v135
    v_fma_f32 v230, v218, v248, -v238
    v_fma_f32 v126, v114, v248, -v134
    v_fma_f32 v234, -v218, v248, -v239
    v_fma_f32 v130, -v114, v248, -v135
    v_fma_f32 v231, v219, v248, -v238
    v_fma_f32 v127, v115, v248, -v134
    v_fma_f32 v235, -v219, v248, -v239
    v_fma_f32 v131, -v115, v248, -v135
    v_exp_f32 v220, v220
    v_exp_f32 v116, v116
    v_exp_f32 v221, v221
    v_exp_f32 v117, v117
    v_exp_f32 v222, v222
    v_exp_f32 v118, v118
    v_exp_f32 v223, v223
    v_exp_f32 v119, v119
    v_exp_f32 v224, v224
    v_exp_f32 v120, v120
    v_exp_f32 v225, v225
    v_exp_f32 v121, v121
    v_exp_f32 v226, v226
    v_exp_f32 v122, v122
    v_exp_f32 v227, v227
    v_exp_f32 v123, v123
    v_exp_f32 v228, v228
    v_exp_f32 v124, v124
    v_exp_f32 v229, v229
    v_exp_f32 v125, v125
    v_exp_f32 v230, v230
    v_exp_f32 v126, v126
    v_exp_f32 v231, v231
    v_exp_f32 v127, v127
    v_exp_f32 v232, v232
    v_exp_f32 v128, v128
    v_exp_f32 v233, v233
    v_exp_f32 v129, v129
    v_exp_f32 v234, v234
    v_exp_f32 v130, v130
    v_exp_f32 v235, v235
    v_exp_f32 v131, v131
    v_add_f32 v236, v220, v221
    v_add_f32 v132, v116, v117
    v_add_f32 v212, v222, v223
    v_add_f32 v108, v118, v119
    v_add_f32 v237, v224, v225
    v_add_f32 v133, v120, v121
    v_add_f32 v213, v226, v227
    v_add_f32 v109, v122, v123
    v_add_f32 v238, v228, v229
    v_add_f32 v134, v124, v125
    v_add_f32 v214, v230, v231
    v_add_f32 v110, v126, v127
    v_add_f32 v239, v232, v233
    v_add_f32 v135, v128, v129
    v_add_f32 v215, v234, v235
    v_add_f32 v111, v130, v131
    v_add_f32 v236, v236, v212
    v_add_f32 v132, v132, v108
    v_add_f32 v237, v237, v213
    v_add_f32 v133, v133, v109
    v_add_f32 v238, v238, v214
    v_add_f32 v134, v134, v110
    v_add_f32 v239, v239, v215
    v_add_f32 v135, v135, v111
    v_permlane32_swap_b32 v236, v237
    v_permlane32_swap_b32 v132, v133
    v_permlane32_swap_b32 v238, v239
    v_permlane32_swap_b32 v134, v135
    v_add_f32 v236, v236, v237
    v_add_f32 v132, v132, v133
    v_add_f32 v238, v238, v239
    v_add_f32 v134, v134, v135
    s_nop 0
    v_permlane16_swap_b32 v236, v238
    v_permlane16_swap_b32 v132, v134
    v_add_f32 v236, v236, v238
    v_add_f32 v132, v132, v134
    v_mov_b32 v238, v236
    v_mov_b32 v134, v132
    s_nop 0
    v_permlane16_swap_b32 v236, v238
    v_permlane16_swap_b32 v132, v134
    v_mov_b32 v237, v236
    v_mov_b32 v133, v132
    v_mov_b32 v239, v238
    v_mov_b32 v135, v134
    v_permlane32_swap_b32 v236, v237
    v_permlane32_swap_b32 v132, v133
    v_permlane32_swap_b32 v238, v239
    v_permlane32_swap_b32 v134, v135
    v_rcp_f32 v236, v236
    v_rcp_f32 v132, v132
    v_rcp_f32 v237, v237
    v_rcp_f32 v133, v133
    v_rcp_f32 v238, v238
    v_rcp_f32 v134, v134
    v_rcp_f32 v239, v239
    v_rcp_f32 v135, v135
    v_pk_mul_f32 v[220:221], v[220:221], v[236:237] op_sel:[0,0] op_sel_hi:[1,0]
    v_pk_mul_f32 v[116:117], v[116:117], v[132:133] op_sel:[0,0] op_sel_hi:[1,0]
    v_pk_mul_f32 v[222:223], v[222:223], v[236:237] op_sel:[0,0] op_sel_hi:[1,0]
    v_pk_mul_f32 v[118:119], v[118:119], v[132:133] op_sel:[0,0] op_sel_hi:[1,0]
    v_pk_mul_f32 v[224:225], v[224:225], v[236:237] op_sel:[0,1] op_sel_hi:[1,1]
    v_pk_mul_f32 v[120:121], v[120:121], v[132:133] op_sel:[0,1] op_sel_hi:[1,1]
    v_pk_mul_f32 v[226:227], v[226:227], v[236:237] op_sel:[0,1] op_sel_hi:[1,1]
    v_pk_mul_f32 v[122:123], v[122:123], v[132:133] op_sel:[0,1] op_sel_hi:[1,1]
    v_pk_mul_f32 v[228:229], v[228:229], v[238:239] op_sel:[0,0] op_sel_hi:[1,0]
    v_pk_mul_f32 v[124:125], v[124:125], v[134:135] op_sel:[0,0] op_sel_hi:[1,0]
    v_pk_mul_f32 v[230:231], v[230:231], v[238:239] op_sel:[0,0] op_sel_hi:[1,0]
    v_pk_mul_f32 v[126:127], v[126:127], v[134:135] op_sel:[0,0] op_sel_hi:[1,0]
    v_pk_mul_f32 v[232:233], v[232:233], v[238:239] op_sel:[0,1] op_sel_hi:[1,1]
    v_pk_mul_f32 v[128:129], v[128:129], v[134:135] op_sel:[0,1] op_sel_hi:[1,1]
    v_pk_mul_f32 v[234:235], v[234:235], v[238:239] op_sel:[0,1] op_sel_hi:[1,1]
    v_pk_mul_f32 v[130:131], v[130:131], v[134:135] op_sel:[0,1] op_sel_hi:[1,1]
    v_cvt_pk_bf16_f32 v240, v220, v221
    v_cvt_pk_bf16_f32 v136, v116, v117
    v_cvt_pk_bf16_f32 v241, v222, v223
    v_cvt_pk_bf16_f32 v137, v118, v119
    v_cvt_pk_bf16_f32 v242, v224, v225
    v_cvt_pk_bf16_f32 v138, v120, v121
    v_cvt_pk_bf16_f32 v243, v226, v227
    v_cvt_pk_bf16_f32 v139, v122, v123
    v_cvt_pk_bf16_f32 v244, v228, v229
    v_cvt_pk_bf16_f32 v140, v124, v125
    v_cvt_pk_bf16_f32 v245, v230, v231
    v_cvt_pk_bf16_f32 v141, v126, v127
    v_cvt_pk_bf16_f32 v246, v232, v233
    v_cvt_pk_bf16_f32 v142, v128, v129
    v_cvt_pk_bf16_f32 v247, v234, v235
    v_cvt_pk_bf16_f32 v143, v130, v131
    s_cmp_eq_u32 s61, 1
    s_cbranch_scc1 sf_interleave_layers__linear_kernel_hedgehog__mixer_channel_mlp__prompt_kernel_108
    global_store_dwordx4 v5, v[240:243], s[54:55] offset:2048 sc1
    s_branch se_interleave_layers__linear_kernel_hedgehog__mixer_channel_mlp__prompt_kernel_109
sf_interleave_layers__linear_kernel_hedgehog__mixer_channel_mlp__prompt_kernel_108:
    global_store_dwordx4 v5, v[240:243], s[54:55] offset:2048
se_interleave_layers__linear_kernel_hedgehog__mixer_channel_mlp__prompt_kernel_109:
    s_cmp_eq_u32 s61, 1
    s_cbranch_scc1 sf_interleave_layers__linear_kernel_hedgehog__mixer_channel_mlp__prompt_kernel_110
    global_store_dwordx4 v12, v[136:139], s[54:55] offset:2048 sc1
    s_branch se_interleave_layers__linear_kernel_hedgehog__mixer_channel_mlp__prompt_kernel_111
sf_interleave_layers__linear_kernel_hedgehog__mixer_channel_mlp__prompt_kernel_110:
    global_store_dwordx4 v12, v[136:139], s[54:55] offset:2048
se_interleave_layers__linear_kernel_hedgehog__mixer_channel_mlp__prompt_kernel_111:
    s_cmp_eq_u32 s61, 1
    s_cbranch_scc1 sf_interleave_layers__linear_kernel_hedgehog__mixer_channel_mlp__prompt_kernel_112
    global_store_dwordx4 v5, v[244:247], s[54:55] offset:3072 sc1
    s_branch se_interleave_layers__linear_kernel_hedgehog__mixer_channel_mlp__prompt_kernel_113
sf_interleave_layers__linear_kernel_hedgehog__mixer_channel_mlp__prompt_kernel_112:
    global_store_dwordx4 v5, v[244:247], s[54:55] offset:3072
se_interleave_layers__linear_kernel_hedgehog__mixer_channel_mlp__prompt_kernel_113:
    s_cmp_eq_u32 s61, 1
    s_cbranch_scc1 sf_interleave_layers__linear_kernel_hedgehog__mixer_channel_mlp__prompt_kernel_114
    global_store_dwordx4 v12, v[140:143], s[54:55] offset:3072 sc1
    s_branch se_interleave_layers__linear_kernel_hedgehog__mixer_channel_mlp__prompt_kernel_115
sf_interleave_layers__linear_kernel_hedgehog__mixer_channel_mlp__prompt_kernel_114:
    global_store_dwordx4 v12, v[140:143], s[54:55] offset:3072
se_interleave_layers__linear_kernel_hedgehog__mixer_channel_mlp__prompt_kernel_115:
    s_waitcnt vmcnt(0)
p1d_interleave_layers__linear_kernel_hedgehog__mixer_channel_mlp__prompt_kernel_93:
    s_nop 15
    s_nop 3
    s_barrier
    s_cmp_lg_u32 s3, 0
    s_cbranch_scc1 sg_interleave_layers__linear_kernel_hedgehog__mixer_channel_mlp__prompt_kernel_116
    s_mov_b64 exec, 1
    s_lshl_b32 s10, s58, 10
    v_mov_b32 v2, s10
    v_mov_b32 v26, 1
    global_atomic_add v2, v26, s[62:63] sc1
    s_cmp_lt_u32 s59, 8
    s_cbranch_scc1 qd_interleave_layers__linear_kernel_hedgehog__mixer_channel_mlp__prompt_kernel_117
    global_atomic_add v2, v26, s[62:63] offset:384 sc1
qd_interleave_layers__linear_kernel_hedgehog__mixer_channel_mlp__prompt_kernel_117:
    s_mov_b64 exec, -1
sg_interleave_layers__linear_kernel_hedgehog__mixer_channel_mlp__prompt_kernel_116:
    s_lshl_b32 s48, s3, 10
    v_add_u32 v9, s48, v5
    v_add_u32 v10, 65536, v9
    ds_write_b128 v9, a[128:131] offset:0
    ds_write_b128 v9, a[132:135] offset:4096
    ds_write_b128 v9, a[136:139] offset:8192
    ds_write_b128 v9, a[140:143] offset:12288
    ds_write_b128 v9, a[144:147] offset:16384
    ds_write_b128 v9, a[148:151] offset:20480
    ds_write_b128 v9, a[152:155] offset:24576
    ds_write_b128 v9, a[156:159] offset:28672
    ds_write_b128 v9, a[160:163] offset:32768
    ds_write_b128 v9, a[164:167] offset:36864
    ds_write_b128 v9, a[168:171] offset:40960
    ds_write_b128 v9, a[172:175] offset:45056
    ds_write_b128 v9, a[176:179] offset:49152
    ds_write_b128 v9, a[180:183] offset:53248
    ds_write_b128 v9, a[184:187] offset:57344
    ds_write_b128 v9, a[188:191] offset:61440
    ds_write_b128 v10, a[192:195] offset:0
    ds_write_b128 v10, a[196:199] offset:4096
    ds_write_b128 v10, a[200:203] offset:8192
    ds_write_b128 v10, a[204:207] offset:12288
    ds_write_b128 v10, a[208:211] offset:16384
    ds_write_b128 v10, a[212:215] offset:20480
    ds_write_b128 v10, a[216:219] offset:24576
    ds_write_b128 v10, a[220:223] offset:28672
    ds_write_b128 v10, a[224:227] offset:32768
    ds_write_b128 v10, a[228:231] offset:36864
    ds_write_b128 v10, a[232:235] offset:40960
    ds_write_b128 v10, a[236:239] offset:45056
    ds_write_b128 v10, a[240:243] offset:49152
    ds_write_b128 v10, a[244:247] offset:53248
    ds_write_b128 v10, a[248:251] offset:57344
    ds_write_b128 v10, a[252:255] offset:61440
    s_lshl_b32 s6, s58, 2
    s_and_b32 s10, s59, 3
    s_add_u32 s6, s6, s10
    s_lshr_b32 s7, s59, 2
    s_lshl_b32 s12, s6, 6
    s_lshl_b32 s13, s3, 3
    s_add_u32 s12, s12, s13
    s_lshl_b32 s12, s12, 10
    s_add_u32 s12, s12, 6291456
    s_add_u32 s44, s38, s12
    s_addc_u32 s45, s39, 0
    v_add_u32 v19, 4096, v5
    v_add_u32 v20, 32768, v5
    v_add_u32 v21, 36864, v5
    s_lshl_b32 s10, s6, 5
    s_lshl_b32 s11, s7, 2
    s_add_u32 s10, s10, s11
    s_add_u32 s10, s10, s3
    s_lshl_b32 s50, s10, 10
    s_add_u32 s10, s50, 4194304
    s_add_u32 s52, s38, s10
    s_addc_u32 s53, s39, 0
    s_mov_b64 exec, 1
    s_lshl_b32 s10, s58, 10
    v_mov_b32 v2, s10
    s_mov_b32 s15, 0
qp_interleave_layers__linear_kernel_hedgehog__mixer_channel_mlp__prompt_kernel_118:
    global_load_dword v26, v2, s[62:63] offset:384 sc1
    s_waitcnt vmcnt(0)
    v_readfirstlane_b32 s10, v26
    s_cmp_ge_u32 s10, 16
    s_cbranch_scc1 qq_interleave_layers__linear_kernel_hedgehog__mixer_channel_mlp__prompt_kernel_119
    s_sleep 1
    s_add_u32 s15, s15, 1
    s_cmp_lt_u32 s15, 400000
    s_cbranch_scc1 qp_interleave_layers__linear_kernel_hedgehog__mixer_channel_mlp__prompt_kernel_118
qq_interleave_layers__linear_kernel_hedgehog__mixer_channel_mlp__prompt_kernel_119:
    s_mov_b64 exec, -1
    global_load_dwordx4 v[96:99], v5, s[44:45] offset:0 sc1
    global_load_dwordx4 v[128:131], v20, s[44:45] offset:0 sc1
    global_load_dwordx4 v[100:103], v5, s[44:45] offset:1024 sc1
    global_load_dwordx4 v[132:135], v20, s[44:45] offset:1024 sc1
    global_load_dwordx4 v[104:107], v5, s[44:45] offset:2048 sc1
    global_load_dwordx4 v[136:139], v20, s[44:45] offset:2048 sc1
    global_load_dwordx4 v[108:111], v5, s[44:45] offset:3072 sc1
    global_load_dwordx4 v[140:143], v20, s[44:45] offset:3072 sc1
    global_load_dwordx4 v[112:115], v19, s[44:45] offset:0 sc1
    global_load_dwordx4 v[144:147], v21, s[44:45] offset:0 sc1
    global_load_dwordx4 v[116:119], v19, s[44:45] offset:1024 sc1
    global_load_dwordx4 v[148:151], v21, s[44:45] offset:1024 sc1
    global_load_dwordx4 v[120:123], v19, s[44:45] offset:2048 sc1
    global_load_dwordx4 v[152:155], v21, s[44:45] offset:2048 sc1
    global_load_dwordx4 v[124:127], v19, s[44:45] offset:3072 sc1
    global_load_dwordx4 v[156:159], v21, s[44:45] offset:3072 sc1
    global_load_dwordx4 v[176:179], v5, s[52:53] sc1
    v_add_u32 v19, 16384, v5
    global_load_dwordx4 v[180:183], v19, s[52:53] sc1
    v_lshrrev_b32 v15, 3, v1
    v_and_b32 v16, 7, v1
    v_lshrrev_b32 v17, 1, v16
    v_lshrrev_b32 v18, 1, v15
    v_and_b32 v18, 3, v18
    v_xor_b32 v17, v17, v18
    v_and_b32 v16, 1, v16
    v_lshlrev_b32 v16, 4, v16
    v_lshl_add_u32 v16, v17, 5, v16
    v_mul_u32_u24 v0, 3584, v15
    v_add_u32 v0, v0, v16
    s_min_u32 s10, s59, 13
    s_lshl_b32 s4, s10, 8
    s_add_u32 s5, s4, 128
    s_mul_i32 s11, s3, 28672
    s_add_u32 s12, s11, s4
    s_add_u32 s24, s26, s12
    s_addc_u32 s25, s27, 0
    s_add_u32 s12, s11, s5
    s_add_u32 s100, s26, s12
    s_addc_u32 s101, s27, 0
    s_cmp_eq_u32 s3, 0
    s_cbranch_scc1 nl_interleave_layers__linear_kernel_hedgehog__mixer_channel_mlp__prompt_kernel_120
    global_load_dwordx4 a[0:3], v0, s[24:25]
    s_add_u32 s24, s24, 114688
    s_addc_u32 s25, s25, 0
    global_load_dwordx4 a[4:7], v0, s[24:25]
    s_add_u32 s24, s24, 114688
    s_addc_u32 s25, s25, 0
    global_load_dwordx4 a[8:11], v0, s[24:25]
    s_add_u32 s24, s24, 114688
    s_addc_u32 s25, s25, 0
    global_load_dwordx4 a[12:15], v0, s[24:25]
    s_add_u32 s24, s24, 114688
    s_addc_u32 s25, s25, 0
    global_load_dwordx4 a[16:19], v0, s[24:25]
    s_add_u32 s24, s24, 114688
    s_addc_u32 s25, s25, 0
    global_load_dwordx4 a[20:23], v0, s[24:25]
    s_add_u32 s24, s24, 114688
    s_addc_u32 s25, s25, 0
    global_load_dwordx4 a[24:27], v0, s[24:25]
    s_add_u32 s24, s24, 114688
    s_addc_u32 s25, s25, 0
    global_load_dwordx4 a[28:31], v0, s[24:25]
    s_add_u32 s24, s24, 114688
    s_addc_u32 s25, s25, 0
    global_load_dwordx4 a[32:35], v0, s[24:25]
    s_add_u32 s24, s24, 114688
    s_addc_u32 s25, s25, 0
    global_load_dwordx4 a[36:39], v0, s[24:25]
    s_add_u32 s24, s24, 114688
    s_addc_u32 s25, s25, 0
    global_load_dwordx4 a[40:43], v0, s[24:25]
    s_add_u32 s24, s24, 114688
    s_addc_u32 s25, s25, 0
    global_load_dwordx4 a[44:47], v0, s[24:25]
    s_add_u32 s24, s24, 114688
    s_addc_u32 s25, s25, 0
    global_load_dwordx4 a[48:51], v0, s[24:25]
    s_add_u32 s24, s24, 114688
    s_addc_u32 s25, s25, 0
    global_load_dwordx4 a[52:55], v0, s[24:25]
    s_add_u32 s24, s24, 114688
    s_addc_u32 s25, s25, 0
    global_load_dwordx4 a[56:59], v0, s[24:25]
    s_add_u32 s24, s24, 114688
    s_addc_u32 s25, s25, 0
    global_load_dwordx4 a[60:63], v0, s[24:25]
    s_add_u32 s24, s24, 114688
    s_addc_u32 s25, s25, 0
    global_load_dwordx4 a[64:67], v0, s[100:101]
    s_add_u32 s100, s100, 114688
    s_addc_u32 s101, s101, 0
    global_load_dwordx4 a[68:71], v0, s[100:101]
    s_add_u32 s100, s100, 114688
    s_addc_u32 s101, s101, 0
    global_load_dwordx4 a[72:75], v0, s[100:101]
    s_add_u32 s100, s100, 114688
    s_addc_u32 s101, s101, 0
    global_load_dwordx4 a[76:79], v0, s[100:101]
    s_add_u32 s100, s100, 114688
    s_addc_u32 s101, s101, 0
    global_load_dwordx4 a[80:83], v0, s[100:101]
    s_add_u32 s100, s100, 114688
    s_addc_u32 s101, s101, 0
    global_load_dwordx4 a[84:87], v0, s[100:101]
    s_add_u32 s100, s100, 114688
    s_addc_u32 s101, s101, 0
    global_load_dwordx4 a[88:91], v0, s[100:101]
    s_add_u32 s100, s100, 114688
    s_addc_u32 s101, s101, 0
    global_load_dwordx4 a[92:95], v0, s[100:101]
    s_add_u32 s100, s100, 114688
    s_addc_u32 s101, s101, 0
    global_load_dwordx4 a[96:99], v0, s[100:101]
    s_add_u32 s100, s100, 114688
    s_addc_u32 s101, s101, 0
    global_load_dwordx4 a[100:103], v0, s[100:101]
    s_add_u32 s100, s100, 114688
    s_addc_u32 s101, s101, 0
    global_load_dwordx4 a[104:107], v0, s[100:101]
    s_add_u32 s100, s100, 114688
    s_addc_u32 s101, s101, 0
    global_load_dwordx4 a[108:111], v0, s[100:101]
    s_add_u32 s100, s100, 114688
    s_addc_u32 s101, s101, 0
    global_load_dwordx4 a[112:115], v0, s[100:101]
    s_add_u32 s100, s100, 114688
    s_addc_u32 s101, s101, 0
    global_load_dwordx4 a[116:119], v0, s[100:101]
    s_add_u32 s100, s100, 114688
    s_addc_u32 s101, s101, 0
    global_load_dwordx4 a[120:123], v0, s[100:101]
    s_add_u32 s100, s100, 114688
    s_addc_u32 s101, s101, 0
    global_load_dwordx4 a[124:127], v0, s[100:101]
    s_add_u32 s100, s100, 114688
    s_addc_u32 s101, s101, 0
nl_interleave_layers__linear_kernel_hedgehog__mixer_channel_mlp__prompt_kernel_120:
    s_cmp_lg_u32 s3, 0
    s_cbranch_scc1 wt_interleave_layers__linear_kernel_hedgehog__mixer_channel_mlp__prompt_kernel_121
    s_mov_b64 exec, 0xffff
    v_lshlrev_b32 v2, 10, v1
    v_mov_b32 v27, 32
    s_mov_b32 s15, 0
pp_interleave_layers__linear_kernel_hedgehog__mixer_channel_mlp__prompt_kernel_122:
    global_load_dword v26, v2, s[62:63] sc1
    s_waitcnt vmcnt(0)
    v_cmp_gt_u32 vcc, v27, v26
    s_nop 4
    s_cbranch_vccz pq_interleave_layers__linear_kernel_hedgehog__mixer_channel_mlp__prompt_kernel_123
    s_sleep 1
    s_add_u32 s15, s15, 1
    s_cmp_lt_u32 s15, 400000
    s_cbranch_scc1 pp_interleave_layers__linear_kernel_hedgehog__mixer_channel_mlp__prompt_kernel_122
pq_interleave_layers__linear_kernel_hedgehog__mixer_channel_mlp__prompt_kernel_123:
    s_mov_b64 exec, -1
wt_interleave_layers__linear_kernel_hedgehog__mixer_channel_mlp__prompt_kernel_121:
    s_waitcnt lgkmcnt(0)
    s_barrier
    s_mov_b32 s9, 1
    s_branch L_layer
L_fin_interleave_layers__linear_kernel_hedgehog__mixer_channel_mlp__prompt_kernel:
L_end_interleave_layers__linear_kernel_hedgehog__mixer_channel_mlp__prompt_kernel:
    s_endpgm
.section .rodata,"a"
.p2align 6
.amdhsa_kernel interleave_layers__linear_kernel_hedgehog__mixer_channel_mlp__prompt_kernel
  .amdhsa_next_free_vgpr 512
  .amdhsa_next_free_sgpr 102
  .amdhsa_accum_offset 256
  .amdhsa_group_segment_fixed_size 0
  .amdhsa_kernarg_size 96
  .amdhsa_user_sgpr_count 2
  .amdhsa_user_sgpr_kernarg_segment_ptr 1
  .amdhsa_system_sgpr_workgroup_id_x 1
.end_amdhsa_kernel
```
